```python
import torch

def _softmax(x, axis=-1):
    return torch.softmax(x, dim=axis)
def _gelu(x):
    return torch.nn.functional.gelu(x, approximate="tanh")
def _silu(x):
    return torch.nn.functional.silu(x)
def _sigmoid(x):
    return torch.sigmoid(x)
def _layernorm(x, axis=-1, eps=1e-5):
    m = x.mean(dim=axis, keepdim=True)
    v = x.var(dim=axis, keepdim=True, unbiased=False)
    return (x - m) / torch.sqrt(v + eps)
def _scatter_add(tgt, idx, src, axis=0):
    return tgt.clone().index_add_(axis, idx, src)
def _segment_sum(src, seg, n):
    out = torch.zeros((n,) + src.shape[1:], dtype=src.dtype)
    return out.index_add_(0, seg, src)
def _pad(x, pw):
    flat = tuple(v for pair in reversed(pw) for v in pair)
    return torch.nn.functional.pad(x, flat)

kernel_name = 'parallel_sum__compressed_kv_cla__glu_gated_glu__prompt'

def setup_inputs():

    _w = (lambda a: (lambda t: t.to(torch.bfloat16) if t.is_floating_point() else t)(torch.as_tensor(a)))
    def _A_setup():
        B, H, Sq, Sk, D, M = 1, 32, 2048, 2048, 128, 512
        Dc = 4 * D
        return {
            "x": _w((lambda *s: torch.randn(*s, dtype=torch.bfloat16) * 0.05)(B, Sq, M)),
            "c_kv": _w((lambda *s: torch.randn(*s, dtype=torch.bfloat16) * 1.6)(B, Sk, Dc)),
            "w_q": _w((lambda *s: torch.randn(*s, dtype=torch.bfloat16) * 0.8)(M, H, D) * (M ** -0.5)),
            "w_uk": _w((lambda *s: torch.randn(*s, dtype=torch.bfloat16) * 0.8)(Dc, H, D) * (Dc ** -0.5)),
            "w_uv": _w((lambda *s: torch.randn(*s, dtype=torch.bfloat16) * 1.6)(Dc, H, D) * (Dc ** -0.5)),
            "w_o": _w((lambda *s: torch.randn(*s, dtype=torch.bfloat16) * 1.6)(H, D, M) * ((H * D) ** -0.5)),
        }
    _A_in = _A_setup()

    def _B_setup():
        B, S, D, F = 1, 2048, 512, 1376
        return {
            "x": _w((lambda *s: torch.randn(*s, dtype=torch.bfloat16) * 0.05)(B, S, D)),
            "w_gate": _w((lambda *s: torch.randn(*s, dtype=torch.bfloat16) * 0.05)(D, F)),
            "w_up": _w((lambda *s: torch.randn(*s, dtype=torch.bfloat16) * 0.05)(D, F)),
            "w_down": _w((lambda *s: torch.randn(*s, dtype=torch.bfloat16) * 0.05)(F, D)),
        }
    _B_in = _B_setup()

    return {
        "A_x": _A_in["x"],
        "A_c_kv": _A_in["c_kv"],
        "A_w_q": _A_in["w_q"],
        "A_w_uk": _A_in["w_uk"],
        "A_w_uv": _A_in["w_uv"],
        "A_w_o": _A_in["w_o"],
        "B_x": _B_in["x"],
        "B_w_gate": _B_in["w_gate"],
        "B_w_up": _B_in["w_up"],
        "B_w_down": _B_in["w_down"],
    }

def reference(A_x, A_c_kv, A_w_q, A_w_uk, A_w_uv, A_w_o, B_x, B_w_gate, B_w_up, B_w_down):
    def _A_ref(x, c_kv, w_q, w_uk, w_uv, w_o):
        B, Sq, M = x.shape[0], x.shape[1], x.shape[2]
        Sk = c_kv.shape[1]
        H, D = w_q.shape[1], w_q.shape[2]
        q = torch.einsum("bqm,mhd->bhqd", x, w_q)
        k = torch.einsum("bkc,chd->bhkd", c_kv, w_uk)
        v = torch.einsum("bkc,chd->bhkd", c_kv, w_uv)
        scores = torch.einsum("bhqd,bhkd->bhqk", q, k) * (D ** -0.5)
        off = Sk - Sq
        qi = torch.arange(Sq)[:, None]
        kj = torch.arange(Sk)[None, :]
        cmask = kj <= (qi + off)
        scores = torch.where(cmask[None, None], scores, -1e9)
        p = _softmax(scores, axis=-1)
        ctx = torch.einsum("bhqk,bhkd->bhqd", p, v)
        return torch.einsum("bhqd,hdm->bqm", ctx, w_o)

    def _B_ref(x, w_gate, w_up, w_down):
        g = torch.einsum("bsd,df->bsf", x, w_gate)
        u = torch.einsum("bsd,df->bsf", x, w_up)
        h = _sigmoid(g) * u
        return torch.einsum("bsf,fd->bsd", h, w_down)

    x = A_x
    xn = _layernorm(x, axis=-1)
    return x + _A_ref(xn, A_c_kv, A_w_q, A_w_uk, A_w_uv, A_w_o) + _B_ref(xn, B_w_gate, B_w_up, B_w_down)
```

```asm
; @launch grid=(256,1,1) block=(256,1,1) lds=163840
.amdgcn_target "amdgcn-amd-amdhsa--gfx950"
.text
.globl parallel_sum__compressed_kv_cla__glu_gated_glu__prompt_kernel
.p2align 8
.type parallel_sum__compressed_kv_cla__glu_gated_glu__prompt_kernel,@function
parallel_sum__compressed_kv_cla__glu_gated_glu__prompt_kernel:
    s_cmp_ge_u32 s2, 256
    s_cbranch_scc1 L_end
    s_load_dwordx16 s[64:79], s[0:1], 0
    s_load_dwordx8 s[80:87], s[0:1], 64
    s_load_dwordx2 s[88:89], s[0:1], 96
    s_and_b32 s3, s2, 0x78
    s_min_u32 s3, s3, 96
    s_load_dwordx2 s[90:91], s[0:1], s3
    s_getpc_b64 s[100:101]
L_pc:
    s_lshr_b32 s5, s2, 3
    v_min_u32 v28, 23, v0
    v_lshlrev_b32 v28, 5, v28
    v_add_u32 v28, s5, v28
    v_lshlrev_b32 v28, 7, v28
    v_cmp_le_u32 vcc, 32, v0
    v_lshlrev_b32 v27, 12, v0
    v_add_u32 v27, L_A_K-L_pc-0x20000, v27
    v_cndmask_b32 v28, v28, v27, vcc
    s_mov_b32 s3, L_A_V-L_pc
    v_writelane_b32 v28, s3, 60
    s_mov_b32 s3, L_B-L_pc
    v_writelane_b32 v28, s3, 61
    s_mov_b32 s3, L_diag0-L_pc
    v_writelane_b32 v28, s3, 62
    s_mov_b32 s3, L_block-L_pc
    v_writelane_b32 v28, s3, 63
    v_min_u32 v92, L_last-L_pc, v28
    global_load_dword v30, v92, s[100:101]
    v_mov_b32 v90, 0
    s_mov_b32 s94, 2097152
    s_waitcnt lgkmcnt(0)
    v_mov_b32 v88, s64
    v_mov_b32 v89, s65
    v_writelane_b32 v88, s66, 0
    v_writelane_b32 v89, s67, 0
    v_writelane_b32 v88, s70, 1
    v_writelane_b32 v89, s71, 1
    v_writelane_b32 v88, s72, 2
    v_writelane_b32 v89, s73, 2
    v_add_co_u32 v88, vcc, v88, v90
    s_nop 1
    v_addc_co_u32 v89, vcc, 0, v89, vcc
    global_load_dword v30, v[88:89], off offset:3968
    v_lshrrev_b32 v29, 6, v0
    v_and_b32 v31, 63, v0
    v_readfirstlane_b32 s6, v29
    s_and_b32 s4, s2, 7
    s_lshl_b32 s4, s4, 2
    s_lshr_b32 s7, s2, 6
    s_add_u32 s4, s4, s7
    s_and_b32 s5, s5, 7
    v_lshlrev_b32 v1, 4, v31
    v_lshrrev_b32 v29, 4, v31
    v_and_b32 v28, 7, v31
    v_xor_b32 v28, v28, v29
    v_lshlrev_b32 v28, 4, v28
    v_lshrrev_b32 v27, 3, v31
    v_lshl_add_u32 v12, v27, 10, v28
    v_xor_b32 v13, 64, v12
    v_and_b32 v28, 15, v31
    v_lshlrev_b32 v27, 1, v29
    v_xor_b32 v28, v28, v27
    v_lshlrev_b32 v28, 4, v28
    v_lshl_add_u32 v14, v29, 13, v28
    v_xor_b32 v15, 0x80, v14
    v_and_b32 v28, 3, v31
    v_lshrrev_b32 v27, 2, v31
    v_lshlrev_b32 v27, 4, v27
    v_lshl_add_u32 v26, v28, 10, v27
    s_and_b32 s3, s6, 1
    s_cselect_b32 s56, 0, 15
    s_xor_b32 s56, s56, s5
    s_lshl_b32 s56, s56, 1
    s_lshr_b32 s7, s6, 1
    s_add_u32 s56, s56, s7
    s_lshl_b32 s56, s56, 16
    s_lshl_b32 s57, s3, 18
    s_lshl_b32 s7, s4, 8
    s_add_u32 s57, s57, s7
    s_lshl_b32 s59, s6, 13
    s_add_u32 s58, s59, 65536
    s_and_b32 s7, s4, 3
    s_lshl_b32 s7, s7, 11
    s_add_u32 s58, s58, s7
    s_lshl_b32 s7, s7, 3
    s_add_u32 s56, s56, s7
    s_and_b32 s7, s5, 3
    s_lshl_b32 s7, s7, 11
    s_add_u32 s59, s59, s7
    s_lshl_b32 s7, s7, 5
    s_add_u32 s57, s57, s7
    s_and_b32 s7, s5, 1
    s_lshl_b32 s7, s7, 7
    v_xor_b32 v14, s7, v14
    v_xor_b32 v15, s7, v15
    s_lshl_b32 s93, s2, 13
    s_lshl_b32 s7, s3, 12
    s_add_u32 s93, s93, s7
    s_lshr_b32 s7, s6, 1
    s_lshl_b32 s7, s7, 9
    s_add_u32 s93, s93, s7
    s_xor_b32 s96, s93, 512
    s_load_dword s77, s[90:91], 0
    s_mov_b32 s40, s64
    s_mov_b32 s41, s65
    s_mov_b32 s42, 2097152
    s_mov_b32 s43, 0x20000
    buffer_load_dwordx4 v[32:35], v26, s[40:43], s93 offen offset:0
    buffer_load_dwordx4 v[36:39], v26, s[40:43], s93 offen offset:256
    buffer_load_dwordx4 v[40:43], v26, s[40:43], s96 offen offset:0
    buffer_load_dwordx4 v[44:47], v26, s[40:43], s96 offen offset:256
    s_mov_b32 s12, s66
    s_mov_b32 s13, s67
    s_mov_b32 s14, 2097152
    s_mov_b32 s15, 0x20000
    s_cmp_lt_u32 s6, 2
    s_cselect_b64 s[70:71], s[70:71], s[72:73]
    s_mov_b32 s16, s70
    s_mov_b32 s17, s71
    s_mov_b32 s18, 4194304
    s_mov_b32 s19, 0x20000
    s_add_u32 s0, s56, 0
    s_xor_b32 m0, s58, 0
    s_xor_b32 s7, s0, 0
    buffer_load_dwordx4 v12, s[12:15], s7 offen  lds
    s_add_u32 s1, s57, 0
    s_xor_b32 m0, s59, 0
    s_xor_b32 s7, s1, 0
    buffer_load_dwordx4 v14, s[16:19], s7 offen  lds
    s_xor_b32 m0, s58, 1024
    s_xor_b32 s7, s0, 8192
    buffer_load_dwordx4 v13, s[12:15], s7 offen  lds
    s_xor_b32 m0, s59, 1024
    s_xor_b32 s7, s1, 32768
    buffer_load_dwordx4 v14, s[16:19], s7 offen  lds
    s_mov_b32 s8, s88
    s_mov_b32 s9, s89
    s_mov_b32 s10, 268435456
    s_mov_b32 s11, 0x20000
    v_and_b32 v28, 15, v31
    v_lshrrev_b32 v27, 1, v28
    v_xor_b32 v27, v27, v29
    v_lshlrev_b32 v27, 4, v27
    v_lshl_add_u32 v27, v28, 7, v27
    s_lshl_b32 s7, s3, 14
    s_add_u32 s7, s7, 65536
    v_add_u32 v10, s7, v27
    v_xor_b32 v11, 64, v10
    v_bfe_u32 v28, v31, 2, 2
    v_lshl_add_u32 v27, v29, 3, v28
    v_and_b32 v26, 1, v29
    v_lshl_add_u32 v26, v26, 2, v28
    v_lshlrev_b32 v26, 5, v26
    v_lshl_add_u32 v26, v27, 8, v26
    v_and_b32 v27, 3, v31
    v_lshl_add_u32 v26, v27, 3, v26
    s_lshr_b32 s7, s6, 1
    s_lshl_b32 s7, s7, 14
    v_add_u32 v2, s7, v26
    v_xor_b32 v3, 32, v2
    v_xor_b32 v4, 64, v2
    v_xor_b32 v5, 96, v2
    v_xor_b32 v6, 128, v2
    v_xor_b32 v7, 160, v2
    v_xor_b32 v8, 192, v2
    v_xor_b32 v9, 224, v2
    v_lshrrev_b32 v26, 2, v31
    v_lshlrev_b32 v26, 8, v26
    v_lshl_add_u32 v27, v27, 4, v26
    s_lshr_b32 s93, s2, 1
    s_lshl_b32 s93, s93, 14
    s_and_b32 s7, s2, 1
    s_lshl_b32 s7, s7, 7
    s_add_u32 s93, s93, s7
    s_lshl_b32 s7, s3, 6
    s_add_u32 s93, s93, s7
    s_lshr_b32 s7, s6, 1
    s_lshl_b32 s7, s7, 13
    s_add_u32 s93, s93, s7
    s_add_u32 s96, s93, 4096
    s_mov_b64 exec, 0
    s_cmp_eq_u32 s6, 0
    s_cbranch_scc1 L_tp0
    s_cmp_eq_u32 s6, 1
    s_cbranch_scc1 L_tp1
    s_cmp_eq_u32 s6, 2
    s_cbranch_scc1 L_tp2
    s_branch L_tp3
L_walk_end:
    s_mov_b64 exec, -1
    s_xor_b32 m0, s58, 2048
    s_xor_b32 s7, s0, 16384
    buffer_load_dwordx4 v12, s[12:15], s7 offen  lds
    s_xor_b32 m0, s59, 2048
    s_xor_b32 s7, s1, 65536
    buffer_load_dwordx4 v15, s[16:19], s7 offen  lds
    s_xor_b32 m0, s58, 3072
    s_xor_b32 s7, s0, 24576
    buffer_load_dwordx4 v13, s[12:15], s7 offen  lds
    s_xor_b32 m0, s59, 3072
    s_xor_b32 s7, s1, 98304
    buffer_load_dwordx4 v15, s[16:19], s7 offen  lds
    s_xor_b32 m0, s58, 4096
    s_xor_b32 s7, s0, 32768
    buffer_load_dwordx4 v12, s[12:15], s7 offen  lds
    s_xor_b32 m0, s59, 4096
    s_xor_b32 s7, s1, 131072
    buffer_load_dwordx4 v14, s[16:19], s7 offen  lds
    s_xor_b32 m0, s58, 5120
    s_xor_b32 s7, s0, 40960
    buffer_load_dwordx4 v13, s[12:15], s7 offen  lds
    s_xor_b32 m0, s59, 5120
    s_xor_b32 s7, s1, 163840
    buffer_load_dwordx4 v14, s[16:19], s7 offen  lds
    s_waitcnt vmcnt(12)
    s_xor_b32 m0, s58, 6144
    s_xor_b32 s7, s0, 49152
    buffer_load_dwordx4 v12, s[12:15], s7 offen  lds
    v_lshlrev_b32 v48, 16, v32
    v_and_b32 v49, 0xffff0000, v32
    v_lshlrev_b32 v50, 16, v33
    v_and_b32 v51, 0xffff0000, v33
    v_lshlrev_b32 v52, 16, v34
    v_and_b32 v53, 0xffff0000, v34
    v_lshlrev_b32 v54, 16, v35
    v_and_b32 v55, 0xffff0000, v35
    v_lshlrev_b32 v56, 16, v36
    v_and_b32 v57, 0xffff0000, v36
    v_lshlrev_b32 v58, 16, v37
    v_and_b32 v59, 0xffff0000, v37
    s_xor_b32 m0, s59, 6144
    s_xor_b32 s7, s1, 196608
    buffer_load_dwordx4 v15, s[16:19], s7 offen  lds
    v_lshlrev_b32 v60, 16, v38
    v_and_b32 v61, 0xffff0000, v38
    v_lshlrev_b32 v62, 16, v39
    v_and_b32 v63, 0xffff0000, v39
    v_lshlrev_b32 v64, 16, v40
    v_and_b32 v65, 0xffff0000, v40
    v_lshlrev_b32 v66, 16, v41
    v_and_b32 v67, 0xffff0000, v41
    v_lshlrev_b32 v68, 16, v42
    v_and_b32 v69, 0xffff0000, v42
    v_lshlrev_b32 v70, 16, v43
    v_and_b32 v71, 0xffff0000, v43
    s_xor_b32 m0, s58, 7168
    s_xor_b32 s7, s0, 57344
    buffer_load_dwordx4 v13, s[12:15], s7 offen  lds
    v_lshlrev_b32 v72, 16, v44
    v_and_b32 v73, 0xffff0000, v44
    v_lshlrev_b32 v74, 16, v45
    v_and_b32 v75, 0xffff0000, v45
    v_lshlrev_b32 v76, 16, v46
    v_and_b32 v77, 0xffff0000, v46
    v_lshlrev_b32 v78, 16, v47
    v_and_b32 v79, 0xffff0000, v47
    v_pk_add_f32 v[80:81], v[48:49], v[50:51]
    v_pk_add_f32 v[80:81], v[80:81], v[52:53]
    v_pk_add_f32 v[80:81], v[80:81], v[54:55]
    v_pk_add_f32 v[80:81], v[80:81], v[56:57]
    s_xor_b32 m0, s59, 7168
    s_xor_b32 s7, s1, 229376
    buffer_load_dwordx4 v15, s[16:19], s7 offen  lds
    v_pk_add_f32 v[80:81], v[80:81], v[58:59]
    v_pk_add_f32 v[80:81], v[80:81], v[60:61]
    v_pk_add_f32 v[80:81], v[80:81], v[62:63]
    v_pk_add_f32 v[80:81], v[80:81], v[64:65]
    v_pk_add_f32 v[80:81], v[80:81], v[66:67]
    v_pk_add_f32 v[80:81], v[80:81], v[68:69]
    v_pk_add_f32 v[80:81], v[80:81], v[70:71]
    v_pk_add_f32 v[80:81], v[80:81], v[72:73]
    v_pk_add_f32 v[80:81], v[80:81], v[74:75]
    v_pk_add_f32 v[80:81], v[80:81], v[76:77]
    v_pk_add_f32 v[80:81], v[80:81], v[78:79]
    v_add_f32 v80, v80, v81
    s_add_u32 s0, s56, 128
    s_xor_b32 m0, s58, 32768
    s_xor_b32 s7, s0, 0
    buffer_load_dwordx4 v12, s[12:15], s7 offen  lds
    s_nop 1
    v_add_f32_dpp v80, v80, v80 row_ror:4 row_mask:0xf bank_mask:0xf
    s_nop 1
    v_add_f32_dpp v80, v80, v80 row_ror:8 row_mask:0xf bank_mask:0xf
    v_mov_b32 v81, v80
    s_nop 1
    v_permlane16_swap_b32 v80, v81
    v_add_f32 v80, v80, v81
    v_mov_b32 v81, v80
    s_nop 1
    v_permlane32_swap_b32 v80, v81
    v_add_f32 v80, v80, v81
    s_add_u32 s1, s57, 524288
    s_xor_b32 m0, s59, 32768
    s_xor_b32 s7, s1, 0
    buffer_load_dwordx4 v14, s[16:19], s7 offen  lds
    v_mul_f32 v80, 0x3b000000, v80
    v_pk_add_f32 v[84:85], v[48:49], v[80:81] op_sel_hi:[1,0] neg_lo:[0,1] neg_hi:[0,1]
    v_pk_mul_f32 v[82:83], v[84:85], v[84:85]
    v_pk_add_f32 v[84:85], v[50:51], v[80:81] op_sel_hi:[1,0] neg_lo:[0,1] neg_hi:[0,1]
    v_pk_fma_f32 v[82:83], v[84:85], v[84:85], v[82:83]
    v_pk_add_f32 v[84:85], v[52:53], v[80:81] op_sel_hi:[1,0] neg_lo:[0,1] neg_hi:[0,1]
    v_pk_fma_f32 v[82:83], v[84:85], v[84:85], v[82:83]
    v_pk_add_f32 v[84:85], v[54:55], v[80:81] op_sel_hi:[1,0] neg_lo:[0,1] neg_hi:[0,1]
    v_pk_fma_f32 v[82:83], v[84:85], v[84:85], v[82:83]
    v_pk_add_f32 v[84:85], v[56:57], v[80:81] op_sel_hi:[1,0] neg_lo:[0,1] neg_hi:[0,1]
    v_pk_fma_f32 v[82:83], v[84:85], v[84:85], v[82:83]
    v_pk_add_f32 v[84:85], v[58:59], v[80:81] op_sel_hi:[1,0] neg_lo:[0,1] neg_hi:[0,1]
    s_xor_b32 m0, s58, 33792
    s_xor_b32 s7, s0, 8192
    buffer_load_dwordx4 v13, s[12:15], s7 offen  lds
    v_pk_fma_f32 v[82:83], v[84:85], v[84:85], v[82:83]
    v_pk_add_f32 v[84:85], v[60:61], v[80:81] op_sel_hi:[1,0] neg_lo:[0,1] neg_hi:[0,1]
    v_pk_fma_f32 v[82:83], v[84:85], v[84:85], v[82:83]
    v_pk_add_f32 v[84:85], v[62:63], v[80:81] op_sel_hi:[1,0] neg_lo:[0,1] neg_hi:[0,1]
    v_pk_fma_f32 v[82:83], v[84:85], v[84:85], v[82:83]
    v_pk_add_f32 v[84:85], v[64:65], v[80:81] op_sel_hi:[1,0] neg_lo:[0,1] neg_hi:[0,1]
    v_pk_fma_f32 v[82:83], v[84:85], v[84:85], v[82:83]
    v_pk_add_f32 v[84:85], v[66:67], v[80:81] op_sel_hi:[1,0] neg_lo:[0,1] neg_hi:[0,1]
    v_pk_fma_f32 v[82:83], v[84:85], v[84:85], v[82:83]
    v_pk_add_f32 v[84:85], v[68:69], v[80:81] op_sel_hi:[1,0] neg_lo:[0,1] neg_hi:[0,1]
    v_pk_fma_f32 v[82:83], v[84:85], v[84:85], v[82:83]
    v_pk_add_f32 v[84:85], v[70:71], v[80:81] op_sel_hi:[1,0] neg_lo:[0,1] neg_hi:[0,1]
    s_xor_b32 m0, s59, 33792
    s_xor_b32 s7, s1, 32768
    buffer_load_dwordx4 v14, s[16:19], s7 offen  lds
    v_pk_fma_f32 v[82:83], v[84:85], v[84:85], v[82:83]
    v_pk_add_f32 v[84:85], v[72:73], v[80:81] op_sel_hi:[1,0] neg_lo:[0,1] neg_hi:[0,1]
    v_pk_fma_f32 v[82:83], v[84:85], v[84:85], v[82:83]
    v_pk_add_f32 v[84:85], v[74:75], v[80:81] op_sel_hi:[1,0] neg_lo:[0,1] neg_hi:[0,1]
    v_pk_fma_f32 v[82:83], v[84:85], v[84:85], v[82:83]
    v_pk_add_f32 v[84:85], v[76:77], v[80:81] op_sel_hi:[1,0] neg_lo:[0,1] neg_hi:[0,1]
    v_pk_fma_f32 v[82:83], v[84:85], v[84:85], v[82:83]
    v_pk_add_f32 v[84:85], v[78:79], v[80:81] op_sel_hi:[1,0] neg_lo:[0,1] neg_hi:[0,1]
    v_pk_fma_f32 v[82:83], v[84:85], v[84:85], v[82:83]
    v_add_f32 v82, v82, v83
    s_nop 1
    v_add_f32_dpp v82, v82, v82 row_ror:4 row_mask:0xf bank_mask:0xf
    s_xor_b32 m0, s58, 34816
    s_xor_b32 s7, s0, 16384
    buffer_load_dwordx4 v12, s[12:15], s7 offen  lds
    s_nop 1
    v_add_f32_dpp v82, v82, v82 row_ror:8 row_mask:0xf bank_mask:0xf
    v_mov_b32 v83, v82
    s_nop 1
    v_permlane16_swap_b32 v82, v83
    v_add_f32 v82, v82, v83
    v_mov_b32 v83, v82
    s_nop 1
    v_permlane32_swap_b32 v82, v83
    v_add_f32 v82, v82, v83
    v_mul_f32 v82, 0x3b000000, v82
    v_cvt_pk_bf16_f32 v80, v80, v82
    s_xor_b32 m0, s59, 34816
    s_xor_b32 s7, s1, 65536
    buffer_load_dwordx4 v15, s[16:19], s7 offen  lds
    v_and_b32 v82, 0xffff0000, v80
    v_lshlrev_b32 v80, 16, v80
    v_add_f32 v82, 0x3727c5ac, v82
    v_cvt_pk_bf16_f32 v82, v82, v82
    v_lshlrev_b32 v82, 16, v82
    v_sqrt_f32 v82, v82
    s_nop 0
    v_cvt_pk_bf16_f32 v82, v82, v82
    v_lshlrev_b32 v82, 16, v82
    v_rcp_f32 v82, v82
    s_nop 0
    v_mul_f32 v82, 0x3e0293ee, v82
    s_xor_b32 m0, s58, 35840
    s_xor_b32 s7, s0, 24576
    buffer_load_dwordx4 v13, s[12:15], s7 offen  lds
    v_pk_add_f32 v[84:85], v[48:49], v[80:81] op_sel_hi:[1,0] neg_lo:[0,1] neg_hi:[0,1]
    v_cvt_pk_bf16_f32 v84, v84, v85
    v_and_b32 v85, 0xffff0000, v84
    v_lshlrev_b32 v84, 16, v84
    v_pk_mul_f32 v[84:85], v[84:85], v[82:83] op_sel_hi:[1,0]
    v_cvt_pk_bf16_f32 v128, v84, v85
    v_pk_add_f32 v[84:85], v[50:51], v[80:81] op_sel_hi:[1,0] neg_lo:[0,1] neg_hi:[0,1]
    v_cvt_pk_bf16_f32 v84, v84, v85
    v_and_b32 v85, 0xffff0000, v84
    v_lshlrev_b32 v84, 16, v84
    v_pk_mul_f32 v[84:85], v[84:85], v[82:83] op_sel_hi:[1,0]
    v_cvt_pk_bf16_f32 v129, v84, v85
    s_xor_b32 m0, s59, 35840
    s_xor_b32 s7, s1, 98304
    buffer_load_dwordx4 v15, s[16:19], s7 offen  lds
    v_pk_add_f32 v[84:85], v[52:53], v[80:81] op_sel_hi:[1,0] neg_lo:[0,1] neg_hi:[0,1]
    v_cvt_pk_bf16_f32 v84, v84, v85
    v_and_b32 v85, 0xffff0000, v84
    v_lshlrev_b32 v84, 16, v84
    v_pk_mul_f32 v[84:85], v[84:85], v[82:83] op_sel_hi:[1,0]
    v_cvt_pk_bf16_f32 v130, v84, v85
    v_pk_add_f32 v[84:85], v[54:55], v[80:81] op_sel_hi:[1,0] neg_lo:[0,1] neg_hi:[0,1]
    v_cvt_pk_bf16_f32 v84, v84, v85
    v_and_b32 v85, 0xffff0000, v84
    v_lshlrev_b32 v84, 16, v84
    v_pk_mul_f32 v[84:85], v[84:85], v[82:83] op_sel_hi:[1,0]
    v_cvt_pk_bf16_f32 v131, v84, v85
    s_xor_b32 m0, s58, 36864
    s_xor_b32 s7, s0, 32768
    buffer_load_dwordx4 v12, s[12:15], s7 offen  lds
    v_pk_add_f32 v[84:85], v[56:57], v[80:81] op_sel_hi:[1,0] neg_lo:[0,1] neg_hi:[0,1]
    v_cvt_pk_bf16_f32 v84, v84, v85
    v_and_b32 v85, 0xffff0000, v84
    v_lshlrev_b32 v84, 16, v84
    v_pk_mul_f32 v[84:85], v[84:85], v[82:83] op_sel_hi:[1,0]
    v_cvt_pk_bf16_f32 v132, v84, v85
    v_pk_add_f32 v[84:85], v[58:59], v[80:81] op_sel_hi:[1,0] neg_lo:[0,1] neg_hi:[0,1]
    v_cvt_pk_bf16_f32 v84, v84, v85
    v_and_b32 v85, 0xffff0000, v84
    v_lshlrev_b32 v84, 16, v84
    v_pk_mul_f32 v[84:85], v[84:85], v[82:83] op_sel_hi:[1,0]
    v_cvt_pk_bf16_f32 v133, v84, v85
    s_xor_b32 m0, s59, 36864
    s_xor_b32 s7, s1, 131072
    buffer_load_dwordx4 v14, s[16:19], s7 offen  lds
    v_pk_add_f32 v[84:85], v[60:61], v[80:81] op_sel_hi:[1,0] neg_lo:[0,1] neg_hi:[0,1]
    v_cvt_pk_bf16_f32 v84, v84, v85
    v_and_b32 v85, 0xffff0000, v84
    v_lshlrev_b32 v84, 16, v84
    v_pk_mul_f32 v[84:85], v[84:85], v[82:83] op_sel_hi:[1,0]
    v_cvt_pk_bf16_f32 v134, v84, v85
    v_pk_add_f32 v[84:85], v[62:63], v[80:81] op_sel_hi:[1,0] neg_lo:[0,1] neg_hi:[0,1]
    v_cvt_pk_bf16_f32 v84, v84, v85
    v_and_b32 v85, 0xffff0000, v84
    v_lshlrev_b32 v84, 16, v84
    v_pk_mul_f32 v[84:85], v[84:85], v[82:83] op_sel_hi:[1,0]
    v_cvt_pk_bf16_f32 v135, v84, v85
    v_mov_b32 v136, v27
    s_mov_b32 s97, s93
    s_waitcnt vmcnt(10) lgkmcnt(0)
    s_barrier
    ds_read_b128 a[0:3], v10 offset:0
    ds_read_b128 a[4:7], v11 offset:0
    ds_read_b64_tr_b16 a[64:65], v2 offset:0
    ds_read_b64_tr_b16 a[66:67], v2 offset:1024
    ds_read_b64_tr_b16 a[68:69], v2 offset:8192
    ds_read_b64_tr_b16 a[70:71], v2 offset:9216
    ds_read_b64_tr_b16 a[72:73], v3 offset:0
    ds_read_b64_tr_b16 a[74:75], v3 offset:1024
    ds_read_b64_tr_b16 a[76:77], v3 offset:8192
    ds_read_b64_tr_b16 a[78:79], v3 offset:9216
    ds_read_b64_tr_b16 a[80:81], v4 offset:0
    ds_read_b64_tr_b16 a[82:83], v4 offset:1024
    ds_read_b64_tr_b16 a[84:85], v4 offset:8192
    ds_read_b64_tr_b16 a[86:87], v4 offset:9216
    ds_read_b64_tr_b16 a[88:89], v5 offset:0
    ds_read_b64_tr_b16 a[90:91], v5 offset:1024
    ds_read_b64_tr_b16 a[92:93], v5 offset:8192
    ds_read_b64_tr_b16 a[94:95], v5 offset:9216
    ds_read_b128 a[8:11], v10 offset:2048
    ds_read_b128 a[12:15], v11 offset:2048
    ds_read_b128 a[16:19], v10 offset:4096
    ds_read_b128 a[20:23], v11 offset:4096
    ds_read_b128 a[24:27], v10 offset:6144
    ds_read_b128 a[28:31], v11 offset:6144
    s_cmp_lt_u32 s6, 2
    s_cbranch_scc0 L_A_V
    s_branch L_A_K
.p2align 12
L_A_K:
L_tp0:
    s_cbranch_execz L_tp4
    s_waitcnt lgkmcnt(7)
    v_mfma_f32_16x16x32_bf16 v[64:67], a[64:67], a[0:3], 0
    s_xor_b32 m0, s58, 37888
    s_xor_b32 s7, s0, 40960
    v_mfma_f32_16x16x32_bf16 v[64:67], a[68:71], a[4:7], v[64:67]
    buffer_load_dwordx4 v13, s[12:15], s7 offen  lds
    v_mfma_f32_16x16x32_bf16 v[68:71], a[76:79], a[4:7], 0
    s_mov_b32 s48, s86
    ds_read_b64_tr_b16 a[96:97], v6 offset:0
    s_mov_b32 s49, s87
    v_mfma_f32_16x16x32_bf16 v[68:71], a[72:75], a[0:3], v[68:71]
    s_mov_b32 s50, 256
    s_mov_b32 s51, 0x20000
    s_mov_b32 s20, s68
    v_mfma_f32_16x16x32_bf16 v[72:75], a[80:83], a[0:3], 0
    s_mov_b32 s21, s69
    s_mov_b32 s22, 4194304
    s_mov_b32 s23, 0x20000
    v_mfma_f32_16x16x32_bf16 v[72:75], a[84:87], a[4:7], v[72:75]
    s_xor_b32 m0, s59, 37888
    s_xor_b32 s7, s1, 163840
    buffer_load_dwordx4 v14, s[16:19], s7 offen  lds
    s_waitcnt lgkmcnt(0)
    v_mfma_f32_16x16x32_bf16 v[76:79], a[92:95], a[4:7], 0
    s_mov_b32 s32, s74
    ds_read_b64_tr_b16 a[98:99], v6 offset:1024
    s_mov_b32 s33, s75
    v_mfma_f32_16x16x32_bf16 v[76:79], a[88:91], a[0:3], v[76:79]
    s_mov_b32 s34, 4194304
    ds_read_b64_tr_b16 a[100:101], v6 offset:8192
    s_mov_b32 s35, 0x20000
    v_mfma_f32_16x16x32_bf16 v[92:95], a[88:91], a[8:11], 0
    s_mov_b32 s24, s78
    ds_read_b64_tr_b16 a[102:103], v6 offset:9216
    s_mov_b32 s25, s79
    v_mfma_f32_16x16x32_bf16 v[92:95], a[92:95], a[12:15], v[92:95]
    s_mov_b32 s26, 1409024
    s_mov_b32 s27, 0x20000
    s_xor_b32 m0, s58, 38912
    s_xor_b32 s7, s0, 49152
    buffer_load_dwordx4 v12, s[12:15], s7 offen  lds
    v_mfma_f32_16x16x32_bf16 v[88:91], a[84:87], a[12:15], 0
    s_mov_b32 s28, s80
    ds_read_b64_tr_b16 a[104:105], v7 offset:0
    s_mov_b32 s29, s81
    v_mfma_f32_16x16x32_bf16 v[88:91], a[80:83], a[8:11], v[88:91]
    s_mov_b32 s30, 1409024
    ds_read_b64_tr_b16 a[106:107], v7 offset:1024
    s_mov_b32 s31, 0x20000
    v_mfma_f32_16x16x32_bf16 v[84:87], a[72:75], a[8:11], 0
    s_mov_b32 s36, s82
    s_mov_b32 s37, s83
    s_mov_b32 s38, 1409024
    v_mfma_f32_16x16x32_bf16 v[84:87], a[76:79], a[12:15], v[84:87]
    s_mov_b32 s39, 0x20000
    s_xor_b32 m0, s59, 38912
    s_xor_b32 s7, s1, 196608
    buffer_load_dwordx4 v15, s[16:19], s7 offen  lds
    v_mfma_f32_16x16x32_bf16 v[80:83], a[68:71], a[12:15], 0
    s_mov_b32 s44, s84
    ds_read_b64_tr_b16 a[108:109], v7 offset:8192
    s_mov_b32 s45, s85
    v_mfma_f32_16x16x32_bf16 v[80:83], a[64:67], a[8:11], v[80:83]
    s_mov_b32 s46, 2097152
    ds_read_b64_tr_b16 a[110:111], v7 offset:9216
    s_mov_b32 s47, 0x20000
    v_mfma_f32_16x16x32_bf16 v[96:99], a[64:67], a[16:19], 0
    s_mov_b32 s52, s88
    ds_read_b64_tr_b16 a[112:113], v8 offset:0
    s_mov_b32 s53, s89
    v_mfma_f32_16x16x32_bf16 v[96:99], a[68:71], a[20:23], v[96:99]
    s_mov_b32 s54, 268435456
    s_mov_b32 s55, 0x20000
    s_xor_b32 m0, s58, 39936
    s_xor_b32 s7, s0, 57344
    buffer_load_dwordx4 v13, s[12:15], s7 offen  lds
    v_mfma_f32_16x16x32_bf16 v[100:103], a[76:79], a[20:23], 0
    s_lshl_b32 s66, s4, 7
    ds_read_b64_tr_b16 a[114:115], v8 offset:1024
    s_lshl_b32 s7, s5, 2
    v_mfma_f32_16x16x32_bf16 v[100:103], a[72:75], a[16:19], v[100:103]
    s_add_u32 s66, s66, s7
    ds_read_b64_tr_b16 a[116:117], v8 offset:8192
    s_add_u32 s66, s66, 2097152
    v_mfma_f32_16x16x32_bf16 v[104:107], a[80:83], a[16:19], 0
    s_lshr_b32 s67, s4, 3
    ds_read_b64_tr_b16 a[118:119], v8 offset:9216
    s_add_u32 s68, s7, s67
    v_mfma_f32_16x16x32_bf16 v[104:107], a[84:87], a[20:23], v[104:107]
    s_lshl_b32 s68, s68, 7
    s_and_b32 s69, s4, 7
    s_lshl_b32 s7, s69, 2
    s_add_u32 s68, s68, s7
    s_add_u32 s68, s68, 2101248
    s_xor_b32 m0, s59, 39936
    s_xor_b32 s7, s1, 229376
    buffer_load_dwordx4 v15, s[16:19], s7 offen  lds
    v_mfma_f32_16x16x32_bf16 v[108:111], a[92:95], a[20:23], 0
    s_lshl_b32 s7, s67, 2
    ds_read_b64_tr_b16 a[120:121], v9 offset:0
    s_and_b32 s7, s7, 4
    v_mfma_f32_16x16x32_bf16 v[108:111], a[88:91], a[16:19], v[108:111]
    s_xor_b32 s69, s69, s7
    ds_read_b64_tr_b16 a[122:123], v9 offset:1024
    s_lshl_b32 s7, s5, 3
    v_mfma_f32_16x16x32_bf16 v[124:127], a[88:91], a[24:27], 0
    s_add_u32 s69, s69, s7
    ds_read_b64_tr_b16 a[124:125], v9 offset:8192
    ds_read_b64_tr_b16 a[126:127], v9 offset:9216
    s_lshl_b32 s69, s69, 7
    v_mfma_f32_16x16x32_bf16 v[124:127], a[92:95], a[28:31], v[124:127]
    s_lshl_b32 s7, s67, 2
    s_add_u32 s69, s69, s7
    s_add_u32 s69, s69, 2105344
    v_mfma_f32_16x16x32_bf16 v[120:123], a[84:87], a[28:31], 0
    v_lshlrev_b32 v28, 10, v31
    v_cmp_gt_u32 vcc, 16, v31
    v_mfma_f32_16x16x32_bf16 v[120:123], a[80:83], a[24:27], v[120:123]
    v_mov_b32 v26, 2147483648
    s_add_u32 s7, s56, 256
    v_cndmask_b32 v16, v26, v28, vcc
    buffer_load_dword v30, v16, s[12:15], s7 offen
    v_mfma_f32_16x16x32_bf16 v[116:119], a[72:75], a[24:27], 0
    v_lshrrev_b32 v28, 1, v31
    v_lshlrev_b32 v28, 13, v28
    v_mfma_f32_16x16x32_bf16 v[116:119], a[76:79], a[28:31], v[116:119]
    v_and_b32 v26, 1, v31
    v_lshl_add_u32 v28, v26, 7, v28
    v_mfma_f32_16x16x32_bf16 v[112:115], a[68:71], a[28:31], 0
    v_cmp_gt_u32 vcc, 8, v31
    v_mov_b32 v26, 2147483648
    v_mfma_f32_16x16x32_bf16 v[112:115], a[64:67], a[24:27], v[112:115]
    s_lshr_b32 s71, s5, 2
    s_lshl_b32 s71, s71, 15
    s_add_u32 s71, s71, s57
    s_waitcnt lgkmcnt(0)
    v_mfma_f32_16x16x32_bf16 a[128:131], a[96:99], a[0:3], 0
    s_add_u32 s7, s71, 1048576
    ds_read_b128 a[32:35], v10 offset:8192
    v_cndmask_b32 v17, v26, v28, vcc
    v_mfma_f32_16x16x32_bf16 a[128:131], a[100:103], a[4:7], a[128:131]
    buffer_load_dword v30, v17, s[16:19], s7 offen
    v_mfma_f32_16x16x32_bf16 a[132:135], a[108:111], a[4:7], 0
    ds_read_b128 a[36:39], v11 offset:8192
    v_mfma_f32_16x16x32_bf16 a[132:135], a[104:107], a[0:3], a[132:135]
    v_mfma_f32_16x16x32_bf16 a[136:139], a[112:115], a[0:3], 0
    v_mfma_f32_16x16x32_bf16 a[136:139], a[116:119], a[4:7], a[136:139]
    ds_read_b128 a[40:43], v10 offset:10240
    v_mfma_f32_16x16x32_bf16 a[140:143], a[124:127], a[4:7], 0
    v_mfma_f32_16x16x32_bf16 a[140:143], a[120:123], a[0:3], a[140:143]
    v_mfma_f32_16x16x32_bf16 a[156:159], a[120:123], a[8:11], 0
    buffer_store_dwordx4 v[128:131], v136, s[8:11], s97 offen sc1
    v_mfma_f32_16x16x32_bf16 a[156:159], a[124:127], a[12:15], a[156:159]
    ds_read_b128 a[44:47], v11 offset:10240
    v_mfma_f32_16x16x32_bf16 a[152:155], a[116:119], a[12:15], 0
    v_mfma_f32_16x16x32_bf16 a[152:155], a[112:115], a[8:11], a[152:155]
    ds_read_b128 a[48:51], v10 offset:12288
    v_mfma_f32_16x16x32_bf16 a[148:151], a[104:107], a[8:11], 0
    v_mfma_f32_16x16x32_bf16 a[148:151], a[108:111], a[12:15], a[148:151]
    ds_read_b128 a[52:55], v11 offset:12288
    v_mfma_f32_16x16x32_bf16 a[144:147], a[100:103], a[12:15], 0
    v_mfma_f32_16x16x32_bf16 a[144:147], a[96:99], a[8:11], a[144:147]
    buffer_store_dwordx4 v[132:135], v136, s[8:11], s96 offen sc1
    v_mfma_f32_16x16x32_bf16 v[32:35], a[96:99], a[16:19], 0
    ds_read_b128 a[56:59], v10 offset:14336
    v_lshlrev_b32 v26, 5, v0
    v_mfma_f32_16x16x32_bf16 v[32:35], a[100:103], a[20:23], v[32:35]
    v_add_u32 v27, s68, v26
    s_sub_u32 s7, s66, 96
    v_mfma_f32_16x16x32_bf16 v[36:39], a[108:111], a[20:23], 0
    v_add_u32 v28, s7, v26
    v_cmp_le_u32 vcc, 3, v0
    v_mfma_f32_16x16x32_bf16 v[36:39], a[104:107], a[16:19], v[36:39]
    ds_read_b128 a[60:63], v11 offset:14336
    v_lshrrev_b32 v26, 1, v26
    v_mfma_f32_16x16x32_bf16 v[40:43], a[112:115], a[16:19], 0
    s_sub_u32 s7, s69, 80
    v_add_u32 v26, s7, v26
    v_mov_b32 v22, 2147483648
    v_mfma_f32_16x16x32_bf16 v[40:43], a[116:119], a[20:23], v[40:43]
    v_cndmask_b32 v27, v27, v28, vcc
    v_cmp_le_u32 vcc, 5, v0
    v_mfma_f32_16x16x32_bf16 v[44:47], a[124:127], a[20:23], 0
    v_mov_b32 v25, 1
    v_mov_b32 v28, 0
    v_mfma_f32_16x16x32_bf16 v[44:47], a[120:123], a[16:19], v[44:47]
    v_cndmask_b32 v27, v27, v26, vcc
    v_cmp_gt_u32 vcc, 9, v0
    s_and_b32 s93, s2, 7
    s_lshl_b32 s93, s93, 5
    v_cndmask_b32 v27, v22, v27, vcc
    v_cmp_eq_u32 vcc, 0, v0
    buffer_store_dword v28, v27, s[8:11], 0 offen sc1
    v_mfma_f32_16x16x32_bf16 v[60:63], a[120:123], a[24:27], 0
    v_lshlrev_b32 v21, 3, v31
    v_cndmask_b32 v22, v22, v28, vcc
    v_mfma_f32_16x16x32_bf16 v[60:63], a[124:127], a[28:31], v[60:63]
    v_mfma_f32_16x16x32_bf16 v[56:59], a[116:119], a[28:31], 0
    v_mfma_f32_16x16x32_bf16 v[56:59], a[112:115], a[24:27], v[56:59]
    v_mfma_f32_16x16x32_bf16 v[52:55], a[104:107], a[24:27], 0
    v_mfma_f32_16x16x32_bf16 v[52:55], a[108:111], a[28:31], v[52:55]
    v_mfma_f32_16x16x32_bf16 v[48:51], a[100:103], a[28:31], 0
    v_mfma_f32_16x16x32_bf16 v[48:51], a[96:99], a[24:27], v[48:51]
    s_waitcnt lgkmcnt(0)
    v_mfma_f32_16x16x32_bf16 v[192:195], a[96:99], a[32:35], 0
    s_waitcnt vmcnt(5) lgkmcnt(0)
    s_barrier
    v_mfma_f32_16x16x32_bf16 v[192:195], a[100:103], a[36:39], v[192:195]
    ds_read_b128 a[0:3], v10 offset:32768
    v_mfma_f32_16x16x32_bf16 v[196:199], a[108:111], a[36:39], 0
    v_mfma_f32_16x16x32_bf16 v[196:199], a[104:107], a[32:35], v[196:199]
    s_add_u32 s0, s56, 256
    s_xor_b32 m0, s58, 0
    s_xor_b32 s7, s0, 0
    v_mfma_f32_16x16x32_bf16 v[200:203], a[112:115], a[32:35], 0
    buffer_load_dwordx4 v12, s[12:15], s7 offen  lds
    v_mfma_f32_16x16x32_bf16 v[200:203], a[116:119], a[36:39], v[200:203]
    ds_read_b128 a[4:7], v11 offset:32768
    v_bfe_u32 v28, v31, 4, 1
    v_mfma_f32_16x16x32_bf16 v[204:207], a[124:127], a[36:39], 0
    v_lshlrev_b32 v28, 1, v28
    v_and_b32 v27, 7, v31
    v_mfma_f32_16x16x32_bf16 v[204:207], a[120:123], a[32:35], v[204:207]
    v_xor_b32 v27, v27, v28
    v_xor_b32 v26, 4, v27
    v_mfma_f32_16x16x32_bf16 v[220:223], a[120:123], a[40:43], 0
    v_lshrrev_b32 v28, 3, v31
    v_mul_u32_u24 v28, 2752, v28
    v_mfma_f32_16x16x32_bf16 v[220:223], a[124:127], a[44:47], v[220:223]
    s_add_u32 s1, s57, 1048576
    s_xor_b32 m0, s59, 0
    s_xor_b32 s7, s1, 0
    v_mfma_f32_16x16x32_bf16 v[216:219], a[116:119], a[44:47], 0
    buffer_load_dwordx4 v14, s[16:19], s7 offen  lds
    v_mfma_f32_16x16x32_bf16 v[216:219], a[112:115], a[40:43], v[216:219]
    ds_read_b128 a[8:11], v10 offset:34816
    v_cmp_gt_u32 vcc, 6, v27
    v_mfma_f32_16x16x32_bf16 v[212:215], a[104:107], a[40:43], 0
    ds_read_b128 a[12:15], v11 offset:34816
    v_lshl_add_u32 v27, v27, 4, v28
    v_mfma_f32_16x16x32_bf16 v[212:215], a[108:111], a[44:47], v[212:215]
    v_mov_b32 v24, 2147483648
    v_cndmask_b32 v19, v24, v27, vcc
    v_mfma_f32_16x16x32_bf16 v[208:211], a[100:103], a[44:47], 0
    v_cmp_gt_u32 vcc, 6, v26
    v_lshl_add_u32 v26, v26, 4, v28
    v_mfma_f32_16x16x32_bf16 v[208:211], a[96:99], a[40:43], v[208:211]
    v_and_b32 v23, 7, v0
    v_cndmask_b32 v20, v24, v26, vcc
    v_lshlrev_b32 v23, 5, v23
    s_xor_b32 m0, s58, 1024
    s_xor_b32 s7, s0, 8192
    buffer_load_dwordx4 v13, s[12:15], s7 offen  lds
    v_mfma_f32_16x16x32_bf16 v[224:227], a[96:99], a[48:51], 0
    s_cmp_gt_u32 s4, 30
    ds_read_b128 a[16:19], v10 offset:36864
    s_cselect_b32 s26, 0, s26
    v_mfma_f32_16x16x32_bf16 v[224:227], a[100:103], a[52:55], v[224:227]
    s_cselect_b32 s30, 0, s30
    ds_read_b128 a[20:23], v11 offset:36864
    s_xor_b32 m0, s59, 1024
    v_mfma_f32_16x16x32_bf16 v[228:231], a[108:111], a[52:55], 0
    s_xor_b32 s7, s1, 32768
    ds_read_b128 a[24:27], v10 offset:38912
    v_mfma_f32_16x16x32_bf16 v[228:231], a[104:107], a[48:51], v[228:231]
    buffer_load_dwordx4 v14, s[16:19], s7 offen  lds
    v_mfma_f32_16x16x32_bf16 v[232:235], a[112:115], a[48:51], 0
    v_mfma_f32_16x16x32_bf16 v[232:235], a[116:119], a[52:55], v[232:235]
    s_xor_b32 m0, s58, 2048
    ds_read_b128 a[28:31], v11 offset:38912
    s_xor_b32 s7, s0, 16384
    v_mfma_f32_16x16x32_bf16 v[236:239], a[124:127], a[52:55], 0
    v_mfma_f32_16x16x32_bf16 v[236:239], a[120:123], a[48:51], v[236:239]
    v_mfma_f32_16x16x32_bf16 v[252:255], a[120:123], a[56:59], 0
    v_mfma_f32_16x16x32_bf16 v[252:255], a[124:127], a[60:63], v[252:255]
    buffer_load_dwordx4 v12, s[12:15], s7 offen  lds
    v_mfma_f32_16x16x32_bf16 v[248:251], a[116:119], a[60:63], 0
    s_cmp_lt_u32 s6, 2
    s_cselect_b64 s[52:53], s[24:25], s[28:29]
    s_mov_b32 s54, s26
    v_mfma_f32_16x16x32_bf16 v[248:251], a[112:115], a[56:59], v[248:251]
    s_xor_b32 m0, s59, 2048
    s_xor_b32 s7, s1, 65536
    v_mfma_f32_16x16x32_bf16 v[244:247], a[104:107], a[56:59], 0
    v_mfma_f32_16x16x32_bf16 v[244:247], a[108:111], a[60:63], v[244:247]
    v_mfma_f32_16x16x32_bf16 v[240:243], a[100:103], a[60:63], 0
    buffer_load_dwordx4 v15, s[16:19], s7 offen  lds
    v_mfma_f32_16x16x32_bf16 v[240:243], a[96:99], a[56:59], v[240:243]
    s_lshl_b32 s60, s4, 20
    s_lshl_b32 s7, s5, 16
    s_sub_u32 s60, s60, s7
    v_mfma_f32_16x16x32_bf16 v[128:131], a[64:67], a[32:35], 0
    s_lshr_b32 s7, s6, 1
    s_lshl_b32 s7, s7, 15
    s_add_u32 s60, s60, s7
    v_mfma_f32_16x16x32_bf16 v[128:131], a[68:71], a[36:39], v[128:131]
    s_xor_b32 m0, s58, 3072
    s_xor_b32 s7, s0, 24576
    v_mfma_f32_16x16x32_bf16 v[132:135], a[76:79], a[36:39], 0
    ds_read_b64_tr_b16 a[96:97], v6 offset:32768
    v_mfma_f32_16x16x32_bf16 v[132:135], a[72:75], a[32:35], v[132:135]
    buffer_load_dwordx4 v13, s[12:15], s7 offen  lds
    v_mfma_f32_16x16x32_bf16 v[136:139], a[80:83], a[32:35], 0
    s_mul_i32 s7, s3, 24576
    ds_read_b64_tr_b16 a[98:99], v6 offset:33792
    s_sub_u32 s95, s60, s7
    v_mfma_f32_16x16x32_bf16 v[136:139], a[84:87], a[36:39], v[136:139]
    s_add_u32 s95, s95, 5201920
    ds_read_b64_tr_b16 a[100:101], v6 offset:40960
    s_lshl_b32 s7, s3, 13
    v_mfma_f32_16x16x32_bf16 v[140:143], a[92:95], a[36:39], 0
    s_sub_u32 s60, s60, s7
    ds_read_b64_tr_b16 a[102:103], v6 offset:41984
    s_add_u32 s60, s60, 5193728
    v_mfma_f32_16x16x32_bf16 v[140:143], a[88:91], a[32:35], v[140:143]
    s_xor_b32 m0, s59, 3072
    s_xor_b32 s7, s1, 98304
    v_mfma_f32_16x16x32_bf16 v[156:159], a[88:91], a[40:43], 0
    buffer_load_dwordx4 v15, s[16:19], s7 offen  lds
    v_mfma_f32_16x16x32_bf16 v[156:159], a[92:95], a[44:47], v[156:159]
    ds_read_b64_tr_b16 a[104:105], v7 offset:32768
    v_mfma_f32_16x16x32_bf16 v[152:155], a[84:87], a[44:47], 0
    s_xor_b32 m0, s58, 4096
    ds_read_b64_tr_b16 a[106:107], v7 offset:33792
    s_xor_b32 s7, s0, 32768
    v_mfma_f32_16x16x32_bf16 v[152:155], a[80:83], a[40:43], v[152:155]
    ds_read_b64_tr_b16 a[108:109], v7 offset:40960
    v_mfma_f32_16x16x32_bf16 v[148:151], a[72:75], a[40:43], 0
    ds_read_b64_tr_b16 a[110:111], v7 offset:41984
    v_mfma_f32_16x16x32_bf16 v[148:151], a[76:79], a[44:47], v[148:151]
    ds_read_b64_tr_b16 a[112:113], v8 offset:32768
    v_mfma_f32_16x16x32_bf16 v[144:147], a[68:71], a[44:47], 0
    buffer_load_dwordx4 v12, s[12:15], s7 offen  lds
    v_mfma_f32_16x16x32_bf16 v[144:147], a[64:67], a[40:43], v[144:147]
    s_sub_u32 s70, 15, s5
    ds_read_b64_tr_b16 a[114:115], v8 offset:33792
    s_cmp_lt_u32 s6, 2
    v_mfma_f32_16x16x32_bf16 v[160:163], a[64:67], a[48:51], 0
    s_cselect_b32 s70, s70, s5
    ds_read_b64_tr_b16 a[116:117], v8 offset:40960
    s_lshl_b32 s61, s70, 17
    v_mfma_f32_16x16x32_bf16 v[160:163], a[68:71], a[52:55], v[160:163]
    s_lshl_b32 s7, s3, 16
    ds_read_b64_tr_b16 a[118:119], v8 offset:41984
    s_add_u32 s61, s61, s7
    v_mfma_f32_16x16x32_bf16 v[164:167], a[76:79], a[52:55], 0
    s_xor_b32 m0, s59, 4096
    s_xor_b32 s7, s1, 131072
    v_mfma_f32_16x16x32_bf16 v[164:167], a[72:75], a[48:51], v[164:167]
    buffer_load_dwordx4 v14, s[16:19], s7 offen  lds
    v_mfma_f32_16x16x32_bf16 v[168:171], a[80:83], a[48:51], 0
    s_mul_i32 s92, s70, 1441792
    ds_read_b64_tr_b16 a[120:121], v9 offset:32768
    s_mul_i32 s7, s4, 12288
    v_mfma_f32_16x16x32_bf16 v[168:171], a[84:87], a[52:55], v[168:171]
    s_add_u32 s92, s92, s7
    ds_read_b64_tr_b16 a[122:123], v9 offset:33792
    s_lshl_b32 s7, s3, 11
    v_mfma_f32_16x16x32_bf16 v[172:175], a[92:95], a[52:55], 0
    s_add_u32 s92, s92, s7
    ds_read_b64_tr_b16 a[124:125], v9 offset:40960
    ds_read_b64_tr_b16 a[126:127], v9 offset:41984
    s_add_u32 s92, s92, 38797312
    v_mfma_f32_16x16x32_bf16 v[172:175], a[88:91], a[48:51], v[172:175]
    s_xor_b32 m0, s58, 5120
    s_xor_b32 s7, s0, 40960
    v_mfma_f32_16x16x32_bf16 v[188:191], a[88:91], a[56:59], 0
    buffer_load_dwordx4 v13, s[12:15], s7 offen  lds
    v_mfma_f32_16x16x32_bf16 v[188:191], a[92:95], a[60:63], v[188:191]
    s_lshl_b32 s62, s6, 17
    s_lshl_b32 s7, s4, 8
    s_add_u32 s62, s62, s7
    v_mfma_f32_16x16x32_bf16 v[184:187], a[84:87], a[60:63], 0
    s_xor_b32 m0, s59, 5120
    s_xor_b32 s7, s1, 163840
    v_mfma_f32_16x16x32_bf16 v[184:187], a[80:83], a[56:59], v[184:187]
    v_mfma_f32_16x16x32_bf16 v[180:183], a[72:75], a[56:59], 0
    v_mfma_f32_16x16x32_bf16 v[180:183], a[76:79], a[60:63], v[180:183]
    buffer_load_dwordx4 v14, s[16:19], s7 offen  lds
    v_mfma_f32_16x16x32_bf16 v[176:179], a[68:71], a[60:63], 0
    v_mfma_f32_16x16x32_bf16 v[176:179], a[64:67], a[56:59], v[176:179]
    s_xor_b32 m0, s58, 6144
    s_xor_b32 s7, s0, 49152
    s_waitcnt lgkmcnt(0)
    v_mfma_f32_16x16x32_bf16 a[128:131], a[96:99], a[0:3], a[128:131]
    ds_read_b64_tr_b16 a[64:65], v2 offset:32768
    v_mfma_f32_16x16x32_bf16 a[128:131], a[100:103], a[4:7], a[128:131]
    ds_read_b64_tr_b16 a[66:67], v2 offset:33792
    v_mfma_f32_16x16x32_bf16 a[132:135], a[108:111], a[4:7], a[132:135]
    v_mfma_f32_16x16x32_bf16 a[132:135], a[104:107], a[0:3], a[132:135]
    buffer_load_dwordx4 v12, s[12:15], s7 offen  lds
    v_mfma_f32_16x16x32_bf16 a[136:139], a[112:115], a[0:3], a[136:139]
    s_mul_i32 s63, s6, 44032
    ds_read_b64_tr_b16 a[68:69], v2 offset:40960
    s_mul_i32 s7, s4, 96
    v_mfma_f32_16x16x32_bf16 a[136:139], a[116:119], a[4:7], a[136:139]
    s_add_u32 s63, s63, s7
    ds_read_b64_tr_b16 a[70:71], v2 offset:41984
    s_xor_b32 m0, s59, 6144
    v_mfma_f32_16x16x32_bf16 a[140:143], a[124:127], a[4:7], a[140:143]
    s_xor_b32 s7, s1, 196608
    ds_read_b64_tr_b16 a[72:73], v3 offset:32768
    v_mfma_f32_16x16x32_bf16 a[140:143], a[120:123], a[0:3], a[140:143]
    ds_read_b64_tr_b16 a[74:75], v3 offset:33792
    v_mfma_f32_16x16x32_bf16 a[156:159], a[120:123], a[8:11], a[156:159]
    buffer_load_dwordx4 v15, s[16:19], s7 offen  lds
    v_mfma_f32_16x16x32_bf16 a[156:159], a[124:127], a[12:15], a[156:159]
    s_lshl_b32 s90, s6, 12
    ds_read_b64_tr_b16 a[76:77], v3 offset:40960
    s_and_b32 s7, s5, 1
    v_mfma_f32_16x16x32_bf16 a[152:155], a[116:119], a[12:15], a[152:155]
    s_lshl_b32 s7, s7, 11
    s_add_u32 s90, s90, s7
    s_lshl_b32 s7, s7, 5
    v_mfma_f32_16x16x32_bf16 a[152:155], a[112:115], a[8:11], a[152:155]
    s_add_u32 s62, s62, s7
    s_xor_b32 m0, s58, 7168
    s_xor_b32 s7, s0, 57344
    v_mfma_f32_16x16x32_bf16 a[148:151], a[104:107], a[8:11], a[148:151]
    ds_read_b64_tr_b16 a[78:79], v3 offset:41984
    v_mfma_f32_16x16x32_bf16 a[148:151], a[108:111], a[12:15], a[148:151]
    buffer_load_dwordx4 v13, s[12:15], s7 offen  lds
    v_mfma_f32_16x16x32_bf16 a[144:147], a[100:103], a[12:15], a[144:147]
    s_lshl_b32 s91, s6, 11
    ds_read_b64_tr_b16 a[80:81], v4 offset:32768
    s_add_u32 s91, s91, 16384
    v_mfma_f32_16x16x32_bf16 a[144:147], a[96:99], a[8:11], a[144:147]
    s_mov_b32 s96, 0x3e0293ee
    ds_read_b64_tr_b16 a[82:83], v4 offset:33792
    s_mov_b32 s97, 0x3e0293ee
    v_mfma_f32_16x16x32_bf16 v[32:35], a[96:99], a[16:19], v[32:35]
    s_mov_b32 s98, 0xc13504f3
    s_mov_b32 s99, s98
    s_xor_b32 m0, s59, 7168
    v_mfma_f32_16x16x32_bf16 v[32:35], a[100:103], a[20:23], v[32:35]
    s_xor_b32 s7, s1, 229376
    ds_read_b64_tr_b16 a[84:85], v4 offset:40960
    v_mfma_f32_16x16x32_bf16 v[36:39], a[108:111], a[20:23], v[36:39]
    buffer_load_dwordx4 v15, s[16:19], s7 offen  lds
    v_mfma_f32_16x16x32_bf16 v[36:39], a[104:107], a[16:19], v[36:39]
    ds_read_b64_tr_b16 a[86:87], v4 offset:41984
    v_mfma_f32_16x16x32_bf16 v[40:43], a[112:115], a[16:19], v[40:43]
    ds_read_b64_tr_b16 a[88:89], v5 offset:32768
    v_mfma_f32_16x16x32_bf16 v[40:43], a[116:119], a[20:23], v[40:43]
    ds_read_b64_tr_b16 a[90:91], v5 offset:33792
    v_mfma_f32_16x16x32_bf16 v[44:47], a[124:127], a[20:23], v[44:47]
    ds_read_b64_tr_b16 a[92:93], v5 offset:40960
    v_mfma_f32_16x16x32_bf16 v[44:47], a[120:123], a[16:19], v[44:47]
    ds_read_b64_tr_b16 a[94:95], v5 offset:41984
    v_mfma_f32_16x16x32_bf16 v[60:63], a[120:123], a[24:27], v[60:63]
    v_mfma_f32_16x16x32_bf16 v[60:63], a[124:127], a[28:31], v[60:63]
    v_mfma_f32_16x16x32_bf16 v[56:59], a[116:119], a[28:31], v[56:59]
    v_mfma_f32_16x16x32_bf16 v[56:59], a[112:115], a[24:27], v[56:59]
    s_add_u32 s7, s56, 384
    v_mfma_f32_16x16x32_bf16 v[52:55], a[104:107], a[24:27], v[52:55]
    buffer_load_dword v30, v16, s[12:15], s7 offen
    v_mfma_f32_16x16x32_bf16 v[52:55], a[108:111], a[28:31], v[52:55]
    v_mfma_f32_16x16x32_bf16 v[48:51], a[100:103], a[28:31], v[48:51]
    v_mfma_f32_16x16x32_bf16 v[48:51], a[96:99], a[24:27], v[48:51]
    s_add_u32 s7, s71, 1572864
    s_waitcnt lgkmcnt(0)
    v_mfma_f32_16x16x32_bf16 v[64:67], a[64:67], a[0:3], v[64:67]
    ds_read_b128 a[32:35], v10 offset:40960
    v_mfma_f32_16x16x32_bf16 v[64:67], a[68:71], a[4:7], v[64:67]
    v_mfma_f32_16x16x32_bf16 v[68:71], a[76:79], a[4:7], v[68:71]
    buffer_load_dword v30, v17, s[16:19], s7 offen
    v_mfma_f32_16x16x32_bf16 v[68:71], a[72:75], a[0:3], v[68:71]
    ds_read_b128 a[36:39], v11 offset:40960
    v_lshrrev_b32 v28, 1, v31
    v_mfma_f32_16x16x32_bf16 v[72:75], a[80:83], a[0:3], v[72:75]
    v_mul_u32_u24 v28, 2752, v28
    v_and_b32 v26, 1, v31
    v_mfma_f32_16x16x32_bf16 v[72:75], a[84:87], a[4:7], v[72:75]
    v_mul_u32_u24 v26, 92, v26
    v_add_u32 v28, v28, v26
    v_mfma_f32_16x16x32_bf16 v[76:79], a[92:95], a[4:7], v[76:79]
    v_cmp_gt_u32 vcc, 16, v31
    v_mov_b32 v26, 2147483648
    v_mfma_f32_16x16x32_bf16 v[76:79], a[88:91], a[0:3], v[76:79]
    s_lshl_b32 s73, s5, 1
    s_add_u32 s73, s73, s3
    s_mul_i32 s73, s73, 88064
    v_mfma_f32_16x16x32_bf16 v[92:95], a[88:91], a[8:11], v[92:95]
    s_mul_i32 s7, s4, 96
    s_add_u32 s73, s73, s7
    s_add_u32 s7, s73, 0
    v_mfma_f32_16x16x32_bf16 v[92:95], a[92:95], a[12:15], v[92:95]
    v_cndmask_b32 v27, v26, v28, vcc
    buffer_load_dword v30, v27, s[52:55], s7 offen
    v_mfma_f32_16x16x32_bf16 v[88:91], a[84:87], a[12:15], v[88:91]
    ds_read_b128 a[40:43], v10 offset:43008
    v_mfma_f32_16x16x32_bf16 v[88:91], a[80:83], a[8:11], v[88:91]
    ds_read_b128 a[44:47], v11 offset:43008
    v_mfma_f32_16x16x32_bf16 v[84:87], a[72:75], a[8:11], v[84:87]
    ds_read_b128 a[48:51], v10 offset:45056
    v_mfma_f32_16x16x32_bf16 v[84:87], a[76:79], a[12:15], v[84:87]
    ds_read_b128 a[52:55], v11 offset:45056
    v_mfma_f32_16x16x32_bf16 v[80:83], a[68:71], a[12:15], v[80:83]
    v_mfma_f32_16x16x32_bf16 v[80:83], a[64:67], a[8:11], v[80:83]
    v_mfma_f32_16x16x32_bf16 v[96:99], a[64:67], a[16:19], v[96:99]
    ds_read_b128 a[56:59], v10 offset:47104
    v_mfma_f32_16x16x32_bf16 v[96:99], a[68:71], a[20:23], v[96:99]
    v_mfma_f32_16x16x32_bf16 v[100:103], a[76:79], a[20:23], v[100:103]
    v_mfma_f32_16x16x32_bf16 v[100:103], a[72:75], a[16:19], v[100:103]
    ds_read_b128 a[60:63], v11 offset:47104
    v_mfma_f32_16x16x32_bf16 v[104:107], a[80:83], a[16:19], v[104:107]
    v_mfma_f32_16x16x32_bf16 v[104:107], a[84:87], a[20:23], v[104:107]
    v_mfma_f32_16x16x32_bf16 v[108:111], a[92:95], a[20:23], v[108:111]
    v_mfma_f32_16x16x32_bf16 v[108:111], a[88:91], a[16:19], v[108:111]
    v_mfma_f32_16x16x32_bf16 v[124:127], a[88:91], a[24:27], v[124:127]
    v_mfma_f32_16x16x32_bf16 v[124:127], a[92:95], a[28:31], v[124:127]
    v_mfma_f32_16x16x32_bf16 v[120:123], a[84:87], a[28:31], v[120:123]
    v_mfma_f32_16x16x32_bf16 v[120:123], a[80:83], a[24:27], v[120:123]
    v_mfma_f32_16x16x32_bf16 v[116:119], a[72:75], a[24:27], v[116:119]
    v_mfma_f32_16x16x32_bf16 v[116:119], a[76:79], a[28:31], v[116:119]
    v_mfma_f32_16x16x32_bf16 v[112:115], a[68:71], a[28:31], v[112:115]
    v_mfma_f32_16x16x32_bf16 v[112:115], a[64:67], a[24:27], v[112:115]
    s_waitcnt lgkmcnt(0)
    v_mfma_f32_16x16x32_bf16 v[128:131], a[64:67], a[32:35], v[128:131]
    s_waitcnt vmcnt(3) lgkmcnt(0)
    s_barrier
    v_mfma_f32_16x16x32_bf16 v[128:131], a[68:71], a[36:39], v[128:131]
    ds_read_b128 a[0:3], v10 offset:0
    v_mfma_f32_16x16x32_bf16 v[132:135], a[76:79], a[36:39], v[132:135]
    v_mfma_f32_16x16x32_bf16 v[132:135], a[72:75], a[32:35], v[132:135]
    s_cmp_eq_u32 s5, 0
    s_cselect_b32 s7, s93, 0x1000
    v_mfma_f32_16x16x32_bf16 v[136:139], a[80:83], a[32:35], v[136:139]
    buffer_atomic_add v25, v22, s[48:51], s7 offen sc1
    v_mfma_f32_16x16x32_bf16 v[136:139], a[84:87], a[36:39], v[136:139]
    s_add_u32 s0, s56, 384
    ds_read_b128 a[4:7], v11 offset:0
    s_xor_b32 m0, s58, 32768
    v_mfma_f32_16x16x32_bf16 v[140:143], a[92:95], a[36:39], v[140:143]
    s_xor_b32 s7, s0, 0
    ds_read_b128 a[8:11], v10 offset:2048
    v_mfma_f32_16x16x32_bf16 v[140:143], a[88:91], a[32:35], v[140:143]
    v_mfma_f32_16x16x32_bf16 v[156:159], a[88:91], a[40:43], v[156:159]
    buffer_load_dwordx4 v12, s[12:15], s7 offen  lds
    v_mfma_f32_16x16x32_bf16 v[156:159], a[92:95], a[44:47], v[156:159]
    s_add_u32 s1, s57, 1572864
    ds_read_b128 a[12:15], v11 offset:2048
    s_xor_b32 m0, s59, 32768
    v_mfma_f32_16x16x32_bf16 v[152:155], a[84:87], a[44:47], v[152:155]
    s_xor_b32 s7, s1, 0
    v_mfma_f32_16x16x32_bf16 v[152:155], a[80:83], a[40:43], v[152:155]
    v_mfma_f32_16x16x32_bf16 v[148:151], a[72:75], a[40:43], v[148:151]
    ds_read_b128 a[16:19], v10 offset:4096
    v_mfma_f32_16x16x32_bf16 v[148:151], a[76:79], a[44:47], v[148:151]
    buffer_load_dwordx4 v14, s[16:19], s7 offen  lds
    v_mfma_f32_16x16x32_bf16 v[144:147], a[68:71], a[44:47], v[144:147]
    s_xor_b32 m0, s58, 33792
    s_xor_b32 s7, s0, 8192
    v_mfma_f32_16x16x32_bf16 v[144:147], a[64:67], a[40:43], v[144:147]
    ds_read_b128 a[20:23], v11 offset:4096
    v_mfma_f32_16x16x32_bf16 v[160:163], a[64:67], a[48:51], v[160:163]
    v_mfma_f32_16x16x32_bf16 v[160:163], a[68:71], a[52:55], v[160:163]
    v_mfma_f32_16x16x32_bf16 v[164:167], a[76:79], a[52:55], v[164:167]
    buffer_load_dwordx4 v13, s[12:15], s7 offen  lds
    v_mfma_f32_16x16x32_bf16 v[164:167], a[72:75], a[48:51], v[164:167]
    s_xor_b32 m0, s59, 33792
    ds_read_b128 a[24:27], v10 offset:6144
    s_xor_b32 s7, s1, 32768
    v_mfma_f32_16x16x32_bf16 v[168:171], a[80:83], a[48:51], v[168:171]
    v_mfma_f32_16x16x32_bf16 v[168:171], a[84:87], a[52:55], v[168:171]
    ds_read_b128 a[28:31], v11 offset:6144
    v_mfma_f32_16x16x32_bf16 v[172:175], a[92:95], a[52:55], v[172:175]
    buffer_load_dwordx4 v14, s[16:19], s7 offen  lds
    v_mfma_f32_16x16x32_bf16 v[172:175], a[88:91], a[48:51], v[172:175]
    s_xor_b32 m0, s58, 34816
    s_xor_b32 s7, s0, 16384
    v_mfma_f32_16x16x32_bf16 v[188:191], a[88:91], a[56:59], v[188:191]
    v_mfma_f32_16x16x32_bf16 v[188:191], a[92:95], a[60:63], v[188:191]
    v_mfma_f32_16x16x32_bf16 v[184:187], a[84:87], a[60:63], v[184:187]
    v_mfma_f32_16x16x32_bf16 v[184:187], a[80:83], a[56:59], v[184:187]
    buffer_load_dwordx4 v12, s[12:15], s7 offen  lds
    v_mfma_f32_16x16x32_bf16 v[180:183], a[72:75], a[56:59], v[180:183]
    s_cmp_eq_u32 s5, 1
    s_cselect_b32 s7, s93, 0x1000
    v_mfma_f32_16x16x32_bf16 v[180:183], a[76:79], a[60:63], v[180:183]
L_tp1:
    s_cbranch_execz L_tp5
    v_mfma_f32_16x16x32_bf16 v[176:179], a[68:71], a[60:63], v[176:179]
    v_mfma_f32_16x16x32_bf16 v[176:179], a[64:67], a[56:59], v[176:179]
    v_mfma_f32_16x16x32_bf16 v[192:195], a[96:99], a[32:35], v[192:195]
    buffer_atomic_add v25, v22, s[48:51], s7 offen sc1
    v_mfma_f32_16x16x32_bf16 v[192:195], a[100:103], a[36:39], v[192:195]
    s_xor_b32 m0, s59, 34816
    ds_read_b64_tr_b16 a[64:65], v2 offset:0
    s_xor_b32 s7, s1, 65536
    v_mfma_f32_16x16x32_bf16 v[196:199], a[108:111], a[36:39], v[196:199]
    ds_read_b64_tr_b16 a[66:67], v2 offset:1024
    v_mfma_f32_16x16x32_bf16 v[196:199], a[104:107], a[32:35], v[196:199]
    ds_read_b64_tr_b16 a[68:69], v2 offset:8192
    v_mfma_f32_16x16x32_bf16 v[200:203], a[112:115], a[32:35], v[200:203]
    buffer_load_dwordx4 v15, s[16:19], s7 offen  lds
    v_mfma_f32_16x16x32_bf16 v[200:203], a[116:119], a[36:39], v[200:203]
    s_xor_b32 m0, s58, 35840
    ds_read_b64_tr_b16 a[70:71], v2 offset:9216
    s_xor_b32 s7, s0, 24576
    v_mfma_f32_16x16x32_bf16 v[204:207], a[124:127], a[36:39], v[204:207]
    ds_read_b64_tr_b16 a[72:73], v3 offset:0
    v_mfma_f32_16x16x32_bf16 v[204:207], a[120:123], a[32:35], v[204:207]
    ds_read_b64_tr_b16 a[74:75], v3 offset:1024
    v_mfma_f32_16x16x32_bf16 v[220:223], a[120:123], a[40:43], v[220:223]
    ds_read_b64_tr_b16 a[76:77], v3 offset:8192
    v_mfma_f32_16x16x32_bf16 v[220:223], a[124:127], a[44:47], v[220:223]
    buffer_load_dwordx4 v13, s[12:15], s7 offen  lds
    v_mfma_f32_16x16x32_bf16 v[216:219], a[116:119], a[44:47], v[216:219]
    s_xor_b32 m0, s59, 35840
    ds_read_b64_tr_b16 a[78:79], v3 offset:9216
    s_xor_b32 s7, s1, 98304
    v_mfma_f32_16x16x32_bf16 v[216:219], a[112:115], a[40:43], v[216:219]
    ds_read_b64_tr_b16 a[80:81], v4 offset:0
    v_mfma_f32_16x16x32_bf16 v[212:215], a[104:107], a[40:43], v[212:215]
    ds_read_b64_tr_b16 a[82:83], v4 offset:1024
    v_mfma_f32_16x16x32_bf16 v[212:215], a[108:111], a[44:47], v[212:215]
    ds_read_b64_tr_b16 a[84:85], v4 offset:8192
    v_mfma_f32_16x16x32_bf16 v[208:211], a[100:103], a[44:47], v[208:211]
    buffer_load_dwordx4 v15, s[16:19], s7 offen  lds
    v_mfma_f32_16x16x32_bf16 v[208:211], a[96:99], a[40:43], v[208:211]
    s_xor_b32 m0, s58, 36864
    s_xor_b32 s7, s0, 32768
    v_mfma_f32_16x16x32_bf16 v[224:227], a[96:99], a[48:51], v[224:227]
    ds_read_b64_tr_b16 a[86:87], v4 offset:9216
    v_mfma_f32_16x16x32_bf16 v[224:227], a[100:103], a[52:55], v[224:227]
    ds_read_b64_tr_b16 a[88:89], v5 offset:0
    v_mfma_f32_16x16x32_bf16 v[228:231], a[108:111], a[52:55], v[228:231]
    buffer_load_dwordx4 v12, s[12:15], s7 offen  lds
    v_mfma_f32_16x16x32_bf16 v[228:231], a[104:107], a[48:51], v[228:231]
    s_xor_b32 m0, s59, 36864
    ds_read_b64_tr_b16 a[90:91], v5 offset:1024
    s_xor_b32 s7, s1, 131072
    v_mfma_f32_16x16x32_bf16 v[232:235], a[112:115], a[48:51], v[232:235]
    ds_read_b64_tr_b16 a[92:93], v5 offset:8192
    v_mfma_f32_16x16x32_bf16 v[232:235], a[116:119], a[52:55], v[232:235]
    ds_read_b64_tr_b16 a[94:95], v5 offset:9216
    v_mfma_f32_16x16x32_bf16 v[236:239], a[124:127], a[52:55], v[236:239]
    v_mfma_f32_16x16x32_bf16 v[236:239], a[120:123], a[48:51], v[236:239]
    buffer_load_dwordx4 v14, s[16:19], s7 offen  lds
    v_mfma_f32_16x16x32_bf16 v[252:255], a[120:123], a[56:59], v[252:255]
    s_xor_b32 m0, s58, 37888
    s_xor_b32 s7, s0, 40960
    v_mfma_f32_16x16x32_bf16 v[252:255], a[124:127], a[60:63], v[252:255]
    v_mfma_f32_16x16x32_bf16 v[248:251], a[116:119], a[60:63], v[248:251]
    v_mfma_f32_16x16x32_bf16 v[248:251], a[112:115], a[56:59], v[248:251]
    v_mfma_f32_16x16x32_bf16 v[244:247], a[104:107], a[56:59], v[244:247]
    buffer_load_dwordx4 v13, s[12:15], s7 offen  lds
    v_mfma_f32_16x16x32_bf16 v[244:247], a[108:111], a[60:63], v[244:247]
    s_xor_b32 m0, s59, 37888
    s_xor_b32 s7, s1, 163840
    v_mfma_f32_16x16x32_bf16 v[240:243], a[100:103], a[60:63], v[240:243]
    v_mfma_f32_16x16x32_bf16 v[240:243], a[96:99], a[56:59], v[240:243]
    s_waitcnt lgkmcnt(0)
    v_mfma_f32_16x16x32_bf16 v[64:67], a[64:67], a[0:3], v[64:67]
    buffer_load_dwordx4 v14, s[16:19], s7 offen  lds
    v_mfma_f32_16x16x32_bf16 v[64:67], a[68:71], a[4:7], v[64:67]
    s_xor_b32 m0, s58, 38912
    ds_read_b64_tr_b16 a[96:97], v6 offset:0
    s_xor_b32 s7, s0, 49152
    v_mfma_f32_16x16x32_bf16 v[68:71], a[76:79], a[4:7], v[68:71]
    ds_read_b64_tr_b16 a[98:99], v6 offset:1024
    v_mfma_f32_16x16x32_bf16 v[68:71], a[72:75], a[0:3], v[68:71]
    ds_read_b64_tr_b16 a[100:101], v6 offset:8192
    v_mfma_f32_16x16x32_bf16 v[72:75], a[80:83], a[0:3], v[72:75]
    ds_read_b64_tr_b16 a[102:103], v6 offset:9216
    v_mfma_f32_16x16x32_bf16 v[72:75], a[84:87], a[4:7], v[72:75]
    buffer_load_dwordx4 v12, s[12:15], s7 offen  lds
    v_mfma_f32_16x16x32_bf16 v[76:79], a[92:95], a[4:7], v[76:79]
    s_xor_b32 m0, s59, 38912
    ds_read_b64_tr_b16 a[104:105], v7 offset:0
    s_xor_b32 s7, s1, 196608
    v_mfma_f32_16x16x32_bf16 v[76:79], a[88:91], a[0:3], v[76:79]
    ds_read_b64_tr_b16 a[106:107], v7 offset:1024
    v_mfma_f32_16x16x32_bf16 v[92:95], a[88:91], a[8:11], v[92:95]
    v_mfma_f32_16x16x32_bf16 v[92:95], a[92:95], a[12:15], v[92:95]
    ds_read_b64_tr_b16 a[108:109], v7 offset:8192
    v_mfma_f32_16x16x32_bf16 v[88:91], a[84:87], a[12:15], v[88:91]
    buffer_load_dwordx4 v15, s[16:19], s7 offen  lds
    v_mfma_f32_16x16x32_bf16 v[88:91], a[80:83], a[8:11], v[88:91]
    s_xor_b32 m0, s58, 39936
    ds_read_b64_tr_b16 a[110:111], v7 offset:9216
    s_xor_b32 s7, s0, 57344
    v_mfma_f32_16x16x32_bf16 v[84:87], a[72:75], a[8:11], v[84:87]
    ds_read_b64_tr_b16 a[112:113], v8 offset:0
    v_mfma_f32_16x16x32_bf16 v[84:87], a[76:79], a[12:15], v[84:87]
    ds_read_b64_tr_b16 a[114:115], v8 offset:1024
    v_mfma_f32_16x16x32_bf16 v[80:83], a[68:71], a[12:15], v[80:83]
    buffer_load_dwordx4 v13, s[12:15], s7 offen  lds
    v_mfma_f32_16x16x32_bf16 v[80:83], a[64:67], a[8:11], v[80:83]
    s_xor_b32 m0, s59, 39936
    ds_read_b64_tr_b16 a[116:117], v8 offset:8192
    s_xor_b32 s7, s1, 229376
    v_mfma_f32_16x16x32_bf16 v[96:99], a[64:67], a[16:19], v[96:99]
    ds_read_b64_tr_b16 a[118:119], v8 offset:9216
    v_mfma_f32_16x16x32_bf16 v[96:99], a[68:71], a[20:23], v[96:99]
    v_mfma_f32_16x16x32_bf16 v[100:103], a[76:79], a[20:23], v[100:103]
    ds_read_b64_tr_b16 a[120:121], v9 offset:0
    v_mfma_f32_16x16x32_bf16 v[100:103], a[72:75], a[16:19], v[100:103]
    buffer_load_dwordx4 v15, s[16:19], s7 offen  lds
    v_mfma_f32_16x16x32_bf16 v[104:107], a[80:83], a[16:19], v[104:107]
    ds_read_b64_tr_b16 a[122:123], v9 offset:1024
    v_mfma_f32_16x16x32_bf16 v[104:107], a[84:87], a[20:23], v[104:107]
    ds_read_b64_tr_b16 a[124:125], v9 offset:8192
    v_mfma_f32_16x16x32_bf16 v[108:111], a[92:95], a[20:23], v[108:111]
    ds_read_b64_tr_b16 a[126:127], v9 offset:9216
    v_mfma_f32_16x16x32_bf16 v[108:111], a[88:91], a[16:19], v[108:111]
    v_mfma_f32_16x16x32_bf16 v[124:127], a[88:91], a[24:27], v[124:127]
    v_mfma_f32_16x16x32_bf16 v[124:127], a[92:95], a[28:31], v[124:127]
    v_mfma_f32_16x16x32_bf16 v[120:123], a[84:87], a[28:31], v[120:123]
    v_mfma_f32_16x16x32_bf16 v[120:123], a[80:83], a[24:27], v[120:123]
    s_cmp_eq_u32 s5, 2
    s_cselect_b32 s7, s93, 0x1000
    v_mfma_f32_16x16x32_bf16 v[116:119], a[72:75], a[24:27], v[116:119]
    buffer_atomic_add v25, v22, s[48:51], s7 offen sc1
    v_mfma_f32_16x16x32_bf16 v[116:119], a[76:79], a[28:31], v[116:119]
    v_mfma_f32_16x16x32_bf16 v[112:115], a[68:71], a[28:31], v[112:115]
    s_add_u32 s7, s56, 512
    v_mfma_f32_16x16x32_bf16 v[112:115], a[64:67], a[24:27], v[112:115]
    s_waitcnt lgkmcnt(0)
    v_mfma_f32_16x16x32_bf16 a[128:131], a[96:99], a[0:3], a[128:131]
    ds_read_b128 a[32:35], v10 offset:8192
    v_mfma_f32_16x16x32_bf16 a[128:131], a[100:103], a[4:7], a[128:131]
    buffer_load_dword v30, v16, s[12:15], s7 offen
    v_mfma_f32_16x16x32_bf16 a[132:135], a[108:111], a[4:7], a[132:135]
    ds_read_b128 a[36:39], v11 offset:8192
    v_mfma_f32_16x16x32_bf16 a[132:135], a[104:107], a[0:3], a[132:135]
    v_mfma_f32_16x16x32_bf16 a[136:139], a[112:115], a[0:3], a[136:139]
    s_add_u32 s7, s71, 2097152
    v_mfma_f32_16x16x32_bf16 a[136:139], a[116:119], a[4:7], a[136:139]
    ds_read_b128 a[40:43], v10 offset:10240
    v_mfma_f32_16x16x32_bf16 a[140:143], a[124:127], a[4:7], a[140:143]
    v_mfma_f32_16x16x32_bf16 a[140:143], a[120:123], a[0:3], a[140:143]
    buffer_load_dword v30, v17, s[16:19], s7 offen
    v_mfma_f32_16x16x32_bf16 a[156:159], a[120:123], a[8:11], a[156:159]
    ds_read_b128 a[44:47], v11 offset:10240
    v_lshrrev_b32 v28, 1, v31
    v_mfma_f32_16x16x32_bf16 a[156:159], a[124:127], a[12:15], a[156:159]
    v_lshlrev_b32 v28, 13, v28
    v_and_b32 v26, 1, v31
    v_mfma_f32_16x16x32_bf16 a[152:155], a[116:119], a[12:15], a[152:155]
    v_lshl_add_u32 v28, v26, 7, v28
    v_cmp_gt_u32 vcc, 16, v31
    v_mfma_f32_16x16x32_bf16 a[152:155], a[112:115], a[8:11], a[152:155]
    v_mov_b32 v26, 2147483648
    s_lshl_b32 s72, s5, 19
    v_mfma_f32_16x16x32_bf16 a[148:151], a[104:107], a[8:11], a[148:151]
    s_add_u32 s72, s72, s62
    s_and_b32 s72, s72, 0xfffeffff
    s_add_u32 s7, s72, 0
    v_mfma_f32_16x16x32_bf16 a[148:151], a[108:111], a[12:15], a[148:151]
    ds_read_b128 a[48:51], v10 offset:12288
    v_cndmask_b32 v18, v26, v28, vcc
    v_mfma_f32_16x16x32_bf16 a[144:147], a[100:103], a[12:15], a[144:147]
    buffer_load_dword v30, v18, s[20:23], s7 offen
    v_mfma_f32_16x16x32_bf16 a[144:147], a[96:99], a[8:11], a[144:147]
    s_add_u32 s7, s73, 22016
    ds_read_b128 a[52:55], v11 offset:12288
    v_mfma_f32_16x16x32_bf16 v[32:35], a[96:99], a[16:19], v[32:35]
    ds_read_b128 a[56:59], v10 offset:14336
    v_mfma_f32_16x16x32_bf16 v[32:35], a[100:103], a[20:23], v[32:35]
    v_mfma_f32_16x16x32_bf16 v[36:39], a[108:111], a[20:23], v[36:39]
    buffer_load_dword v30, v27, s[52:55], s7 offen
    v_mfma_f32_16x16x32_bf16 v[36:39], a[104:107], a[16:19], v[36:39]
    ds_read_b128 a[60:63], v11 offset:14336
    v_mfma_f32_16x16x32_bf16 v[40:43], a[112:115], a[16:19], v[40:43]
    s_cmp_eq_u32 s5, 3
    s_cselect_b32 s7, s93, 0x1000
    v_mfma_f32_16x16x32_bf16 v[40:43], a[116:119], a[20:23], v[40:43]
    v_mfma_f32_16x16x32_bf16 v[44:47], a[124:127], a[20:23], v[44:47]
    v_mfma_f32_16x16x32_bf16 v[44:47], a[120:123], a[16:19], v[44:47]
    v_mfma_f32_16x16x32_bf16 v[60:63], a[120:123], a[24:27], v[60:63]
    buffer_atomic_add v25, v22, s[48:51], s7 offen sc1
    v_mfma_f32_16x16x32_bf16 v[60:63], a[124:127], a[28:31], v[60:63]
    v_mfma_f32_16x16x32_bf16 v[56:59], a[116:119], a[28:31], v[56:59]
    v_mfma_f32_16x16x32_bf16 v[56:59], a[112:115], a[24:27], v[56:59]
    v_mfma_f32_16x16x32_bf16 v[52:55], a[104:107], a[24:27], v[52:55]
    v_mfma_f32_16x16x32_bf16 v[52:55], a[108:111], a[28:31], v[52:55]
    v_mfma_f32_16x16x32_bf16 v[48:51], a[100:103], a[28:31], v[48:51]
    v_mfma_f32_16x16x32_bf16 v[48:51], a[96:99], a[24:27], v[48:51]
    s_waitcnt lgkmcnt(0)
    v_mfma_f32_16x16x32_bf16 v[192:195], a[96:99], a[32:35], v[192:195]
    s_waitcnt vmcnt(6) lgkmcnt(0)
    s_barrier
    v_mfma_f32_16x16x32_bf16 v[192:195], a[100:103], a[36:39], v[192:195]
    ds_read_b128 a[0:3], v10 offset:32768
    v_mfma_f32_16x16x32_bf16 v[196:199], a[108:111], a[36:39], v[196:199]
    v_mfma_f32_16x16x32_bf16 v[196:199], a[104:107], a[32:35], v[196:199]
    s_add_u32 s0, s56, 512
    s_xor_b32 m0, s58, 0
    s_xor_b32 s7, s0, 0
    v_mfma_f32_16x16x32_bf16 v[200:203], a[112:115], a[32:35], v[200:203]
    buffer_load_dwordx4 v12, s[12:15], s7 offen  lds
    v_mfma_f32_16x16x32_bf16 v[200:203], a[116:119], a[36:39], v[200:203]
    s_add_u32 s1, s57, 2097152
    ds_read_b128 a[4:7], v11 offset:32768
    s_xor_b32 m0, s59, 0
    v_mfma_f32_16x16x32_bf16 v[204:207], a[124:127], a[36:39], v[204:207]
    s_xor_b32 s7, s1, 0
    ds_read_b128 a[8:11], v10 offset:34816
    v_mfma_f32_16x16x32_bf16 v[204:207], a[120:123], a[32:35], v[204:207]
    v_mfma_f32_16x16x32_bf16 v[220:223], a[120:123], a[40:43], v[220:223]
    buffer_load_dwordx4 v14, s[16:19], s7 offen  lds
    v_mfma_f32_16x16x32_bf16 v[220:223], a[124:127], a[44:47], v[220:223]
    s_xor_b32 m0, s58, 1024
    ds_read_b128 a[12:15], v11 offset:34816
    s_xor_b32 s7, s0, 8192
    v_mfma_f32_16x16x32_bf16 v[216:219], a[116:119], a[44:47], v[216:219]
    v_mfma_f32_16x16x32_bf16 v[216:219], a[112:115], a[40:43], v[216:219]
    v_mfma_f32_16x16x32_bf16 v[212:215], a[104:107], a[40:43], v[212:215]
    ds_read_b128 a[16:19], v10 offset:36864
    v_mfma_f32_16x16x32_bf16 v[212:215], a[108:111], a[44:47], v[212:215]
    buffer_load_dwordx4 v13, s[12:15], s7 offen  lds
    v_mfma_f32_16x16x32_bf16 v[208:211], a[100:103], a[44:47], v[208:211]
    s_cmp_eq_u32 s5, 4
    s_cselect_b32 s7, s93, 0x1000
    v_mfma_f32_16x16x32_bf16 v[208:211], a[96:99], a[40:43], v[208:211]
    ds_read_b128 a[20:23], v11 offset:36864
    v_mfma_f32_16x16x32_bf16 v[224:227], a[96:99], a[48:51], v[224:227]
    v_mfma_f32_16x16x32_bf16 v[224:227], a[100:103], a[52:55], v[224:227]
    v_mfma_f32_16x16x32_bf16 v[228:231], a[108:111], a[52:55], v[228:231]
    buffer_atomic_add v25, v22, s[48:51], s7 offen sc1
    v_mfma_f32_16x16x32_bf16 v[228:231], a[104:107], a[48:51], v[228:231]
    s_xor_b32 m0, s59, 1024
    ds_read_b128 a[24:27], v10 offset:38912
    s_xor_b32 s7, s1, 32768
    v_mfma_f32_16x16x32_bf16 v[232:235], a[112:115], a[48:51], v[232:235]
    v_mfma_f32_16x16x32_bf16 v[232:235], a[116:119], a[52:55], v[232:235]
    ds_read_b128 a[28:31], v11 offset:38912
    v_mfma_f32_16x16x32_bf16 v[236:239], a[124:127], a[52:55], v[236:239]
    buffer_load_dwordx4 v14, s[16:19], s7 offen  lds
    v_mfma_f32_16x16x32_bf16 v[236:239], a[120:123], a[48:51], v[236:239]
    s_xor_b32 m0, s58, 2048
    s_xor_b32 s7, s0, 16384
    v_mfma_f32_16x16x32_bf16 v[252:255], a[120:123], a[56:59], v[252:255]
    v_mfma_f32_16x16x32_bf16 v[252:255], a[124:127], a[60:63], v[252:255]
    v_mfma_f32_16x16x32_bf16 v[248:251], a[116:119], a[60:63], v[248:251]
    v_mfma_f32_16x16x32_bf16 v[248:251], a[112:115], a[56:59], v[248:251]
    buffer_load_dwordx4 v12, s[12:15], s7 offen  lds
    v_mfma_f32_16x16x32_bf16 v[244:247], a[104:107], a[56:59], v[244:247]
    s_xor_b32 m0, s59, 2048
    s_xor_b32 s7, s1, 65536
    v_mfma_f32_16x16x32_bf16 v[244:247], a[108:111], a[60:63], v[244:247]
    v_mfma_f32_16x16x32_bf16 v[240:243], a[100:103], a[60:63], v[240:243]
    v_mfma_f32_16x16x32_bf16 v[240:243], a[96:99], a[56:59], v[240:243]
    v_mfma_f32_16x16x32_bf16 v[128:131], a[64:67], a[32:35], v[128:131]
    buffer_load_dwordx4 v15, s[16:19], s7 offen  lds
    v_mfma_f32_16x16x32_bf16 v[128:131], a[68:71], a[36:39], v[128:131]
    s_xor_b32 m0, s58, 3072
    ds_read_b64_tr_b16 a[96:97], v6 offset:32768
    s_xor_b32 s7, s0, 24576
    v_mfma_f32_16x16x32_bf16 v[132:135], a[76:79], a[36:39], v[132:135]
    ds_read_b64_tr_b16 a[98:99], v6 offset:33792
    v_mfma_f32_16x16x32_bf16 v[132:135], a[72:75], a[32:35], v[132:135]
    ds_read_b64_tr_b16 a[100:101], v6 offset:40960
    v_mfma_f32_16x16x32_bf16 v[136:139], a[80:83], a[32:35], v[136:139]
    buffer_load_dwordx4 v13, s[12:15], s7 offen  lds
    v_mfma_f32_16x16x32_bf16 v[136:139], a[84:87], a[36:39], v[136:139]
    s_cmp_eq_u32 s5, 5
    ds_read_b64_tr_b16 a[102:103], v6 offset:41984
    s_cselect_b32 s7, s93, 0x1000
    v_mfma_f32_16x16x32_bf16 v[140:143], a[92:95], a[36:39], v[140:143]
    ds_read_b64_tr_b16 a[104:105], v7 offset:32768
    v_mfma_f32_16x16x32_bf16 v[140:143], a[88:91], a[32:35], v[140:143]
    ds_read_b64_tr_b16 a[106:107], v7 offset:33792
    v_mfma_f32_16x16x32_bf16 v[156:159], a[88:91], a[40:43], v[156:159]
    ds_read_b64_tr_b16 a[108:109], v7 offset:40960
    v_mfma_f32_16x16x32_bf16 v[156:159], a[92:95], a[44:47], v[156:159]
    buffer_atomic_add v25, v22, s[48:51], s7 offen sc1
    v_mfma_f32_16x16x32_bf16 v[152:155], a[84:87], a[44:47], v[152:155]
    s_xor_b32 m0, s59, 3072
    ds_read_b64_tr_b16 a[110:111], v7 offset:41984
    s_xor_b32 s7, s1, 98304
    v_mfma_f32_16x16x32_bf16 v[152:155], a[80:83], a[40:43], v[152:155]
    ds_read_b64_tr_b16 a[112:113], v8 offset:32768
    v_mfma_f32_16x16x32_bf16 v[148:151], a[72:75], a[40:43], v[148:151]
    ds_read_b64_tr_b16 a[114:115], v8 offset:33792
    v_mfma_f32_16x16x32_bf16 v[148:151], a[76:79], a[44:47], v[148:151]
    ds_read_b64_tr_b16 a[116:117], v8 offset:40960
    v_mfma_f32_16x16x32_bf16 v[144:147], a[68:71], a[44:47], v[144:147]
    buffer_load_dwordx4 v15, s[16:19], s7 offen  lds
    v_mfma_f32_16x16x32_bf16 v[144:147], a[64:67], a[40:43], v[144:147]
    s_xor_b32 m0, s58, 4096
    s_xor_b32 s7, s0, 32768
    v_mfma_f32_16x16x32_bf16 v[160:163], a[64:67], a[48:51], v[160:163]
    ds_read_b64_tr_b16 a[118:119], v8 offset:41984
    v_mfma_f32_16x16x32_bf16 v[160:163], a[68:71], a[52:55], v[160:163]
    ds_read_b64_tr_b16 a[120:121], v9 offset:32768
    v_mfma_f32_16x16x32_bf16 v[164:167], a[76:79], a[52:55], v[164:167]
    buffer_load_dwordx4 v12, s[12:15], s7 offen  lds
    v_mfma_f32_16x16x32_bf16 v[164:167], a[72:75], a[48:51], v[164:167]
    s_xor_b32 m0, s59, 4096
    ds_read_b64_tr_b16 a[122:123], v9 offset:33792
    s_xor_b32 s7, s1, 131072
    v_mfma_f32_16x16x32_bf16 v[168:171], a[80:83], a[48:51], v[168:171]
    ds_read_b64_tr_b16 a[124:125], v9 offset:40960
    v_mfma_f32_16x16x32_bf16 v[168:171], a[84:87], a[52:55], v[168:171]
    ds_read_b64_tr_b16 a[126:127], v9 offset:41984
    v_mfma_f32_16x16x32_bf16 v[172:175], a[92:95], a[52:55], v[172:175]
    v_mfma_f32_16x16x32_bf16 v[172:175], a[88:91], a[48:51], v[172:175]
    buffer_load_dwordx4 v14, s[16:19], s7 offen  lds
    v_mfma_f32_16x16x32_bf16 v[188:191], a[88:91], a[56:59], v[188:191]
    s_xor_b32 m0, s58, 5120
    s_xor_b32 s7, s0, 40960
    v_mfma_f32_16x16x32_bf16 v[188:191], a[92:95], a[60:63], v[188:191]
    v_mfma_f32_16x16x32_bf16 v[184:187], a[84:87], a[60:63], v[184:187]
    v_mfma_f32_16x16x32_bf16 v[184:187], a[80:83], a[56:59], v[184:187]
    v_mfma_f32_16x16x32_bf16 v[180:183], a[72:75], a[56:59], v[180:183]
    buffer_load_dwordx4 v13, s[12:15], s7 offen  lds
    v_mfma_f32_16x16x32_bf16 v[180:183], a[76:79], a[60:63], v[180:183]
    s_xor_b32 m0, s59, 5120
    s_xor_b32 s7, s1, 163840
    v_mfma_f32_16x16x32_bf16 v[176:179], a[68:71], a[60:63], v[176:179]
    v_mfma_f32_16x16x32_bf16 v[176:179], a[64:67], a[56:59], v[176:179]
    s_waitcnt lgkmcnt(0)
    v_mfma_f32_16x16x32_bf16 a[128:131], a[96:99], a[0:3], a[128:131]
    buffer_load_dwordx4 v14, s[16:19], s7 offen  lds
    v_mfma_f32_16x16x32_bf16 a[128:131], a[100:103], a[4:7], a[128:131]
    s_xor_b32 m0, s58, 6144
    ds_read_b64_tr_b16 a[64:65], v2 offset:32768
    s_xor_b32 s7, s0, 49152
    v_mfma_f32_16x16x32_bf16 a[132:135], a[108:111], a[4:7], a[132:135]
    ds_read_b64_tr_b16 a[66:67], v2 offset:33792
    v_mfma_f32_16x16x32_bf16 a[132:135], a[104:107], a[0:3], a[132:135]
    ds_read_b64_tr_b16 a[68:69], v2 offset:40960
    v_mfma_f32_16x16x32_bf16 a[136:139], a[112:115], a[0:3], a[136:139]
    ds_read_b64_tr_b16 a[70:71], v2 offset:41984
    v_mfma_f32_16x16x32_bf16 a[136:139], a[116:119], a[4:7], a[136:139]
    buffer_load_dwordx4 v12, s[12:15], s7 offen  lds
    v_mfma_f32_16x16x32_bf16 a[140:143], a[124:127], a[4:7], a[140:143]
    s_xor_b32 m0, s59, 6144
    ds_read_b64_tr_b16 a[72:73], v3 offset:32768
    s_xor_b32 s7, s1, 196608
    v_mfma_f32_16x16x32_bf16 a[140:143], a[120:123], a[0:3], a[140:143]
    ds_read_b64_tr_b16 a[74:75], v3 offset:33792
    v_mfma_f32_16x16x32_bf16 a[156:159], a[120:123], a[8:11], a[156:159]
    v_mfma_f32_16x16x32_bf16 a[156:159], a[124:127], a[12:15], a[156:159]
    ds_read_b64_tr_b16 a[76:77], v3 offset:40960
    v_mfma_f32_16x16x32_bf16 a[152:155], a[116:119], a[12:15], a[152:155]
    buffer_load_dwordx4 v15, s[16:19], s7 offen  lds
    v_mfma_f32_16x16x32_bf16 a[152:155], a[112:115], a[8:11], a[152:155]
    s_xor_b32 m0, s58, 7168
    ds_read_b64_tr_b16 a[78:79], v3 offset:41984
    s_xor_b32 s7, s0, 57344
    v_mfma_f32_16x16x32_bf16 a[148:151], a[104:107], a[8:11], a[148:151]
    ds_read_b64_tr_b16 a[80:81], v4 offset:32768
    v_mfma_f32_16x16x32_bf16 a[148:151], a[108:111], a[12:15], a[148:151]
    ds_read_b64_tr_b16 a[82:83], v4 offset:33792
    v_mfma_f32_16x16x32_bf16 a[144:147], a[100:103], a[12:15], a[144:147]
    buffer_load_dwordx4 v13, s[12:15], s7 offen  lds
    v_mfma_f32_16x16x32_bf16 a[144:147], a[96:99], a[8:11], a[144:147]
    s_xor_b32 m0, s59, 7168
    ds_read_b64_tr_b16 a[84:85], v4 offset:40960
    s_xor_b32 s7, s1, 229376
    v_mfma_f32_16x16x32_bf16 v[32:35], a[96:99], a[16:19], v[32:35]
    ds_read_b64_tr_b16 a[86:87], v4 offset:41984
    v_mfma_f32_16x16x32_bf16 v[32:35], a[100:103], a[20:23], v[32:35]
    v_mfma_f32_16x16x32_bf16 v[36:39], a[108:111], a[20:23], v[36:39]
    ds_read_b64_tr_b16 a[88:89], v5 offset:32768
    v_mfma_f32_16x16x32_bf16 v[36:39], a[104:107], a[16:19], v[36:39]
    buffer_load_dwordx4 v15, s[16:19], s7 offen  lds
    v_mfma_f32_16x16x32_bf16 v[40:43], a[112:115], a[16:19], v[40:43]
    ds_read_b64_tr_b16 a[90:91], v5 offset:33792
    v_mfma_f32_16x16x32_bf16 v[40:43], a[116:119], a[20:23], v[40:43]
    ds_read_b64_tr_b16 a[92:93], v5 offset:40960
    v_mfma_f32_16x16x32_bf16 v[44:47], a[124:127], a[20:23], v[44:47]
    ds_read_b64_tr_b16 a[94:95], v5 offset:41984
    v_mfma_f32_16x16x32_bf16 v[44:47], a[120:123], a[16:19], v[44:47]
    v_mfma_f32_16x16x32_bf16 v[60:63], a[120:123], a[24:27], v[60:63]
    v_mfma_f32_16x16x32_bf16 v[60:63], a[124:127], a[28:31], v[60:63]
    v_mfma_f32_16x16x32_bf16 v[56:59], a[116:119], a[28:31], v[56:59]
    v_mfma_f32_16x16x32_bf16 v[56:59], a[112:115], a[24:27], v[56:59]
    s_cmp_eq_u32 s5, 6
    s_cselect_b32 s7, s93, 0x1000
    v_mfma_f32_16x16x32_bf16 v[52:55], a[104:107], a[24:27], v[52:55]
    buffer_atomic_add v25, v22, s[48:51], s7 offen sc1
    v_mfma_f32_16x16x32_bf16 v[52:55], a[108:111], a[28:31], v[52:55]
    v_mfma_f32_16x16x32_bf16 v[48:51], a[100:103], a[28:31], v[48:51]
    s_add_u32 s7, s56, 640
    v_mfma_f32_16x16x32_bf16 v[48:51], a[96:99], a[24:27], v[48:51]
    s_waitcnt lgkmcnt(0)
    v_mfma_f32_16x16x32_bf16 v[64:67], a[64:67], a[0:3], v[64:67]
    ds_read_b128 a[32:35], v10 offset:40960
    v_mfma_f32_16x16x32_bf16 v[64:67], a[68:71], a[4:7], v[64:67]
    buffer_load_dword v30, v16, s[12:15], s7 offen
    v_mfma_f32_16x16x32_bf16 v[68:71], a[76:79], a[4:7], v[68:71]
    ds_read_b128 a[36:39], v11 offset:40960
    v_mfma_f32_16x16x32_bf16 v[68:71], a[72:75], a[0:3], v[68:71]
    v_mfma_f32_16x16x32_bf16 v[72:75], a[80:83], a[0:3], v[72:75]
    s_add_u32 s7, s71, 2621440
    v_mfma_f32_16x16x32_bf16 v[72:75], a[84:87], a[4:7], v[72:75]
    ds_read_b128 a[40:43], v10 offset:43008
    v_mfma_f32_16x16x32_bf16 v[76:79], a[92:95], a[4:7], v[76:79]
    v_mfma_f32_16x16x32_bf16 v[76:79], a[88:91], a[0:3], v[76:79]
    buffer_load_dword v30, v17, s[16:19], s7 offen
    v_mfma_f32_16x16x32_bf16 v[92:95], a[88:91], a[8:11], v[92:95]
    ds_read_b128 a[44:47], v11 offset:43008
    v_mfma_f32_16x16x32_bf16 v[92:95], a[92:95], a[12:15], v[92:95]
    v_mfma_f32_16x16x32_bf16 v[88:91], a[84:87], a[12:15], v[88:91]
    s_add_u32 s7, s72, 65536
    v_mfma_f32_16x16x32_bf16 v[88:91], a[80:83], a[8:11], v[88:91]
    ds_read_b128 a[48:51], v10 offset:45056
    v_mfma_f32_16x16x32_bf16 v[84:87], a[72:75], a[8:11], v[84:87]
    v_mfma_f32_16x16x32_bf16 v[84:87], a[76:79], a[12:15], v[84:87]
    buffer_load_dword v30, v18, s[20:23], s7 offen
    v_mfma_f32_16x16x32_bf16 v[80:83], a[68:71], a[12:15], v[80:83]
    ds_read_b128 a[52:55], v11 offset:45056
    v_mfma_f32_16x16x32_bf16 v[80:83], a[64:67], a[8:11], v[80:83]
    s_add_u32 s7, s73, 44032
    v_mfma_f32_16x16x32_bf16 v[96:99], a[64:67], a[16:19], v[96:99]
    ds_read_b128 a[56:59], v10 offset:47104
    v_mfma_f32_16x16x32_bf16 v[96:99], a[68:71], a[20:23], v[96:99]
    v_mfma_f32_16x16x32_bf16 v[100:103], a[76:79], a[20:23], v[100:103]
    buffer_load_dword v30, v27, s[52:55], s7 offen
    v_mfma_f32_16x16x32_bf16 v[100:103], a[72:75], a[16:19], v[100:103]
    ds_read_b128 a[60:63], v11 offset:47104
    v_mfma_f32_16x16x32_bf16 v[104:107], a[80:83], a[16:19], v[104:107]
    s_cmp_eq_u32 s5, 7
    s_cselect_b32 s7, s93, 0x1000
    v_mfma_f32_16x16x32_bf16 v[104:107], a[84:87], a[20:23], v[104:107]
    v_mfma_f32_16x16x32_bf16 v[108:111], a[92:95], a[20:23], v[108:111]
    v_mfma_f32_16x16x32_bf16 v[108:111], a[88:91], a[16:19], v[108:111]
    v_mfma_f32_16x16x32_bf16 v[124:127], a[88:91], a[24:27], v[124:127]
    buffer_atomic_add v25, v22, s[48:51], s7 offen sc1
    v_mfma_f32_16x16x32_bf16 v[124:127], a[92:95], a[28:31], v[124:127]
    v_mfma_f32_16x16x32_bf16 v[120:123], a[84:87], a[28:31], v[120:123]
    v_mfma_f32_16x16x32_bf16 v[120:123], a[80:83], a[24:27], v[120:123]
    v_mfma_f32_16x16x32_bf16 v[116:119], a[72:75], a[24:27], v[116:119]
    v_mfma_f32_16x16x32_bf16 v[116:119], a[76:79], a[28:31], v[116:119]
    v_mfma_f32_16x16x32_bf16 v[112:115], a[68:71], a[28:31], v[112:115]
    v_mfma_f32_16x16x32_bf16 v[112:115], a[64:67], a[24:27], v[112:115]
    s_waitcnt lgkmcnt(0)
    v_mfma_f32_16x16x32_bf16 v[128:131], a[64:67], a[32:35], v[128:131]
    s_waitcnt vmcnt(6) lgkmcnt(0)
    s_barrier
    v_mfma_f32_16x16x32_bf16 v[128:131], a[68:71], a[36:39], v[128:131]
    ds_read_b128 a[0:3], v10 offset:0
    v_mfma_f32_16x16x32_bf16 v[132:135], a[76:79], a[36:39], v[132:135]
    v_mfma_f32_16x16x32_bf16 v[132:135], a[72:75], a[32:35], v[132:135]
    s_add_u32 s0, s56, 640
    s_xor_b32 m0, s58, 32768
    s_xor_b32 s7, s0, 0
    v_mfma_f32_16x16x32_bf16 v[136:139], a[80:83], a[32:35], v[136:139]
    buffer_load_dwordx4 v12, s[12:15], s7 offen  lds
    v_mfma_f32_16x16x32_bf16 v[136:139], a[84:87], a[36:39], v[136:139]
    s_add_u32 s1, s57, 2621440
    ds_read_b128 a[4:7], v11 offset:0
    s_xor_b32 m0, s59, 32768
    v_mfma_f32_16x16x32_bf16 v[140:143], a[92:95], a[36:39], v[140:143]
    s_xor_b32 s7, s1, 0
    ds_read_b128 a[8:11], v10 offset:2048
    v_mfma_f32_16x16x32_bf16 v[140:143], a[88:91], a[32:35], v[140:143]
    v_mfma_f32_16x16x32_bf16 v[156:159], a[88:91], a[40:43], v[156:159]
    v_mfma_f32_16x16x32_bf16 v[156:159], a[92:95], a[44:47], v[156:159]
    buffer_load_dwordx4 v14, s[16:19], s7 offen  lds
    v_mfma_f32_16x16x32_bf16 v[152:155], a[84:87], a[44:47], v[152:155]
    s_xor_b32 m0, s58, 33792
    ds_read_b128 a[12:15], v11 offset:2048
    s_xor_b32 s7, s0, 8192
    v_mfma_f32_16x16x32_bf16 v[152:155], a[80:83], a[40:43], v[152:155]
    v_mfma_f32_16x16x32_bf16 v[148:151], a[72:75], a[40:43], v[148:151]
    ds_read_b128 a[16:19], v10 offset:4096
    v_mfma_f32_16x16x32_bf16 v[148:151], a[76:79], a[44:47], v[148:151]
    v_mfma_f32_16x16x32_bf16 v[144:147], a[68:71], a[44:47], v[144:147]
    buffer_load_dwordx4 v13, s[12:15], s7 offen  lds
    v_mfma_f32_16x16x32_bf16 v[144:147], a[64:67], a[40:43], v[144:147]
    s_xor_b32 m0, s59, 33792
    ds_read_b128 a[20:23], v11 offset:4096
    s_xor_b32 s7, s1, 32768
    v_mfma_f32_16x16x32_bf16 v[160:163], a[64:67], a[48:51], v[160:163]
    v_mfma_f32_16x16x32_bf16 v[160:163], a[68:71], a[52:55], v[160:163]
    v_mfma_f32_16x16x32_bf16 v[164:167], a[76:79], a[52:55], v[164:167]
    ds_read_b128 a[24:27], v10 offset:6144
    v_mfma_f32_16x16x32_bf16 v[164:167], a[72:75], a[48:51], v[164:167]
    buffer_load_dwordx4 v14, s[16:19], s7 offen  lds
    v_mfma_f32_16x16x32_bf16 v[168:171], a[80:83], a[48:51], v[168:171]
    v_mfma_f32_16x16x32_bf16 v[168:171], a[84:87], a[52:55], v[168:171]
    s_xor_b32 m0, s58, 34816
    ds_read_b128 a[28:31], v11 offset:6144
    s_xor_b32 s7, s0, 16384
    v_mfma_f32_16x16x32_bf16 v[172:175], a[92:95], a[52:55], v[172:175]
    v_mfma_f32_16x16x32_bf16 v[172:175], a[88:91], a[48:51], v[172:175]
    v_mfma_f32_16x16x32_bf16 v[188:191], a[88:91], a[56:59], v[188:191]
    v_mfma_f32_16x16x32_bf16 v[188:191], a[92:95], a[60:63], v[188:191]
    buffer_load_dwordx4 v12, s[12:15], s7 offen  lds
    v_mfma_f32_16x16x32_bf16 v[184:187], a[84:87], a[60:63], v[184:187]
    s_xor_b32 m0, s59, 34816
    s_xor_b32 s7, s1, 65536
    v_mfma_f32_16x16x32_bf16 v[184:187], a[80:83], a[56:59], v[184:187]
    v_mfma_f32_16x16x32_bf16 v[180:183], a[72:75], a[56:59], v[180:183]
    v_mfma_f32_16x16x32_bf16 v[180:183], a[76:79], a[60:63], v[180:183]
    v_mfma_f32_16x16x32_bf16 v[176:179], a[68:71], a[60:63], v[176:179]
    buffer_load_dwordx4 v15, s[16:19], s7 offen  lds
    v_mfma_f32_16x16x32_bf16 v[176:179], a[64:67], a[56:59], v[176:179]
    s_xor_b32 m0, s58, 35840
    s_xor_b32 s7, s0, 24576
    v_mfma_f32_16x16x32_bf16 v[192:195], a[96:99], a[32:35], v[192:195]
    ds_read_b64_tr_b16 a[64:65], v2 offset:0
    v_mfma_f32_16x16x32_bf16 v[192:195], a[100:103], a[36:39], v[192:195]
    ds_read_b64_tr_b16 a[66:67], v2 offset:1024
    v_mfma_f32_16x16x32_bf16 v[196:199], a[108:111], a[36:39], v[196:199]
    ds_read_b64_tr_b16 a[68:69], v2 offset:8192
    v_mfma_f32_16x16x32_bf16 v[196:199], a[104:107], a[32:35], v[196:199]
    buffer_load_dwordx4 v13, s[12:15], s7 offen  lds
    v_mfma_f32_16x16x32_bf16 v[200:203], a[112:115], a[32:35], v[200:203]
    s_xor_b32 m0, s59, 35840
    ds_read_b64_tr_b16 a[70:71], v2 offset:9216
    s_xor_b32 s7, s1, 98304
    v_mfma_f32_16x16x32_bf16 v[200:203], a[116:119], a[36:39], v[200:203]
L_tp2:
    s_cbranch_execz L_tp6
    ds_read_b64_tr_b16 a[72:73], v3 offset:0
    v_mfma_f32_16x16x32_bf16 v[204:207], a[124:127], a[36:39], v[204:207]
    ds_read_b64_tr_b16 a[74:75], v3 offset:1024
    v_mfma_f32_16x16x32_bf16 v[204:207], a[120:123], a[32:35], v[204:207]
    v_mfma_f32_16x16x32_bf16 v[220:223], a[120:123], a[40:43], v[220:223]
    buffer_load_dwordx4 v15, s[16:19], s7 offen  lds
    v_mfma_f32_16x16x32_bf16 v[220:223], a[124:127], a[44:47], v[220:223]
    ds_read_b64_tr_b16 a[76:77], v3 offset:8192
    v_mfma_f32_16x16x32_bf16 v[216:219], a[116:119], a[44:47], v[216:219]
    s_xor_b32 m0, s58, 36864
    ds_read_b64_tr_b16 a[78:79], v3 offset:9216
    s_xor_b32 s7, s0, 32768
    v_mfma_f32_16x16x32_bf16 v[216:219], a[112:115], a[40:43], v[216:219]
    ds_read_b64_tr_b16 a[80:81], v4 offset:0
    v_mfma_f32_16x16x32_bf16 v[212:215], a[104:107], a[40:43], v[212:215]
    ds_read_b64_tr_b16 a[82:83], v4 offset:1024
    v_mfma_f32_16x16x32_bf16 v[212:215], a[108:111], a[44:47], v[212:215]
    ds_read_b64_tr_b16 a[84:85], v4 offset:8192
    v_mfma_f32_16x16x32_bf16 v[208:211], a[100:103], a[44:47], v[208:211]
    buffer_load_dwordx4 v12, s[12:15], s7 offen  lds
    v_mfma_f32_16x16x32_bf16 v[208:211], a[96:99], a[40:43], v[208:211]
    s_xor_b32 m0, s59, 36864
    ds_read_b64_tr_b16 a[86:87], v4 offset:9216
    s_xor_b32 s7, s1, 131072
    v_mfma_f32_16x16x32_bf16 v[224:227], a[96:99], a[48:51], v[224:227]
    ds_read_b64_tr_b16 a[88:89], v5 offset:0
    v_mfma_f32_16x16x32_bf16 v[224:227], a[100:103], a[52:55], v[224:227]
    ds_read_b64_tr_b16 a[90:91], v5 offset:1024
    v_mfma_f32_16x16x32_bf16 v[228:231], a[108:111], a[52:55], v[228:231]
    v_mfma_f32_16x16x32_bf16 v[228:231], a[104:107], a[48:51], v[228:231]
    buffer_load_dwordx4 v14, s[16:19], s7 offen  lds
    v_mfma_f32_16x16x32_bf16 v[232:235], a[112:115], a[48:51], v[232:235]
    s_xor_b32 m0, s58, 37888
    ds_read_b64_tr_b16 a[92:93], v5 offset:8192
    s_xor_b32 s7, s0, 40960
    v_mfma_f32_16x16x32_bf16 v[232:235], a[116:119], a[52:55], v[232:235]
    ds_read_b64_tr_b16 a[94:95], v5 offset:9216
    v_mfma_f32_16x16x32_bf16 v[236:239], a[124:127], a[52:55], v[236:239]
    v_mfma_f32_16x16x32_bf16 v[236:239], a[120:123], a[48:51], v[236:239]
    v_mfma_f32_16x16x32_bf16 v[252:255], a[120:123], a[56:59], v[252:255]
    buffer_load_dwordx4 v13, s[12:15], s7 offen  lds
    v_mfma_f32_16x16x32_bf16 v[252:255], a[124:127], a[60:63], v[252:255]
    s_xor_b32 m0, s59, 37888
    s_xor_b32 s7, s1, 163840
    v_mfma_f32_16x16x32_bf16 v[248:251], a[116:119], a[60:63], v[248:251]
    v_mfma_f32_16x16x32_bf16 v[248:251], a[112:115], a[56:59], v[248:251]
    v_mfma_f32_16x16x32_bf16 v[244:247], a[104:107], a[56:59], v[244:247]
    v_mfma_f32_16x16x32_bf16 v[244:247], a[108:111], a[60:63], v[244:247]
    buffer_load_dwordx4 v14, s[16:19], s7 offen  lds
    v_mfma_f32_16x16x32_bf16 v[240:243], a[100:103], a[60:63], v[240:243]
    v_mfma_f32_16x16x32_bf16 v[240:243], a[96:99], a[56:59], v[240:243]
    s_xor_b32 m0, s58, 38912
    s_xor_b32 s7, s0, 49152
    s_waitcnt lgkmcnt(0)
    v_mfma_f32_16x16x32_bf16 v[64:67], a[64:67], a[0:3], v[64:67]
    ds_read_b64_tr_b16 a[96:97], v6 offset:0
    v_mfma_f32_16x16x32_bf16 v[64:67], a[68:71], a[4:7], v[64:67]
    ds_read_b64_tr_b16 a[98:99], v6 offset:1024
    v_mfma_f32_16x16x32_bf16 v[68:71], a[76:79], a[4:7], v[68:71]
    v_mfma_f32_16x16x32_bf16 v[68:71], a[72:75], a[0:3], v[68:71]
    buffer_load_dwordx4 v12, s[12:15], s7 offen  lds
    v_mfma_f32_16x16x32_bf16 v[72:75], a[80:83], a[0:3], v[72:75]
    s_xor_b32 m0, s59, 38912
    ds_read_b64_tr_b16 a[100:101], v6 offset:8192
    s_xor_b32 s7, s1, 196608
    v_mfma_f32_16x16x32_bf16 v[72:75], a[84:87], a[4:7], v[72:75]
    ds_read_b64_tr_b16 a[102:103], v6 offset:9216
    v_mfma_f32_16x16x32_bf16 v[76:79], a[92:95], a[4:7], v[76:79]
    ds_read_b64_tr_b16 a[104:105], v7 offset:0
    v_mfma_f32_16x16x32_bf16 v[76:79], a[88:91], a[0:3], v[76:79]
    ds_read_b64_tr_b16 a[106:107], v7 offset:1024
    v_mfma_f32_16x16x32_bf16 v[92:95], a[88:91], a[8:11], v[92:95]
    buffer_load_dwordx4 v15, s[16:19], s7 offen  lds
    v_mfma_f32_16x16x32_bf16 v[92:95], a[92:95], a[12:15], v[92:95]
    s_xor_b32 m0, s58, 39936
    ds_read_b64_tr_b16 a[108:109], v7 offset:8192
    s_xor_b32 s7, s0, 57344
    v_mfma_f32_16x16x32_bf16 v[88:91], a[84:87], a[12:15], v[88:91]
    ds_read_b64_tr_b16 a[110:111], v7 offset:9216
    v_mfma_f32_16x16x32_bf16 v[88:91], a[80:83], a[8:11], v[88:91]
    v_mfma_f32_16x16x32_bf16 v[84:87], a[72:75], a[8:11], v[84:87]
    ds_read_b64_tr_b16 a[112:113], v8 offset:0
    v_mfma_f32_16x16x32_bf16 v[84:87], a[76:79], a[12:15], v[84:87]
    buffer_load_dwordx4 v13, s[12:15], s7 offen  lds
    v_mfma_f32_16x16x32_bf16 v[80:83], a[68:71], a[12:15], v[80:83]
    s_xor_b32 m0, s59, 39936
    ds_read_b64_tr_b16 a[114:115], v8 offset:1024
    s_xor_b32 s7, s1, 229376
    v_mfma_f32_16x16x32_bf16 v[80:83], a[64:67], a[8:11], v[80:83]
    ds_read_b64_tr_b16 a[116:117], v8 offset:8192
    v_mfma_f32_16x16x32_bf16 v[96:99], a[64:67], a[16:19], v[96:99]
    ds_read_b64_tr_b16 a[118:119], v8 offset:9216
    v_mfma_f32_16x16x32_bf16 v[96:99], a[68:71], a[20:23], v[96:99]
    v_mfma_f32_16x16x32_bf16 v[100:103], a[76:79], a[20:23], v[100:103]
    buffer_load_dwordx4 v15, s[16:19], s7 offen  lds
    v_mfma_f32_16x16x32_bf16 v[100:103], a[72:75], a[16:19], v[100:103]
    ds_read_b64_tr_b16 a[120:121], v9 offset:0
    v_mfma_f32_16x16x32_bf16 v[104:107], a[80:83], a[16:19], v[104:107]
    ds_read_b64_tr_b16 a[122:123], v9 offset:1024
    v_mfma_f32_16x16x32_bf16 v[104:107], a[84:87], a[20:23], v[104:107]
    ds_read_b64_tr_b16 a[124:125], v9 offset:8192
    v_mfma_f32_16x16x32_bf16 v[108:111], a[92:95], a[20:23], v[108:111]
    ds_read_b64_tr_b16 a[126:127], v9 offset:9216
    v_mfma_f32_16x16x32_bf16 v[108:111], a[88:91], a[16:19], v[108:111]
    v_mfma_f32_16x16x32_bf16 v[124:127], a[88:91], a[24:27], v[124:127]
    v_mfma_f32_16x16x32_bf16 v[124:127], a[92:95], a[28:31], v[124:127]
    v_mfma_f32_16x16x32_bf16 v[120:123], a[84:87], a[28:31], v[120:123]
    v_mfma_f32_16x16x32_bf16 v[120:123], a[80:83], a[24:27], v[120:123]
    s_add_u32 s7, s56, 768
    v_mfma_f32_16x16x32_bf16 v[116:119], a[72:75], a[24:27], v[116:119]
    buffer_load_dword v30, v16, s[12:15], s7 offen
    v_mfma_f32_16x16x32_bf16 v[116:119], a[76:79], a[28:31], v[116:119]
    v_mfma_f32_16x16x32_bf16 v[112:115], a[68:71], a[28:31], v[112:115]
    v_mfma_f32_16x16x32_bf16 v[112:115], a[64:67], a[24:27], v[112:115]
    s_add_u32 s7, s71, 3145728
    s_waitcnt lgkmcnt(0)
    v_mfma_f32_16x16x32_bf16 a[128:131], a[96:99], a[0:3], a[128:131]
    ds_read_b128 a[32:35], v10 offset:8192
    v_mfma_f32_16x16x32_bf16 a[128:131], a[100:103], a[4:7], a[128:131]
    v_mfma_f32_16x16x32_bf16 a[132:135], a[108:111], a[4:7], a[132:135]
    buffer_load_dword v30, v17, s[16:19], s7 offen
    v_mfma_f32_16x16x32_bf16 a[132:135], a[104:107], a[0:3], a[132:135]
    ds_read_b128 a[36:39], v11 offset:8192
    v_mfma_f32_16x16x32_bf16 a[136:139], a[112:115], a[0:3], a[136:139]
    v_mfma_f32_16x16x32_bf16 a[136:139], a[116:119], a[4:7], a[136:139]
    s_add_u32 s7, s73, 66048
    ds_read_b128 a[40:43], v10 offset:10240
    v_mfma_f32_16x16x32_bf16 a[140:143], a[124:127], a[4:7], a[140:143]
    v_mfma_f32_16x16x32_bf16 a[140:143], a[120:123], a[0:3], a[140:143]
    v_mfma_f32_16x16x32_bf16 a[156:159], a[120:123], a[8:11], a[156:159]
    buffer_load_dword v30, v27, s[52:55], s7 offen
    v_mfma_f32_16x16x32_bf16 a[156:159], a[124:127], a[12:15], a[156:159]
    ds_read_b128 a[44:47], v11 offset:10240
    v_mfma_f32_16x16x32_bf16 a[152:155], a[116:119], a[12:15], a[152:155]
    v_mfma_f32_16x16x32_bf16 a[152:155], a[112:115], a[8:11], a[152:155]
    ds_read_b128 a[48:51], v10 offset:12288
    v_mfma_f32_16x16x32_bf16 a[148:151], a[104:107], a[8:11], a[148:151]
    v_mfma_f32_16x16x32_bf16 a[148:151], a[108:111], a[12:15], a[148:151]
    ds_read_b128 a[52:55], v11 offset:12288
    v_mfma_f32_16x16x32_bf16 a[144:147], a[100:103], a[12:15], a[144:147]
    v_mfma_f32_16x16x32_bf16 a[144:147], a[96:99], a[8:11], a[144:147]
    v_mfma_f32_16x16x32_bf16 v[32:35], a[96:99], a[16:19], v[32:35]
    ds_read_b128 a[56:59], v10 offset:14336
    v_mfma_f32_16x16x32_bf16 v[32:35], a[100:103], a[20:23], v[32:35]
    v_mfma_f32_16x16x32_bf16 v[36:39], a[108:111], a[20:23], v[36:39]
    v_mfma_f32_16x16x32_bf16 v[36:39], a[104:107], a[16:19], v[36:39]
    ds_read_b128 a[60:63], v11 offset:14336
    v_mfma_f32_16x16x32_bf16 v[40:43], a[112:115], a[16:19], v[40:43]
    v_mfma_f32_16x16x32_bf16 v[40:43], a[116:119], a[20:23], v[40:43]
    v_mfma_f32_16x16x32_bf16 v[44:47], a[124:127], a[20:23], v[44:47]
    v_mfma_f32_16x16x32_bf16 v[44:47], a[120:123], a[16:19], v[44:47]
    v_mfma_f32_16x16x32_bf16 v[60:63], a[120:123], a[24:27], v[60:63]
    v_mfma_f32_16x16x32_bf16 v[60:63], a[124:127], a[28:31], v[60:63]
    v_mfma_f32_16x16x32_bf16 v[56:59], a[116:119], a[28:31], v[56:59]
    v_mfma_f32_16x16x32_bf16 v[56:59], a[112:115], a[24:27], v[56:59]
    v_mfma_f32_16x16x32_bf16 v[52:55], a[104:107], a[24:27], v[52:55]
    v_mfma_f32_16x16x32_bf16 v[52:55], a[108:111], a[28:31], v[52:55]
    v_mfma_f32_16x16x32_bf16 v[48:51], a[100:103], a[28:31], v[48:51]
    v_mfma_f32_16x16x32_bf16 v[48:51], a[96:99], a[24:27], v[48:51]
    s_waitcnt lgkmcnt(0)
    v_mfma_f32_16x16x32_bf16 v[192:195], a[96:99], a[32:35], v[192:195]
    s_waitcnt vmcnt(3) lgkmcnt(0)
    s_barrier
    v_mfma_f32_16x16x32_bf16 v[192:195], a[100:103], a[36:39], v[192:195]
    ds_read_b128 a[0:3], v10 offset:32768
    v_mfma_f32_16x16x32_bf16 v[196:199], a[108:111], a[36:39], v[196:199]
    v_mfma_f32_16x16x32_bf16 v[196:199], a[104:107], a[32:35], v[196:199]
    s_add_u32 s0, s56, 768
    s_xor_b32 m0, s58, 0
    s_xor_b32 s7, s0, 0
    v_mfma_f32_16x16x32_bf16 v[200:203], a[112:115], a[32:35], v[200:203]
    buffer_load_dwordx4 v12, s[12:15], s7 offen  lds
    v_mfma_f32_16x16x32_bf16 v[200:203], a[116:119], a[36:39], v[200:203]
    s_add_u32 s1, s57, 3145728
    ds_read_b128 a[4:7], v11 offset:32768
    s_xor_b32 m0, s59, 0
    v_mfma_f32_16x16x32_bf16 v[204:207], a[124:127], a[36:39], v[204:207]
    s_xor_b32 s7, s1, 0
    ds_read_b128 a[8:11], v10 offset:34816
    v_mfma_f32_16x16x32_bf16 v[204:207], a[120:123], a[32:35], v[204:207]
    v_mfma_f32_16x16x32_bf16 v[220:223], a[120:123], a[40:43], v[220:223]
    buffer_load_dwordx4 v14, s[16:19], s7 offen  lds
    v_mfma_f32_16x16x32_bf16 v[220:223], a[124:127], a[44:47], v[220:223]
    s_xor_b32 m0, s58, 1024
    s_xor_b32 s7, s0, 8192
    v_mfma_f32_16x16x32_bf16 v[216:219], a[116:119], a[44:47], v[216:219]
    ds_read_b128 a[12:15], v11 offset:34816
    v_mfma_f32_16x16x32_bf16 v[216:219], a[112:115], a[40:43], v[216:219]
    v_mfma_f32_16x16x32_bf16 v[212:215], a[104:107], a[40:43], v[212:215]
    buffer_load_dwordx4 v13, s[12:15], s7 offen  lds
    v_mfma_f32_16x16x32_bf16 v[212:215], a[108:111], a[44:47], v[212:215]
    s_xor_b32 m0, s59, 1024
    ds_read_b128 a[16:19], v10 offset:36864
    s_xor_b32 s7, s1, 32768
    v_mfma_f32_16x16x32_bf16 v[208:211], a[100:103], a[44:47], v[208:211]
    v_mfma_f32_16x16x32_bf16 v[208:211], a[96:99], a[40:43], v[208:211]
    ds_read_b128 a[20:23], v11 offset:36864
    v_mfma_f32_16x16x32_bf16 v[224:227], a[96:99], a[48:51], v[224:227]
    buffer_load_dwordx4 v14, s[16:19], s7 offen  lds
    v_mfma_f32_16x16x32_bf16 v[224:227], a[100:103], a[52:55], v[224:227]
    s_xor_b32 m0, s58, 2048
    s_xor_b32 s7, s0, 16384
    v_mfma_f32_16x16x32_bf16 v[228:231], a[108:111], a[52:55], v[228:231]
    ds_read_b128 a[24:27], v10 offset:38912
    v_mfma_f32_16x16x32_bf16 v[228:231], a[104:107], a[48:51], v[228:231]
    v_mfma_f32_16x16x32_bf16 v[232:235], a[112:115], a[48:51], v[232:235]
    buffer_load_dwordx4 v12, s[12:15], s7 offen  lds
    v_mfma_f32_16x16x32_bf16 v[232:235], a[116:119], a[52:55], v[232:235]
    s_xor_b32 m0, s59, 2048
    ds_read_b128 a[28:31], v11 offset:38912
    s_xor_b32 s7, s1, 65536
    v_mfma_f32_16x16x32_bf16 v[236:239], a[124:127], a[52:55], v[236:239]
    v_mfma_f32_16x16x32_bf16 v[236:239], a[120:123], a[48:51], v[236:239]
    v_mfma_f32_16x16x32_bf16 v[252:255], a[120:123], a[56:59], v[252:255]
    v_mfma_f32_16x16x32_bf16 v[252:255], a[124:127], a[60:63], v[252:255]
    buffer_load_dwordx4 v15, s[16:19], s7 offen  lds
    v_mfma_f32_16x16x32_bf16 v[248:251], a[116:119], a[60:63], v[248:251]
    s_xor_b32 m0, s58, 3072
    s_xor_b32 s7, s0, 24576
    v_mfma_f32_16x16x32_bf16 v[248:251], a[112:115], a[56:59], v[248:251]
    v_mfma_f32_16x16x32_bf16 v[244:247], a[104:107], a[56:59], v[244:247]
    v_mfma_f32_16x16x32_bf16 v[244:247], a[108:111], a[60:63], v[244:247]
    buffer_load_dwordx4 v13, s[12:15], s7 offen  lds
    v_mfma_f32_16x16x32_bf16 v[240:243], a[100:103], a[60:63], v[240:243]
    s_xor_b32 m0, s59, 3072
    s_xor_b32 s7, s1, 98304
    v_mfma_f32_16x16x32_bf16 v[240:243], a[96:99], a[56:59], v[240:243]
    v_mfma_f32_16x16x32_bf16 v[128:131], a[64:67], a[32:35], v[128:131]
    ds_read_b64_tr_b16 a[96:97], v6 offset:32768
    v_mfma_f32_16x16x32_bf16 v[128:131], a[68:71], a[36:39], v[128:131]
    buffer_load_dwordx4 v15, s[16:19], s7 offen  lds
    v_mfma_f32_16x16x32_bf16 v[132:135], a[76:79], a[36:39], v[132:135]
    s_xor_b32 m0, s58, 4096
    ds_read_b64_tr_b16 a[98:99], v6 offset:33792
    s_xor_b32 s7, s0, 32768
    v_mfma_f32_16x16x32_bf16 v[132:135], a[72:75], a[32:35], v[132:135]
    ds_read_b64_tr_b16 a[100:101], v6 offset:40960
    v_mfma_f32_16x16x32_bf16 v[136:139], a[80:83], a[32:35], v[136:139]
    ds_read_b64_tr_b16 a[102:103], v6 offset:41984
    v_mfma_f32_16x16x32_bf16 v[136:139], a[84:87], a[36:39], v[136:139]
    buffer_load_dwordx4 v12, s[12:15], s7 offen  lds
    v_mfma_f32_16x16x32_bf16 v[140:143], a[92:95], a[36:39], v[140:143]
    s_xor_b32 m0, s59, 4096
    ds_read_b64_tr_b16 a[104:105], v7 offset:32768
    s_xor_b32 s7, s1, 131072
    v_mfma_f32_16x16x32_bf16 v[140:143], a[88:91], a[32:35], v[140:143]
    ds_read_b64_tr_b16 a[106:107], v7 offset:33792
    v_mfma_f32_16x16x32_bf16 v[156:159], a[88:91], a[40:43], v[156:159]
    ds_read_b64_tr_b16 a[108:109], v7 offset:40960
    v_mfma_f32_16x16x32_bf16 v[156:159], a[92:95], a[44:47], v[156:159]
    ds_read_b64_tr_b16 a[110:111], v7 offset:41984
    v_mfma_f32_16x16x32_bf16 v[152:155], a[84:87], a[44:47], v[152:155]
    buffer_load_dwordx4 v14, s[16:19], s7 offen  lds
    v_mfma_f32_16x16x32_bf16 v[152:155], a[80:83], a[40:43], v[152:155]
    s_xor_b32 m0, s58, 5120
    s_xor_b32 s7, s0, 40960
    v_mfma_f32_16x16x32_bf16 v[148:151], a[72:75], a[40:43], v[148:151]
    ds_read_b64_tr_b16 a[112:113], v8 offset:32768
    v_mfma_f32_16x16x32_bf16 v[148:151], a[76:79], a[44:47], v[148:151]
    ds_read_b64_tr_b16 a[114:115], v8 offset:33792
    v_mfma_f32_16x16x32_bf16 v[144:147], a[68:71], a[44:47], v[144:147]
    buffer_load_dwordx4 v13, s[12:15], s7 offen  lds
    v_mfma_f32_16x16x32_bf16 v[144:147], a[64:67], a[40:43], v[144:147]
    s_xor_b32 m0, s59, 5120
    ds_read_b64_tr_b16 a[116:117], v8 offset:40960
    s_xor_b32 s7, s1, 163840
    v_mfma_f32_16x16x32_bf16 v[160:163], a[64:67], a[48:51], v[160:163]
    ds_read_b64_tr_b16 a[118:119], v8 offset:41984
    v_mfma_f32_16x16x32_bf16 v[160:163], a[68:71], a[52:55], v[160:163]
    ds_read_b64_tr_b16 a[120:121], v9 offset:32768
    v_mfma_f32_16x16x32_bf16 v[164:167], a[76:79], a[52:55], v[164:167]
    buffer_load_dwordx4 v14, s[16:19], s7 offen  lds
    v_mfma_f32_16x16x32_bf16 v[164:167], a[72:75], a[48:51], v[164:167]
    s_xor_b32 m0, s58, 6144
    ds_read_b64_tr_b16 a[122:123], v9 offset:33792
    s_xor_b32 s7, s0, 49152
    v_mfma_f32_16x16x32_bf16 v[168:171], a[80:83], a[48:51], v[168:171]
    ds_read_b64_tr_b16 a[124:125], v9 offset:40960
    v_mfma_f32_16x16x32_bf16 v[168:171], a[84:87], a[52:55], v[168:171]
    ds_read_b64_tr_b16 a[126:127], v9 offset:41984
    v_mfma_f32_16x16x32_bf16 v[172:175], a[92:95], a[52:55], v[172:175]
    buffer_load_dwordx4 v12, s[12:15], s7 offen  lds
    v_mfma_f32_16x16x32_bf16 v[172:175], a[88:91], a[48:51], v[172:175]
    s_xor_b32 m0, s59, 6144
    s_xor_b32 s7, s1, 196608
    v_mfma_f32_16x16x32_bf16 v[188:191], a[88:91], a[56:59], v[188:191]
    v_mfma_f32_16x16x32_bf16 v[188:191], a[92:95], a[60:63], v[188:191]
    v_mfma_f32_16x16x32_bf16 v[184:187], a[84:87], a[60:63], v[184:187]
    v_mfma_f32_16x16x32_bf16 v[184:187], a[80:83], a[56:59], v[184:187]
    buffer_load_dwordx4 v15, s[16:19], s7 offen  lds
    v_mfma_f32_16x16x32_bf16 v[180:183], a[72:75], a[56:59], v[180:183]
    s_xor_b32 m0, s58, 7168
    s_xor_b32 s7, s0, 57344
    v_mfma_f32_16x16x32_bf16 v[180:183], a[76:79], a[60:63], v[180:183]
    v_mfma_f32_16x16x32_bf16 v[176:179], a[68:71], a[60:63], v[176:179]
    v_mfma_f32_16x16x32_bf16 v[176:179], a[64:67], a[56:59], v[176:179]
    buffer_load_dwordx4 v13, s[12:15], s7 offen  lds
    s_waitcnt lgkmcnt(0)
    v_mfma_f32_16x16x32_bf16 a[128:131], a[96:99], a[0:3], a[128:131]
    s_xor_b32 m0, s59, 7168
    s_xor_b32 s7, s1, 229376
    v_mfma_f32_16x16x32_bf16 a[128:131], a[100:103], a[4:7], a[128:131]
    ds_read_b64_tr_b16 a[64:65], v2 offset:32768
    v_mfma_f32_16x16x32_bf16 a[132:135], a[108:111], a[4:7], a[132:135]
    ds_read_b64_tr_b16 a[66:67], v2 offset:33792
    v_mfma_f32_16x16x32_bf16 a[132:135], a[104:107], a[0:3], a[132:135]
    buffer_load_dwordx4 v15, s[16:19], s7 offen  lds
    v_mfma_f32_16x16x32_bf16 a[136:139], a[112:115], a[0:3], a[136:139]
    ds_read_b64_tr_b16 a[68:69], v2 offset:40960
    v_mfma_f32_16x16x32_bf16 a[136:139], a[116:119], a[4:7], a[136:139]
    ds_read_b64_tr_b16 a[70:71], v2 offset:41984
    v_mfma_f32_16x16x32_bf16 a[140:143], a[124:127], a[4:7], a[140:143]
    ds_read_b64_tr_b16 a[72:73], v3 offset:32768
    v_mfma_f32_16x16x32_bf16 a[140:143], a[120:123], a[0:3], a[140:143]
    buffer_load_dword v24, v23, s[48:51], 0 offen sc1
    v_mfma_f32_16x16x32_bf16 a[156:159], a[120:123], a[8:11], a[156:159]
    ds_read_b64_tr_b16 a[74:75], v3 offset:33792
    v_mfma_f32_16x16x32_bf16 a[156:159], a[124:127], a[12:15], a[156:159]
    ds_read_b64_tr_b16 a[76:77], v3 offset:40960
    v_mfma_f32_16x16x32_bf16 a[152:155], a[116:119], a[12:15], a[152:155]
    ds_read_b64_tr_b16 a[78:79], v3 offset:41984
    v_mfma_f32_16x16x32_bf16 a[152:155], a[112:115], a[8:11], a[152:155]
    v_mfma_f32_16x16x32_bf16 a[148:151], a[104:107], a[8:11], a[148:151]
    ds_read_b64_tr_b16 a[80:81], v4 offset:32768
    v_mfma_f32_16x16x32_bf16 a[148:151], a[108:111], a[12:15], a[148:151]
    ds_read_b64_tr_b16 a[82:83], v4 offset:33792
    v_mfma_f32_16x16x32_bf16 a[144:147], a[100:103], a[12:15], a[144:147]
    v_mfma_f32_16x16x32_bf16 a[144:147], a[96:99], a[8:11], a[144:147]
    s_add_u32 s7, s56, 896
    ds_read_b64_tr_b16 a[84:85], v4 offset:40960
    v_mfma_f32_16x16x32_bf16 v[32:35], a[96:99], a[16:19], v[32:35]
    buffer_load_dword v30, v16, s[12:15], s7 offen
    v_mfma_f32_16x16x32_bf16 v[32:35], a[100:103], a[20:23], v[32:35]
    s_add_u32 s7, s71, 3670016
    ds_read_b64_tr_b16 a[86:87], v4 offset:41984
    v_mfma_f32_16x16x32_bf16 v[36:39], a[108:111], a[20:23], v[36:39]
    ds_read_b64_tr_b16 a[88:89], v5 offset:32768
    v_mfma_f32_16x16x32_bf16 v[36:39], a[104:107], a[16:19], v[36:39]
    ds_read_b64_tr_b16 a[90:91], v5 offset:33792
    v_mfma_f32_16x16x32_bf16 v[40:43], a[112:115], a[16:19], v[40:43]
    buffer_load_dword v30, v17, s[16:19], s7 offen
    v_mfma_f32_16x16x32_bf16 v[40:43], a[116:119], a[20:23], v[40:43]
    s_add_u32 s0, s62, 1048576
    ds_read_b64_tr_b16 a[92:93], v5 offset:40960
    s_xor_b32 m0, s90, 131072
    v_mfma_f32_16x16x32_bf16 v[44:47], a[124:127], a[20:23], v[44:47]
    s_xor_b32 s7, s0, 0
    ds_read_b64_tr_b16 a[94:95], v5 offset:41984
    v_mfma_f32_16x16x32_bf16 v[44:47], a[120:123], a[16:19], v[44:47]
    v_mfma_f32_16x16x32_bf16 v[60:63], a[120:123], a[24:27], v[60:63]
    v_mfma_f32_16x16x32_bf16 v[60:63], a[124:127], a[28:31], v[60:63]
    buffer_load_dwordx4 v14, s[20:23], s7 offen lds
    v_mfma_f32_16x16x32_bf16 v[56:59], a[116:119], a[28:31], v[56:59]
    s_xor_b32 m0, s90, 132096
    s_xor_b32 s7, s0, 32768
    v_mfma_f32_16x16x32_bf16 v[56:59], a[112:115], a[24:27], v[56:59]
    v_mfma_f32_16x16x32_bf16 v[52:55], a[104:107], a[24:27], v[52:55]
    v_mfma_f32_16x16x32_bf16 v[52:55], a[108:111], a[28:31], v[52:55]
    buffer_load_dwordx4 v14, s[20:23], s7 offen lds
    v_mfma_f32_16x16x32_bf16 v[48:51], a[100:103], a[28:31], v[48:51]
    s_xor_b32 m0, s90, 133120
    s_xor_b32 s7, s0, 65536
    v_mfma_f32_16x16x32_bf16 v[48:51], a[96:99], a[24:27], v[48:51]
    s_waitcnt lgkmcnt(0)
    v_mfma_f32_16x16x32_bf16 v[64:67], a[64:67], a[0:3], v[64:67]
    ds_read_b128 a[32:35], v10 offset:40960
    v_mfma_f32_16x16x32_bf16 v[64:67], a[68:71], a[4:7], v[64:67]
    v_mfma_f32_16x16x32_bf16 v[68:71], a[76:79], a[4:7], v[68:71]
    buffer_load_dwordx4 v15, s[20:23], s7 offen lds
    v_mfma_f32_16x16x32_bf16 v[68:71], a[72:75], a[0:3], v[68:71]
    s_xor_b32 m0, s90, 134144
    ds_read_b128 a[36:39], v11 offset:40960
    s_xor_b32 s7, s0, 98304
    v_mfma_f32_16x16x32_bf16 v[72:75], a[80:83], a[0:3], v[72:75]
    v_mfma_f32_16x16x32_bf16 v[72:75], a[84:87], a[4:7], v[72:75]
    ds_read_b128 a[40:43], v10 offset:43008
    v_mfma_f32_16x16x32_bf16 v[76:79], a[92:95], a[4:7], v[76:79]
    v_mfma_f32_16x16x32_bf16 v[76:79], a[88:91], a[0:3], v[76:79]
    buffer_load_dwordx4 v15, s[20:23], s7 offen lds
    v_mfma_f32_16x16x32_bf16 v[92:95], a[88:91], a[8:11], v[92:95]
    s_add_u32 s0, s63, 352256
    s_add_u32 m0, s91, 131072
    s_add_u32 s7, s0, 0
    v_mfma_f32_16x16x32_bf16 v[92:95], a[92:95], a[12:15], v[92:95]
    ds_read_b128 a[44:47], v11 offset:43008
    v_mfma_f32_16x16x32_bf16 v[88:91], a[84:87], a[12:15], v[88:91]
    v_mfma_f32_16x16x32_bf16 v[88:91], a[80:83], a[8:11], v[88:91]
    buffer_load_dwordx4 v19, s[24:27], s7 offen lds
    v_mfma_f32_16x16x32_bf16 v[84:87], a[72:75], a[8:11], v[84:87]
    s_add_u32 m0, s91, 132096
    ds_read_b128 a[48:51], v10 offset:45056
    s_add_u32 s7, s0, 22016
    v_mfma_f32_16x16x32_bf16 v[84:87], a[76:79], a[12:15], v[84:87]
    ds_read_b128 a[52:55], v11 offset:45056
    v_mfma_f32_16x16x32_bf16 v[80:83], a[68:71], a[12:15], v[80:83]
    v_mfma_f32_16x16x32_bf16 v[80:83], a[64:67], a[8:11], v[80:83]
    v_mfma_f32_16x16x32_bf16 v[96:99], a[64:67], a[16:19], v[96:99]
    buffer_load_dwordx4 v20, s[24:27], s7 offen lds
    v_mfma_f32_16x16x32_bf16 v[96:99], a[68:71], a[20:23], v[96:99]
    s_add_u32 m0, s91, 139264
    ds_read_b128 a[56:59], v10 offset:47104
    s_add_u32 s7, s0, 0
    v_mfma_f32_16x16x32_bf16 v[100:103], a[76:79], a[20:23], v[100:103]
    v_mfma_f32_16x16x32_bf16 v[100:103], a[72:75], a[16:19], v[100:103]
    ds_read_b128 a[60:63], v11 offset:47104
    v_mfma_f32_16x16x32_bf16 v[104:107], a[80:83], a[16:19], v[104:107]
    buffer_load_dwordx4 v19, s[28:31], s7 offen lds
    v_mfma_f32_16x16x32_bf16 v[104:107], a[84:87], a[20:23], v[104:107]
    s_add_u32 m0, s91, 140288
    s_add_u32 s7, s0, 22016
    v_mfma_f32_16x16x32_bf16 v[108:111], a[92:95], a[20:23], v[108:111]
    v_mfma_f32_16x16x32_bf16 v[108:111], a[88:91], a[16:19], v[108:111]
    v_mfma_f32_16x16x32_bf16 v[124:127], a[88:91], a[24:27], v[124:127]
    v_mfma_f32_16x16x32_bf16 v[124:127], a[92:95], a[28:31], v[124:127]
    buffer_load_dwordx4 v20, s[28:31], s7 offen lds
    v_mfma_f32_16x16x32_bf16 v[120:123], a[84:87], a[28:31], v[120:123]
    v_mfma_f32_16x16x32_bf16 v[120:123], a[80:83], a[24:27], v[120:123]
    v_mfma_f32_16x16x32_bf16 v[116:119], a[72:75], a[24:27], v[116:119]
    v_mfma_f32_16x16x32_bf16 v[116:119], a[76:79], a[28:31], v[116:119]
    v_mfma_f32_16x16x32_bf16 v[112:115], a[68:71], a[28:31], v[112:115]
    v_mfma_f32_16x16x32_bf16 v[112:115], a[64:67], a[24:27], v[112:115]
    s_waitcnt lgkmcnt(0)
    v_mfma_f32_16x16x32_bf16 v[128:131], a[64:67], a[32:35], v[128:131]
    s_waitcnt vmcnt(10) lgkmcnt(0)
    s_barrier
    v_cmp_gt_u32 vcc, 32, v24
    s_cbranch_vccnz L_poll_xnK
L_back_xnK:
    v_mfma_f32_16x16x32_bf16 v[128:131], a[68:71], a[36:39], v[128:131]
    ds_read_b128 a[0:3], v10 offset:0
    v_mfma_f32_16x16x32_bf16 v[132:135], a[76:79], a[36:39], v[132:135]
    v_mfma_f32_16x16x32_bf16 v[132:135], a[72:75], a[32:35], v[132:135]
    s_add_u32 s0, s56, 896
    s_xor_b32 m0, s58, 32768
    s_xor_b32 s7, s0, 0
    v_mfma_f32_16x16x32_bf16 v[136:139], a[80:83], a[32:35], v[136:139]
    buffer_load_dwordx4 v12, s[12:15], s7 offen  lds
    v_mfma_f32_16x16x32_bf16 v[136:139], a[84:87], a[36:39], v[136:139]
    ds_read_b128 a[4:7], v11 offset:0
    v_bfe_u32 v28, v31, 2, 2
    v_mfma_f32_16x16x32_bf16 v[140:143], a[92:95], a[36:39], v[140:143]
    v_lshrrev_b32 v26, 4, v31
    v_lshl_add_u32 v27, v26, 3, v28
    v_mfma_f32_16x16x32_bf16 v[140:143], a[88:91], a[32:35], v[140:143]
    v_lshrrev_b32 v28, 1, v28
    v_and_b32 v26, 1, v26
    v_mfma_f32_16x16x32_bf16 v[156:159], a[88:91], a[40:43], v[156:159]
    v_lshl_add_u32 v26, v26, 1, v28
    v_lshlrev_b32 v26, 5, v26
    v_mfma_f32_16x16x32_bf16 v[156:159], a[92:95], a[44:47], v[156:159]
    v_lshl_add_u32 v26, v27, 7, v26
    v_and_b32 v16, 3, v31
    v_lshl_add_u32 v16, v16, 3, v26
    v_xor_b32 v17, 32, v16
    v_xor_b32 v18, 64, v16
    s_add_u32 s1, s57, 3670016
    s_xor_b32 m0, s59, 32768
    s_xor_b32 s7, s1, 0
    buffer_load_dwordx4 v14, s[16:19], s7 offen  lds
    v_mfma_f32_16x16x32_bf16 v[152:155], a[84:87], a[44:47], v[152:155]
    s_xor_b32 m0, s58, 33792
    ds_read_b128 a[8:11], v10 offset:2048
    s_xor_b32 s7, s0, 8192
    v_mfma_f32_16x16x32_bf16 v[152:155], a[80:83], a[40:43], v[152:155]
    ds_read_b128 a[12:15], v11 offset:2048
    v_mfma_f32_16x16x32_bf16 v[148:151], a[72:75], a[40:43], v[148:151]
    ds_read_b128 a[16:19], v10 offset:4096
    v_mfma_f32_16x16x32_bf16 v[148:151], a[76:79], a[44:47], v[148:151]
    buffer_load_dwordx4 v13, s[12:15], s7 offen  lds
    v_mfma_f32_16x16x32_bf16 v[144:147], a[68:71], a[44:47], v[144:147]
    s_xor_b32 m0, s59, 33792
    s_xor_b32 s7, s1, 32768
    v_mfma_f32_16x16x32_bf16 v[144:147], a[64:67], a[40:43], v[144:147]
    ds_read_b128 a[20:23], v11 offset:4096
    v_mfma_f32_16x16x32_bf16 v[160:163], a[64:67], a[48:51], v[160:163]
    v_mfma_f32_16x16x32_bf16 v[160:163], a[68:71], a[52:55], v[160:163]
    buffer_load_dwordx4 v14, s[16:19], s7 offen  lds
    v_mfma_f32_16x16x32_bf16 v[164:167], a[76:79], a[52:55], v[164:167]
    s_xor_b32 m0, s58, 34816
    ds_read_b128 a[24:27], v10 offset:6144
    s_xor_b32 s7, s0, 16384
    v_mfma_f32_16x16x32_bf16 v[164:167], a[72:75], a[48:51], v[164:167]
    v_mfma_f32_16x16x32_bf16 v[168:171], a[80:83], a[48:51], v[168:171]
    v_mfma_f32_16x16x32_bf16 v[168:171], a[84:87], a[52:55], v[168:171]
    ds_read_b128 a[28:31], v11 offset:6144
    v_mfma_f32_16x16x32_bf16 v[172:175], a[92:95], a[52:55], v[172:175]
    buffer_load_dwordx4 v12, s[12:15], s7 offen  lds
    v_mfma_f32_16x16x32_bf16 v[172:175], a[88:91], a[48:51], v[172:175]
    s_xor_b32 m0, s59, 34816
    s_xor_b32 s7, s1, 65536
    v_mfma_f32_16x16x32_bf16 v[188:191], a[88:91], a[56:59], v[188:191]
    v_mfma_f32_16x16x32_bf16 v[188:191], a[92:95], a[60:63], v[188:191]
    v_mfma_f32_16x16x32_bf16 v[184:187], a[84:87], a[60:63], v[184:187]
    buffer_load_dwordx4 v15, s[16:19], s7 offen  lds
    v_mfma_f32_16x16x32_bf16 v[184:187], a[80:83], a[56:59], v[184:187]
    s_xor_b32 m0, s58, 35840
    s_xor_b32 s7, s0, 24576
    v_mfma_f32_16x16x32_bf16 v[180:183], a[72:75], a[56:59], v[180:183]
    v_mfma_f32_16x16x32_bf16 v[180:183], a[76:79], a[60:63], v[180:183]
    v_mfma_f32_16x16x32_bf16 v[176:179], a[68:71], a[60:63], v[176:179]
    v_mfma_f32_16x16x32_bf16 v[176:179], a[64:67], a[56:59], v[176:179]
    buffer_load_dwordx4 v13, s[12:15], s7 offen  lds
    v_mfma_f32_16x16x32_bf16 v[192:195], a[96:99], a[32:35], v[192:195]
    s_xor_b32 m0, s59, 35840
    s_xor_b32 s7, s1, 98304
    v_mfma_f32_16x16x32_bf16 v[192:195], a[100:103], a[36:39], v[192:195]
    ds_read_b64_tr_b16 a[64:65], v2 offset:0
    v_mfma_f32_16x16x32_bf16 v[196:199], a[108:111], a[36:39], v[196:199]
    ds_read_b64_tr_b16 a[66:67], v2 offset:1024
    v_mfma_f32_16x16x32_bf16 v[196:199], a[104:107], a[32:35], v[196:199]
    buffer_load_dwordx4 v15, s[16:19], s7 offen  lds
    v_mfma_f32_16x16x32_bf16 v[200:203], a[112:115], a[32:35], v[200:203]
    s_xor_b32 m0, s58, 36864
    ds_read_b64_tr_b16 a[68:69], v2 offset:8192
    s_xor_b32 s7, s0, 32768
    v_mfma_f32_16x16x32_bf16 v[200:203], a[116:119], a[36:39], v[200:203]
    ds_read_b64_tr_b16 a[70:71], v2 offset:9216
    v_mfma_f32_16x16x32_bf16 v[204:207], a[124:127], a[36:39], v[204:207]
    ds_read_b64_tr_b16 a[72:73], v3 offset:0
    v_mfma_f32_16x16x32_bf16 v[204:207], a[120:123], a[32:35], v[204:207]
    ds_read_b64_tr_b16 a[74:75], v3 offset:1024
    v_mfma_f32_16x16x32_bf16 v[220:223], a[120:123], a[40:43], v[220:223]
    buffer_load_dwordx4 v12, s[12:15], s7 offen  lds
    v_mfma_f32_16x16x32_bf16 v[220:223], a[124:127], a[44:47], v[220:223]
    s_xor_b32 m0, s59, 36864
    ds_read_b64_tr_b16 a[76:77], v3 offset:8192
    s_xor_b32 s7, s1, 131072
    v_mfma_f32_16x16x32_bf16 v[216:219], a[116:119], a[44:47], v[216:219]
L_tp3:
    s_cbranch_execz L_tp7
    ds_read_b64_tr_b16 a[78:79], v3 offset:9216
    v_mfma_f32_16x16x32_bf16 v[216:219], a[112:115], a[40:43], v[216:219]
    ds_read_b64_tr_b16 a[80:81], v4 offset:0
    v_mfma_f32_16x16x32_bf16 v[212:215], a[104:107], a[40:43], v[212:215]
    buffer_load_dwordx4 v14, s[16:19], s7 offen  lds
    v_mfma_f32_16x16x32_bf16 v[212:215], a[108:111], a[44:47], v[212:215]
    s_xor_b32 m0, s58, 37888
    ds_read_b64_tr_b16 a[82:83], v4 offset:1024
    s_xor_b32 s7, s0, 40960
    v_mfma_f32_16x16x32_bf16 v[208:211], a[100:103], a[44:47], v[208:211]
    ds_read_b64_tr_b16 a[84:85], v4 offset:8192
    v_mfma_f32_16x16x32_bf16 v[208:211], a[96:99], a[40:43], v[208:211]
    ds_read_b64_tr_b16 a[86:87], v4 offset:9216
    v_mfma_f32_16x16x32_bf16 v[224:227], a[96:99], a[48:51], v[224:227]
    ds_read_b64_tr_b16 a[88:89], v5 offset:0
    v_mfma_f32_16x16x32_bf16 v[224:227], a[100:103], a[52:55], v[224:227]
    buffer_load_dwordx4 v13, s[12:15], s7 offen  lds
    v_mfma_f32_16x16x32_bf16 v[228:231], a[108:111], a[52:55], v[228:231]
    s_xor_b32 m0, s59, 37888
    ds_read_b64_tr_b16 a[90:91], v5 offset:1024
    s_xor_b32 s7, s1, 163840
    v_mfma_f32_16x16x32_bf16 v[228:231], a[104:107], a[48:51], v[228:231]
    ds_read_b64_tr_b16 a[92:93], v5 offset:8192
    v_mfma_f32_16x16x32_bf16 v[232:235], a[112:115], a[48:51], v[232:235]
    ds_read_b64_tr_b16 a[94:95], v5 offset:9216
    v_mfma_f32_16x16x32_bf16 v[232:235], a[116:119], a[52:55], v[232:235]
    buffer_load_dwordx4 v14, s[16:19], s7 offen  lds
    v_mfma_f32_16x16x32_bf16 v[236:239], a[124:127], a[52:55], v[236:239]
    s_xor_b32 m0, s58, 38912
    s_xor_b32 s7, s0, 49152
    v_mfma_f32_16x16x32_bf16 v[236:239], a[120:123], a[48:51], v[236:239]
    v_mfma_f32_16x16x32_bf16 v[252:255], a[120:123], a[56:59], v[252:255]
    v_mfma_f32_16x16x32_bf16 v[252:255], a[124:127], a[60:63], v[252:255]
    v_mfma_f32_16x16x32_bf16 v[248:251], a[116:119], a[60:63], v[248:251]
    buffer_load_dwordx4 v12, s[12:15], s7 offen  lds
    v_mfma_f32_16x16x32_bf16 v[248:251], a[112:115], a[56:59], v[248:251]
    s_xor_b32 m0, s59, 38912
    s_xor_b32 s7, s1, 196608
    v_mfma_f32_16x16x32_bf16 v[244:247], a[104:107], a[56:59], v[244:247]
    v_mfma_f32_16x16x32_bf16 v[244:247], a[108:111], a[60:63], v[244:247]
    v_mfma_f32_16x16x32_bf16 v[240:243], a[100:103], a[60:63], v[240:243]
    buffer_load_dwordx4 v15, s[16:19], s7 offen  lds
    v_mfma_f32_16x16x32_bf16 v[240:243], a[96:99], a[56:59], v[240:243]
    s_xor_b32 m0, s58, 39936
    s_xor_b32 s7, s0, 57344
    s_waitcnt lgkmcnt(0)
    v_mfma_f32_16x16x32_bf16 v[64:67], a[64:67], a[0:3], v[64:67]
    ds_read_b64_tr_b16 a[96:97], v6 offset:0
    v_mfma_f32_16x16x32_bf16 v[64:67], a[68:71], a[4:7], v[64:67]
    ds_read_b64_tr_b16 a[98:99], v6 offset:1024
    v_mfma_f32_16x16x32_bf16 v[68:71], a[76:79], a[4:7], v[68:71]
    v_mfma_f32_16x16x32_bf16 v[68:71], a[72:75], a[0:3], v[68:71]
    buffer_load_dwordx4 v13, s[12:15], s7 offen  lds
    v_mfma_f32_16x16x32_bf16 v[72:75], a[80:83], a[0:3], v[72:75]
    s_xor_b32 m0, s59, 39936
    ds_read_b64_tr_b16 a[100:101], v6 offset:8192
    s_xor_b32 s7, s1, 229376
    v_mfma_f32_16x16x32_bf16 v[72:75], a[84:87], a[4:7], v[72:75]
    ds_read_b64_tr_b16 a[102:103], v6 offset:9216
    v_mfma_f32_16x16x32_bf16 v[76:79], a[92:95], a[4:7], v[76:79]
    ds_read_b64_tr_b16 a[104:105], v7 offset:0
    v_mfma_f32_16x16x32_bf16 v[76:79], a[88:91], a[0:3], v[76:79]
    buffer_load_dwordx4 v15, s[16:19], s7 offen  lds
    v_mfma_f32_16x16x32_bf16 v[92:95], a[88:91], a[8:11], v[92:95]
    ds_read_b64_tr_b16 a[106:107], v7 offset:1024
    v_mfma_f32_16x16x32_bf16 v[92:95], a[92:95], a[12:15], v[92:95]
    ds_read_b64_tr_b16 a[108:109], v7 offset:8192
    v_mfma_f32_16x16x32_bf16 v[88:91], a[84:87], a[12:15], v[88:91]
    ds_read_b64_tr_b16 a[110:111], v7 offset:9216
    v_mfma_f32_16x16x32_bf16 v[88:91], a[80:83], a[8:11], v[88:91]
    v_mfma_f32_16x16x32_bf16 v[84:87], a[72:75], a[8:11], v[84:87]
    ds_read_b64_tr_b16 a[112:113], v8 offset:0
    v_mfma_f32_16x16x32_bf16 v[84:87], a[76:79], a[12:15], v[84:87]
    ds_read_b64_tr_b16 a[114:115], v8 offset:1024
    v_mfma_f32_16x16x32_bf16 v[80:83], a[68:71], a[12:15], v[80:83]
    v_mfma_f32_16x16x32_bf16 v[80:83], a[64:67], a[8:11], v[80:83]
    s_lshr_b32 s7, s2, 3
    v_lshlrev_b32 v28, 5, v0
    v_add_u32 v28, s7, v28
    v_mfma_f32_16x16x32_bf16 v[96:99], a[64:67], a[16:19], v[96:99]
    v_lshlrev_b32 v28, 7, v28
    v_min_u32 v28, L_tail2-L_B, v28
    v_mfma_f32_16x16x32_bf16 v[96:99], a[68:71], a[20:23], v[96:99]
    v_add_u32 v28, L_B-L_pc, v28
    global_load_dword v30, v28, s[100:101]
    v_mfma_f32_16x16x32_bf16 v[100:103], a[76:79], a[20:23], v[100:103]
    s_add_u32 s0, s61, 0
    ds_read_b64_tr_b16 a[116:117], v8 offset:8192
    s_add_u32 s7, s0, 0
    v_mfma_f32_16x16x32_bf16 v[100:103], a[72:75], a[16:19], v[100:103]
    ds_read_b64_tr_b16 a[118:119], v8 offset:9216
    v_mfma_f32_16x16x32_bf16 v[104:107], a[80:83], a[16:19], v[104:107]
    ds_read_b64_tr_b16 a[120:121], v9 offset:0
    v_mfma_f32_16x16x32_bf16 v[104:107], a[84:87], a[20:23], v[104:107]
    buffer_load_dwordx4 a[160:163], v1, s[8:11], s7 offen offset:0 sc1
    v_mfma_f32_16x16x32_bf16 v[108:111], a[92:95], a[20:23], v[108:111]
    ds_read_b64_tr_b16 a[122:123], v9 offset:1024
    v_mfma_f32_16x16x32_bf16 v[108:111], a[88:91], a[16:19], v[108:111]
    ds_read_b64_tr_b16 a[124:125], v9 offset:8192
    v_mfma_f32_16x16x32_bf16 v[124:127], a[88:91], a[24:27], v[124:127]
    ds_read_b64_tr_b16 a[126:127], v9 offset:9216
    v_mfma_f32_16x16x32_bf16 v[124:127], a[92:95], a[28:31], v[124:127]
    v_mfma_f32_16x16x32_bf16 v[120:123], a[84:87], a[28:31], v[120:123]
    buffer_load_dwordx4 a[164:167], v1, s[8:11], s7 offen offset:1024 sc1
    v_mfma_f32_16x16x32_bf16 v[120:123], a[80:83], a[24:27], v[120:123]
    v_mfma_f32_16x16x32_bf16 v[116:119], a[72:75], a[24:27], v[116:119]
    s_add_u32 s7, s0, 16384
    v_mfma_f32_16x16x32_bf16 v[116:119], a[76:79], a[28:31], v[116:119]
    v_mfma_f32_16x16x32_bf16 v[112:115], a[68:71], a[28:31], v[112:115]
    v_mfma_f32_16x16x32_bf16 v[112:115], a[64:67], a[24:27], v[112:115]
    buffer_load_dwordx4 a[168:171], v1, s[8:11], s7 offen offset:0 sc1
    s_waitcnt lgkmcnt(1)
    v_mfma_f32_16x16x32_bf16 a[128:131], a[96:99], a[0:3], a[128:131]
    ds_read_b128 a[32:35], v10 offset:8192
    v_mfma_f32_16x16x32_bf16 a[128:131], a[100:103], a[4:7], a[128:131]
    v_mfma_f32_16x16x32_bf16 a[132:135], a[108:111], a[4:7], a[132:135]
    ds_read_b128 a[36:39], v11 offset:8192
    v_mfma_f32_16x16x32_bf16 a[132:135], a[104:107], a[0:3], a[132:135]
    v_mfma_f32_16x16x32_bf16 a[136:139], a[112:115], a[0:3], a[136:139]
    buffer_load_dwordx4 a[172:175], v1, s[8:11], s7 offen offset:1024 sc1
    v_mfma_f32_16x16x32_bf16 a[136:139], a[116:119], a[4:7], a[136:139]
    ds_read_b128 a[40:43], v10 offset:10240
    s_waitcnt lgkmcnt(3)
    v_mfma_f32_16x16x32_bf16 a[140:143], a[124:127], a[4:7], a[140:143]
    s_add_u32 s7, s0, 32768
    v_mfma_f32_16x16x32_bf16 a[140:143], a[120:123], a[0:3], a[140:143]
    v_mfma_f32_16x16x32_bf16 a[156:159], a[120:123], a[8:11], a[156:159]
    ds_read_b128 a[44:47], v11 offset:10240
    v_mfma_f32_16x16x32_bf16 a[156:159], a[124:127], a[12:15], a[156:159]
    buffer_load_dwordx4 a[176:179], v1, s[8:11], s7 offen offset:0 sc1
    v_mfma_f32_16x16x32_bf16 a[152:155], a[116:119], a[12:15], a[152:155]
    v_mfma_f32_16x16x32_bf16 a[152:155], a[112:115], a[8:11], a[152:155]
    ds_read_b128 a[48:51], v10 offset:12288
    v_mfma_f32_16x16x32_bf16 a[148:151], a[104:107], a[8:11], a[148:151]
    v_mfma_f32_16x16x32_bf16 a[148:151], a[108:111], a[12:15], a[148:151]
    ds_read_b128 a[52:55], v11 offset:12288
    v_mfma_f32_16x16x32_bf16 a[144:147], a[100:103], a[12:15], a[144:147]
    buffer_load_dwordx4 a[180:183], v1, s[8:11], s7 offen offset:1024 sc1
    v_mfma_f32_16x16x32_bf16 a[144:147], a[96:99], a[8:11], a[144:147]
    v_mfma_f32_16x16x32_bf16 v[32:35], a[96:99], a[16:19], v[32:35]
    s_add_u32 s7, s0, 49152
    ds_read_b128 a[56:59], v10 offset:14336
    v_mfma_f32_16x16x32_bf16 v[32:35], a[100:103], a[20:23], v[32:35]
    v_mfma_f32_16x16x32_bf16 v[36:39], a[108:111], a[20:23], v[36:39]
    v_mfma_f32_16x16x32_bf16 v[36:39], a[104:107], a[16:19], v[36:39]
    buffer_load_dwordx4 a[184:187], v1, s[8:11], s7 offen offset:0 sc1
    v_mfma_f32_16x16x32_bf16 v[40:43], a[112:115], a[16:19], v[40:43]
    ds_read_b128 a[60:63], v11 offset:14336
    v_mfma_f32_16x16x32_bf16 v[40:43], a[116:119], a[20:23], v[40:43]
    v_mfma_f32_16x16x32_bf16 v[44:47], a[124:127], a[20:23], v[44:47]
    v_mfma_f32_16x16x32_bf16 v[44:47], a[120:123], a[16:19], v[44:47]
    v_mfma_f32_16x16x32_bf16 v[60:63], a[120:123], a[24:27], v[60:63]
    buffer_load_dwordx4 a[188:191], v1, s[8:11], s7 offen offset:1024 sc1
    v_mfma_f32_16x16x32_bf16 v[60:63], a[124:127], a[28:31], v[60:63]
    v_mfma_f32_16x16x32_bf16 v[56:59], a[116:119], a[28:31], v[56:59]
    v_mfma_f32_16x16x32_bf16 v[56:59], a[112:115], a[24:27], v[56:59]
    v_mfma_f32_16x16x32_bf16 v[52:55], a[104:107], a[24:27], v[52:55]
    v_mfma_f32_16x16x32_bf16 v[52:55], a[108:111], a[28:31], v[52:55]
    v_mfma_f32_16x16x32_bf16 v[48:51], a[100:103], a[28:31], v[48:51]
    v_mfma_f32_16x16x32_bf16 v[48:51], a[96:99], a[24:27], v[48:51]
    s_waitcnt lgkmcnt(0)
    v_mfma_f32_16x16x32_bf16 v[192:195], a[96:99], a[32:35], v[192:195]
    s_waitcnt vmcnt(9) lgkmcnt(0)
    s_barrier
    v_mfma_f32_16x16x32_bf16 v[192:195], a[100:103], a[36:39], v[192:195]
    ds_read_b128 a[0:3], v10 offset:32768
    v_mfma_f32_16x16x32_bf16 v[196:199], a[108:111], a[36:39], v[196:199]
    v_mfma_f32_16x16x32_bf16 v[196:199], a[104:107], a[32:35], v[196:199]
    s_add_u32 s0, s62, 0
    s_xor_b32 m0, s90, 0
    s_xor_b32 s7, s0, 0
    v_mfma_f32_16x16x32_bf16 v[200:203], a[112:115], a[32:35], v[200:203]
    buffer_load_dwordx4 v14, s[20:23], s7 offen lds
    v_mfma_f32_16x16x32_bf16 v[200:203], a[116:119], a[36:39], v[200:203]
    s_xor_b32 m0, s90, 1024
    ds_read_b128 a[4:7], v11 offset:32768
    s_xor_b32 s7, s0, 32768
    v_mfma_f32_16x16x32_bf16 v[204:207], a[124:127], a[36:39], v[204:207]
    ds_read_b128 a[8:11], v10 offset:34816
    v_mfma_f32_16x16x32_bf16 v[204:207], a[120:123], a[32:35], v[204:207]
    v_mfma_f32_16x16x32_bf16 v[220:223], a[120:123], a[40:43], v[220:223]
    buffer_load_dwordx4 v14, s[20:23], s7 offen lds
    v_mfma_f32_16x16x32_bf16 v[220:223], a[124:127], a[44:47], v[220:223]
    s_xor_b32 m0, s90, 2048
    s_xor_b32 s7, s0, 65536
    v_mfma_f32_16x16x32_bf16 v[216:219], a[116:119], a[44:47], v[216:219]
    ds_read_b128 a[12:15], v11 offset:34816
    v_mfma_f32_16x16x32_bf16 v[216:219], a[112:115], a[40:43], v[216:219]
    v_mfma_f32_16x16x32_bf16 v[212:215], a[104:107], a[40:43], v[212:215]
    buffer_load_dwordx4 v15, s[20:23], s7 offen lds
    v_mfma_f32_16x16x32_bf16 v[212:215], a[108:111], a[44:47], v[212:215]
    s_xor_b32 m0, s90, 3072
    ds_read_b128 a[16:19], v10 offset:36864
    s_xor_b32 s7, s0, 98304
    v_mfma_f32_16x16x32_bf16 v[208:211], a[100:103], a[44:47], v[208:211]
    v_mfma_f32_16x16x32_bf16 v[208:211], a[96:99], a[40:43], v[208:211]
    ds_read_b128 a[20:23], v11 offset:36864
    v_mfma_f32_16x16x32_bf16 v[224:227], a[96:99], a[48:51], v[224:227]
    v_mfma_f32_16x16x32_bf16 v[224:227], a[100:103], a[52:55], v[224:227]
    buffer_load_dwordx4 v15, s[20:23], s7 offen lds
    v_mfma_f32_16x16x32_bf16 v[228:231], a[108:111], a[52:55], v[228:231]
    s_add_u32 s0, s63, 0
    s_add_u32 m0, s91, 0
    s_add_u32 s7, s0, 0
    v_mfma_f32_16x16x32_bf16 v[228:231], a[104:107], a[48:51], v[228:231]
    ds_read_b128 a[24:27], v10 offset:38912
    v_mfma_f32_16x16x32_bf16 v[232:235], a[112:115], a[48:51], v[232:235]
    v_mfma_f32_16x16x32_bf16 v[232:235], a[116:119], a[52:55], v[232:235]
    buffer_load_dwordx4 v19, s[24:27], s7 offen lds
    v_mfma_f32_16x16x32_bf16 v[236:239], a[124:127], a[52:55], v[236:239]
    s_add_u32 m0, s91, 1024
    ds_read_b128 a[28:31], v11 offset:38912
    s_add_u32 s7, s0, 22016
    v_mfma_f32_16x16x32_bf16 v[236:239], a[120:123], a[48:51], v[236:239]
    v_mfma_f32_16x16x32_bf16 v[252:255], a[120:123], a[56:59], v[252:255]
    v_mfma_f32_16x16x32_bf16 v[252:255], a[124:127], a[60:63], v[252:255]
    buffer_load_dwordx4 v20, s[24:27], s7 offen lds
    v_mfma_f32_16x16x32_bf16 v[248:251], a[116:119], a[60:63], v[248:251]
    s_add_u32 m0, s91, 8192
    s_add_u32 s7, s0, 0
    v_mfma_f32_16x16x32_bf16 v[248:251], a[112:115], a[56:59], v[248:251]
    v_mfma_f32_16x16x32_bf16 v[244:247], a[104:107], a[56:59], v[244:247]
    v_mfma_f32_16x16x32_bf16 v[244:247], a[108:111], a[60:63], v[244:247]
    v_mfma_f32_16x16x32_bf16 v[240:243], a[100:103], a[60:63], v[240:243]
    buffer_load_dwordx4 v19, s[28:31], s7 offen lds
    v_mfma_f32_16x16x32_bf16 v[240:243], a[96:99], a[56:59], v[240:243]
    s_add_u32 m0, s91, 9216
    s_add_u32 s7, s0, 22016
    v_mfma_f32_16x16x32_bf16 v[128:131], a[64:67], a[32:35], v[128:131]
    ds_read_b64_tr_b16 a[96:97], v6 offset:32768
    v_mfma_f32_16x16x32_bf16 v[128:131], a[68:71], a[36:39], v[128:131]
    ds_read_b64_tr_b16 a[98:99], v6 offset:33792
    v_mfma_f32_16x16x32_bf16 v[132:135], a[76:79], a[36:39], v[132:135]
    buffer_load_dwordx4 v20, s[28:31], s7 offen lds
    v_mfma_f32_16x16x32_bf16 v[132:135], a[72:75], a[32:35], v[132:135]
    s_add_u32 s0, s61, 2048
    ds_read_b64_tr_b16 a[100:101], v6 offset:40960
    s_add_u32 s7, s0, 0
    v_mfma_f32_16x16x32_bf16 v[136:139], a[80:83], a[32:35], v[136:139]
    ds_read_b64_tr_b16 a[102:103], v6 offset:41984
    v_mfma_f32_16x16x32_bf16 v[136:139], a[84:87], a[36:39], v[136:139]
    ds_read_b64_tr_b16 a[104:105], v7 offset:32768
    v_mfma_f32_16x16x32_bf16 v[140:143], a[92:95], a[36:39], v[140:143]
    buffer_load_dwordx4 a[192:195], v1, s[8:11], s7 offen offset:0 sc1
    v_mfma_f32_16x16x32_bf16 v[140:143], a[88:91], a[32:35], v[140:143]
    ds_read_b64_tr_b16 a[106:107], v7 offset:33792
    v_mfma_f32_16x16x32_bf16 v[156:159], a[88:91], a[40:43], v[156:159]
    ds_read_b64_tr_b16 a[108:109], v7 offset:40960
    v_mfma_f32_16x16x32_bf16 v[156:159], a[92:95], a[44:47], v[156:159]
    ds_read_b64_tr_b16 a[110:111], v7 offset:41984
    v_mfma_f32_16x16x32_bf16 v[152:155], a[84:87], a[44:47], v[152:155]
    v_mfma_f32_16x16x32_bf16 v[152:155], a[80:83], a[40:43], v[152:155]
    buffer_load_dwordx4 a[196:199], v1, s[8:11], s7 offen offset:1024 sc1
    v_mfma_f32_16x16x32_bf16 v[148:151], a[72:75], a[40:43], v[148:151]
    s_add_u32 s7, s0, 16384
    ds_read_b64_tr_b16 a[112:113], v8 offset:32768
    v_mfma_f32_16x16x32_bf16 v[148:151], a[76:79], a[44:47], v[148:151]
    ds_read_b64_tr_b16 a[114:115], v8 offset:33792
    v_mfma_f32_16x16x32_bf16 v[144:147], a[68:71], a[44:47], v[144:147]
    ds_read_b64_tr_b16 a[116:117], v8 offset:40960
    v_mfma_f32_16x16x32_bf16 v[144:147], a[64:67], a[40:43], v[144:147]
    buffer_load_dwordx4 a[200:203], v1, s[8:11], s7 offen offset:0 sc1
    v_mfma_f32_16x16x32_bf16 v[160:163], a[64:67], a[48:51], v[160:163]
    ds_read_b64_tr_b16 a[118:119], v8 offset:41984
    v_mfma_f32_16x16x32_bf16 v[160:163], a[68:71], a[52:55], v[160:163]
    ds_read_b64_tr_b16 a[120:121], v9 offset:32768
    v_mfma_f32_16x16x32_bf16 v[164:167], a[76:79], a[52:55], v[164:167]
    ds_read_b64_tr_b16 a[122:123], v9 offset:33792
    v_mfma_f32_16x16x32_bf16 v[164:167], a[72:75], a[48:51], v[164:167]
    buffer_load_dwordx4 a[204:207], v1, s[8:11], s7 offen offset:1024 sc1
    v_mfma_f32_16x16x32_bf16 v[168:171], a[80:83], a[48:51], v[168:171]
    ds_read_b64_tr_b16 a[124:125], v9 offset:40960
    v_mfma_f32_16x16x32_bf16 v[168:171], a[84:87], a[52:55], v[168:171]
    s_add_u32 s7, s0, 32768
    ds_read_b64_tr_b16 a[126:127], v9 offset:41984
    v_mfma_f32_16x16x32_bf16 v[172:175], a[92:95], a[52:55], v[172:175]
    v_mfma_f32_16x16x32_bf16 v[172:175], a[88:91], a[48:51], v[172:175]
    v_mfma_f32_16x16x32_bf16 v[188:191], a[88:91], a[56:59], v[188:191]
    buffer_load_dwordx4 a[208:211], v1, s[8:11], s7 offen offset:0 sc1
    v_mfma_f32_16x16x32_bf16 v[188:191], a[92:95], a[60:63], v[188:191]
    v_mfma_f32_16x16x32_bf16 v[184:187], a[84:87], a[60:63], v[184:187]
    v_mfma_f32_16x16x32_bf16 v[184:187], a[80:83], a[56:59], v[184:187]
    v_mfma_f32_16x16x32_bf16 v[180:183], a[72:75], a[56:59], v[180:183]
    buffer_load_dwordx4 a[212:215], v1, s[8:11], s7 offen offset:1024 sc1
    v_mfma_f32_16x16x32_bf16 v[180:183], a[76:79], a[60:63], v[180:183]
    s_add_u32 s7, s0, 49152
    v_mfma_f32_16x16x32_bf16 v[176:179], a[68:71], a[60:63], v[176:179]
    v_mfma_f32_16x16x32_bf16 v[176:179], a[64:67], a[56:59], v[176:179]
    s_waitcnt lgkmcnt(0)
    v_mfma_f32_16x16x32_bf16 a[128:131], a[96:99], a[0:3], a[128:131]
    buffer_load_dwordx4 a[216:219], v1, s[8:11], s7 offen offset:0 sc1
    v_mfma_f32_16x16x32_bf16 a[128:131], a[100:103], a[4:7], a[128:131]
    ds_read_b64_tr_b16 a[64:65], v2 offset:32768
    v_mfma_f32_16x16x32_bf16 a[132:135], a[108:111], a[4:7], a[132:135]
    ds_read_b64_tr_b16 a[66:67], v2 offset:33792
    v_mfma_f32_16x16x32_bf16 a[132:135], a[104:107], a[0:3], a[132:135]
    ds_read_b64_tr_b16 a[68:69], v2 offset:40960
    v_mfma_f32_16x16x32_bf16 a[136:139], a[112:115], a[0:3], a[136:139]
    ds_read_b64_tr_b16 a[70:71], v2 offset:41984
    v_mfma_f32_16x16x32_bf16 a[136:139], a[116:119], a[4:7], a[136:139]
    buffer_load_dwordx4 a[220:223], v1, s[8:11], s7 offen offset:1024 sc1
    v_mfma_f32_16x16x32_bf16 a[140:143], a[124:127], a[4:7], a[140:143]
    s_add_u32 s0, s61, 4096
    s_add_u32 s7, s0, 0
    v_mfma_f32_16x16x32_bf16 a[140:143], a[120:123], a[0:3], a[140:143]
    ds_read_b64_tr_b16 a[72:73], v3 offset:32768
    v_mfma_f32_16x16x32_bf16 a[156:159], a[120:123], a[8:11], a[156:159]
    ds_read_b64_tr_b16 a[74:75], v3 offset:33792
    v_mfma_f32_16x16x32_bf16 a[156:159], a[124:127], a[12:15], a[156:159]
    buffer_load_dwordx4 a[224:227], v1, s[8:11], s7 offen offset:0 sc1
    v_mfma_f32_16x16x32_bf16 a[152:155], a[116:119], a[12:15], a[152:155]
    ds_read_b64_tr_b16 a[76:77], v3 offset:40960
    v_mfma_f32_16x16x32_bf16 a[152:155], a[112:115], a[8:11], a[152:155]
    ds_read_b64_tr_b16 a[78:79], v3 offset:41984
    v_mfma_f32_16x16x32_bf16 a[148:151], a[104:107], a[8:11], a[148:151]
    ds_read_b64_tr_b16 a[80:81], v4 offset:32768
    v_mfma_f32_16x16x32_bf16 a[148:151], a[108:111], a[12:15], a[148:151]
    buffer_load_dwordx4 a[228:231], v1, s[8:11], s7 offen offset:1024 sc1
    v_mfma_f32_16x16x32_bf16 a[144:147], a[100:103], a[12:15], a[144:147]
    ds_read_b64_tr_b16 a[82:83], v4 offset:33792
    v_mfma_f32_16x16x32_bf16 a[144:147], a[96:99], a[8:11], a[144:147]
    s_add_u32 s7, s0, 16384
    ds_read_b64_tr_b16 a[84:85], v4 offset:40960
    v_mfma_f32_16x16x32_bf16 v[32:35], a[96:99], a[16:19], v[32:35]
    ds_read_b64_tr_b16 a[86:87], v4 offset:41984
    v_mfma_f32_16x16x32_bf16 v[32:35], a[100:103], a[20:23], v[32:35]
    v_mfma_f32_16x16x32_bf16 v[36:39], a[108:111], a[20:23], v[36:39]
    buffer_load_dwordx4 a[232:235], v1, s[8:11], s7 offen offset:0 sc1
    v_mfma_f32_16x16x32_bf16 v[36:39], a[104:107], a[16:19], v[36:39]
    ds_read_b64_tr_b16 a[88:89], v5 offset:32768
    v_mfma_f32_16x16x32_bf16 v[40:43], a[112:115], a[16:19], v[40:43]
    ds_read_b64_tr_b16 a[90:91], v5 offset:33792
    v_mfma_f32_16x16x32_bf16 v[40:43], a[116:119], a[20:23], v[40:43]
    ds_read_b64_tr_b16 a[92:93], v5 offset:40960
    v_mfma_f32_16x16x32_bf16 v[44:47], a[124:127], a[20:23], v[44:47]
    buffer_load_dwordx4 a[236:239], v1, s[8:11], s7 offen offset:1024 sc1
    v_mfma_f32_16x16x32_bf16 v[44:47], a[120:123], a[16:19], v[44:47]
    s_add_u32 s7, s0, 32768
    ds_read_b64_tr_b16 a[94:95], v5 offset:41984
    v_mfma_f32_16x16x32_bf16 v[60:63], a[120:123], a[24:27], v[60:63]
    v_mfma_f32_16x16x32_bf16 v[60:63], a[124:127], a[28:31], v[60:63]
    v_mfma_f32_16x16x32_bf16 v[56:59], a[116:119], a[28:31], v[56:59]
    buffer_load_dwordx4 a[240:243], v1, s[8:11], s7 offen offset:0 sc1
    v_mfma_f32_16x16x32_bf16 v[56:59], a[112:115], a[24:27], v[56:59]
    v_mfma_f32_16x16x32_bf16 v[52:55], a[104:107], a[24:27], v[52:55]
    v_mfma_f32_16x16x32_bf16 v[52:55], a[108:111], a[28:31], v[52:55]
    v_mfma_f32_16x16x32_bf16 v[48:51], a[100:103], a[28:31], v[48:51]
    v_mfma_f32_16x16x32_bf16 v[48:51], a[96:99], a[24:27], v[48:51]
    buffer_load_dwordx4 a[244:247], v1, s[8:11], s7 offen offset:1024 sc1
    s_waitcnt lgkmcnt(1)
    v_mfma_f32_16x16x32_bf16 v[64:67], a[64:67], a[0:3], v[64:67]
    s_add_u32 s7, s0, 49152
    ds_read_b128 a[32:35], v10 offset:40960
    v_mfma_f32_16x16x32_bf16 v[64:67], a[68:71], a[4:7], v[64:67]
    v_mfma_f32_16x16x32_bf16 v[68:71], a[76:79], a[4:7], v[68:71]
    ds_read_b128 a[36:39], v11 offset:40960
    v_mfma_f32_16x16x32_bf16 v[68:71], a[72:75], a[0:3], v[68:71]
    buffer_load_dwordx4 a[248:251], v1, s[8:11], s7 offen offset:0 sc1
    v_mfma_f32_16x16x32_bf16 v[72:75], a[80:83], a[0:3], v[72:75]
    v_cvt_pk_bf16_f32 v32, v32, v33
    v_cvt_pk_bf16_f32 v33, v34, v35
    v_mfma_f32_16x16x32_bf16 v[72:75], a[84:87], a[4:7], v[72:75]
    ds_read_b128 a[40:43], v10 offset:43008
    s_waitcnt lgkmcnt(2)
    v_cvt_pk_bf16_f32 v34, v36, v37
    v_mfma_f32_16x16x32_bf16 v[76:79], a[92:95], a[4:7], v[76:79]
    v_cvt_pk_bf16_f32 v35, v38, v39
    v_cvt_pk_bf16_f32 v40, v40, v41
    v_mfma_f32_16x16x32_bf16 v[76:79], a[88:91], a[0:3], v[76:79]
    buffer_load_dwordx4 a[252:255], v1, s[8:11], s7 offen offset:1024 sc1
    v_mfma_f32_16x16x32_bf16 v[92:95], a[88:91], a[8:11], v[92:95]
    ds_read_b128 a[44:47], v11 offset:43008
    v_cvt_pk_bf16_f32 v41, v42, v43
    v_mfma_f32_16x16x32_bf16 v[92:95], a[92:95], a[12:15], v[92:95]
    v_cvt_pk_bf16_f32 v42, v44, v45
    v_cvt_pk_bf16_f32 v43, v46, v47
    v_mfma_f32_16x16x32_bf16 v[88:91], a[84:87], a[12:15], v[88:91]
    v_cvt_pk_bf16_f32 v48, v48, v49
    v_cvt_pk_bf16_f32 v49, v50, v51
    v_mfma_f32_16x16x32_bf16 v[88:91], a[80:83], a[8:11], v[88:91]
    ds_read_b128 a[48:51], v10 offset:45056
    v_cvt_pk_bf16_f32 v50, v52, v53
    v_mfma_f32_16x16x32_bf16 v[84:87], a[72:75], a[8:11], v[84:87]
    v_cvt_pk_bf16_f32 v51, v54, v55
    v_cvt_pk_bf16_f32 v56, v56, v57
    v_mfma_f32_16x16x32_bf16 v[84:87], a[76:79], a[12:15], v[84:87]
    ds_read_b128 a[52:55], v11 offset:45056
    v_cvt_pk_bf16_f32 v57, v58, v59
    v_mfma_f32_16x16x32_bf16 v[80:83], a[68:71], a[12:15], v[80:83]
    v_cvt_pk_bf16_f32 v58, v60, v61
    v_cvt_pk_bf16_f32 v59, v62, v63
    v_mfma_f32_16x16x32_bf16 v[80:83], a[64:67], a[8:11], v[80:83]
    v_accvgpr_read_b32 v26, a128
    v_accvgpr_read_b32 v27, a129
    v_mfma_f32_16x16x32_bf16 v[96:99], a[64:67], a[16:19], v[96:99]
    ds_read_b128 a[56:59], v10 offset:47104
    v_cvt_pk_bf16_f32 v36, v26, v27
    v_mfma_f32_16x16x32_bf16 v[96:99], a[68:71], a[20:23], v[96:99]
    s_add_u32 s7, s95, 4096
    v_accvgpr_read_b32 v26, a130
    v_accvgpr_read_b32 v27, a131
    v_mfma_f32_16x16x32_bf16 v[100:103], a[76:79], a[20:23], v[100:103]
    buffer_store_dwordx4 v[32:35], v1, s[8:11], s7 offen sc1
    v_mfma_f32_16x16x32_bf16 v[100:103], a[72:75], a[16:19], v[100:103]
    ds_read_b128 a[60:63], v11 offset:47104
    v_cvt_pk_bf16_f32 v37, v26, v27
    v_mfma_f32_16x16x32_bf16 v[104:107], a[80:83], a[16:19], v[104:107]
    v_accvgpr_read_b32 v26, a132
    v_accvgpr_read_b32 v27, a133
    v_mfma_f32_16x16x32_bf16 v[104:107], a[84:87], a[20:23], v[104:107]
    v_cvt_pk_bf16_f32 v38, v26, v27
    v_accvgpr_read_b32 v26, a134
    v_mfma_f32_16x16x32_bf16 v[108:111], a[92:95], a[20:23], v[108:111]
    v_accvgpr_read_b32 v27, a135
    v_cvt_pk_bf16_f32 v39, v26, v27
    v_mfma_f32_16x16x32_bf16 v[108:111], a[88:91], a[16:19], v[108:111]
    v_accvgpr_read_b32 v26, a136
    v_accvgpr_read_b32 v27, a137
    v_mfma_f32_16x16x32_bf16 v[124:127], a[88:91], a[24:27], v[124:127]
    v_cvt_pk_bf16_f32 v44, v26, v27
    v_accvgpr_read_b32 v26, a138
    v_mfma_f32_16x16x32_bf16 v[124:127], a[92:95], a[28:31], v[124:127]
    v_accvgpr_read_b32 v27, a139
    v_cvt_pk_bf16_f32 v45, v26, v27
    v_mfma_f32_16x16x32_bf16 v[120:123], a[84:87], a[28:31], v[120:123]
    v_accvgpr_read_b32 v26, a140
    v_accvgpr_read_b32 v27, a141
    v_mfma_f32_16x16x32_bf16 v[120:123], a[80:83], a[24:27], v[120:123]
    v_cvt_pk_bf16_f32 v46, v26, v27
    v_accvgpr_read_b32 v26, a142
    v_mfma_f32_16x16x32_bf16 v[116:119], a[72:75], a[24:27], v[116:119]
    v_accvgpr_read_b32 v27, a143
    v_cvt_pk_bf16_f32 v47, v26, v27
    v_mfma_f32_16x16x32_bf16 v[116:119], a[76:79], a[28:31], v[116:119]
    v_accvgpr_read_b32 v26, a144
    v_accvgpr_read_b32 v27, a145
    v_mfma_f32_16x16x32_bf16 v[112:115], a[68:71], a[28:31], v[112:115]
    v_cvt_pk_bf16_f32 v52, v26, v27
    v_accvgpr_read_b32 v26, a146
    v_mfma_f32_16x16x32_bf16 v[112:115], a[64:67], a[24:27], v[112:115]
    v_accvgpr_read_b32 v27, a147
    v_cvt_pk_bf16_f32 v53, v26, v27
    v_mfma_f32_16x16x32_bf16 v[128:131], a[64:67], a[32:35], v[128:131]
    s_waitcnt vmcnt(17) lgkmcnt(0)
    s_barrier
    v_accvgpr_read_b32 v26, a148
    v_mfma_f32_16x16x32_bf16 v[128:131], a[68:71], a[36:39], v[128:131]
    s_add_u32 s0, s62, 524288
    s_xor_b32 m0, s90, 32768
    s_xor_b32 s7, s0, 0
    v_mfma_f32_16x16x32_bf16 v[132:135], a[76:79], a[36:39], v[132:135]
    buffer_load_dwordx4 v14, s[20:23], s7 offen lds
    v_mfma_f32_16x16x32_bf16 v[132:135], a[72:75], a[32:35], v[132:135]
    v_and_b32 v2, 0x3fff, v2
    v_and_b32 v3, 0x3fff, v3
    v_mfma_f32_16x16x32_bf16 v[136:139], a[80:83], a[32:35], v[136:139]
    s_xor_b32 m0, s90, 33792
    s_xor_b32 s7, s0, 32768
    v_and_b32 v4, 0x3fff, v4
    v_mfma_f32_16x16x32_bf16 v[136:139], a[84:87], a[36:39], v[136:139]
    v_and_b32 v5, 0x3fff, v5
    v_and_b32 v6, 0x3fff, v6
    v_mfma_f32_16x16x32_bf16 v[140:143], a[92:95], a[36:39], v[140:143]
    v_and_b32 v7, 0x3fff, v7
    v_and_b32 v8, 0x3fff, v8
    v_mfma_f32_16x16x32_bf16 v[140:143], a[88:91], a[32:35], v[140:143]
    v_and_b32 v9, 0x3fff, v9
    v_accvgpr_read_b32 v27, a149
    v_mfma_f32_16x16x32_bf16 v[156:159], a[88:91], a[40:43], v[156:159]
    buffer_load_dwordx4 v14, s[20:23], s7 offen lds
    v_mfma_f32_16x16x32_bf16 v[156:159], a[92:95], a[44:47], v[156:159]
    v_cvt_pk_bf16_f32 v54, v26, v27
    v_accvgpr_read_b32 v26, a150
    v_mfma_f32_16x16x32_bf16 v[152:155], a[84:87], a[44:47], v[152:155]
    s_xor_b32 m0, s90, 34816
    s_xor_b32 s7, s0, 65536
    v_accvgpr_read_b32 v27, a151
    v_mfma_f32_16x16x32_bf16 v[152:155], a[80:83], a[40:43], v[152:155]
    v_cvt_pk_bf16_f32 v55, v26, v27
    v_accvgpr_read_b32 v26, a152
    v_mfma_f32_16x16x32_bf16 v[148:151], a[72:75], a[40:43], v[148:151]
    v_accvgpr_read_b32 v27, a153
    v_cvt_pk_bf16_f32 v60, v26, v27
    v_mfma_f32_16x16x32_bf16 v[148:151], a[76:79], a[44:47], v[148:151]
    v_accvgpr_read_b32 v26, a154
    v_accvgpr_read_b32 v27, a155
    v_mfma_f32_16x16x32_bf16 v[144:147], a[68:71], a[44:47], v[144:147]
    buffer_load_dwordx4 v15, s[20:23], s7 offen lds
    v_mfma_f32_16x16x32_bf16 v[144:147], a[64:67], a[40:43], v[144:147]
    v_cvt_pk_bf16_f32 v61, v26, v27
    v_accvgpr_read_b32 v26, a156
    v_mfma_f32_16x16x32_bf16 v[160:163], a[64:67], a[48:51], v[160:163]
    s_xor_b32 m0, s90, 35840
    s_xor_b32 s7, s0, 98304
    v_accvgpr_read_b32 v27, a157
    v_mfma_f32_16x16x32_bf16 v[160:163], a[68:71], a[52:55], v[160:163]
    v_cvt_pk_bf16_f32 v62, v26, v27
    v_accvgpr_read_b32 v26, a158
    v_mfma_f32_16x16x32_bf16 v[164:167], a[76:79], a[52:55], v[164:167]
    v_accvgpr_read_b32 v27, a159
    v_cvt_pk_bf16_f32 v63, v26, v27
    v_mfma_f32_16x16x32_bf16 v[164:167], a[72:75], a[48:51], v[164:167]
    v_accvgpr_write_b32 a140, v56
    v_accvgpr_write_b32 a141, v57
    v_mfma_f32_16x16x32_bf16 v[168:171], a[80:83], a[48:51], v[168:171]
    buffer_load_dwordx4 v15, s[20:23], s7 offen lds
    v_mfma_f32_16x16x32_bf16 v[168:171], a[84:87], a[52:55], v[168:171]
    v_accvgpr_write_b32 a142, v58
    v_accvgpr_write_b32 a143, v59
    v_mfma_f32_16x16x32_bf16 v[172:175], a[92:95], a[52:55], v[172:175]
    v_accvgpr_write_b32 a144, v36
    v_accvgpr_write_b32 a145, v37
    v_mfma_f32_16x16x32_bf16 v[172:175], a[88:91], a[48:51], v[172:175]
    s_add_u32 s7, s95, 5120
    v_accvgpr_write_b32 a146, v38
    v_accvgpr_write_b32 a147, v39
    v_mfma_f32_16x16x32_bf16 v[188:191], a[88:91], a[56:59], v[188:191]
    v_accvgpr_write_b32 a148, v44
    v_accvgpr_write_b32 a149, v45
    v_mfma_f32_16x16x32_bf16 v[188:191], a[92:95], a[60:63], v[188:191]
    v_accvgpr_write_b32 a150, v46
    v_accvgpr_write_b32 a151, v47
    v_mfma_f32_16x16x32_bf16 v[184:187], a[84:87], a[60:63], v[184:187]
L_tp4:
    s_cbranch_execz L_tp8
    buffer_store_dwordx4 v[40:43], v1, s[8:11], s7 offen sc1
    v_mfma_f32_16x16x32_bf16 v[184:187], a[80:83], a[56:59], v[184:187]
    v_accvgpr_write_b32 a152, v52
    v_accvgpr_write_b32 a153, v53
    v_mfma_f32_16x16x32_bf16 v[180:183], a[72:75], a[56:59], v[180:183]
    s_add_u32 s0, s63, 176128
    s_add_u32 m0, s91, 32768
    s_add_u32 s7, s0, 0
    v_mfma_f32_16x16x32_bf16 v[180:183], a[76:79], a[60:63], v[180:183]
    v_accvgpr_write_b32 a154, v54
    v_accvgpr_write_b32 a155, v55
    v_mfma_f32_16x16x32_bf16 v[176:179], a[68:71], a[60:63], v[176:179]
    v_accvgpr_write_b32 a156, v60
    v_accvgpr_write_b32 a157, v61
    v_mfma_f32_16x16x32_bf16 v[176:179], a[64:67], a[56:59], v[176:179]
    v_accvgpr_write_b32 a158, v62
    v_accvgpr_write_b32 a159, v63
    v_mfma_f32_16x16x32_bf16 v[192:195], a[96:99], a[32:35], v[192:195]
    buffer_load_dwordx4 v19, s[24:27], s7 offen lds
    v_mfma_f32_16x16x32_bf16 v[192:195], a[100:103], a[36:39], v[192:195]
    v_cvt_pk_bf16_f32 v64, v64, v65
    v_cvt_pk_bf16_f32 v65, v66, v67
    v_mfma_f32_16x16x32_bf16 v[196:199], a[108:111], a[36:39], v[196:199]
    s_add_u32 m0, s91, 33792
    s_add_u32 s7, s0, 22016
    v_cvt_pk_bf16_f32 v66, v68, v69
    v_mfma_f32_16x16x32_bf16 v[196:199], a[104:107], a[32:35], v[196:199]
    v_cvt_pk_bf16_f32 v67, v70, v71
    v_accvgpr_write_b32 a0, v64
    v_mfma_f32_16x16x32_bf16 v[200:203], a[112:115], a[32:35], v[200:203]
    v_accvgpr_write_b32 a1, v65
    v_accvgpr_write_b32 a2, v66
    v_mfma_f32_16x16x32_bf16 v[200:203], a[116:119], a[36:39], v[200:203]
    v_accvgpr_write_b32 a3, v67
    v_cvt_pk_bf16_f32 v72, v72, v73
    v_mfma_f32_16x16x32_bf16 v[204:207], a[124:127], a[36:39], v[204:207]
    buffer_load_dwordx4 v20, s[24:27], s7 offen lds
    v_mfma_f32_16x16x32_bf16 v[204:207], a[120:123], a[32:35], v[204:207]
    v_cvt_pk_bf16_f32 v73, v74, v75
    v_cvt_pk_bf16_f32 v74, v76, v77
    v_mfma_f32_16x16x32_bf16 v[220:223], a[120:123], a[40:43], v[220:223]
    s_add_u32 m0, s91, 40960
    s_add_u32 s7, s0, 0
    v_cvt_pk_bf16_f32 v75, v78, v79
    v_mfma_f32_16x16x32_bf16 v[220:223], a[124:127], a[44:47], v[220:223]
    v_accvgpr_write_b32 a4, v72
    v_accvgpr_write_b32 a5, v73
    v_mfma_f32_16x16x32_bf16 v[216:219], a[116:119], a[44:47], v[216:219]
    v_accvgpr_write_b32 a6, v74
    v_accvgpr_write_b32 a7, v75
    v_mfma_f32_16x16x32_bf16 v[216:219], a[112:115], a[40:43], v[216:219]
    v_cvt_pk_bf16_f32 v80, v80, v81
    v_cvt_pk_bf16_f32 v81, v82, v83
    v_mfma_f32_16x16x32_bf16 v[212:215], a[104:107], a[40:43], v[212:215]
    buffer_load_dwordx4 v19, s[28:31], s7 offen lds
    v_mfma_f32_16x16x32_bf16 v[212:215], a[108:111], a[44:47], v[212:215]
    v_cvt_pk_bf16_f32 v82, v84, v85
    v_cvt_pk_bf16_f32 v83, v86, v87
    v_mfma_f32_16x16x32_bf16 v[208:211], a[100:103], a[44:47], v[208:211]
    s_add_u32 m0, s91, 41984
    ds_read_b64_tr_b16 a[64:65], v2 offset:0
    s_add_u32 s7, s0, 22016
    v_mfma_f32_16x16x32_bf16 v[208:211], a[96:99], a[40:43], v[208:211]
    ds_read_b64_tr_b16 a[66:67], v2 offset:1024
    v_accvgpr_write_b32 a8, v80
    v_mfma_f32_16x16x32_bf16 v[224:227], a[96:99], a[48:51], v[224:227]
    v_accvgpr_write_b32 a9, v81
    v_accvgpr_write_b32 a10, v82
    v_mfma_f32_16x16x32_bf16 v[224:227], a[100:103], a[52:55], v[224:227]
    ds_read_b64_tr_b16 a[68:69], v2 offset:8192
    v_accvgpr_write_b32 a11, v83
    v_mfma_f32_16x16x32_bf16 v[228:231], a[108:111], a[52:55], v[228:231]
    buffer_load_dwordx4 v20, s[28:31], s7 offen lds
    v_mfma_f32_16x16x32_bf16 v[228:231], a[104:107], a[48:51], v[228:231]
    ds_read_b64_tr_b16 a[70:71], v2 offset:9216
    v_cvt_pk_bf16_f32 v88, v88, v89
    v_mfma_f32_16x16x32_bf16 v[232:235], a[112:115], a[48:51], v[232:235]
    ds_read_b64_tr_b16 a[72:73], v3 offset:0
    v_cvt_pk_bf16_f32 v89, v90, v91
    v_mfma_f32_16x16x32_bf16 v[232:235], a[116:119], a[52:55], v[232:235]
    s_add_u32 s7, s95, 6144
    ds_read_b64_tr_b16 a[74:75], v3 offset:1024
    v_cvt_pk_bf16_f32 v90, v92, v93
    v_mfma_f32_16x16x32_bf16 v[236:239], a[124:127], a[52:55], v[236:239]
    v_cvt_pk_bf16_f32 v91, v94, v95
    v_cvt_pk_bf16_f32 v96, v96, v97
    v_mfma_f32_16x16x32_bf16 v[236:239], a[120:123], a[48:51], v[236:239]
    ds_read_b64_tr_b16 a[76:77], v3 offset:8192
    v_cvt_pk_bf16_f32 v97, v98, v99
    v_mfma_f32_16x16x32_bf16 v[252:255], a[120:123], a[56:59], v[252:255]
    buffer_store_dwordx4 v[48:51], v1, s[8:11], s7 offen sc1
    v_mfma_f32_16x16x32_bf16 v[252:255], a[124:127], a[60:63], v[252:255]
    ds_read_b64_tr_b16 a[78:79], v3 offset:9216
    v_cvt_pk_bf16_f32 v98, v100, v101
    v_mfma_f32_16x16x32_bf16 v[248:251], a[116:119], a[60:63], v[248:251]
    v_cvt_pk_bf16_f32 v99, v102, v103
    v_cvt_pk_bf16_f32 v104, v104, v105
    v_mfma_f32_16x16x32_bf16 v[248:251], a[112:115], a[56:59], v[248:251]
    v_cvt_pk_bf16_f32 v105, v106, v107
    v_cvt_pk_bf16_f32 v106, v108, v109
    v_mfma_f32_16x16x32_bf16 v[244:247], a[104:107], a[56:59], v[244:247]
    v_cvt_pk_bf16_f32 v107, v110, v111
    v_cvt_pk_bf16_f32 v112, v112, v113
    v_mfma_f32_16x16x32_bf16 v[244:247], a[108:111], a[60:63], v[244:247]
    v_cvt_pk_bf16_f32 v113, v114, v115
    v_cvt_pk_bf16_f32 v114, v116, v117
    v_mfma_f32_16x16x32_bf16 v[240:243], a[100:103], a[60:63], v[240:243]
    v_cvt_pk_bf16_f32 v115, v118, v119
    v_cvt_pk_bf16_f32 v120, v120, v121
    v_mfma_f32_16x16x32_bf16 v[240:243], a[96:99], a[56:59], v[240:243]
    v_cvt_pk_bf16_f32 v121, v122, v123
    v_cvt_pk_bf16_f32 v122, v124, v125
    v_cvt_pk_bf16_f32 v123, v126, v127
    s_branch L_B
L_A_V:
L_tp5:
    s_cbranch_execz L_tp9
    s_waitcnt lgkmcnt(7)
    v_mfma_f32_16x16x32_bf16 v[64:67], a[0:3], a[64:67], 0
    s_xor_b32 m0, s58, 37888
    s_xor_b32 s7, s0, 40960
    v_mfma_f32_16x16x32_bf16 v[64:67], a[4:7], a[68:71], v[64:67]
    buffer_load_dwordx4 v13, s[12:15], s7 offen  lds
    v_mfma_f32_16x16x32_bf16 v[72:75], a[4:7], a[76:79], 0
    s_mov_b32 s48, s86
    ds_read_b64_tr_b16 a[96:97], v6 offset:0
    s_mov_b32 s49, s87
    v_mfma_f32_16x16x32_bf16 v[72:75], a[0:3], a[72:75], v[72:75]
    s_mov_b32 s50, 256
    s_mov_b32 s51, 0x20000
    s_mov_b32 s20, s68
    v_mfma_f32_16x16x32_bf16 v[80:83], a[0:3], a[80:83], 0
    s_mov_b32 s21, s69
    s_mov_b32 s22, 4194304
    s_mov_b32 s23, 0x20000
    v_mfma_f32_16x16x32_bf16 v[80:83], a[4:7], a[84:87], v[80:83]
    s_xor_b32 m0, s59, 37888
    s_xor_b32 s7, s1, 163840
    buffer_load_dwordx4 v14, s[16:19], s7 offen  lds
    s_waitcnt lgkmcnt(0)
    v_mfma_f32_16x16x32_bf16 v[88:91], a[4:7], a[92:95], 0
    s_mov_b32 s32, s74
    ds_read_b64_tr_b16 a[98:99], v6 offset:1024
    s_mov_b32 s33, s75
    v_mfma_f32_16x16x32_bf16 v[88:91], a[0:3], a[88:91], v[88:91]
    s_mov_b32 s34, 4194304
    ds_read_b64_tr_b16 a[100:101], v6 offset:8192
    s_mov_b32 s35, 0x20000
    v_mfma_f32_16x16x32_bf16 v[92:95], a[8:11], a[88:91], 0
    s_mov_b32 s24, s78
    ds_read_b64_tr_b16 a[102:103], v6 offset:9216
    s_mov_b32 s25, s79
    v_mfma_f32_16x16x32_bf16 v[92:95], a[12:15], a[92:95], v[92:95]
    s_mov_b32 s26, 1409024
    s_mov_b32 s27, 0x20000
    s_xor_b32 m0, s58, 38912
    s_xor_b32 s7, s0, 49152
    buffer_load_dwordx4 v12, s[12:15], s7 offen  lds
    v_mfma_f32_16x16x32_bf16 v[84:87], a[12:15], a[84:87], 0
    s_mov_b32 s28, s80
    ds_read_b64_tr_b16 a[104:105], v7 offset:0
    s_mov_b32 s29, s81
    v_mfma_f32_16x16x32_bf16 v[84:87], a[8:11], a[80:83], v[84:87]
    s_mov_b32 s30, 1409024
    ds_read_b64_tr_b16 a[106:107], v7 offset:1024
    s_mov_b32 s31, 0x20000
    v_mfma_f32_16x16x32_bf16 v[76:79], a[8:11], a[72:75], 0
    s_mov_b32 s36, s82
    s_mov_b32 s37, s83
    s_mov_b32 s38, 1409024
    v_mfma_f32_16x16x32_bf16 v[76:79], a[12:15], a[76:79], v[76:79]
    s_mov_b32 s39, 0x20000
    s_xor_b32 m0, s59, 38912
    s_xor_b32 s7, s1, 196608
    buffer_load_dwordx4 v15, s[16:19], s7 offen  lds
    v_mfma_f32_16x16x32_bf16 v[68:71], a[12:15], a[68:71], 0
    s_mov_b32 s44, s84
    ds_read_b64_tr_b16 a[108:109], v7 offset:8192
    s_mov_b32 s45, s85
    v_mfma_f32_16x16x32_bf16 v[68:71], a[8:11], a[64:67], v[68:71]
    s_mov_b32 s46, 2097152
    ds_read_b64_tr_b16 a[110:111], v7 offset:9216
    s_mov_b32 s47, 0x20000
    v_mfma_f32_16x16x32_bf16 v[96:99], a[16:19], a[64:67], 0
    s_mov_b32 s52, s88
    ds_read_b64_tr_b16 a[112:113], v8 offset:0
    s_mov_b32 s53, s89
    v_mfma_f32_16x16x32_bf16 v[96:99], a[20:23], a[68:71], v[96:99]
    s_mov_b32 s54, 268435456
    s_mov_b32 s55, 0x20000
    s_xor_b32 m0, s58, 39936
    s_xor_b32 s7, s0, 57344
    buffer_load_dwordx4 v13, s[12:15], s7 offen  lds
    v_mfma_f32_16x16x32_bf16 v[104:107], a[20:23], a[76:79], 0
    s_lshl_b32 s66, s4, 7
    ds_read_b64_tr_b16 a[114:115], v8 offset:1024
    s_lshl_b32 s7, s5, 2
    v_mfma_f32_16x16x32_bf16 v[104:107], a[16:19], a[72:75], v[104:107]
    s_add_u32 s66, s66, s7
    ds_read_b64_tr_b16 a[116:117], v8 offset:8192
    s_add_u32 s66, s66, 2097152
    v_mfma_f32_16x16x32_bf16 v[112:115], a[16:19], a[80:83], 0
    s_lshr_b32 s67, s4, 3
    ds_read_b64_tr_b16 a[118:119], v8 offset:9216
    s_add_u32 s68, s7, s67
    v_mfma_f32_16x16x32_bf16 v[112:115], a[20:23], a[84:87], v[112:115]
    s_lshl_b32 s68, s68, 7
    s_and_b32 s69, s4, 7
    s_lshl_b32 s7, s69, 2
    s_add_u32 s68, s68, s7
    s_add_u32 s68, s68, 2101248
    s_xor_b32 m0, s59, 39936
    s_xor_b32 s7, s1, 229376
    buffer_load_dwordx4 v15, s[16:19], s7 offen  lds
    v_mfma_f32_16x16x32_bf16 v[120:123], a[20:23], a[92:95], 0
    s_lshl_b32 s7, s67, 2
    ds_read_b64_tr_b16 a[120:121], v9 offset:0
    s_and_b32 s7, s7, 4
    v_mfma_f32_16x16x32_bf16 v[120:123], a[16:19], a[88:91], v[120:123]
    s_xor_b32 s69, s69, s7
    ds_read_b64_tr_b16 a[122:123], v9 offset:1024
    s_lshl_b32 s7, s5, 3
    v_mfma_f32_16x16x32_bf16 v[124:127], a[24:27], a[88:91], 0
    s_add_u32 s69, s69, s7
    ds_read_b64_tr_b16 a[124:125], v9 offset:8192
    ds_read_b64_tr_b16 a[126:127], v9 offset:9216
    s_lshl_b32 s69, s69, 7
    v_mfma_f32_16x16x32_bf16 v[124:127], a[28:31], a[92:95], v[124:127]
    s_lshl_b32 s7, s67, 2
    s_add_u32 s69, s69, s7
    s_add_u32 s69, s69, 2105344
    v_mfma_f32_16x16x32_bf16 v[116:119], a[28:31], a[84:87], 0
    v_lshlrev_b32 v28, 10, v31
    v_cmp_gt_u32 vcc, 16, v31
    v_mfma_f32_16x16x32_bf16 v[116:119], a[24:27], a[80:83], v[116:119]
    v_mov_b32 v26, 2147483648
    s_add_u32 s7, s56, 256
    v_cndmask_b32 v16, v26, v28, vcc
    buffer_load_dword v30, v16, s[12:15], s7 offen
    v_mfma_f32_16x16x32_bf16 v[108:111], a[24:27], a[72:75], 0
    v_lshrrev_b32 v28, 1, v31
    v_lshlrev_b32 v28, 13, v28
    v_mfma_f32_16x16x32_bf16 v[108:111], a[28:31], a[76:79], v[108:111]
    v_and_b32 v26, 1, v31
    v_lshl_add_u32 v28, v26, 7, v28
    v_mfma_f32_16x16x32_bf16 v[100:103], a[28:31], a[68:71], 0
    v_cmp_gt_u32 vcc, 8, v31
    v_mov_b32 v26, 2147483648
    v_mfma_f32_16x16x32_bf16 v[100:103], a[24:27], a[64:67], v[100:103]
    s_lshr_b32 s71, s5, 2
    s_lshl_b32 s71, s71, 15
    s_add_u32 s71, s71, s57
    s_waitcnt lgkmcnt(0)
    v_mfma_f32_16x16x32_bf16 a[128:131], a[0:3], a[96:99], 0
    s_add_u32 s7, s71, 1048576
    ds_read_b128 a[32:35], v10 offset:8192
    v_cndmask_b32 v17, v26, v28, vcc
    v_mfma_f32_16x16x32_bf16 a[128:131], a[4:7], a[100:103], a[128:131]
    buffer_load_dword v30, v17, s[16:19], s7 offen
    v_mfma_f32_16x16x32_bf16 a[136:139], a[4:7], a[108:111], 0
    ds_read_b128 a[36:39], v11 offset:8192
    v_mfma_f32_16x16x32_bf16 a[136:139], a[0:3], a[104:107], a[136:139]
    v_mfma_f32_16x16x32_bf16 a[144:147], a[0:3], a[112:115], 0
    v_mfma_f32_16x16x32_bf16 a[144:147], a[4:7], a[116:119], a[144:147]
    ds_read_b128 a[40:43], v10 offset:10240
    v_mfma_f32_16x16x32_bf16 a[152:155], a[4:7], a[124:127], 0
    v_mfma_f32_16x16x32_bf16 a[152:155], a[0:3], a[120:123], a[152:155]
    v_mfma_f32_16x16x32_bf16 a[156:159], a[8:11], a[120:123], 0
    buffer_store_dwordx4 v[128:131], v136, s[8:11], s97 offen sc1
    v_mfma_f32_16x16x32_bf16 a[156:159], a[12:15], a[124:127], a[156:159]
    ds_read_b128 a[44:47], v11 offset:10240
    v_mfma_f32_16x16x32_bf16 a[148:151], a[12:15], a[116:119], 0
    v_mfma_f32_16x16x32_bf16 a[148:151], a[8:11], a[112:115], a[148:151]
    ds_read_b128 a[48:51], v10 offset:12288
    v_mfma_f32_16x16x32_bf16 a[140:143], a[8:11], a[104:107], 0
    v_mfma_f32_16x16x32_bf16 a[140:143], a[12:15], a[108:111], a[140:143]
    ds_read_b128 a[52:55], v11 offset:12288
    v_mfma_f32_16x16x32_bf16 a[132:135], a[12:15], a[100:103], 0
    v_mfma_f32_16x16x32_bf16 a[132:135], a[8:11], a[96:99], a[132:135]
    buffer_store_dwordx4 v[132:135], v136, s[8:11], s96 offen sc1
    v_mfma_f32_16x16x32_bf16 v[32:35], a[16:19], a[96:99], 0
    ds_read_b128 a[56:59], v10 offset:14336
    v_lshlrev_b32 v26, 5, v0
    v_mfma_f32_16x16x32_bf16 v[32:35], a[20:23], a[100:103], v[32:35]
    v_add_u32 v27, s68, v26
    s_sub_u32 s7, s66, 96
    v_mfma_f32_16x16x32_bf16 v[40:43], a[20:23], a[108:111], 0
    v_add_u32 v28, s7, v26
    v_cmp_le_u32 vcc, 3, v0
    v_mfma_f32_16x16x32_bf16 v[40:43], a[16:19], a[104:107], v[40:43]
    ds_read_b128 a[60:63], v11 offset:14336
    v_lshrrev_b32 v26, 1, v26
    v_mfma_f32_16x16x32_bf16 v[48:51], a[16:19], a[112:115], 0
    s_sub_u32 s7, s69, 80
    v_add_u32 v26, s7, v26
    v_mov_b32 v22, 2147483648
    v_mfma_f32_16x16x32_bf16 v[48:51], a[20:23], a[116:119], v[48:51]
    v_cndmask_b32 v27, v27, v28, vcc
    v_cmp_le_u32 vcc, 5, v0
    v_mfma_f32_16x16x32_bf16 v[56:59], a[20:23], a[124:127], 0
    v_mov_b32 v25, 1
    v_mov_b32 v28, 0
    v_mfma_f32_16x16x32_bf16 v[56:59], a[16:19], a[120:123], v[56:59]
    v_cndmask_b32 v27, v27, v26, vcc
    v_cmp_gt_u32 vcc, 9, v0
    s_and_b32 s93, s2, 7
    s_lshl_b32 s93, s93, 5
    v_cndmask_b32 v27, v22, v27, vcc
    v_cmp_eq_u32 vcc, 0, v0
    buffer_store_dword v28, v27, s[8:11], 0 offen sc1
    v_mfma_f32_16x16x32_bf16 v[60:63], a[24:27], a[120:123], 0
    v_lshlrev_b32 v21, 3, v31
    v_cndmask_b32 v22, v22, v28, vcc
    v_mfma_f32_16x16x32_bf16 v[60:63], a[28:31], a[124:127], v[60:63]
    v_mfma_f32_16x16x32_bf16 v[52:55], a[28:31], a[116:119], 0
    v_mfma_f32_16x16x32_bf16 v[52:55], a[24:27], a[112:115], v[52:55]
    v_mfma_f32_16x16x32_bf16 v[44:47], a[24:27], a[104:107], 0
    v_mfma_f32_16x16x32_bf16 v[44:47], a[28:31], a[108:111], v[44:47]
    v_mfma_f32_16x16x32_bf16 v[36:39], a[28:31], a[100:103], 0
    v_mfma_f32_16x16x32_bf16 v[36:39], a[24:27], a[96:99], v[36:39]
    s_waitcnt lgkmcnt(0)
    v_mfma_f32_16x16x32_bf16 v[192:195], a[32:35], a[96:99], 0
    s_waitcnt vmcnt(5) lgkmcnt(0)
    s_barrier
    v_mfma_f32_16x16x32_bf16 v[192:195], a[36:39], a[100:103], v[192:195]
    ds_read_b128 a[0:3], v10 offset:32768
    v_mfma_f32_16x16x32_bf16 v[200:203], a[36:39], a[108:111], 0
    v_mfma_f32_16x16x32_bf16 v[200:203], a[32:35], a[104:107], v[200:203]
    s_add_u32 s0, s56, 256
    s_xor_b32 m0, s58, 0
    s_xor_b32 s7, s0, 0
    v_mfma_f32_16x16x32_bf16 v[208:211], a[32:35], a[112:115], 0
    buffer_load_dwordx4 v12, s[12:15], s7 offen  lds
    v_mfma_f32_16x16x32_bf16 v[208:211], a[36:39], a[116:119], v[208:211]
    ds_read_b128 a[4:7], v11 offset:32768
    v_bfe_u32 v28, v31, 4, 1
    v_mfma_f32_16x16x32_bf16 v[216:219], a[36:39], a[124:127], 0
    v_lshlrev_b32 v28, 1, v28
    v_and_b32 v27, 7, v31
    v_mfma_f32_16x16x32_bf16 v[216:219], a[32:35], a[120:123], v[216:219]
    v_xor_b32 v27, v27, v28
    v_xor_b32 v26, 4, v27
    v_mfma_f32_16x16x32_bf16 v[220:223], a[40:43], a[120:123], 0
    v_lshrrev_b32 v28, 3, v31
    v_mul_u32_u24 v28, 2752, v28
    v_mfma_f32_16x16x32_bf16 v[220:223], a[44:47], a[124:127], v[220:223]
    s_add_u32 s1, s57, 1048576
    s_xor_b32 m0, s59, 0
    s_xor_b32 s7, s1, 0
    v_mfma_f32_16x16x32_bf16 v[212:215], a[44:47], a[116:119], 0
    buffer_load_dwordx4 v14, s[16:19], s7 offen  lds
    v_mfma_f32_16x16x32_bf16 v[212:215], a[40:43], a[112:115], v[212:215]
    ds_read_b128 a[8:11], v10 offset:34816
    v_cmp_gt_u32 vcc, 6, v27
    v_mfma_f32_16x16x32_bf16 v[204:207], a[40:43], a[104:107], 0
    ds_read_b128 a[12:15], v11 offset:34816
    v_lshl_add_u32 v27, v27, 4, v28
    v_mfma_f32_16x16x32_bf16 v[204:207], a[44:47], a[108:111], v[204:207]
    v_mov_b32 v24, 2147483648
    v_cndmask_b32 v19, v24, v27, vcc
    v_mfma_f32_16x16x32_bf16 v[196:199], a[44:47], a[100:103], 0
    v_cmp_gt_u32 vcc, 6, v26
    v_lshl_add_u32 v26, v26, 4, v28
    v_mfma_f32_16x16x32_bf16 v[196:199], a[40:43], a[96:99], v[196:199]
    v_and_b32 v23, 7, v0
    v_cndmask_b32 v20, v24, v26, vcc
    v_lshlrev_b32 v23, 5, v23
    s_xor_b32 m0, s58, 1024
    s_xor_b32 s7, s0, 8192
    buffer_load_dwordx4 v13, s[12:15], s7 offen  lds
    v_mfma_f32_16x16x32_bf16 v[224:227], a[48:51], a[96:99], 0
    s_cmp_gt_u32 s4, 30
    ds_read_b128 a[16:19], v10 offset:36864
    s_cselect_b32 s26, 0, s26
    v_mfma_f32_16x16x32_bf16 v[224:227], a[52:55], a[100:103], v[224:227]
    s_cselect_b32 s30, 0, s30
    ds_read_b128 a[20:23], v11 offset:36864
    s_xor_b32 m0, s59, 1024
    v_mfma_f32_16x16x32_bf16 v[232:235], a[52:55], a[108:111], 0
    s_xor_b32 s7, s1, 32768
    ds_read_b128 a[24:27], v10 offset:38912
    v_mfma_f32_16x16x32_bf16 v[232:235], a[48:51], a[104:107], v[232:235]
    buffer_load_dwordx4 v14, s[16:19], s7 offen  lds
    v_mfma_f32_16x16x32_bf16 v[240:243], a[48:51], a[112:115], 0
    v_mfma_f32_16x16x32_bf16 v[240:243], a[52:55], a[116:119], v[240:243]
    s_xor_b32 m0, s58, 2048
    ds_read_b128 a[28:31], v11 offset:38912
    s_xor_b32 s7, s0, 16384
    v_mfma_f32_16x16x32_bf16 v[248:251], a[52:55], a[124:127], 0
    v_mfma_f32_16x16x32_bf16 v[248:251], a[48:51], a[120:123], v[248:251]
    v_mfma_f32_16x16x32_bf16 v[252:255], a[56:59], a[120:123], 0
    v_mfma_f32_16x16x32_bf16 v[252:255], a[60:63], a[124:127], v[252:255]
    buffer_load_dwordx4 v12, s[12:15], s7 offen  lds
    v_mfma_f32_16x16x32_bf16 v[244:247], a[60:63], a[116:119], 0
    s_cmp_lt_u32 s6, 2
    s_cselect_b64 s[52:53], s[24:25], s[28:29]
    s_mov_b32 s54, s26
    v_mfma_f32_16x16x32_bf16 v[244:247], a[56:59], a[112:115], v[244:247]
    s_xor_b32 m0, s59, 2048
    s_xor_b32 s7, s1, 65536
    v_mfma_f32_16x16x32_bf16 v[236:239], a[56:59], a[104:107], 0
    v_mfma_f32_16x16x32_bf16 v[236:239], a[60:63], a[108:111], v[236:239]
    v_mfma_f32_16x16x32_bf16 v[228:231], a[60:63], a[100:103], 0
    buffer_load_dwordx4 v15, s[16:19], s7 offen  lds
    v_mfma_f32_16x16x32_bf16 v[228:231], a[56:59], a[96:99], v[228:231]
    s_lshl_b32 s60, s4, 20
    s_lshl_b32 s7, s5, 16
    s_sub_u32 s60, s60, s7
    v_mfma_f32_16x16x32_bf16 v[128:131], a[32:35], a[64:67], 0
    s_lshr_b32 s7, s6, 1
    s_lshl_b32 s7, s7, 15
    s_add_u32 s60, s60, s7
    v_mfma_f32_16x16x32_bf16 v[128:131], a[36:39], a[68:71], v[128:131]
    s_xor_b32 m0, s58, 3072
    s_xor_b32 s7, s0, 24576
    v_mfma_f32_16x16x32_bf16 v[136:139], a[36:39], a[76:79], 0
    ds_read_b64_tr_b16 a[96:97], v6 offset:32768
    v_mfma_f32_16x16x32_bf16 v[136:139], a[32:35], a[72:75], v[136:139]
    buffer_load_dwordx4 v13, s[12:15], s7 offen  lds
    v_mfma_f32_16x16x32_bf16 v[144:147], a[32:35], a[80:83], 0
    s_mul_i32 s7, s3, 24576
    ds_read_b64_tr_b16 a[98:99], v6 offset:33792
    s_sub_u32 s95, s60, s7
    v_mfma_f32_16x16x32_bf16 v[144:147], a[36:39], a[84:87], v[144:147]
    s_add_u32 s95, s95, 5201920
    ds_read_b64_tr_b16 a[100:101], v6 offset:40960
    s_lshl_b32 s7, s3, 13
    v_mfma_f32_16x16x32_bf16 v[152:155], a[36:39], a[92:95], 0
    s_sub_u32 s60, s60, s7
    ds_read_b64_tr_b16 a[102:103], v6 offset:41984
    s_add_u32 s60, s60, 5193728
    v_mfma_f32_16x16x32_bf16 v[152:155], a[32:35], a[88:91], v[152:155]
    s_xor_b32 m0, s59, 3072
    s_xor_b32 s7, s1, 98304
    v_mfma_f32_16x16x32_bf16 v[156:159], a[40:43], a[88:91], 0
    buffer_load_dwordx4 v15, s[16:19], s7 offen  lds
    v_mfma_f32_16x16x32_bf16 v[156:159], a[44:47], a[92:95], v[156:159]
    ds_read_b64_tr_b16 a[104:105], v7 offset:32768
    v_mfma_f32_16x16x32_bf16 v[148:151], a[44:47], a[84:87], 0
    s_xor_b32 m0, s58, 4096
    ds_read_b64_tr_b16 a[106:107], v7 offset:33792
    s_xor_b32 s7, s0, 32768
    v_mfma_f32_16x16x32_bf16 v[148:151], a[40:43], a[80:83], v[148:151]
    ds_read_b64_tr_b16 a[108:109], v7 offset:40960
    v_mfma_f32_16x16x32_bf16 v[140:143], a[40:43], a[72:75], 0
    ds_read_b64_tr_b16 a[110:111], v7 offset:41984
    v_mfma_f32_16x16x32_bf16 v[140:143], a[44:47], a[76:79], v[140:143]
    ds_read_b64_tr_b16 a[112:113], v8 offset:32768
    v_mfma_f32_16x16x32_bf16 v[132:135], a[44:47], a[68:71], 0
    buffer_load_dwordx4 v12, s[12:15], s7 offen  lds
    v_mfma_f32_16x16x32_bf16 v[132:135], a[40:43], a[64:67], v[132:135]
    s_sub_u32 s70, 15, s5
    ds_read_b64_tr_b16 a[114:115], v8 offset:33792
    s_cmp_lt_u32 s6, 2
    v_mfma_f32_16x16x32_bf16 v[160:163], a[48:51], a[64:67], 0
    s_cselect_b32 s70, s70, s5
    ds_read_b64_tr_b16 a[116:117], v8 offset:40960
    s_lshl_b32 s61, s70, 17
    v_mfma_f32_16x16x32_bf16 v[160:163], a[52:55], a[68:71], v[160:163]
    s_lshl_b32 s7, s3, 16
    ds_read_b64_tr_b16 a[118:119], v8 offset:41984
    s_add_u32 s61, s61, s7
    v_mfma_f32_16x16x32_bf16 v[168:171], a[52:55], a[76:79], 0
    s_xor_b32 m0, s59, 4096
    s_xor_b32 s7, s1, 131072
    v_mfma_f32_16x16x32_bf16 v[168:171], a[48:51], a[72:75], v[168:171]
    buffer_load_dwordx4 v14, s[16:19], s7 offen  lds
    v_mfma_f32_16x16x32_bf16 v[176:179], a[48:51], a[80:83], 0
    s_mul_i32 s92, s70, 1441792
    ds_read_b64_tr_b16 a[120:121], v9 offset:32768
    s_mul_i32 s7, s4, 12288
    v_mfma_f32_16x16x32_bf16 v[176:179], a[52:55], a[84:87], v[176:179]
    s_add_u32 s92, s92, s7
    ds_read_b64_tr_b16 a[122:123], v9 offset:33792
    s_lshl_b32 s7, s3, 11
    v_mfma_f32_16x16x32_bf16 v[184:187], a[52:55], a[92:95], 0
    s_add_u32 s92, s92, s7
    ds_read_b64_tr_b16 a[124:125], v9 offset:40960
    ds_read_b64_tr_b16 a[126:127], v9 offset:41984
    s_add_u32 s92, s92, 38797312
    v_mfma_f32_16x16x32_bf16 v[184:187], a[48:51], a[88:91], v[184:187]
    s_xor_b32 m0, s58, 5120
    s_xor_b32 s7, s0, 40960
    v_mfma_f32_16x16x32_bf16 v[188:191], a[56:59], a[88:91], 0
    buffer_load_dwordx4 v13, s[12:15], s7 offen  lds
    v_mfma_f32_16x16x32_bf16 v[188:191], a[60:63], a[92:95], v[188:191]
    s_lshl_b32 s62, s6, 17
    s_lshl_b32 s7, s4, 8
    s_add_u32 s62, s62, s7
    v_mfma_f32_16x16x32_bf16 v[180:183], a[60:63], a[84:87], 0
    s_xor_b32 m0, s59, 5120
    s_xor_b32 s7, s1, 163840
    v_mfma_f32_16x16x32_bf16 v[180:183], a[56:59], a[80:83], v[180:183]
    v_mfma_f32_16x16x32_bf16 v[172:175], a[56:59], a[72:75], 0
    v_mfma_f32_16x16x32_bf16 v[172:175], a[60:63], a[76:79], v[172:175]
    buffer_load_dwordx4 v14, s[16:19], s7 offen  lds
    v_mfma_f32_16x16x32_bf16 v[164:167], a[60:63], a[68:71], 0
    v_mfma_f32_16x16x32_bf16 v[164:167], a[56:59], a[64:67], v[164:167]
    s_xor_b32 m0, s58, 6144
    s_xor_b32 s7, s0, 49152
    s_waitcnt lgkmcnt(0)
    v_mfma_f32_16x16x32_bf16 a[128:131], a[0:3], a[96:99], a[128:131]
    ds_read_b64_tr_b16 a[64:65], v2 offset:32768
    v_mfma_f32_16x16x32_bf16 a[128:131], a[4:7], a[100:103], a[128:131]
    ds_read_b64_tr_b16 a[66:67], v2 offset:33792
    v_mfma_f32_16x16x32_bf16 a[136:139], a[4:7], a[108:111], a[136:139]
    v_mfma_f32_16x16x32_bf16 a[136:139], a[0:3], a[104:107], a[136:139]
    buffer_load_dwordx4 v12, s[12:15], s7 offen  lds
    v_mfma_f32_16x16x32_bf16 a[144:147], a[0:3], a[112:115], a[144:147]
    s_mul_i32 s63, s6, 44032
    ds_read_b64_tr_b16 a[68:69], v2 offset:40960
    s_mul_i32 s7, s4, 96
    v_mfma_f32_16x16x32_bf16 a[144:147], a[4:7], a[116:119], a[144:147]
    s_add_u32 s63, s63, s7
    ds_read_b64_tr_b16 a[70:71], v2 offset:41984
    s_xor_b32 m0, s59, 6144
    v_mfma_f32_16x16x32_bf16 a[152:155], a[4:7], a[124:127], a[152:155]
    s_xor_b32 s7, s1, 196608
    ds_read_b64_tr_b16 a[72:73], v3 offset:32768
    v_mfma_f32_16x16x32_bf16 a[152:155], a[0:3], a[120:123], a[152:155]
    ds_read_b64_tr_b16 a[74:75], v3 offset:33792
    v_mfma_f32_16x16x32_bf16 a[156:159], a[8:11], a[120:123], a[156:159]
    buffer_load_dwordx4 v15, s[16:19], s7 offen  lds
    v_mfma_f32_16x16x32_bf16 a[156:159], a[12:15], a[124:127], a[156:159]
    s_lshl_b32 s90, s6, 12
    ds_read_b64_tr_b16 a[76:77], v3 offset:40960
    s_and_b32 s7, s5, 1
    v_mfma_f32_16x16x32_bf16 a[148:151], a[12:15], a[116:119], a[148:151]
    s_lshl_b32 s7, s7, 11
    s_add_u32 s90, s90, s7
    s_lshl_b32 s7, s7, 5
    v_mfma_f32_16x16x32_bf16 a[148:151], a[8:11], a[112:115], a[148:151]
    s_add_u32 s62, s62, s7
    s_xor_b32 m0, s58, 7168
    s_xor_b32 s7, s0, 57344
    v_mfma_f32_16x16x32_bf16 a[140:143], a[8:11], a[104:107], a[140:143]
    ds_read_b64_tr_b16 a[78:79], v3 offset:41984
    v_mfma_f32_16x16x32_bf16 a[140:143], a[12:15], a[108:111], a[140:143]
    buffer_load_dwordx4 v13, s[12:15], s7 offen  lds
    v_mfma_f32_16x16x32_bf16 a[132:135], a[12:15], a[100:103], a[132:135]
    s_lshl_b32 s91, s6, 11
    ds_read_b64_tr_b16 a[80:81], v4 offset:32768
    s_add_u32 s91, s91, 16384
    v_mfma_f32_16x16x32_bf16 a[132:135], a[8:11], a[96:99], a[132:135]
    s_mov_b32 s96, 0x3e0293ee
    ds_read_b64_tr_b16 a[82:83], v4 offset:33792
    s_mov_b32 s97, 0x3e0293ee
    v_mfma_f32_16x16x32_bf16 v[32:35], a[16:19], a[96:99], v[32:35]
    s_mov_b32 s98, 0xc13504f3
    s_mov_b32 s99, s98
    s_xor_b32 m0, s59, 7168
    v_mfma_f32_16x16x32_bf16 v[32:35], a[20:23], a[100:103], v[32:35]
    s_xor_b32 s7, s1, 229376
    ds_read_b64_tr_b16 a[84:85], v4 offset:40960
    v_mfma_f32_16x16x32_bf16 v[40:43], a[20:23], a[108:111], v[40:43]
    buffer_load_dwordx4 v15, s[16:19], s7 offen  lds
    v_mfma_f32_16x16x32_bf16 v[40:43], a[16:19], a[104:107], v[40:43]
    ds_read_b64_tr_b16 a[86:87], v4 offset:41984
    v_mfma_f32_16x16x32_bf16 v[48:51], a[16:19], a[112:115], v[48:51]
    ds_read_b64_tr_b16 a[88:89], v5 offset:32768
    v_mfma_f32_16x16x32_bf16 v[48:51], a[20:23], a[116:119], v[48:51]
    ds_read_b64_tr_b16 a[90:91], v5 offset:33792
    v_mfma_f32_16x16x32_bf16 v[56:59], a[20:23], a[124:127], v[56:59]
    ds_read_b64_tr_b16 a[92:93], v5 offset:40960
    v_mfma_f32_16x16x32_bf16 v[56:59], a[16:19], a[120:123], v[56:59]
    ds_read_b64_tr_b16 a[94:95], v5 offset:41984
    v_mfma_f32_16x16x32_bf16 v[60:63], a[24:27], a[120:123], v[60:63]
    v_mfma_f32_16x16x32_bf16 v[60:63], a[28:31], a[124:127], v[60:63]
    v_mfma_f32_16x16x32_bf16 v[52:55], a[28:31], a[116:119], v[52:55]
    v_mfma_f32_16x16x32_bf16 v[52:55], a[24:27], a[112:115], v[52:55]
    s_add_u32 s7, s56, 384
    v_mfma_f32_16x16x32_bf16 v[44:47], a[24:27], a[104:107], v[44:47]
    buffer_load_dword v30, v16, s[12:15], s7 offen
    v_mfma_f32_16x16x32_bf16 v[44:47], a[28:31], a[108:111], v[44:47]
    v_mfma_f32_16x16x32_bf16 v[36:39], a[28:31], a[100:103], v[36:39]
    v_mfma_f32_16x16x32_bf16 v[36:39], a[24:27], a[96:99], v[36:39]
L_tp6:
    s_cbranch_execz L_tp10
    s_add_u32 s7, s71, 1572864
    s_waitcnt lgkmcnt(0)
    v_mfma_f32_16x16x32_bf16 v[64:67], a[0:3], a[64:67], v[64:67]
    ds_read_b128 a[32:35], v10 offset:40960
    v_mfma_f32_16x16x32_bf16 v[64:67], a[4:7], a[68:71], v[64:67]
    v_mfma_f32_16x16x32_bf16 v[72:75], a[4:7], a[76:79], v[72:75]
    buffer_load_dword v30, v17, s[16:19], s7 offen
    v_mfma_f32_16x16x32_bf16 v[72:75], a[0:3], a[72:75], v[72:75]
    ds_read_b128 a[36:39], v11 offset:40960
    v_lshrrev_b32 v28, 1, v31
    v_mfma_f32_16x16x32_bf16 v[80:83], a[0:3], a[80:83], v[80:83]
    v_mul_u32_u24 v28, 2752, v28
    v_and_b32 v26, 1, v31
    v_mfma_f32_16x16x32_bf16 v[80:83], a[4:7], a[84:87], v[80:83]
    v_mul_u32_u24 v26, 92, v26
    v_add_u32 v28, v28, v26
    v_mfma_f32_16x16x32_bf16 v[88:91], a[4:7], a[92:95], v[88:91]
    v_cmp_gt_u32 vcc, 16, v31
    v_mov_b32 v26, 2147483648
    v_mfma_f32_16x16x32_bf16 v[88:91], a[0:3], a[88:91], v[88:91]
    s_lshl_b32 s73, s5, 1
    s_add_u32 s73, s73, s3
    s_mul_i32 s73, s73, 88064
    v_mfma_f32_16x16x32_bf16 v[92:95], a[8:11], a[88:91], v[92:95]
    s_mul_i32 s7, s4, 96
    s_add_u32 s73, s73, s7
    s_add_u32 s7, s73, 0
    v_mfma_f32_16x16x32_bf16 v[92:95], a[12:15], a[92:95], v[92:95]
    v_cndmask_b32 v27, v26, v28, vcc
    buffer_load_dword v30, v27, s[52:55], s7 offen
    v_mfma_f32_16x16x32_bf16 v[84:87], a[12:15], a[84:87], v[84:87]
    ds_read_b128 a[40:43], v10 offset:43008
    v_mfma_f32_16x16x32_bf16 v[84:87], a[8:11], a[80:83], v[84:87]
    ds_read_b128 a[44:47], v11 offset:43008
    v_mfma_f32_16x16x32_bf16 v[76:79], a[8:11], a[72:75], v[76:79]
    ds_read_b128 a[48:51], v10 offset:45056
    v_mfma_f32_16x16x32_bf16 v[76:79], a[12:15], a[76:79], v[76:79]
    ds_read_b128 a[52:55], v11 offset:45056
    v_mfma_f32_16x16x32_bf16 v[68:71], a[12:15], a[68:71], v[68:71]
    v_mfma_f32_16x16x32_bf16 v[68:71], a[8:11], a[64:67], v[68:71]
    v_mfma_f32_16x16x32_bf16 v[96:99], a[16:19], a[64:67], v[96:99]
    ds_read_b128 a[56:59], v10 offset:47104
    v_mfma_f32_16x16x32_bf16 v[96:99], a[20:23], a[68:71], v[96:99]
    v_mfma_f32_16x16x32_bf16 v[104:107], a[20:23], a[76:79], v[104:107]
    v_mfma_f32_16x16x32_bf16 v[104:107], a[16:19], a[72:75], v[104:107]
    ds_read_b128 a[60:63], v11 offset:47104
    v_mfma_f32_16x16x32_bf16 v[112:115], a[16:19], a[80:83], v[112:115]
    v_mfma_f32_16x16x32_bf16 v[112:115], a[20:23], a[84:87], v[112:115]
    v_mfma_f32_16x16x32_bf16 v[120:123], a[20:23], a[92:95], v[120:123]
    v_mfma_f32_16x16x32_bf16 v[120:123], a[16:19], a[88:91], v[120:123]
    v_mfma_f32_16x16x32_bf16 v[124:127], a[24:27], a[88:91], v[124:127]
    v_mfma_f32_16x16x32_bf16 v[124:127], a[28:31], a[92:95], v[124:127]
    v_mfma_f32_16x16x32_bf16 v[116:119], a[28:31], a[84:87], v[116:119]
    v_mfma_f32_16x16x32_bf16 v[116:119], a[24:27], a[80:83], v[116:119]
    v_mfma_f32_16x16x32_bf16 v[108:111], a[24:27], a[72:75], v[108:111]
    v_mfma_f32_16x16x32_bf16 v[108:111], a[28:31], a[76:79], v[108:111]
    v_mfma_f32_16x16x32_bf16 v[100:103], a[28:31], a[68:71], v[100:103]
    v_mfma_f32_16x16x32_bf16 v[100:103], a[24:27], a[64:67], v[100:103]
    s_waitcnt lgkmcnt(0)
    v_mfma_f32_16x16x32_bf16 v[128:131], a[32:35], a[64:67], v[128:131]
    s_waitcnt vmcnt(3) lgkmcnt(0)
    s_barrier
    v_mfma_f32_16x16x32_bf16 v[128:131], a[36:39], a[68:71], v[128:131]
    ds_read_b128 a[0:3], v10 offset:0
    v_mfma_f32_16x16x32_bf16 v[136:139], a[36:39], a[76:79], v[136:139]
    v_mfma_f32_16x16x32_bf16 v[136:139], a[32:35], a[72:75], v[136:139]
    s_cmp_eq_u32 s5, 0
    s_cselect_b32 s7, s93, 0x1000
    v_mfma_f32_16x16x32_bf16 v[144:147], a[32:35], a[80:83], v[144:147]
    buffer_atomic_add v25, v22, s[48:51], s7 offen sc1
    v_mfma_f32_16x16x32_bf16 v[144:147], a[36:39], a[84:87], v[144:147]
    s_add_u32 s0, s56, 384
    ds_read_b128 a[4:7], v11 offset:0
    s_xor_b32 m0, s58, 32768
    v_mfma_f32_16x16x32_bf16 v[152:155], a[36:39], a[92:95], v[152:155]
    s_xor_b32 s7, s0, 0
    ds_read_b128 a[8:11], v10 offset:2048
    v_mfma_f32_16x16x32_bf16 v[152:155], a[32:35], a[88:91], v[152:155]
    v_mfma_f32_16x16x32_bf16 v[156:159], a[40:43], a[88:91], v[156:159]
    buffer_load_dwordx4 v12, s[12:15], s7 offen  lds
    v_mfma_f32_16x16x32_bf16 v[156:159], a[44:47], a[92:95], v[156:159]
    s_add_u32 s1, s57, 1572864
    ds_read_b128 a[12:15], v11 offset:2048
    s_xor_b32 m0, s59, 32768
    v_mfma_f32_16x16x32_bf16 v[148:151], a[44:47], a[84:87], v[148:151]
    s_xor_b32 s7, s1, 0
    v_mfma_f32_16x16x32_bf16 v[148:151], a[40:43], a[80:83], v[148:151]
    v_mfma_f32_16x16x32_bf16 v[140:143], a[40:43], a[72:75], v[140:143]
    ds_read_b128 a[16:19], v10 offset:4096
    v_mfma_f32_16x16x32_bf16 v[140:143], a[44:47], a[76:79], v[140:143]
    buffer_load_dwordx4 v14, s[16:19], s7 offen  lds
    v_mfma_f32_16x16x32_bf16 v[132:135], a[44:47], a[68:71], v[132:135]
    s_xor_b32 m0, s58, 33792
    s_xor_b32 s7, s0, 8192
    v_mfma_f32_16x16x32_bf16 v[132:135], a[40:43], a[64:67], v[132:135]
    ds_read_b128 a[20:23], v11 offset:4096
    v_mfma_f32_16x16x32_bf16 v[160:163], a[48:51], a[64:67], v[160:163]
    v_mfma_f32_16x16x32_bf16 v[160:163], a[52:55], a[68:71], v[160:163]
    v_mfma_f32_16x16x32_bf16 v[168:171], a[52:55], a[76:79], v[168:171]
    buffer_load_dwordx4 v13, s[12:15], s7 offen  lds
    v_mfma_f32_16x16x32_bf16 v[168:171], a[48:51], a[72:75], v[168:171]
    s_xor_b32 m0, s59, 33792
    ds_read_b128 a[24:27], v10 offset:6144
    s_xor_b32 s7, s1, 32768
    v_mfma_f32_16x16x32_bf16 v[176:179], a[48:51], a[80:83], v[176:179]
    v_mfma_f32_16x16x32_bf16 v[176:179], a[52:55], a[84:87], v[176:179]
    ds_read_b128 a[28:31], v11 offset:6144
    v_mfma_f32_16x16x32_bf16 v[184:187], a[52:55], a[92:95], v[184:187]
    buffer_load_dwordx4 v14, s[16:19], s7 offen  lds
    v_mfma_f32_16x16x32_bf16 v[184:187], a[48:51], a[88:91], v[184:187]
    s_xor_b32 m0, s58, 34816
    s_xor_b32 s7, s0, 16384
    v_mfma_f32_16x16x32_bf16 v[188:191], a[56:59], a[88:91], v[188:191]
    v_mfma_f32_16x16x32_bf16 v[188:191], a[60:63], a[92:95], v[188:191]
    v_mfma_f32_16x16x32_bf16 v[180:183], a[60:63], a[84:87], v[180:183]
    v_mfma_f32_16x16x32_bf16 v[180:183], a[56:59], a[80:83], v[180:183]
    buffer_load_dwordx4 v12, s[12:15], s7 offen  lds
    v_mfma_f32_16x16x32_bf16 v[172:175], a[56:59], a[72:75], v[172:175]
    s_cmp_eq_u32 s5, 1
    s_cselect_b32 s7, s93, 0x1000
    v_mfma_f32_16x16x32_bf16 v[172:175], a[60:63], a[76:79], v[172:175]
    v_mfma_f32_16x16x32_bf16 v[164:167], a[60:63], a[68:71], v[164:167]
    v_mfma_f32_16x16x32_bf16 v[164:167], a[56:59], a[64:67], v[164:167]
    v_mfma_f32_16x16x32_bf16 v[192:195], a[32:35], a[96:99], v[192:195]
    buffer_atomic_add v25, v22, s[48:51], s7 offen sc1
    v_mfma_f32_16x16x32_bf16 v[192:195], a[36:39], a[100:103], v[192:195]
    s_xor_b32 m0, s59, 34816
    ds_read_b64_tr_b16 a[64:65], v2 offset:0
    s_xor_b32 s7, s1, 65536
    v_mfma_f32_16x16x32_bf16 v[200:203], a[36:39], a[108:111], v[200:203]
    ds_read_b64_tr_b16 a[66:67], v2 offset:1024
    v_mfma_f32_16x16x32_bf16 v[200:203], a[32:35], a[104:107], v[200:203]
    ds_read_b64_tr_b16 a[68:69], v2 offset:8192
    v_mfma_f32_16x16x32_bf16 v[208:211], a[32:35], a[112:115], v[208:211]
    buffer_load_dwordx4 v15, s[16:19], s7 offen  lds
    v_mfma_f32_16x16x32_bf16 v[208:211], a[36:39], a[116:119], v[208:211]
    s_xor_b32 m0, s58, 35840
    ds_read_b64_tr_b16 a[70:71], v2 offset:9216
    s_xor_b32 s7, s0, 24576
    v_mfma_f32_16x16x32_bf16 v[216:219], a[36:39], a[124:127], v[216:219]
    ds_read_b64_tr_b16 a[72:73], v3 offset:0
    v_mfma_f32_16x16x32_bf16 v[216:219], a[32:35], a[120:123], v[216:219]
    ds_read_b64_tr_b16 a[74:75], v3 offset:1024
    v_mfma_f32_16x16x32_bf16 v[220:223], a[40:43], a[120:123], v[220:223]
    ds_read_b64_tr_b16 a[76:77], v3 offset:8192
    v_mfma_f32_16x16x32_bf16 v[220:223], a[44:47], a[124:127], v[220:223]
    buffer_load_dwordx4 v13, s[12:15], s7 offen  lds
    v_mfma_f32_16x16x32_bf16 v[212:215], a[44:47], a[116:119], v[212:215]
    s_xor_b32 m0, s59, 35840
    ds_read_b64_tr_b16 a[78:79], v3 offset:9216
    s_xor_b32 s7, s1, 98304
    v_mfma_f32_16x16x32_bf16 v[212:215], a[40:43], a[112:115], v[212:215]
    ds_read_b64_tr_b16 a[80:81], v4 offset:0
    v_mfma_f32_16x16x32_bf16 v[204:207], a[40:43], a[104:107], v[204:207]
    ds_read_b64_tr_b16 a[82:83], v4 offset:1024
    v_mfma_f32_16x16x32_bf16 v[204:207], a[44:47], a[108:111], v[204:207]
    ds_read_b64_tr_b16 a[84:85], v4 offset:8192
    v_mfma_f32_16x16x32_bf16 v[196:199], a[44:47], a[100:103], v[196:199]
    buffer_load_dwordx4 v15, s[16:19], s7 offen  lds
    v_mfma_f32_16x16x32_bf16 v[196:199], a[40:43], a[96:99], v[196:199]
    s_xor_b32 m0, s58, 36864
    s_xor_b32 s7, s0, 32768
    v_mfma_f32_16x16x32_bf16 v[224:227], a[48:51], a[96:99], v[224:227]
    ds_read_b64_tr_b16 a[86:87], v4 offset:9216
    v_mfma_f32_16x16x32_bf16 v[224:227], a[52:55], a[100:103], v[224:227]
    ds_read_b64_tr_b16 a[88:89], v5 offset:0
    v_mfma_f32_16x16x32_bf16 v[232:235], a[52:55], a[108:111], v[232:235]
    buffer_load_dwordx4 v12, s[12:15], s7 offen  lds
    v_mfma_f32_16x16x32_bf16 v[232:235], a[48:51], a[104:107], v[232:235]
    s_xor_b32 m0, s59, 36864
    ds_read_b64_tr_b16 a[90:91], v5 offset:1024
    s_xor_b32 s7, s1, 131072
    v_mfma_f32_16x16x32_bf16 v[240:243], a[48:51], a[112:115], v[240:243]
    ds_read_b64_tr_b16 a[92:93], v5 offset:8192
    v_mfma_f32_16x16x32_bf16 v[240:243], a[52:55], a[116:119], v[240:243]
    ds_read_b64_tr_b16 a[94:95], v5 offset:9216
    v_mfma_f32_16x16x32_bf16 v[248:251], a[52:55], a[124:127], v[248:251]
    v_mfma_f32_16x16x32_bf16 v[248:251], a[48:51], a[120:123], v[248:251]
    buffer_load_dwordx4 v14, s[16:19], s7 offen  lds
    v_mfma_f32_16x16x32_bf16 v[252:255], a[56:59], a[120:123], v[252:255]
    s_xor_b32 m0, s58, 37888
    s_xor_b32 s7, s0, 40960
    v_mfma_f32_16x16x32_bf16 v[252:255], a[60:63], a[124:127], v[252:255]
    v_mfma_f32_16x16x32_bf16 v[244:247], a[60:63], a[116:119], v[244:247]
    v_mfma_f32_16x16x32_bf16 v[244:247], a[56:59], a[112:115], v[244:247]
    v_mfma_f32_16x16x32_bf16 v[236:239], a[56:59], a[104:107], v[236:239]
    buffer_load_dwordx4 v13, s[12:15], s7 offen  lds
    v_mfma_f32_16x16x32_bf16 v[236:239], a[60:63], a[108:111], v[236:239]
    s_xor_b32 m0, s59, 37888
    s_xor_b32 s7, s1, 163840
    v_mfma_f32_16x16x32_bf16 v[228:231], a[60:63], a[100:103], v[228:231]
    v_mfma_f32_16x16x32_bf16 v[228:231], a[56:59], a[96:99], v[228:231]
    s_waitcnt lgkmcnt(0)
    v_mfma_f32_16x16x32_bf16 v[64:67], a[0:3], a[64:67], v[64:67]
    buffer_load_dwordx4 v14, s[16:19], s7 offen  lds
    v_mfma_f32_16x16x32_bf16 v[64:67], a[4:7], a[68:71], v[64:67]
    s_xor_b32 m0, s58, 38912
    ds_read_b64_tr_b16 a[96:97], v6 offset:0
    s_xor_b32 s7, s0, 49152
    v_mfma_f32_16x16x32_bf16 v[72:75], a[4:7], a[76:79], v[72:75]
    ds_read_b64_tr_b16 a[98:99], v6 offset:1024
    v_mfma_f32_16x16x32_bf16 v[72:75], a[0:3], a[72:75], v[72:75]
    ds_read_b64_tr_b16 a[100:101], v6 offset:8192
    v_mfma_f32_16x16x32_bf16 v[80:83], a[0:3], a[80:83], v[80:83]
    ds_read_b64_tr_b16 a[102:103], v6 offset:9216
    v_mfma_f32_16x16x32_bf16 v[80:83], a[4:7], a[84:87], v[80:83]
    buffer_load_dwordx4 v12, s[12:15], s7 offen  lds
    v_mfma_f32_16x16x32_bf16 v[88:91], a[4:7], a[92:95], v[88:91]
    s_xor_b32 m0, s59, 38912
    ds_read_b64_tr_b16 a[104:105], v7 offset:0
    s_xor_b32 s7, s1, 196608
    v_mfma_f32_16x16x32_bf16 v[88:91], a[0:3], a[88:91], v[88:91]
    ds_read_b64_tr_b16 a[106:107], v7 offset:1024
    v_mfma_f32_16x16x32_bf16 v[92:95], a[8:11], a[88:91], v[92:95]
    v_mfma_f32_16x16x32_bf16 v[92:95], a[12:15], a[92:95], v[92:95]
    ds_read_b64_tr_b16 a[108:109], v7 offset:8192
    v_mfma_f32_16x16x32_bf16 v[84:87], a[12:15], a[84:87], v[84:87]
    buffer_load_dwordx4 v15, s[16:19], s7 offen  lds
    v_mfma_f32_16x16x32_bf16 v[84:87], a[8:11], a[80:83], v[84:87]
    s_xor_b32 m0, s58, 39936
    ds_read_b64_tr_b16 a[110:111], v7 offset:9216
    s_xor_b32 s7, s0, 57344
    v_mfma_f32_16x16x32_bf16 v[76:79], a[8:11], a[72:75], v[76:79]
    ds_read_b64_tr_b16 a[112:113], v8 offset:0
    v_mfma_f32_16x16x32_bf16 v[76:79], a[12:15], a[76:79], v[76:79]
    ds_read_b64_tr_b16 a[114:115], v8 offset:1024
    v_mfma_f32_16x16x32_bf16 v[68:71], a[12:15], a[68:71], v[68:71]
    buffer_load_dwordx4 v13, s[12:15], s7 offen  lds
    v_mfma_f32_16x16x32_bf16 v[68:71], a[8:11], a[64:67], v[68:71]
    s_xor_b32 m0, s59, 39936
    ds_read_b64_tr_b16 a[116:117], v8 offset:8192
    s_xor_b32 s7, s1, 229376
    v_mfma_f32_16x16x32_bf16 v[96:99], a[16:19], a[64:67], v[96:99]
    ds_read_b64_tr_b16 a[118:119], v8 offset:9216
    v_mfma_f32_16x16x32_bf16 v[96:99], a[20:23], a[68:71], v[96:99]
    v_mfma_f32_16x16x32_bf16 v[104:107], a[20:23], a[76:79], v[104:107]
    ds_read_b64_tr_b16 a[120:121], v9 offset:0
    v_mfma_f32_16x16x32_bf16 v[104:107], a[16:19], a[72:75], v[104:107]
    buffer_load_dwordx4 v15, s[16:19], s7 offen  lds
    v_mfma_f32_16x16x32_bf16 v[112:115], a[16:19], a[80:83], v[112:115]
    ds_read_b64_tr_b16 a[122:123], v9 offset:1024
    v_mfma_f32_16x16x32_bf16 v[112:115], a[20:23], a[84:87], v[112:115]
    ds_read_b64_tr_b16 a[124:125], v9 offset:8192
    v_mfma_f32_16x16x32_bf16 v[120:123], a[20:23], a[92:95], v[120:123]
    ds_read_b64_tr_b16 a[126:127], v9 offset:9216
    v_mfma_f32_16x16x32_bf16 v[120:123], a[16:19], a[88:91], v[120:123]
    v_mfma_f32_16x16x32_bf16 v[124:127], a[24:27], a[88:91], v[124:127]
    v_mfma_f32_16x16x32_bf16 v[124:127], a[28:31], a[92:95], v[124:127]
    v_mfma_f32_16x16x32_bf16 v[116:119], a[28:31], a[84:87], v[116:119]
    v_mfma_f32_16x16x32_bf16 v[116:119], a[24:27], a[80:83], v[116:119]
    s_cmp_eq_u32 s5, 2
    s_cselect_b32 s7, s93, 0x1000
    v_mfma_f32_16x16x32_bf16 v[108:111], a[24:27], a[72:75], v[108:111]
    buffer_atomic_add v25, v22, s[48:51], s7 offen sc1
    v_mfma_f32_16x16x32_bf16 v[108:111], a[28:31], a[76:79], v[108:111]
    v_mfma_f32_16x16x32_bf16 v[100:103], a[28:31], a[68:71], v[100:103]
    s_add_u32 s7, s56, 512
    v_mfma_f32_16x16x32_bf16 v[100:103], a[24:27], a[64:67], v[100:103]
    s_waitcnt lgkmcnt(0)
    v_mfma_f32_16x16x32_bf16 a[128:131], a[0:3], a[96:99], a[128:131]
    ds_read_b128 a[32:35], v10 offset:8192
    v_mfma_f32_16x16x32_bf16 a[128:131], a[4:7], a[100:103], a[128:131]
    buffer_load_dword v30, v16, s[12:15], s7 offen
    v_mfma_f32_16x16x32_bf16 a[136:139], a[4:7], a[108:111], a[136:139]
    ds_read_b128 a[36:39], v11 offset:8192
    v_mfma_f32_16x16x32_bf16 a[136:139], a[0:3], a[104:107], a[136:139]
    v_mfma_f32_16x16x32_bf16 a[144:147], a[0:3], a[112:115], a[144:147]
    s_add_u32 s7, s71, 2097152
    v_mfma_f32_16x16x32_bf16 a[144:147], a[4:7], a[116:119], a[144:147]
    ds_read_b128 a[40:43], v10 offset:10240
    v_mfma_f32_16x16x32_bf16 a[152:155], a[4:7], a[124:127], a[152:155]
    v_mfma_f32_16x16x32_bf16 a[152:155], a[0:3], a[120:123], a[152:155]
    buffer_load_dword v30, v17, s[16:19], s7 offen
    v_mfma_f32_16x16x32_bf16 a[156:159], a[8:11], a[120:123], a[156:159]
    ds_read_b128 a[44:47], v11 offset:10240
    v_lshrrev_b32 v28, 1, v31
    v_mfma_f32_16x16x32_bf16 a[156:159], a[12:15], a[124:127], a[156:159]
    v_lshlrev_b32 v28, 13, v28
    v_and_b32 v26, 1, v31
    v_mfma_f32_16x16x32_bf16 a[148:151], a[12:15], a[116:119], a[148:151]
    v_lshl_add_u32 v28, v26, 7, v28
    v_cmp_gt_u32 vcc, 16, v31
    v_mfma_f32_16x16x32_bf16 a[148:151], a[8:11], a[112:115], a[148:151]
    v_mov_b32 v26, 2147483648
    s_lshl_b32 s72, s5, 19
    v_mfma_f32_16x16x32_bf16 a[140:143], a[8:11], a[104:107], a[140:143]
    s_add_u32 s72, s72, s62
    s_and_b32 s72, s72, 0xfffeffff
    s_add_u32 s7, s72, 0
    v_mfma_f32_16x16x32_bf16 a[140:143], a[12:15], a[108:111], a[140:143]
    ds_read_b128 a[48:51], v10 offset:12288
    v_cndmask_b32 v18, v26, v28, vcc
    v_mfma_f32_16x16x32_bf16 a[132:135], a[12:15], a[100:103], a[132:135]
    buffer_load_dword v30, v18, s[20:23], s7 offen
    v_mfma_f32_16x16x32_bf16 a[132:135], a[8:11], a[96:99], a[132:135]
    s_add_u32 s7, s73, 22016
    ds_read_b128 a[52:55], v11 offset:12288
    v_mfma_f32_16x16x32_bf16 v[32:35], a[16:19], a[96:99], v[32:35]
    ds_read_b128 a[56:59], v10 offset:14336
    v_mfma_f32_16x16x32_bf16 v[32:35], a[20:23], a[100:103], v[32:35]
    v_mfma_f32_16x16x32_bf16 v[40:43], a[20:23], a[108:111], v[40:43]
    buffer_load_dword v30, v27, s[52:55], s7 offen
    v_mfma_f32_16x16x32_bf16 v[40:43], a[16:19], a[104:107], v[40:43]
    ds_read_b128 a[60:63], v11 offset:14336
    v_mfma_f32_16x16x32_bf16 v[48:51], a[16:19], a[112:115], v[48:51]
    s_cmp_eq_u32 s5, 3
    s_cselect_b32 s7, s93, 0x1000
    v_mfma_f32_16x16x32_bf16 v[48:51], a[20:23], a[116:119], v[48:51]
    v_mfma_f32_16x16x32_bf16 v[56:59], a[20:23], a[124:127], v[56:59]
    v_mfma_f32_16x16x32_bf16 v[56:59], a[16:19], a[120:123], v[56:59]
    v_mfma_f32_16x16x32_bf16 v[60:63], a[24:27], a[120:123], v[60:63]
    buffer_atomic_add v25, v22, s[48:51], s7 offen sc1
    v_mfma_f32_16x16x32_bf16 v[60:63], a[28:31], a[124:127], v[60:63]
    v_mfma_f32_16x16x32_bf16 v[52:55], a[28:31], a[116:119], v[52:55]
    v_mfma_f32_16x16x32_bf16 v[52:55], a[24:27], a[112:115], v[52:55]
    v_mfma_f32_16x16x32_bf16 v[44:47], a[24:27], a[104:107], v[44:47]
    v_mfma_f32_16x16x32_bf16 v[44:47], a[28:31], a[108:111], v[44:47]
    v_mfma_f32_16x16x32_bf16 v[36:39], a[28:31], a[100:103], v[36:39]
    v_mfma_f32_16x16x32_bf16 v[36:39], a[24:27], a[96:99], v[36:39]
    s_waitcnt lgkmcnt(0)
    v_mfma_f32_16x16x32_bf16 v[192:195], a[32:35], a[96:99], v[192:195]
    s_waitcnt vmcnt(6) lgkmcnt(0)
    s_barrier
    v_mfma_f32_16x16x32_bf16 v[192:195], a[36:39], a[100:103], v[192:195]
    ds_read_b128 a[0:3], v10 offset:32768
    v_mfma_f32_16x16x32_bf16 v[200:203], a[36:39], a[108:111], v[200:203]
    v_mfma_f32_16x16x32_bf16 v[200:203], a[32:35], a[104:107], v[200:203]
    s_add_u32 s0, s56, 512
    s_xor_b32 m0, s58, 0
    s_xor_b32 s7, s0, 0
    v_mfma_f32_16x16x32_bf16 v[208:211], a[32:35], a[112:115], v[208:211]
    buffer_load_dwordx4 v12, s[12:15], s7 offen  lds
    v_mfma_f32_16x16x32_bf16 v[208:211], a[36:39], a[116:119], v[208:211]
    s_add_u32 s1, s57, 2097152
    ds_read_b128 a[4:7], v11 offset:32768
    s_xor_b32 m0, s59, 0
    v_mfma_f32_16x16x32_bf16 v[216:219], a[36:39], a[124:127], v[216:219]
    s_xor_b32 s7, s1, 0
    ds_read_b128 a[8:11], v10 offset:34816
    v_mfma_f32_16x16x32_bf16 v[216:219], a[32:35], a[120:123], v[216:219]
    v_mfma_f32_16x16x32_bf16 v[220:223], a[40:43], a[120:123], v[220:223]
    buffer_load_dwordx4 v14, s[16:19], s7 offen  lds
    v_mfma_f32_16x16x32_bf16 v[220:223], a[44:47], a[124:127], v[220:223]
    s_xor_b32 m0, s58, 1024
    ds_read_b128 a[12:15], v11 offset:34816
    s_xor_b32 s7, s0, 8192
    v_mfma_f32_16x16x32_bf16 v[212:215], a[44:47], a[116:119], v[212:215]
    v_mfma_f32_16x16x32_bf16 v[212:215], a[40:43], a[112:115], v[212:215]
    v_mfma_f32_16x16x32_bf16 v[204:207], a[40:43], a[104:107], v[204:207]
    ds_read_b128 a[16:19], v10 offset:36864
    v_mfma_f32_16x16x32_bf16 v[204:207], a[44:47], a[108:111], v[204:207]
    buffer_load_dwordx4 v13, s[12:15], s7 offen  lds
    v_mfma_f32_16x16x32_bf16 v[196:199], a[44:47], a[100:103], v[196:199]
    s_cmp_eq_u32 s5, 4
    s_cselect_b32 s7, s93, 0x1000
    v_mfma_f32_16x16x32_bf16 v[196:199], a[40:43], a[96:99], v[196:199]
    ds_read_b128 a[20:23], v11 offset:36864
    v_mfma_f32_16x16x32_bf16 v[224:227], a[48:51], a[96:99], v[224:227]
    v_mfma_f32_16x16x32_bf16 v[224:227], a[52:55], a[100:103], v[224:227]
    v_mfma_f32_16x16x32_bf16 v[232:235], a[52:55], a[108:111], v[232:235]
    buffer_atomic_add v25, v22, s[48:51], s7 offen sc1
    v_mfma_f32_16x16x32_bf16 v[232:235], a[48:51], a[104:107], v[232:235]
    s_xor_b32 m0, s59, 1024
    ds_read_b128 a[24:27], v10 offset:38912
    s_xor_b32 s7, s1, 32768
    v_mfma_f32_16x16x32_bf16 v[240:243], a[48:51], a[112:115], v[240:243]
    v_mfma_f32_16x16x32_bf16 v[240:243], a[52:55], a[116:119], v[240:243]
    ds_read_b128 a[28:31], v11 offset:38912
    v_mfma_f32_16x16x32_bf16 v[248:251], a[52:55], a[124:127], v[248:251]
    buffer_load_dwordx4 v14, s[16:19], s7 offen  lds
    v_mfma_f32_16x16x32_bf16 v[248:251], a[48:51], a[120:123], v[248:251]
    s_xor_b32 m0, s58, 2048
    s_xor_b32 s7, s0, 16384
    v_mfma_f32_16x16x32_bf16 v[252:255], a[56:59], a[120:123], v[252:255]
    v_mfma_f32_16x16x32_bf16 v[252:255], a[60:63], a[124:127], v[252:255]
    v_mfma_f32_16x16x32_bf16 v[244:247], a[60:63], a[116:119], v[244:247]
    v_mfma_f32_16x16x32_bf16 v[244:247], a[56:59], a[112:115], v[244:247]
    buffer_load_dwordx4 v12, s[12:15], s7 offen  lds
    v_mfma_f32_16x16x32_bf16 v[236:239], a[56:59], a[104:107], v[236:239]
    s_xor_b32 m0, s59, 2048
    s_xor_b32 s7, s1, 65536
    v_mfma_f32_16x16x32_bf16 v[236:239], a[60:63], a[108:111], v[236:239]
    v_mfma_f32_16x16x32_bf16 v[228:231], a[60:63], a[100:103], v[228:231]
    v_mfma_f32_16x16x32_bf16 v[228:231], a[56:59], a[96:99], v[228:231]
    v_mfma_f32_16x16x32_bf16 v[128:131], a[32:35], a[64:67], v[128:131]
    buffer_load_dwordx4 v15, s[16:19], s7 offen  lds
    v_mfma_f32_16x16x32_bf16 v[128:131], a[36:39], a[68:71], v[128:131]
    s_xor_b32 m0, s58, 3072
    ds_read_b64_tr_b16 a[96:97], v6 offset:32768
    s_xor_b32 s7, s0, 24576
    v_mfma_f32_16x16x32_bf16 v[136:139], a[36:39], a[76:79], v[136:139]
    ds_read_b64_tr_b16 a[98:99], v6 offset:33792
    v_mfma_f32_16x16x32_bf16 v[136:139], a[32:35], a[72:75], v[136:139]
    ds_read_b64_tr_b16 a[100:101], v6 offset:40960
    v_mfma_f32_16x16x32_bf16 v[144:147], a[32:35], a[80:83], v[144:147]
    buffer_load_dwordx4 v13, s[12:15], s7 offen  lds
    v_mfma_f32_16x16x32_bf16 v[144:147], a[36:39], a[84:87], v[144:147]
    s_cmp_eq_u32 s5, 5
    ds_read_b64_tr_b16 a[102:103], v6 offset:41984
    s_cselect_b32 s7, s93, 0x1000
    v_mfma_f32_16x16x32_bf16 v[152:155], a[36:39], a[92:95], v[152:155]
    ds_read_b64_tr_b16 a[104:105], v7 offset:32768
    v_mfma_f32_16x16x32_bf16 v[152:155], a[32:35], a[88:91], v[152:155]
    ds_read_b64_tr_b16 a[106:107], v7 offset:33792
    v_mfma_f32_16x16x32_bf16 v[156:159], a[40:43], a[88:91], v[156:159]
    ds_read_b64_tr_b16 a[108:109], v7 offset:40960
    v_mfma_f32_16x16x32_bf16 v[156:159], a[44:47], a[92:95], v[156:159]
    buffer_atomic_add v25, v22, s[48:51], s7 offen sc1
    v_mfma_f32_16x16x32_bf16 v[148:151], a[44:47], a[84:87], v[148:151]
    s_xor_b32 m0, s59, 3072
    ds_read_b64_tr_b16 a[110:111], v7 offset:41984
    s_xor_b32 s7, s1, 98304
    v_mfma_f32_16x16x32_bf16 v[148:151], a[40:43], a[80:83], v[148:151]
    ds_read_b64_tr_b16 a[112:113], v8 offset:32768
    v_mfma_f32_16x16x32_bf16 v[140:143], a[40:43], a[72:75], v[140:143]
    ds_read_b64_tr_b16 a[114:115], v8 offset:33792
    v_mfma_f32_16x16x32_bf16 v[140:143], a[44:47], a[76:79], v[140:143]
    ds_read_b64_tr_b16 a[116:117], v8 offset:40960
    v_mfma_f32_16x16x32_bf16 v[132:135], a[44:47], a[68:71], v[132:135]
    buffer_load_dwordx4 v15, s[16:19], s7 offen  lds
    v_mfma_f32_16x16x32_bf16 v[132:135], a[40:43], a[64:67], v[132:135]
    s_xor_b32 m0, s58, 4096
    s_xor_b32 s7, s0, 32768
    v_mfma_f32_16x16x32_bf16 v[160:163], a[48:51], a[64:67], v[160:163]
    ds_read_b64_tr_b16 a[118:119], v8 offset:41984
    v_mfma_f32_16x16x32_bf16 v[160:163], a[52:55], a[68:71], v[160:163]
    ds_read_b64_tr_b16 a[120:121], v9 offset:32768
    v_mfma_f32_16x16x32_bf16 v[168:171], a[52:55], a[76:79], v[168:171]
    buffer_load_dwordx4 v12, s[12:15], s7 offen  lds
    v_mfma_f32_16x16x32_bf16 v[168:171], a[48:51], a[72:75], v[168:171]
    s_xor_b32 m0, s59, 4096
    ds_read_b64_tr_b16 a[122:123], v9 offset:33792
    s_xor_b32 s7, s1, 131072
    v_mfma_f32_16x16x32_bf16 v[176:179], a[48:51], a[80:83], v[176:179]
    ds_read_b64_tr_b16 a[124:125], v9 offset:40960
    v_mfma_f32_16x16x32_bf16 v[176:179], a[52:55], a[84:87], v[176:179]
    ds_read_b64_tr_b16 a[126:127], v9 offset:41984
    v_mfma_f32_16x16x32_bf16 v[184:187], a[52:55], a[92:95], v[184:187]
    v_mfma_f32_16x16x32_bf16 v[184:187], a[48:51], a[88:91], v[184:187]
    buffer_load_dwordx4 v14, s[16:19], s7 offen  lds
    v_mfma_f32_16x16x32_bf16 v[188:191], a[56:59], a[88:91], v[188:191]
    s_xor_b32 m0, s58, 5120
    s_xor_b32 s7, s0, 40960
    v_mfma_f32_16x16x32_bf16 v[188:191], a[60:63], a[92:95], v[188:191]
    v_mfma_f32_16x16x32_bf16 v[180:183], a[60:63], a[84:87], v[180:183]
    v_mfma_f32_16x16x32_bf16 v[180:183], a[56:59], a[80:83], v[180:183]
    v_mfma_f32_16x16x32_bf16 v[172:175], a[56:59], a[72:75], v[172:175]
    buffer_load_dwordx4 v13, s[12:15], s7 offen  lds
    v_mfma_f32_16x16x32_bf16 v[172:175], a[60:63], a[76:79], v[172:175]
    s_xor_b32 m0, s59, 5120
    s_xor_b32 s7, s1, 163840
    v_mfma_f32_16x16x32_bf16 v[164:167], a[60:63], a[68:71], v[164:167]
    v_mfma_f32_16x16x32_bf16 v[164:167], a[56:59], a[64:67], v[164:167]
    s_waitcnt lgkmcnt(0)
    v_mfma_f32_16x16x32_bf16 a[128:131], a[0:3], a[96:99], a[128:131]
    buffer_load_dwordx4 v14, s[16:19], s7 offen  lds
    v_mfma_f32_16x16x32_bf16 a[128:131], a[4:7], a[100:103], a[128:131]
    s_xor_b32 m0, s58, 6144
    ds_read_b64_tr_b16 a[64:65], v2 offset:32768
    s_xor_b32 s7, s0, 49152
    v_mfma_f32_16x16x32_bf16 a[136:139], a[4:7], a[108:111], a[136:139]
    ds_read_b64_tr_b16 a[66:67], v2 offset:33792
    v_mfma_f32_16x16x32_bf16 a[136:139], a[0:3], a[104:107], a[136:139]
    ds_read_b64_tr_b16 a[68:69], v2 offset:40960
    v_mfma_f32_16x16x32_bf16 a[144:147], a[0:3], a[112:115], a[144:147]
    ds_read_b64_tr_b16 a[70:71], v2 offset:41984
    v_mfma_f32_16x16x32_bf16 a[144:147], a[4:7], a[116:119], a[144:147]
    buffer_load_dwordx4 v12, s[12:15], s7 offen  lds
    v_mfma_f32_16x16x32_bf16 a[152:155], a[4:7], a[124:127], a[152:155]
    s_xor_b32 m0, s59, 6144
    ds_read_b64_tr_b16 a[72:73], v3 offset:32768
    s_xor_b32 s7, s1, 196608
    v_mfma_f32_16x16x32_bf16 a[152:155], a[0:3], a[120:123], a[152:155]
    ds_read_b64_tr_b16 a[74:75], v3 offset:33792
    v_mfma_f32_16x16x32_bf16 a[156:159], a[8:11], a[120:123], a[156:159]
    v_mfma_f32_16x16x32_bf16 a[156:159], a[12:15], a[124:127], a[156:159]
    ds_read_b64_tr_b16 a[76:77], v3 offset:40960
    v_mfma_f32_16x16x32_bf16 a[148:151], a[12:15], a[116:119], a[148:151]
    buffer_load_dwordx4 v15, s[16:19], s7 offen  lds
    v_mfma_f32_16x16x32_bf16 a[148:151], a[8:11], a[112:115], a[148:151]
    s_xor_b32 m0, s58, 7168
    ds_read_b64_tr_b16 a[78:79], v3 offset:41984
    s_xor_b32 s7, s0, 57344
    v_mfma_f32_16x16x32_bf16 a[140:143], a[8:11], a[104:107], a[140:143]
    ds_read_b64_tr_b16 a[80:81], v4 offset:32768
    v_mfma_f32_16x16x32_bf16 a[140:143], a[12:15], a[108:111], a[140:143]
    ds_read_b64_tr_b16 a[82:83], v4 offset:33792
    v_mfma_f32_16x16x32_bf16 a[132:135], a[12:15], a[100:103], a[132:135]
    buffer_load_dwordx4 v13, s[12:15], s7 offen  lds
    v_mfma_f32_16x16x32_bf16 a[132:135], a[8:11], a[96:99], a[132:135]
    s_xor_b32 m0, s59, 7168
    ds_read_b64_tr_b16 a[84:85], v4 offset:40960
    s_xor_b32 s7, s1, 229376
    v_mfma_f32_16x16x32_bf16 v[32:35], a[16:19], a[96:99], v[32:35]
    ds_read_b64_tr_b16 a[86:87], v4 offset:41984
    v_mfma_f32_16x16x32_bf16 v[32:35], a[20:23], a[100:103], v[32:35]
    v_mfma_f32_16x16x32_bf16 v[40:43], a[20:23], a[108:111], v[40:43]
    ds_read_b64_tr_b16 a[88:89], v5 offset:32768
    v_mfma_f32_16x16x32_bf16 v[40:43], a[16:19], a[104:107], v[40:43]
    buffer_load_dwordx4 v15, s[16:19], s7 offen  lds
    v_mfma_f32_16x16x32_bf16 v[48:51], a[16:19], a[112:115], v[48:51]
    ds_read_b64_tr_b16 a[90:91], v5 offset:33792
    v_mfma_f32_16x16x32_bf16 v[48:51], a[20:23], a[116:119], v[48:51]
    ds_read_b64_tr_b16 a[92:93], v5 offset:40960
    v_mfma_f32_16x16x32_bf16 v[56:59], a[20:23], a[124:127], v[56:59]
    ds_read_b64_tr_b16 a[94:95], v5 offset:41984
    v_mfma_f32_16x16x32_bf16 v[56:59], a[16:19], a[120:123], v[56:59]
    v_mfma_f32_16x16x32_bf16 v[60:63], a[24:27], a[120:123], v[60:63]
    v_mfma_f32_16x16x32_bf16 v[60:63], a[28:31], a[124:127], v[60:63]
    v_mfma_f32_16x16x32_bf16 v[52:55], a[28:31], a[116:119], v[52:55]
    v_mfma_f32_16x16x32_bf16 v[52:55], a[24:27], a[112:115], v[52:55]
    s_cmp_eq_u32 s5, 6
    s_cselect_b32 s7, s93, 0x1000
    v_mfma_f32_16x16x32_bf16 v[44:47], a[24:27], a[104:107], v[44:47]
    buffer_atomic_add v25, v22, s[48:51], s7 offen sc1
    v_mfma_f32_16x16x32_bf16 v[44:47], a[28:31], a[108:111], v[44:47]
    v_mfma_f32_16x16x32_bf16 v[36:39], a[28:31], a[100:103], v[36:39]
    s_add_u32 s7, s56, 640
    v_mfma_f32_16x16x32_bf16 v[36:39], a[24:27], a[96:99], v[36:39]
    s_waitcnt lgkmcnt(0)
    v_mfma_f32_16x16x32_bf16 v[64:67], a[0:3], a[64:67], v[64:67]
    ds_read_b128 a[32:35], v10 offset:40960
    v_mfma_f32_16x16x32_bf16 v[64:67], a[4:7], a[68:71], v[64:67]
    buffer_load_dword v30, v16, s[12:15], s7 offen
    v_mfma_f32_16x16x32_bf16 v[72:75], a[4:7], a[76:79], v[72:75]
    ds_read_b128 a[36:39], v11 offset:40960
    v_mfma_f32_16x16x32_bf16 v[72:75], a[0:3], a[72:75], v[72:75]
    v_mfma_f32_16x16x32_bf16 v[80:83], a[0:3], a[80:83], v[80:83]
    s_add_u32 s7, s71, 2621440
    v_mfma_f32_16x16x32_bf16 v[80:83], a[4:7], a[84:87], v[80:83]
    ds_read_b128 a[40:43], v10 offset:43008
    v_mfma_f32_16x16x32_bf16 v[88:91], a[4:7], a[92:95], v[88:91]
L_tp7:
    s_cbranch_execz L_tp11
    v_mfma_f32_16x16x32_bf16 v[88:91], a[0:3], a[88:91], v[88:91]
    buffer_load_dword v30, v17, s[16:19], s7 offen
    v_mfma_f32_16x16x32_bf16 v[92:95], a[8:11], a[88:91], v[92:95]
    ds_read_b128 a[44:47], v11 offset:43008
    v_mfma_f32_16x16x32_bf16 v[92:95], a[12:15], a[92:95], v[92:95]
    v_mfma_f32_16x16x32_bf16 v[84:87], a[12:15], a[84:87], v[84:87]
    s_add_u32 s7, s72, 65536
    v_mfma_f32_16x16x32_bf16 v[84:87], a[8:11], a[80:83], v[84:87]
    ds_read_b128 a[48:51], v10 offset:45056
    v_mfma_f32_16x16x32_bf16 v[76:79], a[8:11], a[72:75], v[76:79]
    v_mfma_f32_16x16x32_bf16 v[76:79], a[12:15], a[76:79], v[76:79]
    buffer_load_dword v30, v18, s[20:23], s7 offen
    v_mfma_f32_16x16x32_bf16 v[68:71], a[12:15], a[68:71], v[68:71]
    ds_read_b128 a[52:55], v11 offset:45056
    v_mfma_f32_16x16x32_bf16 v[68:71], a[8:11], a[64:67], v[68:71]
    s_add_u32 s7, s73, 44032
    v_mfma_f32_16x16x32_bf16 v[96:99], a[16:19], a[64:67], v[96:99]
    ds_read_b128 a[56:59], v10 offset:47104
    v_mfma_f32_16x16x32_bf16 v[96:99], a[20:23], a[68:71], v[96:99]
    v_mfma_f32_16x16x32_bf16 v[104:107], a[20:23], a[76:79], v[104:107]
    buffer_load_dword v30, v27, s[52:55], s7 offen
    v_mfma_f32_16x16x32_bf16 v[104:107], a[16:19], a[72:75], v[104:107]
    ds_read_b128 a[60:63], v11 offset:47104
    v_mfma_f32_16x16x32_bf16 v[112:115], a[16:19], a[80:83], v[112:115]
    s_cmp_eq_u32 s5, 7
    s_cselect_b32 s7, s93, 0x1000
    v_mfma_f32_16x16x32_bf16 v[112:115], a[20:23], a[84:87], v[112:115]
    v_mfma_f32_16x16x32_bf16 v[120:123], a[20:23], a[92:95], v[120:123]
    v_mfma_f32_16x16x32_bf16 v[120:123], a[16:19], a[88:91], v[120:123]
    v_mfma_f32_16x16x32_bf16 v[124:127], a[24:27], a[88:91], v[124:127]
    buffer_atomic_add v25, v22, s[48:51], s7 offen sc1
    v_mfma_f32_16x16x32_bf16 v[124:127], a[28:31], a[92:95], v[124:127]
    v_mfma_f32_16x16x32_bf16 v[116:119], a[28:31], a[84:87], v[116:119]
    v_mfma_f32_16x16x32_bf16 v[116:119], a[24:27], a[80:83], v[116:119]
    v_mfma_f32_16x16x32_bf16 v[108:111], a[24:27], a[72:75], v[108:111]
    v_mfma_f32_16x16x32_bf16 v[108:111], a[28:31], a[76:79], v[108:111]
    v_mfma_f32_16x16x32_bf16 v[100:103], a[28:31], a[68:71], v[100:103]
    v_mfma_f32_16x16x32_bf16 v[100:103], a[24:27], a[64:67], v[100:103]
    s_waitcnt lgkmcnt(0)
    v_mfma_f32_16x16x32_bf16 v[128:131], a[32:35], a[64:67], v[128:131]
    s_waitcnt vmcnt(6) lgkmcnt(0)
    s_barrier
    v_mfma_f32_16x16x32_bf16 v[128:131], a[36:39], a[68:71], v[128:131]
    ds_read_b128 a[0:3], v10 offset:0
    v_mfma_f32_16x16x32_bf16 v[136:139], a[36:39], a[76:79], v[136:139]
    v_mfma_f32_16x16x32_bf16 v[136:139], a[32:35], a[72:75], v[136:139]
    s_add_u32 s0, s56, 640
    s_xor_b32 m0, s58, 32768
    s_xor_b32 s7, s0, 0
    v_mfma_f32_16x16x32_bf16 v[144:147], a[32:35], a[80:83], v[144:147]
    buffer_load_dwordx4 v12, s[12:15], s7 offen  lds
    v_mfma_f32_16x16x32_bf16 v[144:147], a[36:39], a[84:87], v[144:147]
    s_add_u32 s1, s57, 2621440
    ds_read_b128 a[4:7], v11 offset:0
    s_xor_b32 m0, s59, 32768
    v_mfma_f32_16x16x32_bf16 v[152:155], a[36:39], a[92:95], v[152:155]
    s_xor_b32 s7, s1, 0
    ds_read_b128 a[8:11], v10 offset:2048
    v_mfma_f32_16x16x32_bf16 v[152:155], a[32:35], a[88:91], v[152:155]
    v_mfma_f32_16x16x32_bf16 v[156:159], a[40:43], a[88:91], v[156:159]
    v_mfma_f32_16x16x32_bf16 v[156:159], a[44:47], a[92:95], v[156:159]
    buffer_load_dwordx4 v14, s[16:19], s7 offen  lds
    v_mfma_f32_16x16x32_bf16 v[148:151], a[44:47], a[84:87], v[148:151]
    s_xor_b32 m0, s58, 33792
    ds_read_b128 a[12:15], v11 offset:2048
    s_xor_b32 s7, s0, 8192
    v_mfma_f32_16x16x32_bf16 v[148:151], a[40:43], a[80:83], v[148:151]
    v_mfma_f32_16x16x32_bf16 v[140:143], a[40:43], a[72:75], v[140:143]
    ds_read_b128 a[16:19], v10 offset:4096
    v_mfma_f32_16x16x32_bf16 v[140:143], a[44:47], a[76:79], v[140:143]
    v_mfma_f32_16x16x32_bf16 v[132:135], a[44:47], a[68:71], v[132:135]
    buffer_load_dwordx4 v13, s[12:15], s7 offen  lds
    v_mfma_f32_16x16x32_bf16 v[132:135], a[40:43], a[64:67], v[132:135]
    s_xor_b32 m0, s59, 33792
    ds_read_b128 a[20:23], v11 offset:4096
    s_xor_b32 s7, s1, 32768
    v_mfma_f32_16x16x32_bf16 v[160:163], a[48:51], a[64:67], v[160:163]
    v_mfma_f32_16x16x32_bf16 v[160:163], a[52:55], a[68:71], v[160:163]
    v_mfma_f32_16x16x32_bf16 v[168:171], a[52:55], a[76:79], v[168:171]
    ds_read_b128 a[24:27], v10 offset:6144
    v_mfma_f32_16x16x32_bf16 v[168:171], a[48:51], a[72:75], v[168:171]
    buffer_load_dwordx4 v14, s[16:19], s7 offen  lds
    v_mfma_f32_16x16x32_bf16 v[176:179], a[48:51], a[80:83], v[176:179]
    v_mfma_f32_16x16x32_bf16 v[176:179], a[52:55], a[84:87], v[176:179]
    s_xor_b32 m0, s58, 34816
    ds_read_b128 a[28:31], v11 offset:6144
    s_xor_b32 s7, s0, 16384
    v_mfma_f32_16x16x32_bf16 v[184:187], a[52:55], a[92:95], v[184:187]
    v_mfma_f32_16x16x32_bf16 v[184:187], a[48:51], a[88:91], v[184:187]
    v_mfma_f32_16x16x32_bf16 v[188:191], a[56:59], a[88:91], v[188:191]
    v_mfma_f32_16x16x32_bf16 v[188:191], a[60:63], a[92:95], v[188:191]
    buffer_load_dwordx4 v12, s[12:15], s7 offen  lds
    v_mfma_f32_16x16x32_bf16 v[180:183], a[60:63], a[84:87], v[180:183]
    s_xor_b32 m0, s59, 34816
    s_xor_b32 s7, s1, 65536
    v_mfma_f32_16x16x32_bf16 v[180:183], a[56:59], a[80:83], v[180:183]
    v_mfma_f32_16x16x32_bf16 v[172:175], a[56:59], a[72:75], v[172:175]
    v_mfma_f32_16x16x32_bf16 v[172:175], a[60:63], a[76:79], v[172:175]
    v_mfma_f32_16x16x32_bf16 v[164:167], a[60:63], a[68:71], v[164:167]
    buffer_load_dwordx4 v15, s[16:19], s7 offen  lds
    v_mfma_f32_16x16x32_bf16 v[164:167], a[56:59], a[64:67], v[164:167]
    s_xor_b32 m0, s58, 35840
    s_xor_b32 s7, s0, 24576
    v_mfma_f32_16x16x32_bf16 v[192:195], a[32:35], a[96:99], v[192:195]
    ds_read_b64_tr_b16 a[64:65], v2 offset:0
    v_mfma_f32_16x16x32_bf16 v[192:195], a[36:39], a[100:103], v[192:195]
    ds_read_b64_tr_b16 a[66:67], v2 offset:1024
    v_mfma_f32_16x16x32_bf16 v[200:203], a[36:39], a[108:111], v[200:203]
    ds_read_b64_tr_b16 a[68:69], v2 offset:8192
    v_mfma_f32_16x16x32_bf16 v[200:203], a[32:35], a[104:107], v[200:203]
    buffer_load_dwordx4 v13, s[12:15], s7 offen  lds
    v_mfma_f32_16x16x32_bf16 v[208:211], a[32:35], a[112:115], v[208:211]
    s_xor_b32 m0, s59, 35840
    ds_read_b64_tr_b16 a[70:71], v2 offset:9216
    s_xor_b32 s7, s1, 98304
    v_mfma_f32_16x16x32_bf16 v[208:211], a[36:39], a[116:119], v[208:211]
    ds_read_b64_tr_b16 a[72:73], v3 offset:0
    v_mfma_f32_16x16x32_bf16 v[216:219], a[36:39], a[124:127], v[216:219]
    ds_read_b64_tr_b16 a[74:75], v3 offset:1024
    v_mfma_f32_16x16x32_bf16 v[216:219], a[32:35], a[120:123], v[216:219]
    v_mfma_f32_16x16x32_bf16 v[220:223], a[40:43], a[120:123], v[220:223]
    buffer_load_dwordx4 v15, s[16:19], s7 offen  lds
    v_mfma_f32_16x16x32_bf16 v[220:223], a[44:47], a[124:127], v[220:223]
    ds_read_b64_tr_b16 a[76:77], v3 offset:8192
    v_mfma_f32_16x16x32_bf16 v[212:215], a[44:47], a[116:119], v[212:215]
    s_xor_b32 m0, s58, 36864
    ds_read_b64_tr_b16 a[78:79], v3 offset:9216
    s_xor_b32 s7, s0, 32768
    v_mfma_f32_16x16x32_bf16 v[212:215], a[40:43], a[112:115], v[212:215]
    ds_read_b64_tr_b16 a[80:81], v4 offset:0
    v_mfma_f32_16x16x32_bf16 v[204:207], a[40:43], a[104:107], v[204:207]
    ds_read_b64_tr_b16 a[82:83], v4 offset:1024
    v_mfma_f32_16x16x32_bf16 v[204:207], a[44:47], a[108:111], v[204:207]
    ds_read_b64_tr_b16 a[84:85], v4 offset:8192
    v_mfma_f32_16x16x32_bf16 v[196:199], a[44:47], a[100:103], v[196:199]
    buffer_load_dwordx4 v12, s[12:15], s7 offen  lds
    v_mfma_f32_16x16x32_bf16 v[196:199], a[40:43], a[96:99], v[196:199]
    s_xor_b32 m0, s59, 36864
    ds_read_b64_tr_b16 a[86:87], v4 offset:9216
    s_xor_b32 s7, s1, 131072
    v_mfma_f32_16x16x32_bf16 v[224:227], a[48:51], a[96:99], v[224:227]
    ds_read_b64_tr_b16 a[88:89], v5 offset:0
    v_mfma_f32_16x16x32_bf16 v[224:227], a[52:55], a[100:103], v[224:227]
    ds_read_b64_tr_b16 a[90:91], v5 offset:1024
    v_mfma_f32_16x16x32_bf16 v[232:235], a[52:55], a[108:111], v[232:235]
    v_mfma_f32_16x16x32_bf16 v[232:235], a[48:51], a[104:107], v[232:235]
    buffer_load_dwordx4 v14, s[16:19], s7 offen  lds
    v_mfma_f32_16x16x32_bf16 v[240:243], a[48:51], a[112:115], v[240:243]
    s_xor_b32 m0, s58, 37888
    ds_read_b64_tr_b16 a[92:93], v5 offset:8192
    s_xor_b32 s7, s0, 40960
    v_mfma_f32_16x16x32_bf16 v[240:243], a[52:55], a[116:119], v[240:243]
    ds_read_b64_tr_b16 a[94:95], v5 offset:9216
    v_mfma_f32_16x16x32_bf16 v[248:251], a[52:55], a[124:127], v[248:251]
    v_mfma_f32_16x16x32_bf16 v[248:251], a[48:51], a[120:123], v[248:251]
    v_mfma_f32_16x16x32_bf16 v[252:255], a[56:59], a[120:123], v[252:255]
    buffer_load_dwordx4 v13, s[12:15], s7 offen  lds
    v_mfma_f32_16x16x32_bf16 v[252:255], a[60:63], a[124:127], v[252:255]
    s_xor_b32 m0, s59, 37888
    s_xor_b32 s7, s1, 163840
    v_mfma_f32_16x16x32_bf16 v[244:247], a[60:63], a[116:119], v[244:247]
    v_mfma_f32_16x16x32_bf16 v[244:247], a[56:59], a[112:115], v[244:247]
    v_mfma_f32_16x16x32_bf16 v[236:239], a[56:59], a[104:107], v[236:239]
    v_mfma_f32_16x16x32_bf16 v[236:239], a[60:63], a[108:111], v[236:239]
    buffer_load_dwordx4 v14, s[16:19], s7 offen  lds
    v_mfma_f32_16x16x32_bf16 v[228:231], a[60:63], a[100:103], v[228:231]
    v_mfma_f32_16x16x32_bf16 v[228:231], a[56:59], a[96:99], v[228:231]
    s_xor_b32 m0, s58, 38912
    s_xor_b32 s7, s0, 49152
    s_waitcnt lgkmcnt(0)
    v_mfma_f32_16x16x32_bf16 v[64:67], a[0:3], a[64:67], v[64:67]
    ds_read_b64_tr_b16 a[96:97], v6 offset:0
    v_mfma_f32_16x16x32_bf16 v[64:67], a[4:7], a[68:71], v[64:67]
    ds_read_b64_tr_b16 a[98:99], v6 offset:1024
    v_mfma_f32_16x16x32_bf16 v[72:75], a[4:7], a[76:79], v[72:75]
    v_mfma_f32_16x16x32_bf16 v[72:75], a[0:3], a[72:75], v[72:75]
    buffer_load_dwordx4 v12, s[12:15], s7 offen  lds
    v_mfma_f32_16x16x32_bf16 v[80:83], a[0:3], a[80:83], v[80:83]
    s_xor_b32 m0, s59, 38912
    ds_read_b64_tr_b16 a[100:101], v6 offset:8192
    s_xor_b32 s7, s1, 196608
    v_mfma_f32_16x16x32_bf16 v[80:83], a[4:7], a[84:87], v[80:83]
    ds_read_b64_tr_b16 a[102:103], v6 offset:9216
    v_mfma_f32_16x16x32_bf16 v[88:91], a[4:7], a[92:95], v[88:91]
    ds_read_b64_tr_b16 a[104:105], v7 offset:0
    v_mfma_f32_16x16x32_bf16 v[88:91], a[0:3], a[88:91], v[88:91]
    ds_read_b64_tr_b16 a[106:107], v7 offset:1024
    v_mfma_f32_16x16x32_bf16 v[92:95], a[8:11], a[88:91], v[92:95]
    buffer_load_dwordx4 v15, s[16:19], s7 offen  lds
    v_mfma_f32_16x16x32_bf16 v[92:95], a[12:15], a[92:95], v[92:95]
    s_xor_b32 m0, s58, 39936
    ds_read_b64_tr_b16 a[108:109], v7 offset:8192
    s_xor_b32 s7, s0, 57344
    v_mfma_f32_16x16x32_bf16 v[84:87], a[12:15], a[84:87], v[84:87]
    ds_read_b64_tr_b16 a[110:111], v7 offset:9216
    v_mfma_f32_16x16x32_bf16 v[84:87], a[8:11], a[80:83], v[84:87]
    v_mfma_f32_16x16x32_bf16 v[76:79], a[8:11], a[72:75], v[76:79]
    ds_read_b64_tr_b16 a[112:113], v8 offset:0
    v_mfma_f32_16x16x32_bf16 v[76:79], a[12:15], a[76:79], v[76:79]
    buffer_load_dwordx4 v13, s[12:15], s7 offen  lds
    v_mfma_f32_16x16x32_bf16 v[68:71], a[12:15], a[68:71], v[68:71]
    s_xor_b32 m0, s59, 39936
    ds_read_b64_tr_b16 a[114:115], v8 offset:1024
    s_xor_b32 s7, s1, 229376
    v_mfma_f32_16x16x32_bf16 v[68:71], a[8:11], a[64:67], v[68:71]
    ds_read_b64_tr_b16 a[116:117], v8 offset:8192
    v_mfma_f32_16x16x32_bf16 v[96:99], a[16:19], a[64:67], v[96:99]
    ds_read_b64_tr_b16 a[118:119], v8 offset:9216
    v_mfma_f32_16x16x32_bf16 v[96:99], a[20:23], a[68:71], v[96:99]
    v_mfma_f32_16x16x32_bf16 v[104:107], a[20:23], a[76:79], v[104:107]
    buffer_load_dwordx4 v15, s[16:19], s7 offen  lds
    v_mfma_f32_16x16x32_bf16 v[104:107], a[16:19], a[72:75], v[104:107]
    ds_read_b64_tr_b16 a[120:121], v9 offset:0
    v_mfma_f32_16x16x32_bf16 v[112:115], a[16:19], a[80:83], v[112:115]
    ds_read_b64_tr_b16 a[122:123], v9 offset:1024
    v_mfma_f32_16x16x32_bf16 v[112:115], a[20:23], a[84:87], v[112:115]
    ds_read_b64_tr_b16 a[124:125], v9 offset:8192
    v_mfma_f32_16x16x32_bf16 v[120:123], a[20:23], a[92:95], v[120:123]
    ds_read_b64_tr_b16 a[126:127], v9 offset:9216
    v_mfma_f32_16x16x32_bf16 v[120:123], a[16:19], a[88:91], v[120:123]
    v_mfma_f32_16x16x32_bf16 v[124:127], a[24:27], a[88:91], v[124:127]
    v_mfma_f32_16x16x32_bf16 v[124:127], a[28:31], a[92:95], v[124:127]
    v_mfma_f32_16x16x32_bf16 v[116:119], a[28:31], a[84:87], v[116:119]
    v_mfma_f32_16x16x32_bf16 v[116:119], a[24:27], a[80:83], v[116:119]
    s_add_u32 s7, s56, 768
    v_mfma_f32_16x16x32_bf16 v[108:111], a[24:27], a[72:75], v[108:111]
    buffer_load_dword v30, v16, s[12:15], s7 offen
    v_mfma_f32_16x16x32_bf16 v[108:111], a[28:31], a[76:79], v[108:111]
    v_mfma_f32_16x16x32_bf16 v[100:103], a[28:31], a[68:71], v[100:103]
    v_mfma_f32_16x16x32_bf16 v[100:103], a[24:27], a[64:67], v[100:103]
    s_add_u32 s7, s71, 3145728
    s_waitcnt lgkmcnt(0)
    v_mfma_f32_16x16x32_bf16 a[128:131], a[0:3], a[96:99], a[128:131]
    ds_read_b128 a[32:35], v10 offset:8192
    v_mfma_f32_16x16x32_bf16 a[128:131], a[4:7], a[100:103], a[128:131]
    v_mfma_f32_16x16x32_bf16 a[136:139], a[4:7], a[108:111], a[136:139]
    buffer_load_dword v30, v17, s[16:19], s7 offen
    v_mfma_f32_16x16x32_bf16 a[136:139], a[0:3], a[104:107], a[136:139]
    ds_read_b128 a[36:39], v11 offset:8192
    v_mfma_f32_16x16x32_bf16 a[144:147], a[0:3], a[112:115], a[144:147]
    v_mfma_f32_16x16x32_bf16 a[144:147], a[4:7], a[116:119], a[144:147]
    s_add_u32 s7, s73, 66048
    ds_read_b128 a[40:43], v10 offset:10240
    v_mfma_f32_16x16x32_bf16 a[152:155], a[4:7], a[124:127], a[152:155]
    v_mfma_f32_16x16x32_bf16 a[152:155], a[0:3], a[120:123], a[152:155]
    v_mfma_f32_16x16x32_bf16 a[156:159], a[8:11], a[120:123], a[156:159]
    buffer_load_dword v30, v27, s[52:55], s7 offen
    v_mfma_f32_16x16x32_bf16 a[156:159], a[12:15], a[124:127], a[156:159]
    ds_read_b128 a[44:47], v11 offset:10240
    v_mfma_f32_16x16x32_bf16 a[148:151], a[12:15], a[116:119], a[148:151]
    v_mfma_f32_16x16x32_bf16 a[148:151], a[8:11], a[112:115], a[148:151]
    ds_read_b128 a[48:51], v10 offset:12288
    v_mfma_f32_16x16x32_bf16 a[140:143], a[8:11], a[104:107], a[140:143]
    v_mfma_f32_16x16x32_bf16 a[140:143], a[12:15], a[108:111], a[140:143]
    ds_read_b128 a[52:55], v11 offset:12288
    v_mfma_f32_16x16x32_bf16 a[132:135], a[12:15], a[100:103], a[132:135]
    v_mfma_f32_16x16x32_bf16 a[132:135], a[8:11], a[96:99], a[132:135]
    v_mfma_f32_16x16x32_bf16 v[32:35], a[16:19], a[96:99], v[32:35]
    ds_read_b128 a[56:59], v10 offset:14336
    v_mfma_f32_16x16x32_bf16 v[32:35], a[20:23], a[100:103], v[32:35]
    v_mfma_f32_16x16x32_bf16 v[40:43], a[20:23], a[108:111], v[40:43]
    v_mfma_f32_16x16x32_bf16 v[40:43], a[16:19], a[104:107], v[40:43]
    ds_read_b128 a[60:63], v11 offset:14336
    v_mfma_f32_16x16x32_bf16 v[48:51], a[16:19], a[112:115], v[48:51]
    v_mfma_f32_16x16x32_bf16 v[48:51], a[20:23], a[116:119], v[48:51]
    v_mfma_f32_16x16x32_bf16 v[56:59], a[20:23], a[124:127], v[56:59]
    v_mfma_f32_16x16x32_bf16 v[56:59], a[16:19], a[120:123], v[56:59]
    v_mfma_f32_16x16x32_bf16 v[60:63], a[24:27], a[120:123], v[60:63]
    v_mfma_f32_16x16x32_bf16 v[60:63], a[28:31], a[124:127], v[60:63]
    v_mfma_f32_16x16x32_bf16 v[52:55], a[28:31], a[116:119], v[52:55]
    v_mfma_f32_16x16x32_bf16 v[52:55], a[24:27], a[112:115], v[52:55]
    v_mfma_f32_16x16x32_bf16 v[44:47], a[24:27], a[104:107], v[44:47]
    v_mfma_f32_16x16x32_bf16 v[44:47], a[28:31], a[108:111], v[44:47]
    v_mfma_f32_16x16x32_bf16 v[36:39], a[28:31], a[100:103], v[36:39]
    v_mfma_f32_16x16x32_bf16 v[36:39], a[24:27], a[96:99], v[36:39]
    s_waitcnt lgkmcnt(0)
    v_mfma_f32_16x16x32_bf16 v[192:195], a[32:35], a[96:99], v[192:195]
    s_waitcnt vmcnt(3) lgkmcnt(0)
    s_barrier
    v_mfma_f32_16x16x32_bf16 v[192:195], a[36:39], a[100:103], v[192:195]
    ds_read_b128 a[0:3], v10 offset:32768
    v_mfma_f32_16x16x32_bf16 v[200:203], a[36:39], a[108:111], v[200:203]
    v_mfma_f32_16x16x32_bf16 v[200:203], a[32:35], a[104:107], v[200:203]
    s_add_u32 s0, s56, 768
    s_xor_b32 m0, s58, 0
    s_xor_b32 s7, s0, 0
    v_mfma_f32_16x16x32_bf16 v[208:211], a[32:35], a[112:115], v[208:211]
    buffer_load_dwordx4 v12, s[12:15], s7 offen  lds
    v_mfma_f32_16x16x32_bf16 v[208:211], a[36:39], a[116:119], v[208:211]
    s_add_u32 s1, s57, 3145728
    ds_read_b128 a[4:7], v11 offset:32768
    s_xor_b32 m0, s59, 0
    v_mfma_f32_16x16x32_bf16 v[216:219], a[36:39], a[124:127], v[216:219]
    s_xor_b32 s7, s1, 0
    ds_read_b128 a[8:11], v10 offset:34816
    v_mfma_f32_16x16x32_bf16 v[216:219], a[32:35], a[120:123], v[216:219]
    v_mfma_f32_16x16x32_bf16 v[220:223], a[40:43], a[120:123], v[220:223]
    buffer_load_dwordx4 v14, s[16:19], s7 offen  lds
    v_mfma_f32_16x16x32_bf16 v[220:223], a[44:47], a[124:127], v[220:223]
    s_xor_b32 m0, s58, 1024
    s_xor_b32 s7, s0, 8192
    v_mfma_f32_16x16x32_bf16 v[212:215], a[44:47], a[116:119], v[212:215]
    ds_read_b128 a[12:15], v11 offset:34816
    v_mfma_f32_16x16x32_bf16 v[212:215], a[40:43], a[112:115], v[212:215]
    v_mfma_f32_16x16x32_bf16 v[204:207], a[40:43], a[104:107], v[204:207]
    buffer_load_dwordx4 v13, s[12:15], s7 offen  lds
    v_mfma_f32_16x16x32_bf16 v[204:207], a[44:47], a[108:111], v[204:207]
    s_xor_b32 m0, s59, 1024
    ds_read_b128 a[16:19], v10 offset:36864
    s_xor_b32 s7, s1, 32768
    v_mfma_f32_16x16x32_bf16 v[196:199], a[44:47], a[100:103], v[196:199]
    v_mfma_f32_16x16x32_bf16 v[196:199], a[40:43], a[96:99], v[196:199]
    ds_read_b128 a[20:23], v11 offset:36864
    v_mfma_f32_16x16x32_bf16 v[224:227], a[48:51], a[96:99], v[224:227]
    buffer_load_dwordx4 v14, s[16:19], s7 offen  lds
    v_mfma_f32_16x16x32_bf16 v[224:227], a[52:55], a[100:103], v[224:227]
    s_xor_b32 m0, s58, 2048
    s_xor_b32 s7, s0, 16384
    v_mfma_f32_16x16x32_bf16 v[232:235], a[52:55], a[108:111], v[232:235]
    ds_read_b128 a[24:27], v10 offset:38912
    v_mfma_f32_16x16x32_bf16 v[232:235], a[48:51], a[104:107], v[232:235]
    v_mfma_f32_16x16x32_bf16 v[240:243], a[48:51], a[112:115], v[240:243]
    buffer_load_dwordx4 v12, s[12:15], s7 offen  lds
    v_mfma_f32_16x16x32_bf16 v[240:243], a[52:55], a[116:119], v[240:243]
    s_xor_b32 m0, s59, 2048
    ds_read_b128 a[28:31], v11 offset:38912
    s_xor_b32 s7, s1, 65536
    v_mfma_f32_16x16x32_bf16 v[248:251], a[52:55], a[124:127], v[248:251]
    v_mfma_f32_16x16x32_bf16 v[248:251], a[48:51], a[120:123], v[248:251]
    v_mfma_f32_16x16x32_bf16 v[252:255], a[56:59], a[120:123], v[252:255]
    v_mfma_f32_16x16x32_bf16 v[252:255], a[60:63], a[124:127], v[252:255]
    buffer_load_dwordx4 v15, s[16:19], s7 offen  lds
    v_mfma_f32_16x16x32_bf16 v[244:247], a[60:63], a[116:119], v[244:247]
    s_xor_b32 m0, s58, 3072
    s_xor_b32 s7, s0, 24576
    v_mfma_f32_16x16x32_bf16 v[244:247], a[56:59], a[112:115], v[244:247]
    v_mfma_f32_16x16x32_bf16 v[236:239], a[56:59], a[104:107], v[236:239]
    v_mfma_f32_16x16x32_bf16 v[236:239], a[60:63], a[108:111], v[236:239]
    buffer_load_dwordx4 v13, s[12:15], s7 offen  lds
    v_mfma_f32_16x16x32_bf16 v[228:231], a[60:63], a[100:103], v[228:231]
    s_xor_b32 m0, s59, 3072
    s_xor_b32 s7, s1, 98304
    v_mfma_f32_16x16x32_bf16 v[228:231], a[56:59], a[96:99], v[228:231]
    v_mfma_f32_16x16x32_bf16 v[128:131], a[32:35], a[64:67], v[128:131]
    ds_read_b64_tr_b16 a[96:97], v6 offset:32768
    v_mfma_f32_16x16x32_bf16 v[128:131], a[36:39], a[68:71], v[128:131]
    buffer_load_dwordx4 v15, s[16:19], s7 offen  lds
    v_mfma_f32_16x16x32_bf16 v[136:139], a[36:39], a[76:79], v[136:139]
    s_xor_b32 m0, s58, 4096
    ds_read_b64_tr_b16 a[98:99], v6 offset:33792
    s_xor_b32 s7, s0, 32768
    v_mfma_f32_16x16x32_bf16 v[136:139], a[32:35], a[72:75], v[136:139]
    ds_read_b64_tr_b16 a[100:101], v6 offset:40960
    v_mfma_f32_16x16x32_bf16 v[144:147], a[32:35], a[80:83], v[144:147]
    ds_read_b64_tr_b16 a[102:103], v6 offset:41984
    v_mfma_f32_16x16x32_bf16 v[144:147], a[36:39], a[84:87], v[144:147]
    buffer_load_dwordx4 v12, s[12:15], s7 offen  lds
    v_mfma_f32_16x16x32_bf16 v[152:155], a[36:39], a[92:95], v[152:155]
    s_xor_b32 m0, s59, 4096
    ds_read_b64_tr_b16 a[104:105], v7 offset:32768
    s_xor_b32 s7, s1, 131072
    v_mfma_f32_16x16x32_bf16 v[152:155], a[32:35], a[88:91], v[152:155]
    ds_read_b64_tr_b16 a[106:107], v7 offset:33792
    v_mfma_f32_16x16x32_bf16 v[156:159], a[40:43], a[88:91], v[156:159]
    ds_read_b64_tr_b16 a[108:109], v7 offset:40960
    v_mfma_f32_16x16x32_bf16 v[156:159], a[44:47], a[92:95], v[156:159]
    ds_read_b64_tr_b16 a[110:111], v7 offset:41984
    v_mfma_f32_16x16x32_bf16 v[148:151], a[44:47], a[84:87], v[148:151]
    buffer_load_dwordx4 v14, s[16:19], s7 offen  lds
    v_mfma_f32_16x16x32_bf16 v[148:151], a[40:43], a[80:83], v[148:151]
    s_xor_b32 m0, s58, 5120
    s_xor_b32 s7, s0, 40960
    v_mfma_f32_16x16x32_bf16 v[140:143], a[40:43], a[72:75], v[140:143]
    ds_read_b64_tr_b16 a[112:113], v8 offset:32768
    v_mfma_f32_16x16x32_bf16 v[140:143], a[44:47], a[76:79], v[140:143]
    ds_read_b64_tr_b16 a[114:115], v8 offset:33792
    v_mfma_f32_16x16x32_bf16 v[132:135], a[44:47], a[68:71], v[132:135]
    buffer_load_dwordx4 v13, s[12:15], s7 offen  lds
    v_mfma_f32_16x16x32_bf16 v[132:135], a[40:43], a[64:67], v[132:135]
    s_xor_b32 m0, s59, 5120
    ds_read_b64_tr_b16 a[116:117], v8 offset:40960
    s_xor_b32 s7, s1, 163840
    v_mfma_f32_16x16x32_bf16 v[160:163], a[48:51], a[64:67], v[160:163]
    ds_read_b64_tr_b16 a[118:119], v8 offset:41984
    v_mfma_f32_16x16x32_bf16 v[160:163], a[52:55], a[68:71], v[160:163]
    ds_read_b64_tr_b16 a[120:121], v9 offset:32768
    v_mfma_f32_16x16x32_bf16 v[168:171], a[52:55], a[76:79], v[168:171]
    buffer_load_dwordx4 v14, s[16:19], s7 offen  lds
    v_mfma_f32_16x16x32_bf16 v[168:171], a[48:51], a[72:75], v[168:171]
    s_xor_b32 m0, s58, 6144
    ds_read_b64_tr_b16 a[122:123], v9 offset:33792
    s_xor_b32 s7, s0, 49152
    v_mfma_f32_16x16x32_bf16 v[176:179], a[48:51], a[80:83], v[176:179]
    ds_read_b64_tr_b16 a[124:125], v9 offset:40960
    v_mfma_f32_16x16x32_bf16 v[176:179], a[52:55], a[84:87], v[176:179]
    ds_read_b64_tr_b16 a[126:127], v9 offset:41984
    v_mfma_f32_16x16x32_bf16 v[184:187], a[52:55], a[92:95], v[184:187]
    buffer_load_dwordx4 v12, s[12:15], s7 offen  lds
    v_mfma_f32_16x16x32_bf16 v[184:187], a[48:51], a[88:91], v[184:187]
    s_xor_b32 m0, s59, 6144
    s_xor_b32 s7, s1, 196608
    v_mfma_f32_16x16x32_bf16 v[188:191], a[56:59], a[88:91], v[188:191]
    v_mfma_f32_16x16x32_bf16 v[188:191], a[60:63], a[92:95], v[188:191]
    v_mfma_f32_16x16x32_bf16 v[180:183], a[60:63], a[84:87], v[180:183]
    v_mfma_f32_16x16x32_bf16 v[180:183], a[56:59], a[80:83], v[180:183]
    buffer_load_dwordx4 v15, s[16:19], s7 offen  lds
    v_mfma_f32_16x16x32_bf16 v[172:175], a[56:59], a[72:75], v[172:175]
    s_xor_b32 m0, s58, 7168
    s_xor_b32 s7, s0, 57344
    v_mfma_f32_16x16x32_bf16 v[172:175], a[60:63], a[76:79], v[172:175]
    v_mfma_f32_16x16x32_bf16 v[164:167], a[60:63], a[68:71], v[164:167]
    v_mfma_f32_16x16x32_bf16 v[164:167], a[56:59], a[64:67], v[164:167]
    buffer_load_dwordx4 v13, s[12:15], s7 offen  lds
    s_waitcnt lgkmcnt(0)
    v_mfma_f32_16x16x32_bf16 a[128:131], a[0:3], a[96:99], a[128:131]
    s_xor_b32 m0, s59, 7168
    s_xor_b32 s7, s1, 229376
    v_mfma_f32_16x16x32_bf16 a[128:131], a[4:7], a[100:103], a[128:131]
    ds_read_b64_tr_b16 a[64:65], v2 offset:32768
    v_mfma_f32_16x16x32_bf16 a[136:139], a[4:7], a[108:111], a[136:139]
    ds_read_b64_tr_b16 a[66:67], v2 offset:33792
    v_mfma_f32_16x16x32_bf16 a[136:139], a[0:3], a[104:107], a[136:139]
    buffer_load_dwordx4 v15, s[16:19], s7 offen  lds
    v_mfma_f32_16x16x32_bf16 a[144:147], a[0:3], a[112:115], a[144:147]
    ds_read_b64_tr_b16 a[68:69], v2 offset:40960
    v_mfma_f32_16x16x32_bf16 a[144:147], a[4:7], a[116:119], a[144:147]
    ds_read_b64_tr_b16 a[70:71], v2 offset:41984
    v_mfma_f32_16x16x32_bf16 a[152:155], a[4:7], a[124:127], a[152:155]
    ds_read_b64_tr_b16 a[72:73], v3 offset:32768
    v_mfma_f32_16x16x32_bf16 a[152:155], a[0:3], a[120:123], a[152:155]
    buffer_load_dword v24, v23, s[48:51], 0 offen sc1
    v_mfma_f32_16x16x32_bf16 a[156:159], a[8:11], a[120:123], a[156:159]
    ds_read_b64_tr_b16 a[74:75], v3 offset:33792
    v_mfma_f32_16x16x32_bf16 a[156:159], a[12:15], a[124:127], a[156:159]
    ds_read_b64_tr_b16 a[76:77], v3 offset:40960
    v_mfma_f32_16x16x32_bf16 a[148:151], a[12:15], a[116:119], a[148:151]
    ds_read_b64_tr_b16 a[78:79], v3 offset:41984
    v_mfma_f32_16x16x32_bf16 a[148:151], a[8:11], a[112:115], a[148:151]
    v_mfma_f32_16x16x32_bf16 a[140:143], a[8:11], a[104:107], a[140:143]
    ds_read_b64_tr_b16 a[80:81], v4 offset:32768
    v_mfma_f32_16x16x32_bf16 a[140:143], a[12:15], a[108:111], a[140:143]
    ds_read_b64_tr_b16 a[82:83], v4 offset:33792
    v_mfma_f32_16x16x32_bf16 a[132:135], a[12:15], a[100:103], a[132:135]
    v_mfma_f32_16x16x32_bf16 a[132:135], a[8:11], a[96:99], a[132:135]
    s_add_u32 s7, s56, 896
    ds_read_b64_tr_b16 a[84:85], v4 offset:40960
    v_mfma_f32_16x16x32_bf16 v[32:35], a[16:19], a[96:99], v[32:35]
    buffer_load_dword v30, v16, s[12:15], s7 offen
    v_mfma_f32_16x16x32_bf16 v[32:35], a[20:23], a[100:103], v[32:35]
    s_add_u32 s7, s71, 3670016
    ds_read_b64_tr_b16 a[86:87], v4 offset:41984
    v_mfma_f32_16x16x32_bf16 v[40:43], a[20:23], a[108:111], v[40:43]
    ds_read_b64_tr_b16 a[88:89], v5 offset:32768
    v_mfma_f32_16x16x32_bf16 v[40:43], a[16:19], a[104:107], v[40:43]
    ds_read_b64_tr_b16 a[90:91], v5 offset:33792
    v_mfma_f32_16x16x32_bf16 v[48:51], a[16:19], a[112:115], v[48:51]
    buffer_load_dword v30, v17, s[16:19], s7 offen
    v_mfma_f32_16x16x32_bf16 v[48:51], a[20:23], a[116:119], v[48:51]
    s_add_u32 s0, s62, 1048576
    ds_read_b64_tr_b16 a[92:93], v5 offset:40960
    s_xor_b32 m0, s90, 131072
    v_mfma_f32_16x16x32_bf16 v[56:59], a[20:23], a[124:127], v[56:59]
    s_xor_b32 s7, s0, 0
    ds_read_b64_tr_b16 a[94:95], v5 offset:41984
    v_mfma_f32_16x16x32_bf16 v[56:59], a[16:19], a[120:123], v[56:59]
    v_mfma_f32_16x16x32_bf16 v[60:63], a[24:27], a[120:123], v[60:63]
    v_mfma_f32_16x16x32_bf16 v[60:63], a[28:31], a[124:127], v[60:63]
    buffer_load_dwordx4 v14, s[20:23], s7 offen lds
    v_mfma_f32_16x16x32_bf16 v[52:55], a[28:31], a[116:119], v[52:55]
    s_xor_b32 m0, s90, 132096
    s_xor_b32 s7, s0, 32768
    v_mfma_f32_16x16x32_bf16 v[52:55], a[24:27], a[112:115], v[52:55]
    v_mfma_f32_16x16x32_bf16 v[44:47], a[24:27], a[104:107], v[44:47]
    v_mfma_f32_16x16x32_bf16 v[44:47], a[28:31], a[108:111], v[44:47]
    buffer_load_dwordx4 v14, s[20:23], s7 offen lds
    v_mfma_f32_16x16x32_bf16 v[36:39], a[28:31], a[100:103], v[36:39]
    s_xor_b32 m0, s90, 133120
    s_xor_b32 s7, s0, 65536
    v_mfma_f32_16x16x32_bf16 v[36:39], a[24:27], a[96:99], v[36:39]
    s_waitcnt lgkmcnt(0)
    v_mfma_f32_16x16x32_bf16 v[64:67], a[0:3], a[64:67], v[64:67]
    ds_read_b128 a[32:35], v10 offset:40960
    v_mfma_f32_16x16x32_bf16 v[64:67], a[4:7], a[68:71], v[64:67]
    v_mfma_f32_16x16x32_bf16 v[72:75], a[4:7], a[76:79], v[72:75]
    buffer_load_dwordx4 v15, s[20:23], s7 offen lds
    v_mfma_f32_16x16x32_bf16 v[72:75], a[0:3], a[72:75], v[72:75]
    s_xor_b32 m0, s90, 134144
    ds_read_b128 a[36:39], v11 offset:40960
    s_xor_b32 s7, s0, 98304
    v_mfma_f32_16x16x32_bf16 v[80:83], a[0:3], a[80:83], v[80:83]
    v_mfma_f32_16x16x32_bf16 v[80:83], a[4:7], a[84:87], v[80:83]
    ds_read_b128 a[40:43], v10 offset:43008
    v_mfma_f32_16x16x32_bf16 v[88:91], a[4:7], a[92:95], v[88:91]
    v_mfma_f32_16x16x32_bf16 v[88:91], a[0:3], a[88:91], v[88:91]
    buffer_load_dwordx4 v15, s[20:23], s7 offen lds
    v_mfma_f32_16x16x32_bf16 v[92:95], a[8:11], a[88:91], v[92:95]
    s_add_u32 s0, s63, 352256
    s_add_u32 m0, s91, 131072
    s_add_u32 s7, s0, 0
    v_mfma_f32_16x16x32_bf16 v[92:95], a[12:15], a[92:95], v[92:95]
    ds_read_b128 a[44:47], v11 offset:43008
    v_mfma_f32_16x16x32_bf16 v[84:87], a[12:15], a[84:87], v[84:87]
    v_mfma_f32_16x16x32_bf16 v[84:87], a[8:11], a[80:83], v[84:87]
    buffer_load_dwordx4 v19, s[24:27], s7 offen lds
    v_mfma_f32_16x16x32_bf16 v[76:79], a[8:11], a[72:75], v[76:79]
    s_add_u32 m0, s91, 132096
    ds_read_b128 a[48:51], v10 offset:45056
    s_add_u32 s7, s0, 22016
    v_mfma_f32_16x16x32_bf16 v[76:79], a[12:15], a[76:79], v[76:79]
    ds_read_b128 a[52:55], v11 offset:45056
    v_mfma_f32_16x16x32_bf16 v[68:71], a[12:15], a[68:71], v[68:71]
    v_mfma_f32_16x16x32_bf16 v[68:71], a[8:11], a[64:67], v[68:71]
    v_mfma_f32_16x16x32_bf16 v[96:99], a[16:19], a[64:67], v[96:99]
    buffer_load_dwordx4 v20, s[24:27], s7 offen lds
    v_mfma_f32_16x16x32_bf16 v[96:99], a[20:23], a[68:71], v[96:99]
    s_add_u32 m0, s91, 139264
    ds_read_b128 a[56:59], v10 offset:47104
    s_add_u32 s7, s0, 0
    v_mfma_f32_16x16x32_bf16 v[104:107], a[20:23], a[76:79], v[104:107]
    v_mfma_f32_16x16x32_bf16 v[104:107], a[16:19], a[72:75], v[104:107]
    ds_read_b128 a[60:63], v11 offset:47104
    v_mfma_f32_16x16x32_bf16 v[112:115], a[16:19], a[80:83], v[112:115]
L_tp8:
    s_cbranch_execz L_tp12
    buffer_load_dwordx4 v19, s[28:31], s7 offen lds
    v_mfma_f32_16x16x32_bf16 v[112:115], a[20:23], a[84:87], v[112:115]
    s_add_u32 m0, s91, 140288
    s_add_u32 s7, s0, 22016
    v_mfma_f32_16x16x32_bf16 v[120:123], a[20:23], a[92:95], v[120:123]
    v_mfma_f32_16x16x32_bf16 v[120:123], a[16:19], a[88:91], v[120:123]
    v_mfma_f32_16x16x32_bf16 v[124:127], a[24:27], a[88:91], v[124:127]
    v_mfma_f32_16x16x32_bf16 v[124:127], a[28:31], a[92:95], v[124:127]
    buffer_load_dwordx4 v20, s[28:31], s7 offen lds
    v_mfma_f32_16x16x32_bf16 v[116:119], a[28:31], a[84:87], v[116:119]
    v_mfma_f32_16x16x32_bf16 v[116:119], a[24:27], a[80:83], v[116:119]
    v_mfma_f32_16x16x32_bf16 v[108:111], a[24:27], a[72:75], v[108:111]
    v_mfma_f32_16x16x32_bf16 v[108:111], a[28:31], a[76:79], v[108:111]
    v_mfma_f32_16x16x32_bf16 v[100:103], a[28:31], a[68:71], v[100:103]
    v_mfma_f32_16x16x32_bf16 v[100:103], a[24:27], a[64:67], v[100:103]
    s_waitcnt lgkmcnt(0)
    v_mfma_f32_16x16x32_bf16 v[128:131], a[32:35], a[64:67], v[128:131]
    s_waitcnt vmcnt(10) lgkmcnt(0)
    s_barrier
    v_cmp_gt_u32 vcc, 32, v24
    s_cbranch_vccnz L_poll_xnV
L_back_xnV:
    v_mfma_f32_16x16x32_bf16 v[128:131], a[36:39], a[68:71], v[128:131]
    ds_read_b128 a[0:3], v10 offset:0
    v_mfma_f32_16x16x32_bf16 v[136:139], a[36:39], a[76:79], v[136:139]
    v_mfma_f32_16x16x32_bf16 v[136:139], a[32:35], a[72:75], v[136:139]
    s_add_u32 s0, s56, 896
    s_xor_b32 m0, s58, 32768
    s_xor_b32 s7, s0, 0
    v_mfma_f32_16x16x32_bf16 v[144:147], a[32:35], a[80:83], v[144:147]
    buffer_load_dwordx4 v12, s[12:15], s7 offen  lds
    v_mfma_f32_16x16x32_bf16 v[144:147], a[36:39], a[84:87], v[144:147]
    ds_read_b128 a[4:7], v11 offset:0
    v_bfe_u32 v28, v31, 2, 2
    v_mfma_f32_16x16x32_bf16 v[152:155], a[36:39], a[92:95], v[152:155]
    v_lshrrev_b32 v26, 4, v31
    v_lshl_add_u32 v27, v26, 3, v28
    v_mfma_f32_16x16x32_bf16 v[152:155], a[32:35], a[88:91], v[152:155]
    v_lshrrev_b32 v28, 1, v28
    v_and_b32 v26, 1, v26
    v_mfma_f32_16x16x32_bf16 v[156:159], a[40:43], a[88:91], v[156:159]
    v_lshl_add_u32 v26, v26, 1, v28
    v_lshlrev_b32 v26, 5, v26
    v_mfma_f32_16x16x32_bf16 v[156:159], a[44:47], a[92:95], v[156:159]
    v_lshl_add_u32 v26, v27, 7, v26
    v_and_b32 v16, 3, v31
    v_lshl_add_u32 v16, v16, 3, v26
    v_xor_b32 v17, 32, v16
    v_xor_b32 v18, 64, v16
    s_add_u32 s1, s57, 3670016
    s_xor_b32 m0, s59, 32768
    s_xor_b32 s7, s1, 0
    buffer_load_dwordx4 v14, s[16:19], s7 offen  lds
    v_mfma_f32_16x16x32_bf16 v[148:151], a[44:47], a[84:87], v[148:151]
    s_xor_b32 m0, s58, 33792
    ds_read_b128 a[8:11], v10 offset:2048
    s_xor_b32 s7, s0, 8192
    v_mfma_f32_16x16x32_bf16 v[148:151], a[40:43], a[80:83], v[148:151]
    ds_read_b128 a[12:15], v11 offset:2048
    v_mfma_f32_16x16x32_bf16 v[140:143], a[40:43], a[72:75], v[140:143]
    ds_read_b128 a[16:19], v10 offset:4096
    v_mfma_f32_16x16x32_bf16 v[140:143], a[44:47], a[76:79], v[140:143]
    buffer_load_dwordx4 v13, s[12:15], s7 offen  lds
    v_mfma_f32_16x16x32_bf16 v[132:135], a[44:47], a[68:71], v[132:135]
    s_xor_b32 m0, s59, 33792
    s_xor_b32 s7, s1, 32768
    v_mfma_f32_16x16x32_bf16 v[132:135], a[40:43], a[64:67], v[132:135]
    ds_read_b128 a[20:23], v11 offset:4096
    v_mfma_f32_16x16x32_bf16 v[160:163], a[48:51], a[64:67], v[160:163]
    v_mfma_f32_16x16x32_bf16 v[160:163], a[52:55], a[68:71], v[160:163]
    buffer_load_dwordx4 v14, s[16:19], s7 offen  lds
    v_mfma_f32_16x16x32_bf16 v[168:171], a[52:55], a[76:79], v[168:171]
    s_xor_b32 m0, s58, 34816
    ds_read_b128 a[24:27], v10 offset:6144
    s_xor_b32 s7, s0, 16384
    v_mfma_f32_16x16x32_bf16 v[168:171], a[48:51], a[72:75], v[168:171]
    v_mfma_f32_16x16x32_bf16 v[176:179], a[48:51], a[80:83], v[176:179]
    v_mfma_f32_16x16x32_bf16 v[176:179], a[52:55], a[84:87], v[176:179]
    ds_read_b128 a[28:31], v11 offset:6144
    v_mfma_f32_16x16x32_bf16 v[184:187], a[52:55], a[92:95], v[184:187]
    buffer_load_dwordx4 v12, s[12:15], s7 offen  lds
    v_mfma_f32_16x16x32_bf16 v[184:187], a[48:51], a[88:91], v[184:187]
    s_xor_b32 m0, s59, 34816
    s_xor_b32 s7, s1, 65536
    v_mfma_f32_16x16x32_bf16 v[188:191], a[56:59], a[88:91], v[188:191]
    v_mfma_f32_16x16x32_bf16 v[188:191], a[60:63], a[92:95], v[188:191]
    v_mfma_f32_16x16x32_bf16 v[180:183], a[60:63], a[84:87], v[180:183]
    buffer_load_dwordx4 v15, s[16:19], s7 offen  lds
    v_mfma_f32_16x16x32_bf16 v[180:183], a[56:59], a[80:83], v[180:183]
    s_xor_b32 m0, s58, 35840
    s_xor_b32 s7, s0, 24576
    v_mfma_f32_16x16x32_bf16 v[172:175], a[56:59], a[72:75], v[172:175]
    v_mfma_f32_16x16x32_bf16 v[172:175], a[60:63], a[76:79], v[172:175]
    v_mfma_f32_16x16x32_bf16 v[164:167], a[60:63], a[68:71], v[164:167]
    v_mfma_f32_16x16x32_bf16 v[164:167], a[56:59], a[64:67], v[164:167]
    buffer_load_dwordx4 v13, s[12:15], s7 offen  lds
    v_mfma_f32_16x16x32_bf16 v[192:195], a[32:35], a[96:99], v[192:195]
    s_xor_b32 m0, s59, 35840
    s_xor_b32 s7, s1, 98304
    v_mfma_f32_16x16x32_bf16 v[192:195], a[36:39], a[100:103], v[192:195]
    ds_read_b64_tr_b16 a[64:65], v2 offset:0
    v_mfma_f32_16x16x32_bf16 v[200:203], a[36:39], a[108:111], v[200:203]
    ds_read_b64_tr_b16 a[66:67], v2 offset:1024
    v_mfma_f32_16x16x32_bf16 v[200:203], a[32:35], a[104:107], v[200:203]
    buffer_load_dwordx4 v15, s[16:19], s7 offen  lds
    v_mfma_f32_16x16x32_bf16 v[208:211], a[32:35], a[112:115], v[208:211]
    s_xor_b32 m0, s58, 36864
    ds_read_b64_tr_b16 a[68:69], v2 offset:8192
    s_xor_b32 s7, s0, 32768
    v_mfma_f32_16x16x32_bf16 v[208:211], a[36:39], a[116:119], v[208:211]
    ds_read_b64_tr_b16 a[70:71], v2 offset:9216
    v_mfma_f32_16x16x32_bf16 v[216:219], a[36:39], a[124:127], v[216:219]
    ds_read_b64_tr_b16 a[72:73], v3 offset:0
    v_mfma_f32_16x16x32_bf16 v[216:219], a[32:35], a[120:123], v[216:219]
    ds_read_b64_tr_b16 a[74:75], v3 offset:1024
    v_mfma_f32_16x16x32_bf16 v[220:223], a[40:43], a[120:123], v[220:223]
    buffer_load_dwordx4 v12, s[12:15], s7 offen  lds
    v_mfma_f32_16x16x32_bf16 v[220:223], a[44:47], a[124:127], v[220:223]
    s_xor_b32 m0, s59, 36864
    ds_read_b64_tr_b16 a[76:77], v3 offset:8192
    s_xor_b32 s7, s1, 131072
    v_mfma_f32_16x16x32_bf16 v[212:215], a[44:47], a[116:119], v[212:215]
    ds_read_b64_tr_b16 a[78:79], v3 offset:9216
    v_mfma_f32_16x16x32_bf16 v[212:215], a[40:43], a[112:115], v[212:215]
    ds_read_b64_tr_b16 a[80:81], v4 offset:0
    v_mfma_f32_16x16x32_bf16 v[204:207], a[40:43], a[104:107], v[204:207]
    buffer_load_dwordx4 v14, s[16:19], s7 offen  lds
    v_mfma_f32_16x16x32_bf16 v[204:207], a[44:47], a[108:111], v[204:207]
    s_xor_b32 m0, s58, 37888
    ds_read_b64_tr_b16 a[82:83], v4 offset:1024
    s_xor_b32 s7, s0, 40960
    v_mfma_f32_16x16x32_bf16 v[196:199], a[44:47], a[100:103], v[196:199]
    ds_read_b64_tr_b16 a[84:85], v4 offset:8192
    v_mfma_f32_16x16x32_bf16 v[196:199], a[40:43], a[96:99], v[196:199]
    ds_read_b64_tr_b16 a[86:87], v4 offset:9216
    v_mfma_f32_16x16x32_bf16 v[224:227], a[48:51], a[96:99], v[224:227]
    ds_read_b64_tr_b16 a[88:89], v5 offset:0
    v_mfma_f32_16x16x32_bf16 v[224:227], a[52:55], a[100:103], v[224:227]
    buffer_load_dwordx4 v13, s[12:15], s7 offen  lds
    v_mfma_f32_16x16x32_bf16 v[232:235], a[52:55], a[108:111], v[232:235]
    s_xor_b32 m0, s59, 37888
    ds_read_b64_tr_b16 a[90:91], v5 offset:1024
    s_xor_b32 s7, s1, 163840
    v_mfma_f32_16x16x32_bf16 v[232:235], a[48:51], a[104:107], v[232:235]
    ds_read_b64_tr_b16 a[92:93], v5 offset:8192
    v_mfma_f32_16x16x32_bf16 v[240:243], a[48:51], a[112:115], v[240:243]
    ds_read_b64_tr_b16 a[94:95], v5 offset:9216
    v_mfma_f32_16x16x32_bf16 v[240:243], a[52:55], a[116:119], v[240:243]
    buffer_load_dwordx4 v14, s[16:19], s7 offen  lds
    v_mfma_f32_16x16x32_bf16 v[248:251], a[52:55], a[124:127], v[248:251]
    s_xor_b32 m0, s58, 38912
    s_xor_b32 s7, s0, 49152
    v_mfma_f32_16x16x32_bf16 v[248:251], a[48:51], a[120:123], v[248:251]
    v_mfma_f32_16x16x32_bf16 v[252:255], a[56:59], a[120:123], v[252:255]
    v_mfma_f32_16x16x32_bf16 v[252:255], a[60:63], a[124:127], v[252:255]
    v_mfma_f32_16x16x32_bf16 v[244:247], a[60:63], a[116:119], v[244:247]
    buffer_load_dwordx4 v12, s[12:15], s7 offen  lds
    v_mfma_f32_16x16x32_bf16 v[244:247], a[56:59], a[112:115], v[244:247]
    s_xor_b32 m0, s59, 38912
    s_xor_b32 s7, s1, 196608
    v_mfma_f32_16x16x32_bf16 v[236:239], a[56:59], a[104:107], v[236:239]
    v_mfma_f32_16x16x32_bf16 v[236:239], a[60:63], a[108:111], v[236:239]
    v_mfma_f32_16x16x32_bf16 v[228:231], a[60:63], a[100:103], v[228:231]
    buffer_load_dwordx4 v15, s[16:19], s7 offen  lds
    v_mfma_f32_16x16x32_bf16 v[228:231], a[56:59], a[96:99], v[228:231]
    s_xor_b32 m0, s58, 39936
    s_xor_b32 s7, s0, 57344
    s_waitcnt lgkmcnt(0)
    v_mfma_f32_16x16x32_bf16 v[64:67], a[0:3], a[64:67], v[64:67]
    ds_read_b64_tr_b16 a[96:97], v6 offset:0
    v_mfma_f32_16x16x32_bf16 v[64:67], a[4:7], a[68:71], v[64:67]
    ds_read_b64_tr_b16 a[98:99], v6 offset:1024
    v_mfma_f32_16x16x32_bf16 v[72:75], a[4:7], a[76:79], v[72:75]
    v_mfma_f32_16x16x32_bf16 v[72:75], a[0:3], a[72:75], v[72:75]
    buffer_load_dwordx4 v13, s[12:15], s7 offen  lds
    v_mfma_f32_16x16x32_bf16 v[80:83], a[0:3], a[80:83], v[80:83]
    s_xor_b32 m0, s59, 39936
    ds_read_b64_tr_b16 a[100:101], v6 offset:8192
    s_xor_b32 s7, s1, 229376
    v_mfma_f32_16x16x32_bf16 v[80:83], a[4:7], a[84:87], v[80:83]
    ds_read_b64_tr_b16 a[102:103], v6 offset:9216
    v_mfma_f32_16x16x32_bf16 v[88:91], a[4:7], a[92:95], v[88:91]
    ds_read_b64_tr_b16 a[104:105], v7 offset:0
    v_mfma_f32_16x16x32_bf16 v[88:91], a[0:3], a[88:91], v[88:91]
    buffer_load_dwordx4 v15, s[16:19], s7 offen  lds
    v_mfma_f32_16x16x32_bf16 v[92:95], a[8:11], a[88:91], v[92:95]
    ds_read_b64_tr_b16 a[106:107], v7 offset:1024
    v_mfma_f32_16x16x32_bf16 v[92:95], a[12:15], a[92:95], v[92:95]
    ds_read_b64_tr_b16 a[108:109], v7 offset:8192
    v_mfma_f32_16x16x32_bf16 v[84:87], a[12:15], a[84:87], v[84:87]
    ds_read_b64_tr_b16 a[110:111], v7 offset:9216
    v_mfma_f32_16x16x32_bf16 v[84:87], a[8:11], a[80:83], v[84:87]
    v_mfma_f32_16x16x32_bf16 v[76:79], a[8:11], a[72:75], v[76:79]
    ds_read_b64_tr_b16 a[112:113], v8 offset:0
    v_mfma_f32_16x16x32_bf16 v[76:79], a[12:15], a[76:79], v[76:79]
    ds_read_b64_tr_b16 a[114:115], v8 offset:1024
    v_mfma_f32_16x16x32_bf16 v[68:71], a[12:15], a[68:71], v[68:71]
    v_mfma_f32_16x16x32_bf16 v[68:71], a[8:11], a[64:67], v[68:71]
    s_lshr_b32 s7, s2, 3
    v_lshlrev_b32 v28, 5, v0
    v_add_u32 v28, s7, v28
    v_mfma_f32_16x16x32_bf16 v[96:99], a[16:19], a[64:67], v[96:99]
    v_lshlrev_b32 v28, 7, v28
    v_min_u32 v28, L_tail2-L_B, v28
    v_mfma_f32_16x16x32_bf16 v[96:99], a[20:23], a[68:71], v[96:99]
    v_add_u32 v28, L_B-L_pc, v28
    global_load_dword v30, v28, s[100:101]
    v_mfma_f32_16x16x32_bf16 v[104:107], a[20:23], a[76:79], v[104:107]
    s_add_u32 s0, s61, 0
    ds_read_b64_tr_b16 a[116:117], v8 offset:8192
    s_add_u32 s7, s0, 0
    v_mfma_f32_16x16x32_bf16 v[104:107], a[16:19], a[72:75], v[104:107]
    ds_read_b64_tr_b16 a[118:119], v8 offset:9216
    v_mfma_f32_16x16x32_bf16 v[112:115], a[16:19], a[80:83], v[112:115]
    ds_read_b64_tr_b16 a[120:121], v9 offset:0
    v_mfma_f32_16x16x32_bf16 v[112:115], a[20:23], a[84:87], v[112:115]
    buffer_load_dwordx4 a[160:163], v1, s[8:11], s7 offen offset:0 sc1
    v_mfma_f32_16x16x32_bf16 v[120:123], a[20:23], a[92:95], v[120:123]
    ds_read_b64_tr_b16 a[122:123], v9 offset:1024
    v_mfma_f32_16x16x32_bf16 v[120:123], a[16:19], a[88:91], v[120:123]
    ds_read_b64_tr_b16 a[124:125], v9 offset:8192
    v_mfma_f32_16x16x32_bf16 v[124:127], a[24:27], a[88:91], v[124:127]
    ds_read_b64_tr_b16 a[126:127], v9 offset:9216
    v_mfma_f32_16x16x32_bf16 v[124:127], a[28:31], a[92:95], v[124:127]
    v_mfma_f32_16x16x32_bf16 v[116:119], a[28:31], a[84:87], v[116:119]
    buffer_load_dwordx4 a[164:167], v1, s[8:11], s7 offen offset:1024 sc1
    v_mfma_f32_16x16x32_bf16 v[116:119], a[24:27], a[80:83], v[116:119]
    v_mfma_f32_16x16x32_bf16 v[108:111], a[24:27], a[72:75], v[108:111]
    s_add_u32 s7, s0, 16384
    v_mfma_f32_16x16x32_bf16 v[108:111], a[28:31], a[76:79], v[108:111]
    v_mfma_f32_16x16x32_bf16 v[100:103], a[28:31], a[68:71], v[100:103]
    v_mfma_f32_16x16x32_bf16 v[100:103], a[24:27], a[64:67], v[100:103]
    buffer_load_dwordx4 a[168:171], v1, s[8:11], s7 offen offset:0 sc1
    s_waitcnt lgkmcnt(1)
    v_mfma_f32_16x16x32_bf16 a[128:131], a[0:3], a[96:99], a[128:131]
    ds_read_b128 a[32:35], v10 offset:8192
    v_mfma_f32_16x16x32_bf16 a[128:131], a[4:7], a[100:103], a[128:131]
    v_mfma_f32_16x16x32_bf16 a[136:139], a[4:7], a[108:111], a[136:139]
    ds_read_b128 a[36:39], v11 offset:8192
    v_mfma_f32_16x16x32_bf16 a[136:139], a[0:3], a[104:107], a[136:139]
    v_mfma_f32_16x16x32_bf16 a[144:147], a[0:3], a[112:115], a[144:147]
    buffer_load_dwordx4 a[172:175], v1, s[8:11], s7 offen offset:1024 sc1
    v_mfma_f32_16x16x32_bf16 a[144:147], a[4:7], a[116:119], a[144:147]
    ds_read_b128 a[40:43], v10 offset:10240
    s_waitcnt lgkmcnt(3)
    v_mfma_f32_16x16x32_bf16 a[152:155], a[4:7], a[124:127], a[152:155]
    s_add_u32 s7, s0, 32768
    v_mfma_f32_16x16x32_bf16 a[152:155], a[0:3], a[120:123], a[152:155]
    v_mfma_f32_16x16x32_bf16 a[156:159], a[8:11], a[120:123], a[156:159]
    ds_read_b128 a[44:47], v11 offset:10240
    v_mfma_f32_16x16x32_bf16 a[156:159], a[12:15], a[124:127], a[156:159]
    buffer_load_dwordx4 a[176:179], v1, s[8:11], s7 offen offset:0 sc1
    v_mfma_f32_16x16x32_bf16 a[148:151], a[12:15], a[116:119], a[148:151]
    v_mfma_f32_16x16x32_bf16 a[148:151], a[8:11], a[112:115], a[148:151]
    ds_read_b128 a[48:51], v10 offset:12288
    v_mfma_f32_16x16x32_bf16 a[140:143], a[8:11], a[104:107], a[140:143]
    v_mfma_f32_16x16x32_bf16 a[140:143], a[12:15], a[108:111], a[140:143]
    ds_read_b128 a[52:55], v11 offset:12288
    v_mfma_f32_16x16x32_bf16 a[132:135], a[12:15], a[100:103], a[132:135]
    buffer_load_dwordx4 a[180:183], v1, s[8:11], s7 offen offset:1024 sc1
    v_mfma_f32_16x16x32_bf16 a[132:135], a[8:11], a[96:99], a[132:135]
    v_mfma_f32_16x16x32_bf16 v[32:35], a[16:19], a[96:99], v[32:35]
    s_add_u32 s7, s0, 49152
    ds_read_b128 a[56:59], v10 offset:14336
    v_mfma_f32_16x16x32_bf16 v[32:35], a[20:23], a[100:103], v[32:35]
    v_mfma_f32_16x16x32_bf16 v[40:43], a[20:23], a[108:111], v[40:43]
    v_mfma_f32_16x16x32_bf16 v[40:43], a[16:19], a[104:107], v[40:43]
    buffer_load_dwordx4 a[184:187], v1, s[8:11], s7 offen offset:0 sc1
    v_mfma_f32_16x16x32_bf16 v[48:51], a[16:19], a[112:115], v[48:51]
    ds_read_b128 a[60:63], v11 offset:14336
    v_mfma_f32_16x16x32_bf16 v[48:51], a[20:23], a[116:119], v[48:51]
    v_mfma_f32_16x16x32_bf16 v[56:59], a[20:23], a[124:127], v[56:59]
    v_mfma_f32_16x16x32_bf16 v[56:59], a[16:19], a[120:123], v[56:59]
    v_mfma_f32_16x16x32_bf16 v[60:63], a[24:27], a[120:123], v[60:63]
    buffer_load_dwordx4 a[188:191], v1, s[8:11], s7 offen offset:1024 sc1
    v_mfma_f32_16x16x32_bf16 v[60:63], a[28:31], a[124:127], v[60:63]
    v_mfma_f32_16x16x32_bf16 v[52:55], a[28:31], a[116:119], v[52:55]
    v_mfma_f32_16x16x32_bf16 v[52:55], a[24:27], a[112:115], v[52:55]
    v_mfma_f32_16x16x32_bf16 v[44:47], a[24:27], a[104:107], v[44:47]
    v_mfma_f32_16x16x32_bf16 v[44:47], a[28:31], a[108:111], v[44:47]
    v_mfma_f32_16x16x32_bf16 v[36:39], a[28:31], a[100:103], v[36:39]
    v_mfma_f32_16x16x32_bf16 v[36:39], a[24:27], a[96:99], v[36:39]
    s_waitcnt lgkmcnt(0)
    v_mfma_f32_16x16x32_bf16 v[192:195], a[32:35], a[96:99], v[192:195]
    s_waitcnt vmcnt(9) lgkmcnt(0)
    s_barrier
    v_mfma_f32_16x16x32_bf16 v[192:195], a[36:39], a[100:103], v[192:195]
    ds_read_b128 a[0:3], v10 offset:32768
    v_mfma_f32_16x16x32_bf16 v[200:203], a[36:39], a[108:111], v[200:203]
    v_mfma_f32_16x16x32_bf16 v[200:203], a[32:35], a[104:107], v[200:203]
    s_add_u32 s0, s62, 0
    s_xor_b32 m0, s90, 0
    s_xor_b32 s7, s0, 0
    v_mfma_f32_16x16x32_bf16 v[208:211], a[32:35], a[112:115], v[208:211]
    buffer_load_dwordx4 v14, s[20:23], s7 offen lds
    v_mfma_f32_16x16x32_bf16 v[208:211], a[36:39], a[116:119], v[208:211]
    s_xor_b32 m0, s90, 1024
    ds_read_b128 a[4:7], v11 offset:32768
    s_xor_b32 s7, s0, 32768
    v_mfma_f32_16x16x32_bf16 v[216:219], a[36:39], a[124:127], v[216:219]
    ds_read_b128 a[8:11], v10 offset:34816
    v_mfma_f32_16x16x32_bf16 v[216:219], a[32:35], a[120:123], v[216:219]
    v_mfma_f32_16x16x32_bf16 v[220:223], a[40:43], a[120:123], v[220:223]
    buffer_load_dwordx4 v14, s[20:23], s7 offen lds
    v_mfma_f32_16x16x32_bf16 v[220:223], a[44:47], a[124:127], v[220:223]
    s_xor_b32 m0, s90, 2048
    s_xor_b32 s7, s0, 65536
    v_mfma_f32_16x16x32_bf16 v[212:215], a[44:47], a[116:119], v[212:215]
    ds_read_b128 a[12:15], v11 offset:34816
    v_mfma_f32_16x16x32_bf16 v[212:215], a[40:43], a[112:115], v[212:215]
    v_mfma_f32_16x16x32_bf16 v[204:207], a[40:43], a[104:107], v[204:207]
    buffer_load_dwordx4 v15, s[20:23], s7 offen lds
    v_mfma_f32_16x16x32_bf16 v[204:207], a[44:47], a[108:111], v[204:207]
    s_xor_b32 m0, s90, 3072
    ds_read_b128 a[16:19], v10 offset:36864
    s_xor_b32 s7, s0, 98304
    v_mfma_f32_16x16x32_bf16 v[196:199], a[44:47], a[100:103], v[196:199]
    v_mfma_f32_16x16x32_bf16 v[196:199], a[40:43], a[96:99], v[196:199]
    ds_read_b128 a[20:23], v11 offset:36864
    v_mfma_f32_16x16x32_bf16 v[224:227], a[48:51], a[96:99], v[224:227]
    v_mfma_f32_16x16x32_bf16 v[224:227], a[52:55], a[100:103], v[224:227]
    buffer_load_dwordx4 v15, s[20:23], s7 offen lds
    v_mfma_f32_16x16x32_bf16 v[232:235], a[52:55], a[108:111], v[232:235]
    s_add_u32 s0, s63, 0
    s_add_u32 m0, s91, 0
    s_add_u32 s7, s0, 0
    v_mfma_f32_16x16x32_bf16 v[232:235], a[48:51], a[104:107], v[232:235]
    ds_read_b128 a[24:27], v10 offset:38912
    v_mfma_f32_16x16x32_bf16 v[240:243], a[48:51], a[112:115], v[240:243]
    v_mfma_f32_16x16x32_bf16 v[240:243], a[52:55], a[116:119], v[240:243]
    buffer_load_dwordx4 v19, s[24:27], s7 offen lds
    v_mfma_f32_16x16x32_bf16 v[248:251], a[52:55], a[124:127], v[248:251]
    s_add_u32 m0, s91, 1024
    ds_read_b128 a[28:31], v11 offset:38912
    s_add_u32 s7, s0, 22016
    v_mfma_f32_16x16x32_bf16 v[248:251], a[48:51], a[120:123], v[248:251]
    v_mfma_f32_16x16x32_bf16 v[252:255], a[56:59], a[120:123], v[252:255]
    v_mfma_f32_16x16x32_bf16 v[252:255], a[60:63], a[124:127], v[252:255]
    buffer_load_dwordx4 v20, s[24:27], s7 offen lds
    v_mfma_f32_16x16x32_bf16 v[244:247], a[60:63], a[116:119], v[244:247]
    s_add_u32 m0, s91, 8192
    s_add_u32 s7, s0, 0
    v_mfma_f32_16x16x32_bf16 v[244:247], a[56:59], a[112:115], v[244:247]
    v_mfma_f32_16x16x32_bf16 v[236:239], a[56:59], a[104:107], v[236:239]
    v_mfma_f32_16x16x32_bf16 v[236:239], a[60:63], a[108:111], v[236:239]
    v_mfma_f32_16x16x32_bf16 v[228:231], a[60:63], a[100:103], v[228:231]
    buffer_load_dwordx4 v19, s[28:31], s7 offen lds
    v_mfma_f32_16x16x32_bf16 v[228:231], a[56:59], a[96:99], v[228:231]
    s_add_u32 m0, s91, 9216
    s_add_u32 s7, s0, 22016
    v_mfma_f32_16x16x32_bf16 v[128:131], a[32:35], a[64:67], v[128:131]
    ds_read_b64_tr_b16 a[96:97], v6 offset:32768
    v_mfma_f32_16x16x32_bf16 v[128:131], a[36:39], a[68:71], v[128:131]
    ds_read_b64_tr_b16 a[98:99], v6 offset:33792
    v_mfma_f32_16x16x32_bf16 v[136:139], a[36:39], a[76:79], v[136:139]
    buffer_load_dwordx4 v20, s[28:31], s7 offen lds
    v_mfma_f32_16x16x32_bf16 v[136:139], a[32:35], a[72:75], v[136:139]
    s_add_u32 s0, s61, 2048
    ds_read_b64_tr_b16 a[100:101], v6 offset:40960
    s_add_u32 s7, s0, 0
    v_mfma_f32_16x16x32_bf16 v[144:147], a[32:35], a[80:83], v[144:147]
    ds_read_b64_tr_b16 a[102:103], v6 offset:41984
    v_mfma_f32_16x16x32_bf16 v[144:147], a[36:39], a[84:87], v[144:147]
    ds_read_b64_tr_b16 a[104:105], v7 offset:32768
    v_mfma_f32_16x16x32_bf16 v[152:155], a[36:39], a[92:95], v[152:155]
    buffer_load_dwordx4 a[192:195], v1, s[8:11], s7 offen offset:0 sc1
    v_mfma_f32_16x16x32_bf16 v[152:155], a[32:35], a[88:91], v[152:155]
    ds_read_b64_tr_b16 a[106:107], v7 offset:33792
    v_mfma_f32_16x16x32_bf16 v[156:159], a[40:43], a[88:91], v[156:159]
    ds_read_b64_tr_b16 a[108:109], v7 offset:40960
    v_mfma_f32_16x16x32_bf16 v[156:159], a[44:47], a[92:95], v[156:159]
    ds_read_b64_tr_b16 a[110:111], v7 offset:41984
    v_mfma_f32_16x16x32_bf16 v[148:151], a[44:47], a[84:87], v[148:151]
    v_mfma_f32_16x16x32_bf16 v[148:151], a[40:43], a[80:83], v[148:151]
    buffer_load_dwordx4 a[196:199], v1, s[8:11], s7 offen offset:1024 sc1
    v_mfma_f32_16x16x32_bf16 v[140:143], a[40:43], a[72:75], v[140:143]
    s_add_u32 s7, s0, 16384
    ds_read_b64_tr_b16 a[112:113], v8 offset:32768
    v_mfma_f32_16x16x32_bf16 v[140:143], a[44:47], a[76:79], v[140:143]
    ds_read_b64_tr_b16 a[114:115], v8 offset:33792
    v_mfma_f32_16x16x32_bf16 v[132:135], a[44:47], a[68:71], v[132:135]
    ds_read_b64_tr_b16 a[116:117], v8 offset:40960
    v_mfma_f32_16x16x32_bf16 v[132:135], a[40:43], a[64:67], v[132:135]
    buffer_load_dwordx4 a[200:203], v1, s[8:11], s7 offen offset:0 sc1
    v_mfma_f32_16x16x32_bf16 v[160:163], a[48:51], a[64:67], v[160:163]
    ds_read_b64_tr_b16 a[118:119], v8 offset:41984
    v_mfma_f32_16x16x32_bf16 v[160:163], a[52:55], a[68:71], v[160:163]
    ds_read_b64_tr_b16 a[120:121], v9 offset:32768
    v_mfma_f32_16x16x32_bf16 v[168:171], a[52:55], a[76:79], v[168:171]
    ds_read_b64_tr_b16 a[122:123], v9 offset:33792
    v_mfma_f32_16x16x32_bf16 v[168:171], a[48:51], a[72:75], v[168:171]
    buffer_load_dwordx4 a[204:207], v1, s[8:11], s7 offen offset:1024 sc1
    v_mfma_f32_16x16x32_bf16 v[176:179], a[48:51], a[80:83], v[176:179]
    ds_read_b64_tr_b16 a[124:125], v9 offset:40960
    v_mfma_f32_16x16x32_bf16 v[176:179], a[52:55], a[84:87], v[176:179]
    s_add_u32 s7, s0, 32768
    ds_read_b64_tr_b16 a[126:127], v9 offset:41984
    v_mfma_f32_16x16x32_bf16 v[184:187], a[52:55], a[92:95], v[184:187]
    v_mfma_f32_16x16x32_bf16 v[184:187], a[48:51], a[88:91], v[184:187]
    v_mfma_f32_16x16x32_bf16 v[188:191], a[56:59], a[88:91], v[188:191]
    buffer_load_dwordx4 a[208:211], v1, s[8:11], s7 offen offset:0 sc1
    v_mfma_f32_16x16x32_bf16 v[188:191], a[60:63], a[92:95], v[188:191]
    v_mfma_f32_16x16x32_bf16 v[180:183], a[60:63], a[84:87], v[180:183]
    v_mfma_f32_16x16x32_bf16 v[180:183], a[56:59], a[80:83], v[180:183]
    v_mfma_f32_16x16x32_bf16 v[172:175], a[56:59], a[72:75], v[172:175]
    buffer_load_dwordx4 a[212:215], v1, s[8:11], s7 offen offset:1024 sc1
    v_mfma_f32_16x16x32_bf16 v[172:175], a[60:63], a[76:79], v[172:175]
    s_add_u32 s7, s0, 49152
    v_mfma_f32_16x16x32_bf16 v[164:167], a[60:63], a[68:71], v[164:167]
    v_mfma_f32_16x16x32_bf16 v[164:167], a[56:59], a[64:67], v[164:167]
    s_waitcnt lgkmcnt(0)
    v_mfma_f32_16x16x32_bf16 a[128:131], a[0:3], a[96:99], a[128:131]
    buffer_load_dwordx4 a[216:219], v1, s[8:11], s7 offen offset:0 sc1
    v_mfma_f32_16x16x32_bf16 a[128:131], a[4:7], a[100:103], a[128:131]
    ds_read_b64_tr_b16 a[64:65], v2 offset:32768
    v_mfma_f32_16x16x32_bf16 a[136:139], a[4:7], a[108:111], a[136:139]
    ds_read_b64_tr_b16 a[66:67], v2 offset:33792
    v_mfma_f32_16x16x32_bf16 a[136:139], a[0:3], a[104:107], a[136:139]
    ds_read_b64_tr_b16 a[68:69], v2 offset:40960
    v_mfma_f32_16x16x32_bf16 a[144:147], a[0:3], a[112:115], a[144:147]
    ds_read_b64_tr_b16 a[70:71], v2 offset:41984
    v_mfma_f32_16x16x32_bf16 a[144:147], a[4:7], a[116:119], a[144:147]
    buffer_load_dwordx4 a[220:223], v1, s[8:11], s7 offen offset:1024 sc1
    v_mfma_f32_16x16x32_bf16 a[152:155], a[4:7], a[124:127], a[152:155]
    s_add_u32 s0, s61, 4096
    s_add_u32 s7, s0, 0
    v_mfma_f32_16x16x32_bf16 a[152:155], a[0:3], a[120:123], a[152:155]
    ds_read_b64_tr_b16 a[72:73], v3 offset:32768
    v_mfma_f32_16x16x32_bf16 a[156:159], a[8:11], a[120:123], a[156:159]
    ds_read_b64_tr_b16 a[74:75], v3 offset:33792
    v_mfma_f32_16x16x32_bf16 a[156:159], a[12:15], a[124:127], a[156:159]
    buffer_load_dwordx4 a[224:227], v1, s[8:11], s7 offen offset:0 sc1
    v_mfma_f32_16x16x32_bf16 a[148:151], a[12:15], a[116:119], a[148:151]
    ds_read_b64_tr_b16 a[76:77], v3 offset:40960
    v_mfma_f32_16x16x32_bf16 a[148:151], a[8:11], a[112:115], a[148:151]
    ds_read_b64_tr_b16 a[78:79], v3 offset:41984
    v_mfma_f32_16x16x32_bf16 a[140:143], a[8:11], a[104:107], a[140:143]
    ds_read_b64_tr_b16 a[80:81], v4 offset:32768
    v_mfma_f32_16x16x32_bf16 a[140:143], a[12:15], a[108:111], a[140:143]
    buffer_load_dwordx4 a[228:231], v1, s[8:11], s7 offen offset:1024 sc1
    v_mfma_f32_16x16x32_bf16 a[132:135], a[12:15], a[100:103], a[132:135]
    ds_read_b64_tr_b16 a[82:83], v4 offset:33792
    v_mfma_f32_16x16x32_bf16 a[132:135], a[8:11], a[96:99], a[132:135]
    s_add_u32 s7, s0, 16384
    ds_read_b64_tr_b16 a[84:85], v4 offset:40960
    v_mfma_f32_16x16x32_bf16 v[32:35], a[16:19], a[96:99], v[32:35]
    ds_read_b64_tr_b16 a[86:87], v4 offset:41984
    v_mfma_f32_16x16x32_bf16 v[32:35], a[20:23], a[100:103], v[32:35]
    v_mfma_f32_16x16x32_bf16 v[40:43], a[20:23], a[108:111], v[40:43]
    buffer_load_dwordx4 a[232:235], v1, s[8:11], s7 offen offset:0 sc1
    v_mfma_f32_16x16x32_bf16 v[40:43], a[16:19], a[104:107], v[40:43]
    ds_read_b64_tr_b16 a[88:89], v5 offset:32768
    v_mfma_f32_16x16x32_bf16 v[48:51], a[16:19], a[112:115], v[48:51]
    ds_read_b64_tr_b16 a[90:91], v5 offset:33792
    v_mfma_f32_16x16x32_bf16 v[48:51], a[20:23], a[116:119], v[48:51]
    ds_read_b64_tr_b16 a[92:93], v5 offset:40960
    v_mfma_f32_16x16x32_bf16 v[56:59], a[20:23], a[124:127], v[56:59]
    buffer_load_dwordx4 a[236:239], v1, s[8:11], s7 offen offset:1024 sc1
    v_mfma_f32_16x16x32_bf16 v[56:59], a[16:19], a[120:123], v[56:59]
    s_add_u32 s7, s0, 32768
    ds_read_b64_tr_b16 a[94:95], v5 offset:41984
    v_mfma_f32_16x16x32_bf16 v[60:63], a[24:27], a[120:123], v[60:63]
    v_mfma_f32_16x16x32_bf16 v[60:63], a[28:31], a[124:127], v[60:63]
    v_mfma_f32_16x16x32_bf16 v[52:55], a[28:31], a[116:119], v[52:55]
    buffer_load_dwordx4 a[240:243], v1, s[8:11], s7 offen offset:0 sc1
    v_mfma_f32_16x16x32_bf16 v[52:55], a[24:27], a[112:115], v[52:55]
    v_mfma_f32_16x16x32_bf16 v[44:47], a[24:27], a[104:107], v[44:47]
    v_mfma_f32_16x16x32_bf16 v[44:47], a[28:31], a[108:111], v[44:47]
    v_mfma_f32_16x16x32_bf16 v[36:39], a[28:31], a[100:103], v[36:39]
    v_mfma_f32_16x16x32_bf16 v[36:39], a[24:27], a[96:99], v[36:39]
    buffer_load_dwordx4 a[244:247], v1, s[8:11], s7 offen offset:1024 sc1
    s_waitcnt lgkmcnt(1)
    v_mfma_f32_16x16x32_bf16 v[64:67], a[0:3], a[64:67], v[64:67]
    s_add_u32 s7, s0, 49152
    ds_read_b128 a[32:35], v10 offset:40960
    v_mfma_f32_16x16x32_bf16 v[64:67], a[4:7], a[68:71], v[64:67]
    v_mfma_f32_16x16x32_bf16 v[72:75], a[4:7], a[76:79], v[72:75]
    ds_read_b128 a[36:39], v11 offset:40960
    v_mfma_f32_16x16x32_bf16 v[72:75], a[0:3], a[72:75], v[72:75]
    buffer_load_dwordx4 a[248:251], v1, s[8:11], s7 offen offset:0 sc1
    v_mfma_f32_16x16x32_bf16 v[80:83], a[0:3], a[80:83], v[80:83]
    v_cvt_pk_bf16_f32 v32, v32, v33
    v_cvt_pk_bf16_f32 v33, v34, v35
    v_mfma_f32_16x16x32_bf16 v[80:83], a[4:7], a[84:87], v[80:83]
    ds_read_b128 a[40:43], v10 offset:43008
    s_waitcnt lgkmcnt(2)
    v_cvt_pk_bf16_f32 v34, v36, v37
    v_mfma_f32_16x16x32_bf16 v[88:91], a[4:7], a[92:95], v[88:91]
    v_cvt_pk_bf16_f32 v35, v38, v39
    v_cvt_pk_bf16_f32 v40, v40, v41
    v_mfma_f32_16x16x32_bf16 v[88:91], a[0:3], a[88:91], v[88:91]
    buffer_load_dwordx4 a[252:255], v1, s[8:11], s7 offen offset:1024 sc1
    v_mfma_f32_16x16x32_bf16 v[92:95], a[8:11], a[88:91], v[92:95]
    ds_read_b128 a[44:47], v11 offset:43008
    v_cvt_pk_bf16_f32 v41, v42, v43
    v_mfma_f32_16x16x32_bf16 v[92:95], a[12:15], a[92:95], v[92:95]
    v_cvt_pk_bf16_f32 v42, v44, v45
    v_cvt_pk_bf16_f32 v43, v46, v47
    v_mfma_f32_16x16x32_bf16 v[84:87], a[12:15], a[84:87], v[84:87]
    v_cvt_pk_bf16_f32 v48, v48, v49
    v_cvt_pk_bf16_f32 v49, v50, v51
    v_mfma_f32_16x16x32_bf16 v[84:87], a[8:11], a[80:83], v[84:87]
    ds_read_b128 a[48:51], v10 offset:45056
    v_cvt_pk_bf16_f32 v50, v52, v53
    v_mfma_f32_16x16x32_bf16 v[76:79], a[8:11], a[72:75], v[76:79]
    v_cvt_pk_bf16_f32 v51, v54, v55
    v_cvt_pk_bf16_f32 v56, v56, v57
    v_mfma_f32_16x16x32_bf16 v[76:79], a[12:15], a[76:79], v[76:79]
    ds_read_b128 a[52:55], v11 offset:45056
    v_cvt_pk_bf16_f32 v57, v58, v59
    v_mfma_f32_16x16x32_bf16 v[68:71], a[12:15], a[68:71], v[68:71]
    v_cvt_pk_bf16_f32 v58, v60, v61
    v_cvt_pk_bf16_f32 v59, v62, v63
    v_mfma_f32_16x16x32_bf16 v[68:71], a[8:11], a[64:67], v[68:71]
    v_accvgpr_read_b32 v26, a128
    v_accvgpr_read_b32 v27, a129
    v_mfma_f32_16x16x32_bf16 v[96:99], a[16:19], a[64:67], v[96:99]
    ds_read_b128 a[56:59], v10 offset:47104
    v_cvt_pk_bf16_f32 v36, v26, v27
    v_mfma_f32_16x16x32_bf16 v[96:99], a[20:23], a[68:71], v[96:99]
    s_add_u32 s7, s95, 4096
    v_accvgpr_read_b32 v26, a130
    v_accvgpr_read_b32 v27, a131
    v_mfma_f32_16x16x32_bf16 v[104:107], a[20:23], a[76:79], v[104:107]
    buffer_store_dwordx4 v[32:35], v1, s[8:11], s7 offen sc1
    v_mfma_f32_16x16x32_bf16 v[104:107], a[16:19], a[72:75], v[104:107]
    ds_read_b128 a[60:63], v11 offset:47104
    v_cvt_pk_bf16_f32 v37, v26, v27
    v_mfma_f32_16x16x32_bf16 v[112:115], a[16:19], a[80:83], v[112:115]
    v_accvgpr_read_b32 v26, a132
    v_accvgpr_read_b32 v27, a133
    v_mfma_f32_16x16x32_bf16 v[112:115], a[20:23], a[84:87], v[112:115]
L_tp9:
    s_cbranch_execz L_tp13
    v_cvt_pk_bf16_f32 v38, v26, v27
    v_accvgpr_read_b32 v26, a134
    v_mfma_f32_16x16x32_bf16 v[120:123], a[20:23], a[92:95], v[120:123]
    v_accvgpr_read_b32 v27, a135
    v_cvt_pk_bf16_f32 v39, v26, v27
    v_mfma_f32_16x16x32_bf16 v[120:123], a[16:19], a[88:91], v[120:123]
    v_accvgpr_read_b32 v26, a136
    v_accvgpr_read_b32 v27, a137
    v_mfma_f32_16x16x32_bf16 v[124:127], a[24:27], a[88:91], v[124:127]
    v_cvt_pk_bf16_f32 v44, v26, v27
    v_accvgpr_read_b32 v26, a138
    v_mfma_f32_16x16x32_bf16 v[124:127], a[28:31], a[92:95], v[124:127]
    v_accvgpr_read_b32 v27, a139
    v_cvt_pk_bf16_f32 v45, v26, v27
    v_mfma_f32_16x16x32_bf16 v[116:119], a[28:31], a[84:87], v[116:119]
    v_accvgpr_read_b32 v26, a140
    v_accvgpr_read_b32 v27, a141
    v_mfma_f32_16x16x32_bf16 v[116:119], a[24:27], a[80:83], v[116:119]
    v_cvt_pk_bf16_f32 v46, v26, v27
    v_accvgpr_read_b32 v26, a142
    v_mfma_f32_16x16x32_bf16 v[108:111], a[24:27], a[72:75], v[108:111]
    v_accvgpr_read_b32 v27, a143
    v_cvt_pk_bf16_f32 v47, v26, v27
    v_mfma_f32_16x16x32_bf16 v[108:111], a[28:31], a[76:79], v[108:111]
    v_accvgpr_read_b32 v26, a144
    v_accvgpr_read_b32 v27, a145
    v_mfma_f32_16x16x32_bf16 v[100:103], a[28:31], a[68:71], v[100:103]
    v_cvt_pk_bf16_f32 v52, v26, v27
    v_accvgpr_read_b32 v26, a146
    v_mfma_f32_16x16x32_bf16 v[100:103], a[24:27], a[64:67], v[100:103]
    v_accvgpr_read_b32 v27, a147
    v_cvt_pk_bf16_f32 v53, v26, v27
    v_mfma_f32_16x16x32_bf16 v[128:131], a[32:35], a[64:67], v[128:131]
    s_waitcnt vmcnt(17) lgkmcnt(0)
    s_barrier
    v_accvgpr_read_b32 v26, a148
    v_mfma_f32_16x16x32_bf16 v[128:131], a[36:39], a[68:71], v[128:131]
    s_add_u32 s0, s62, 524288
    s_xor_b32 m0, s90, 32768
    s_xor_b32 s7, s0, 0
    v_mfma_f32_16x16x32_bf16 v[136:139], a[36:39], a[76:79], v[136:139]
    buffer_load_dwordx4 v14, s[20:23], s7 offen lds
    v_mfma_f32_16x16x32_bf16 v[136:139], a[32:35], a[72:75], v[136:139]
    v_and_b32 v2, 0x3fff, v2
    v_and_b32 v3, 0x3fff, v3
    v_mfma_f32_16x16x32_bf16 v[144:147], a[32:35], a[80:83], v[144:147]
    s_xor_b32 m0, s90, 33792
    s_xor_b32 s7, s0, 32768
    v_and_b32 v4, 0x3fff, v4
    v_mfma_f32_16x16x32_bf16 v[144:147], a[36:39], a[84:87], v[144:147]
    v_and_b32 v5, 0x3fff, v5
    v_and_b32 v6, 0x3fff, v6
    v_mfma_f32_16x16x32_bf16 v[152:155], a[36:39], a[92:95], v[152:155]
    v_and_b32 v7, 0x3fff, v7
    v_and_b32 v8, 0x3fff, v8
    v_mfma_f32_16x16x32_bf16 v[152:155], a[32:35], a[88:91], v[152:155]
    v_and_b32 v9, 0x3fff, v9
    v_accvgpr_read_b32 v27, a149
    v_mfma_f32_16x16x32_bf16 v[156:159], a[40:43], a[88:91], v[156:159]
    buffer_load_dwordx4 v14, s[20:23], s7 offen lds
    v_mfma_f32_16x16x32_bf16 v[156:159], a[44:47], a[92:95], v[156:159]
    v_cvt_pk_bf16_f32 v54, v26, v27
    v_accvgpr_read_b32 v26, a150
    v_mfma_f32_16x16x32_bf16 v[148:151], a[44:47], a[84:87], v[148:151]
    s_xor_b32 m0, s90, 34816
    s_xor_b32 s7, s0, 65536
    v_accvgpr_read_b32 v27, a151
    v_mfma_f32_16x16x32_bf16 v[148:151], a[40:43], a[80:83], v[148:151]
    v_cvt_pk_bf16_f32 v55, v26, v27
    v_accvgpr_read_b32 v26, a152
    v_mfma_f32_16x16x32_bf16 v[140:143], a[40:43], a[72:75], v[140:143]
    v_accvgpr_read_b32 v27, a153
    v_cvt_pk_bf16_f32 v60, v26, v27
    v_mfma_f32_16x16x32_bf16 v[140:143], a[44:47], a[76:79], v[140:143]
    v_accvgpr_read_b32 v26, a154
    v_accvgpr_read_b32 v27, a155
    v_mfma_f32_16x16x32_bf16 v[132:135], a[44:47], a[68:71], v[132:135]
    buffer_load_dwordx4 v15, s[20:23], s7 offen lds
    v_mfma_f32_16x16x32_bf16 v[132:135], a[40:43], a[64:67], v[132:135]
    v_cvt_pk_bf16_f32 v61, v26, v27
    v_accvgpr_read_b32 v26, a156
    v_mfma_f32_16x16x32_bf16 v[160:163], a[48:51], a[64:67], v[160:163]
    s_xor_b32 m0, s90, 35840
    s_xor_b32 s7, s0, 98304
    v_accvgpr_read_b32 v27, a157
    v_mfma_f32_16x16x32_bf16 v[160:163], a[52:55], a[68:71], v[160:163]
    v_cvt_pk_bf16_f32 v62, v26, v27
    v_accvgpr_read_b32 v26, a158
    v_mfma_f32_16x16x32_bf16 v[168:171], a[52:55], a[76:79], v[168:171]
    v_accvgpr_read_b32 v27, a159
    v_cvt_pk_bf16_f32 v63, v26, v27
    v_mfma_f32_16x16x32_bf16 v[168:171], a[48:51], a[72:75], v[168:171]
    v_accvgpr_write_b32 a140, v56
    v_accvgpr_write_b32 a141, v57
    v_mfma_f32_16x16x32_bf16 v[176:179], a[48:51], a[80:83], v[176:179]
    buffer_load_dwordx4 v15, s[20:23], s7 offen lds
    v_mfma_f32_16x16x32_bf16 v[176:179], a[52:55], a[84:87], v[176:179]
    v_accvgpr_write_b32 a142, v58
    v_accvgpr_write_b32 a143, v59
    v_mfma_f32_16x16x32_bf16 v[184:187], a[52:55], a[92:95], v[184:187]
    v_accvgpr_write_b32 a144, v36
    v_accvgpr_write_b32 a145, v37
    v_mfma_f32_16x16x32_bf16 v[184:187], a[48:51], a[88:91], v[184:187]
    s_add_u32 s7, s95, 5120
    v_accvgpr_write_b32 a146, v38
    v_accvgpr_write_b32 a147, v39
    v_mfma_f32_16x16x32_bf16 v[188:191], a[56:59], a[88:91], v[188:191]
    v_accvgpr_write_b32 a148, v44
    v_accvgpr_write_b32 a149, v45
    v_mfma_f32_16x16x32_bf16 v[188:191], a[60:63], a[92:95], v[188:191]
    v_accvgpr_write_b32 a150, v46
    v_accvgpr_write_b32 a151, v47
    v_mfma_f32_16x16x32_bf16 v[180:183], a[60:63], a[84:87], v[180:183]
    buffer_store_dwordx4 v[40:43], v1, s[8:11], s7 offen sc1
    v_mfma_f32_16x16x32_bf16 v[180:183], a[56:59], a[80:83], v[180:183]
    v_accvgpr_write_b32 a152, v52
    v_accvgpr_write_b32 a153, v53
    v_mfma_f32_16x16x32_bf16 v[172:175], a[56:59], a[72:75], v[172:175]
    s_add_u32 s0, s63, 176128
    s_add_u32 m0, s91, 32768
    s_add_u32 s7, s0, 0
    v_mfma_f32_16x16x32_bf16 v[172:175], a[60:63], a[76:79], v[172:175]
    v_accvgpr_write_b32 a154, v54
    v_accvgpr_write_b32 a155, v55
    v_mfma_f32_16x16x32_bf16 v[164:167], a[60:63], a[68:71], v[164:167]
    v_accvgpr_write_b32 a156, v60
    v_accvgpr_write_b32 a157, v61
    v_mfma_f32_16x16x32_bf16 v[164:167], a[56:59], a[64:67], v[164:167]
    v_accvgpr_write_b32 a158, v62
    v_accvgpr_write_b32 a159, v63
    v_mfma_f32_16x16x32_bf16 v[192:195], a[32:35], a[96:99], v[192:195]
    buffer_load_dwordx4 v19, s[24:27], s7 offen lds
    v_mfma_f32_16x16x32_bf16 v[192:195], a[36:39], a[100:103], v[192:195]
    v_cvt_pk_bf16_f32 v64, v64, v65
    v_cvt_pk_bf16_f32 v65, v66, v67
    v_mfma_f32_16x16x32_bf16 v[200:203], a[36:39], a[108:111], v[200:203]
    s_add_u32 m0, s91, 33792
    s_add_u32 s7, s0, 22016
    v_cvt_pk_bf16_f32 v66, v68, v69
    v_mfma_f32_16x16x32_bf16 v[200:203], a[32:35], a[104:107], v[200:203]
    v_cvt_pk_bf16_f32 v67, v70, v71
    v_accvgpr_write_b32 a0, v64
    v_mfma_f32_16x16x32_bf16 v[208:211], a[32:35], a[112:115], v[208:211]
    v_accvgpr_write_b32 a1, v65
    v_accvgpr_write_b32 a2, v66
    v_mfma_f32_16x16x32_bf16 v[208:211], a[36:39], a[116:119], v[208:211]
    v_accvgpr_write_b32 a3, v67
    v_cvt_pk_bf16_f32 v72, v72, v73
    v_mfma_f32_16x16x32_bf16 v[216:219], a[36:39], a[124:127], v[216:219]
    buffer_load_dwordx4 v20, s[24:27], s7 offen lds
    v_mfma_f32_16x16x32_bf16 v[216:219], a[32:35], a[120:123], v[216:219]
    v_cvt_pk_bf16_f32 v73, v74, v75
    v_cvt_pk_bf16_f32 v74, v76, v77
    v_mfma_f32_16x16x32_bf16 v[220:223], a[40:43], a[120:123], v[220:223]
    s_add_u32 m0, s91, 40960
    s_add_u32 s7, s0, 0
    v_cvt_pk_bf16_f32 v75, v78, v79
    v_mfma_f32_16x16x32_bf16 v[220:223], a[44:47], a[124:127], v[220:223]
    v_accvgpr_write_b32 a4, v72
    v_accvgpr_write_b32 a5, v73
    v_mfma_f32_16x16x32_bf16 v[212:215], a[44:47], a[116:119], v[212:215]
    v_accvgpr_write_b32 a6, v74
    v_accvgpr_write_b32 a7, v75
    v_mfma_f32_16x16x32_bf16 v[212:215], a[40:43], a[112:115], v[212:215]
    v_cvt_pk_bf16_f32 v80, v80, v81
    v_cvt_pk_bf16_f32 v81, v82, v83
    v_mfma_f32_16x16x32_bf16 v[204:207], a[40:43], a[104:107], v[204:207]
    buffer_load_dwordx4 v19, s[28:31], s7 offen lds
    v_mfma_f32_16x16x32_bf16 v[204:207], a[44:47], a[108:111], v[204:207]
    v_cvt_pk_bf16_f32 v82, v84, v85
    v_cvt_pk_bf16_f32 v83, v86, v87
    v_mfma_f32_16x16x32_bf16 v[196:199], a[44:47], a[100:103], v[196:199]
    s_add_u32 m0, s91, 41984
    ds_read_b64_tr_b16 a[64:65], v2 offset:0
    s_add_u32 s7, s0, 22016
    v_mfma_f32_16x16x32_bf16 v[196:199], a[40:43], a[96:99], v[196:199]
    ds_read_b64_tr_b16 a[66:67], v2 offset:1024
    v_accvgpr_write_b32 a8, v80
    v_mfma_f32_16x16x32_bf16 v[224:227], a[48:51], a[96:99], v[224:227]
    v_accvgpr_write_b32 a9, v81
    v_accvgpr_write_b32 a10, v82
    v_mfma_f32_16x16x32_bf16 v[224:227], a[52:55], a[100:103], v[224:227]
    ds_read_b64_tr_b16 a[68:69], v2 offset:8192
    v_accvgpr_write_b32 a11, v83
    v_mfma_f32_16x16x32_bf16 v[232:235], a[52:55], a[108:111], v[232:235]
    buffer_load_dwordx4 v20, s[28:31], s7 offen lds
    v_mfma_f32_16x16x32_bf16 v[232:235], a[48:51], a[104:107], v[232:235]
    ds_read_b64_tr_b16 a[70:71], v2 offset:9216
    v_cvt_pk_bf16_f32 v88, v88, v89
    v_mfma_f32_16x16x32_bf16 v[240:243], a[48:51], a[112:115], v[240:243]
    ds_read_b64_tr_b16 a[72:73], v3 offset:0
    v_cvt_pk_bf16_f32 v89, v90, v91
    v_mfma_f32_16x16x32_bf16 v[240:243], a[52:55], a[116:119], v[240:243]
    s_add_u32 s7, s95, 6144
    ds_read_b64_tr_b16 a[74:75], v3 offset:1024
    v_cvt_pk_bf16_f32 v90, v92, v93
    v_mfma_f32_16x16x32_bf16 v[248:251], a[52:55], a[124:127], v[248:251]
    v_cvt_pk_bf16_f32 v91, v94, v95
    v_cvt_pk_bf16_f32 v96, v96, v97
    v_mfma_f32_16x16x32_bf16 v[248:251], a[48:51], a[120:123], v[248:251]
    ds_read_b64_tr_b16 a[76:77], v3 offset:8192
    v_cvt_pk_bf16_f32 v97, v98, v99
    v_mfma_f32_16x16x32_bf16 v[252:255], a[56:59], a[120:123], v[252:255]
    buffer_store_dwordx4 v[48:51], v1, s[8:11], s7 offen sc1
    v_mfma_f32_16x16x32_bf16 v[252:255], a[60:63], a[124:127], v[252:255]
    ds_read_b64_tr_b16 a[78:79], v3 offset:9216
    v_cvt_pk_bf16_f32 v98, v100, v101
    v_mfma_f32_16x16x32_bf16 v[244:247], a[60:63], a[116:119], v[244:247]
    v_cvt_pk_bf16_f32 v99, v102, v103
    v_cvt_pk_bf16_f32 v104, v104, v105
    v_mfma_f32_16x16x32_bf16 v[244:247], a[56:59], a[112:115], v[244:247]
    v_cvt_pk_bf16_f32 v105, v106, v107
    v_cvt_pk_bf16_f32 v106, v108, v109
    v_mfma_f32_16x16x32_bf16 v[236:239], a[56:59], a[104:107], v[236:239]
    v_cvt_pk_bf16_f32 v107, v110, v111
    v_cvt_pk_bf16_f32 v112, v112, v113
    v_mfma_f32_16x16x32_bf16 v[236:239], a[60:63], a[108:111], v[236:239]
    v_cvt_pk_bf16_f32 v113, v114, v115
    v_cvt_pk_bf16_f32 v114, v116, v117
    v_mfma_f32_16x16x32_bf16 v[228:231], a[60:63], a[100:103], v[228:231]
    v_cvt_pk_bf16_f32 v115, v118, v119
    v_cvt_pk_bf16_f32 v120, v120, v121
    v_mfma_f32_16x16x32_bf16 v[228:231], a[56:59], a[96:99], v[228:231]
    v_cvt_pk_bf16_f32 v121, v122, v123
    v_cvt_pk_bf16_f32 v122, v124, v125
    v_cvt_pk_bf16_f32 v123, v126, v127
L_B:
L_tp10:
    s_cbranch_execz L_tp14
    s_waitcnt lgkmcnt(0)
    v_mfma_f32_16x16x32_bf16 v[32:35], a[64:67], a[160:163], 0
    s_add_u32 s7, s95, 7168
    ds_read_b64_tr_b16 a[80:81], v4 offset:0
    v_accvgpr_write_b32 a12, v88
    v_mfma_f32_16x16x32_bf16 v[32:35], a[68:71], a[164:167], v[32:35]
    buffer_store_dwordx4 a[140:143], v1, s[8:11], s7 offen sc1
    v_mfma_f32_16x16x32_bf16 v[36:39], a[68:71], a[172:175], 0
    ds_read_b64_tr_b16 a[82:83], v4 offset:1024
    v_accvgpr_write_b32 a13, v89
    v_mfma_f32_16x16x32_bf16 v[36:39], a[64:67], a[168:171], v[36:39]
    ds_read_b64_tr_b16 a[84:85], v4 offset:8192
    v_accvgpr_write_b32 a14, v90
    v_mfma_f32_16x16x32_bf16 v[40:43], a[64:67], a[176:179], 0
    ds_read_b64_tr_b16 a[86:87], v4 offset:9216
    v_accvgpr_write_b32 a15, v91
    v_mfma_f32_16x16x32_bf16 v[40:43], a[68:71], a[180:183], v[40:43]
    v_accvgpr_write_b32 a16, v96
    v_accvgpr_write_b32 a17, v97
    v_mfma_f32_16x16x32_bf16 v[44:47], a[68:71], a[188:191], 0
    v_accvgpr_write_b32 a18, v98
    v_accvgpr_write_b32 a19, v99
    v_mfma_f32_16x16x32_bf16 v[44:47], a[64:67], a[184:187], v[44:47]
    v_accvgpr_write_b32 a20, v104
    v_accvgpr_write_b32 a21, v105
    v_mfma_f32_16x16x32_bf16 v[60:63], a[72:75], a[184:187], 0
    ds_read_b64_tr_b16 a[88:89], v5 offset:0
    v_accvgpr_write_b32 a22, v106
    v_mfma_f32_16x16x32_bf16 v[60:63], a[76:79], a[188:191], v[60:63]
    ds_read_b64_tr_b16 a[90:91], v5 offset:1024
    v_accvgpr_write_b32 a23, v107
    v_mfma_f32_16x16x32_bf16 v[56:59], a[76:79], a[180:183], 0
    s_add_u32 s7, s60, 4096
    ds_read_b64_tr_b16 a[92:93], v5 offset:8192
    v_accvgpr_write_b32 a24, v112
    v_mfma_f32_16x16x32_bf16 v[56:59], a[72:75], a[176:179], v[56:59]
    ds_read_b64_tr_b16 a[94:95], v5 offset:9216
    v_accvgpr_write_b32 a25, v113
    v_mfma_f32_16x16x32_bf16 v[52:55], a[72:75], a[168:171], 0
    v_accvgpr_write_b32 a26, v114
    v_accvgpr_write_b32 a27, v115
    v_mfma_f32_16x16x32_bf16 v[52:55], a[76:79], a[172:175], v[52:55]
    buffer_store_dwordx4 a[144:147], v1, s[8:11], s7 offen sc1
    v_mfma_f32_16x16x32_bf16 v[48:51], a[76:79], a[164:167], 0
    v_accvgpr_write_b32 a28, v120
    v_accvgpr_write_b32 a29, v121
    v_mfma_f32_16x16x32_bf16 v[48:51], a[72:75], a[160:163], v[48:51]
    s_waitcnt lgkmcnt(0)
    v_accvgpr_write_b32 a30, v122
    v_accvgpr_write_b32 a31, v123
    v_mfma_f32_16x16x32_bf16 v[64:67], a[80:83], a[160:163], 0
    ds_read_b64_tr_b16 a[64:65], v6 offset:0
    v_cvt_pk_bf16_f32 v128, v128, v129
    v_mfma_f32_16x16x32_bf16 v[64:67], a[84:87], a[164:167], v[64:67]
    ds_read_b64_tr_b16 a[66:67], v6 offset:1024
    v_cvt_pk_bf16_f32 v129, v130, v131
    v_mfma_f32_16x16x32_bf16 v[68:71], a[84:87], a[172:175], 0
    ds_read_b64_tr_b16 a[68:69], v6 offset:8192
    v_cvt_pk_bf16_f32 v130, v132, v133
    v_mfma_f32_16x16x32_bf16 v[68:71], a[80:83], a[168:171], v[68:71]
    ds_read_b64_tr_b16 a[70:71], v6 offset:9216
    v_cvt_pk_bf16_f32 v131, v134, v135
    v_mfma_f32_16x16x32_bf16 v[72:75], a[80:83], a[176:179], 0
    v_accvgpr_write_b32 a32, v128
    v_accvgpr_write_b32 a33, v129
    v_mfma_f32_16x16x32_bf16 v[72:75], a[84:87], a[180:183], v[72:75]
    v_accvgpr_write_b32 a34, v130
    v_accvgpr_write_b32 a35, v131
    v_mfma_f32_16x16x32_bf16 v[76:79], a[84:87], a[188:191], 0
    v_cvt_pk_bf16_f32 v136, v136, v137
    v_cvt_pk_bf16_f32 v137, v138, v139
    v_mfma_f32_16x16x32_bf16 v[76:79], a[80:83], a[184:187], v[76:79]
    s_add_u32 s7, s60, 5120
    v_cvt_pk_bf16_f32 v138, v140, v141
    v_cvt_pk_bf16_f32 v139, v142, v143
    v_mfma_f32_16x16x32_bf16 v[92:95], a[88:91], a[184:187], 0
    ds_read_b64_tr_b16 a[72:73], v7 offset:0
    v_accvgpr_write_b32 a36, v136
    v_mfma_f32_16x16x32_bf16 v[92:95], a[92:95], a[188:191], v[92:95]
    ds_read_b64_tr_b16 a[74:75], v7 offset:1024
    v_accvgpr_write_b32 a37, v137
    v_mfma_f32_16x16x32_bf16 v[88:91], a[92:95], a[180:183], 0
    buffer_store_dwordx4 a[148:151], v1, s[8:11], s7 offen sc1
    v_mfma_f32_16x16x32_bf16 v[88:91], a[88:91], a[176:179], v[88:91]
    ds_read_b64_tr_b16 a[76:77], v7 offset:8192
    v_accvgpr_write_b32 a38, v138
    v_mfma_f32_16x16x32_bf16 v[84:87], a[88:91], a[168:171], 0
    ds_read_b64_tr_b16 a[78:79], v7 offset:9216
    v_accvgpr_write_b32 a39, v139
    v_mfma_f32_16x16x32_bf16 v[84:87], a[92:95], a[172:175], v[84:87]
    v_cvt_pk_bf16_f32 v144, v144, v145
    v_cvt_pk_bf16_f32 v145, v146, v147
    v_mfma_f32_16x16x32_bf16 v[80:83], a[92:95], a[164:167], 0
    v_cvt_pk_bf16_f32 v146, v148, v149
    v_cvt_pk_bf16_f32 v147, v150, v151
    v_mfma_f32_16x16x32_bf16 v[80:83], a[88:91], a[160:163], v[80:83]
    s_waitcnt lgkmcnt(1)
    v_accvgpr_write_b32 a40, v144
    v_accvgpr_write_b32 a41, v145
    v_mfma_f32_16x16x32_bf16 v[96:99], a[64:67], a[160:163], 0
    ds_read_b64_tr_b16 a[80:81], v8 offset:0
    v_accvgpr_write_b32 a42, v146
    v_mfma_f32_16x16x32_bf16 v[96:99], a[68:71], a[164:167], v[96:99]
    ds_read_b64_tr_b16 a[82:83], v8 offset:1024
    v_accvgpr_write_b32 a43, v147
    v_mfma_f32_16x16x32_bf16 v[100:103], a[68:71], a[172:175], 0
    ds_read_b64_tr_b16 a[84:85], v8 offset:8192
    v_cvt_pk_bf16_f32 v152, v152, v153
    v_mfma_f32_16x16x32_bf16 v[100:103], a[64:67], a[168:171], v[100:103]
    s_add_u32 s7, s60, 6144
    ds_read_b64_tr_b16 a[86:87], v8 offset:9216
    v_cvt_pk_bf16_f32 v153, v154, v155
    v_mfma_f32_16x16x32_bf16 v[104:107], a[64:67], a[176:179], 0
    v_cvt_pk_bf16_f32 v154, v156, v157
    v_cvt_pk_bf16_f32 v155, v158, v159
    v_mfma_f32_16x16x32_bf16 v[104:107], a[68:71], a[180:183], v[104:107]
    v_accvgpr_write_b32 a44, v152
    v_accvgpr_write_b32 a45, v153
    v_mfma_f32_16x16x32_bf16 v[108:111], a[68:71], a[188:191], 0
    buffer_store_dwordx4 a[152:155], v1, s[8:11], s7 offen sc1
    v_mfma_f32_16x16x32_bf16 v[108:111], a[64:67], a[184:187], v[108:111]
    v_accvgpr_write_b32 a46, v154
    v_accvgpr_write_b32 a47, v155
    v_mfma_f32_16x16x32_bf16 v[124:127], a[72:75], a[184:187], 0
    ds_read_b64_tr_b16 a[88:89], v9 offset:0
    s_waitcnt lgkmcnt(1)
    v_cvt_pk_bf16_f32 v160, v160, v161
    v_mfma_f32_16x16x32_bf16 v[124:127], a[76:79], a[188:191], v[124:127]
    ds_read_b64_tr_b16 a[90:91], v9 offset:1024
    v_cvt_pk_bf16_f32 v161, v162, v163
    v_mfma_f32_16x16x32_bf16 v[120:123], a[76:79], a[180:183], 0
    ds_read_b64_tr_b16 a[92:93], v9 offset:8192
    v_cvt_pk_bf16_f32 v162, v164, v165
    v_mfma_f32_16x16x32_bf16 v[120:123], a[72:75], a[176:179], v[120:123]
    ds_read_b64_tr_b16 a[94:95], v9 offset:9216
    v_cvt_pk_bf16_f32 v163, v166, v167
    v_mfma_f32_16x16x32_bf16 v[116:119], a[72:75], a[168:171], 0
    v_accvgpr_write_b32 a48, v160
    v_accvgpr_write_b32 a49, v161
    v_mfma_f32_16x16x32_bf16 v[116:119], a[76:79], a[172:175], v[116:119]
    v_accvgpr_write_b32 a50, v162
    v_accvgpr_write_b32 a51, v163
    v_mfma_f32_16x16x32_bf16 v[112:115], a[76:79], a[164:167], 0
    v_cvt_pk_bf16_f32 v168, v168, v169
    v_cvt_pk_bf16_f32 v169, v170, v171
    v_mfma_f32_16x16x32_bf16 v[112:115], a[72:75], a[160:163], v[112:115]
    v_cvt_pk_bf16_f32 v170, v172, v173
    v_cvt_pk_bf16_f32 v171, v174, v175
    v_mfma_f32_16x16x32_bf16 v[128:131], a[80:83], a[160:163], 0
    s_add_u32 s7, s60, 7168
    ds_read_b64_tr_b16 a[64:65], v16 offset:16384
    v_accvgpr_write_b32 a52, v168
    v_mfma_f32_16x16x32_bf16 v[128:131], a[84:87], a[164:167], v[128:131]
    ds_read_b64_tr_b16 a[66:67], v16 offset:16896
    v_accvgpr_write_b32 a53, v169
    v_mfma_f32_16x16x32_bf16 v[132:135], a[84:87], a[172:175], 0
    ds_read_b64_tr_b16 a[68:69], v16 offset:20480
    v_accvgpr_write_b32 a54, v170
    v_mfma_f32_16x16x32_bf16 v[132:135], a[80:83], a[168:171], v[132:135]
    buffer_store_dwordx4 a[156:159], v1, s[8:11], s7 offen sc1
    v_mfma_f32_16x16x32_bf16 v[136:139], a[80:83], a[176:179], 0
    ds_read_b64_tr_b16 a[70:71], v16 offset:20992
    v_accvgpr_write_b32 a55, v171
    v_mfma_f32_16x16x32_bf16 v[136:139], a[84:87], a[180:183], v[136:139]
    v_cvt_pk_bf16_f32 v176, v176, v177
    v_cvt_pk_bf16_f32 v177, v178, v179
    v_mfma_f32_16x16x32_bf16 v[140:143], a[84:87], a[188:191], 0
    v_cvt_pk_bf16_f32 v178, v180, v181
    v_cvt_pk_bf16_f32 v179, v182, v183
    v_mfma_f32_16x16x32_bf16 v[140:143], a[80:83], a[184:187], v[140:143]
    s_waitcnt lgkmcnt(1)
    v_accvgpr_write_b32 a56, v176
    v_accvgpr_write_b32 a57, v177
    v_mfma_f32_16x16x32_bf16 v[156:159], a[88:91], a[184:187], 0
    ds_read_b64_tr_b16 a[72:73], v16 offset:24576
    v_accvgpr_write_b32 a58, v178
    v_mfma_f32_16x16x32_bf16 v[156:159], a[92:95], a[188:191], v[156:159]
    ds_read_b64_tr_b16 a[74:75], v16 offset:25088
    v_accvgpr_write_b32 a59, v179
    v_mfma_f32_16x16x32_bf16 v[152:155], a[92:95], a[180:183], 0
    ds_read_b64_tr_b16 a[76:77], v16 offset:28672
    v_cvt_pk_bf16_f32 v184, v184, v185
    v_mfma_f32_16x16x32_bf16 v[152:155], a[88:91], a[176:179], v[152:155]
    ds_read_b64_tr_b16 a[78:79], v16 offset:29184
    v_cvt_pk_bf16_f32 v185, v186, v187
    v_mfma_f32_16x16x32_bf16 v[148:151], a[88:91], a[168:171], 0
    v_cvt_pk_bf16_f32 v186, v188, v189
    v_cvt_pk_bf16_f32 v187, v190, v191
    v_mfma_f32_16x16x32_bf16 v[148:151], a[92:95], a[172:175], v[148:151]
    v_accvgpr_write_b32 a60, v184
    v_accvgpr_write_b32 a61, v185
    v_mfma_f32_16x16x32_bf16 v[144:147], a[92:95], a[164:167], 0
    v_accvgpr_write_b32 a62, v186
    v_accvgpr_write_b32 a63, v187
    v_mfma_f32_16x16x32_bf16 v[144:147], a[88:91], a[160:163], v[144:147]
    v_cvt_pk_bf16_f32 v192, v192, v193
    v_cvt_pk_bf16_f32 v193, v194, v195
    v_mfma_f32_16x16x32_bf16 v[160:163], a[64:67], a[160:163], 0
    ds_read_b64_tr_b16 a[80:81], v17 offset:16384
    s_waitcnt lgkmcnt(1)
    v_cvt_pk_bf16_f32 v194, v196, v197
    v_mfma_f32_16x16x32_bf16 v[160:163], a[68:71], a[164:167], v[160:163]
    s_add_u32 s0, s61, 6144
    s_add_u32 s7, s0, 0
    v_cvt_pk_bf16_f32 v195, v198, v199
    v_mfma_f32_16x16x32_bf16 v[164:167], a[68:71], a[172:175], 0
    buffer_load_dwordx4 a[128:131], v1, s[8:11], s7 offen offset:0 sc1
    v_mfma_f32_16x16x32_bf16 v[164:167], a[64:67], a[168:171], v[164:167]
    ds_read_b64_tr_b16 a[82:83], v17 offset:16896
    v_accvgpr_write_b32 a96, v192
    v_mfma_f32_16x16x32_bf16 v[168:171], a[64:67], a[176:179], 0
    ds_read_b64_tr_b16 a[84:85], v17 offset:20480
    v_accvgpr_write_b32 a97, v193
    v_mfma_f32_16x16x32_bf16 v[168:171], a[68:71], a[180:183], v[168:171]
    ds_read_b64_tr_b16 a[86:87], v17 offset:20992
    v_accvgpr_write_b32 a98, v194
    v_mfma_f32_16x16x32_bf16 v[172:175], a[68:71], a[188:191], 0
    v_accvgpr_write_b32 a99, v195
    v_cvt_pk_bf16_f32 v200, v200, v201
    v_mfma_f32_16x16x32_bf16 v[172:175], a[64:67], a[184:187], v[172:175]
    buffer_load_dwordx4 a[132:135], v1, s[8:11], s7 offen offset:1024 sc1
    v_mfma_f32_16x16x32_bf16 v[188:191], a[72:75], a[184:187], 0
    ds_read_b64_tr_b16 a[88:89], v17 offset:24576
    v_cvt_pk_bf16_f32 v201, v202, v203
    v_mfma_f32_16x16x32_bf16 v[188:191], a[76:79], a[188:191], v[188:191]
    s_add_u32 s7, s60, 0
    ds_read_b64_tr_b16 a[90:91], v17 offset:25088
    v_cvt_pk_bf16_f32 v202, v204, v205
    v_mfma_f32_16x16x32_bf16 v[184:187], a[76:79], a[180:183], 0
    ds_read_b64_tr_b16 a[92:93], v17 offset:28672
    v_cvt_pk_bf16_f32 v203, v206, v207
    v_mfma_f32_16x16x32_bf16 v[184:187], a[72:75], a[176:179], v[184:187]
    ds_read_b64_tr_b16 a[94:95], v17 offset:29184
    v_accvgpr_write_b32 a100, v200
    v_mfma_f32_16x16x32_bf16 v[180:183], a[72:75], a[168:171], 0
    buffer_store_dwordx4 a[0:3], v1, s[8:11], s7 offen sc1
    v_mfma_f32_16x16x32_bf16 v[180:183], a[76:79], a[172:175], v[180:183]
    v_accvgpr_write_b32 a101, v201
    v_accvgpr_write_b32 a102, v202
    v_mfma_f32_16x16x32_bf16 v[176:179], a[76:79], a[164:167], 0
    s_add_u32 s7, s0, 16384
    v_accvgpr_write_b32 a103, v203
    v_cvt_pk_bf16_f32 v208, v208, v209
    v_mfma_f32_16x16x32_bf16 v[176:179], a[72:75], a[160:163], v[176:179]
    s_waitcnt lgkmcnt(0)
    v_cvt_pk_bf16_f32 v209, v210, v211
    v_cvt_pk_bf16_f32 v210, v212, v213
    v_mfma_f32_16x16x32_bf16 v[192:195], a[80:83], a[160:163], 0
    ds_read_b64_tr_b16 a[64:65], v18 offset:16384
    v_cvt_pk_bf16_f32 v211, v214, v215
    v_mfma_f32_16x16x32_bf16 v[192:195], a[84:87], a[164:167], v[192:195]
    buffer_load_dwordx4 a[136:139], v1, s[8:11], s7 offen offset:0 sc1
    v_mfma_f32_16x16x32_bf16 v[196:199], a[84:87], a[172:175], 0
    ds_read_b64_tr_b16 a[66:67], v18 offset:16896
    v_accvgpr_write_b32 a104, v208
    v_mfma_f32_16x16x32_bf16 v[196:199], a[80:83], a[168:171], v[196:199]
    ds_read_b64_tr_b16 a[68:69], v18 offset:20480
    v_accvgpr_write_b32 a105, v209
    v_mfma_f32_16x16x32_bf16 v[200:203], a[80:83], a[176:179], 0
    ds_read_b64_tr_b16 a[70:71], v18 offset:20992
    v_accvgpr_write_b32 a106, v210
    v_mfma_f32_16x16x32_bf16 v[200:203], a[84:87], a[180:183], v[200:203]
    v_accvgpr_write_b32 a107, v211
    v_cvt_pk_bf16_f32 v216, v216, v217
    v_mfma_f32_16x16x32_bf16 v[204:207], a[84:87], a[188:191], 0
    v_cvt_pk_bf16_f32 v217, v218, v219
    v_cvt_pk_bf16_f32 v218, v220, v221
    v_cvt_pk_bf16_f32 v219, v222, v223
    v_accvgpr_write_b32 a108, v216
    v_accvgpr_write_b32 a109, v217
    v_accvgpr_write_b32 a110, v218
    v_accvgpr_write_b32 a111, v219
    v_mfma_f32_16x16x32_bf16 v[204:207], a[80:83], a[184:187], v[204:207]
    buffer_load_dwordx4 a[140:143], v1, s[8:11], s7 offen offset:1024 sc1
    v_mfma_f32_16x16x32_bf16 v[220:223], a[88:91], a[184:187], 0
    s_add_u32 s7, s0, 32768
    ds_read_b64_tr_b16 a[72:73], v18 offset:24576
    v_cvt_pk_bf16_f32 v224, v224, v225
    v_mfma_f32_16x16x32_bf16 v[220:223], a[92:95], a[188:191], v[220:223]
    ds_read_b64_tr_b16 a[74:75], v18 offset:25088
    v_cvt_pk_bf16_f32 v225, v226, v227
    v_mfma_f32_16x16x32_bf16 v[216:219], a[92:95], a[180:183], 0
    ds_read_b64_tr_b16 a[76:77], v18 offset:28672
    v_cvt_pk_bf16_f32 v226, v228, v229
    v_mfma_f32_16x16x32_bf16 v[216:219], a[88:91], a[176:179], v[216:219]
    buffer_load_dwordx4 a[144:147], v1, s[8:11], s7 offen offset:0 sc1
    v_mfma_f32_16x16x32_bf16 v[212:215], a[88:91], a[168:171], 0
    ds_read_b64_tr_b16 a[78:79], v18 offset:29184
    v_cvt_pk_bf16_f32 v227, v230, v231
    v_mfma_f32_16x16x32_bf16 v[212:215], a[92:95], a[172:175], v[212:215]
    v_accvgpr_write_b32 a112, v224
    v_accvgpr_write_b32 a113, v225
    v_mfma_f32_16x16x32_bf16 v[208:211], a[92:95], a[164:167], 0
L_tp11:
    s_cbranch_execz L_tp15
    v_accvgpr_write_b32 a114, v226
    v_accvgpr_write_b32 a115, v227
    v_cvt_pk_bf16_f32 v232, v232, v233
    v_cvt_pk_bf16_f32 v233, v234, v235
    v_cvt_pk_bf16_f32 v234, v236, v237
    v_cvt_pk_bf16_f32 v235, v238, v239
    v_accvgpr_write_b32 a116, v232
    v_accvgpr_write_b32 a117, v233
    v_accvgpr_write_b32 a118, v234
    v_accvgpr_write_b32 a119, v235
    v_mfma_f32_16x16x32_bf16 v[208:211], a[88:91], a[160:163], v[208:211]
    s_waitcnt lgkmcnt(0)
    v_cvt_pk_bf16_f32 v240, v240, v241
    v_cvt_pk_bf16_f32 v241, v242, v243
    v_mfma_f32_16x16x32_bf16 v[224:227], a[64:67], a[160:163], 0
    v_cvt_pk_bf16_f32 v242, v244, v245
    v_cvt_pk_bf16_f32 v243, v246, v247
    v_mfma_f32_16x16x32_bf16 v[224:227], a[68:71], a[164:167], v[224:227]
    s_waitcnt vmcnt(11) lgkmcnt(0)
    s_barrier
    v_accvgpr_write_b32 a120, v240
    v_mfma_f32_16x16x32_bf16 v[228:231], a[68:71], a[172:175], 0
    ds_read_b64_tr_b16 a[80:81], v2 offset:32768
    v_accvgpr_write_b32 a121, v241
    v_mfma_f32_16x16x32_bf16 v[228:231], a[64:67], a[168:171], v[228:231]
    ds_read_b64_tr_b16 a[82:83], v2 offset:33792
    v_accvgpr_write_b32 a122, v242
    v_mfma_f32_16x16x32_bf16 v[232:235], a[64:67], a[176:179], 0
    ds_read_b64_tr_b16 a[84:85], v2 offset:40960
    v_accvgpr_write_b32 a123, v243
    v_mfma_f32_16x16x32_bf16 v[232:235], a[68:71], a[180:183], v[232:235]
    ds_read_b64_tr_b16 a[86:87], v2 offset:41984
    v_cvt_pk_bf16_f32 v248, v248, v249
    v_mfma_f32_16x16x32_bf16 v[236:239], a[68:71], a[188:191], 0
    buffer_load_dwordx4 a[148:151], v1, s[8:11], s7 offen offset:1024 sc1
    v_cvt_pk_bf16_f32 v249, v250, v251
    v_cvt_pk_bf16_f32 v250, v252, v253
    v_cvt_pk_bf16_f32 v251, v254, v255
    v_accvgpr_write_b32 a124, v248
    v_accvgpr_write_b32 a125, v249
    v_accvgpr_write_b32 a126, v250
    v_accvgpr_write_b32 a127, v251
    v_mfma_f32_16x16x32_bf16 v[236:239], a[64:67], a[184:187], v[236:239]
    s_add_u32 s7, s0, 49152
    v_add_u32 v2, 131072, v2
    v_mfma_f32_16x16x32_bf16 v[252:255], a[72:75], a[184:187], 0
    buffer_load_dwordx4 a[152:155], v1, s[8:11], s7 offen offset:0 sc1
    v_mfma_f32_16x16x32_bf16 v[252:255], a[76:79], a[188:191], v[252:255]
    ds_read_b64_tr_b16 a[88:89], v3 offset:32768
    v_mfma_f32_16x16x32_bf16 v[248:251], a[76:79], a[180:183], 0
    ds_read_b64_tr_b16 a[90:91], v3 offset:33792
    v_mfma_f32_16x16x32_bf16 v[248:251], a[72:75], a[176:179], v[248:251]
    buffer_load_dwordx4 a[156:159], v1, s[8:11], s7 offen offset:1024 sc1
    v_mfma_f32_16x16x32_bf16 v[244:247], a[72:75], a[168:171], 0
    ds_read_b64_tr_b16 a[92:93], v3 offset:40960
    v_mfma_f32_16x16x32_bf16 v[244:247], a[76:79], a[172:175], v[244:247]
    ds_read_b64_tr_b16 a[94:95], v3 offset:41984
    v_add_u32 v3, 131072, v3
    v_mfma_f32_16x16x32_bf16 v[240:243], a[76:79], a[164:167], 0
    v_mfma_f32_16x16x32_bf16 v[240:243], a[72:75], a[160:163], v[240:243]
    s_waitcnt lgkmcnt(3)
    v_mfma_f32_16x16x32_bf16 v[32:35], a[80:83], a[192:195], v[32:35]
    s_add_u32 s0, s62, 1572864
    s_xor_b32 m0, s90, 0
    s_xor_b32 s7, s0, 0
    v_mfma_f32_16x16x32_bf16 v[32:35], a[84:87], a[196:199], v[32:35]
    buffer_load_dwordx4 v14, s[20:23], s7 offen lds
    v_mfma_f32_16x16x32_bf16 v[36:39], a[84:87], a[204:207], v[36:39]
    ds_read_b64_tr_b16 a[64:65], v4 offset:32768
    v_mfma_f32_16x16x32_bf16 v[36:39], a[80:83], a[200:203], v[36:39]
    s_xor_b32 m0, s90, 1024
    ds_read_b64_tr_b16 a[66:67], v4 offset:33792
    s_xor_b32 s7, s0, 32768
    v_mfma_f32_16x16x32_bf16 v[40:43], a[80:83], a[208:211], v[40:43]
    ds_read_b64_tr_b16 a[68:69], v4 offset:40960
    v_mfma_f32_16x16x32_bf16 v[40:43], a[84:87], a[212:215], v[40:43]
    ds_read_b64_tr_b16 a[70:71], v4 offset:41984
    v_add_u32 v4, 131072, v4
    v_mfma_f32_16x16x32_bf16 v[44:47], a[84:87], a[220:223], v[44:47]
    v_mfma_f32_16x16x32_bf16 v[44:47], a[80:83], a[216:219], v[44:47]
    buffer_load_dwordx4 v14, s[20:23], s7 offen lds
    s_waitcnt lgkmcnt(3)
    v_mfma_f32_16x16x32_bf16 v[60:63], a[88:91], a[216:219], v[60:63]
    ds_read_b64_tr_b16 a[72:73], v5 offset:32768
    v_mfma_f32_16x16x32_bf16 v[60:63], a[92:95], a[220:223], v[60:63]
    s_xor_b32 m0, s90, 2048
    ds_read_b64_tr_b16 a[74:75], v5 offset:33792
    s_xor_b32 s7, s0, 65536
    v_mfma_f32_16x16x32_bf16 v[56:59], a[92:95], a[212:215], v[56:59]
    ds_read_b64_tr_b16 a[76:77], v5 offset:40960
    v_mfma_f32_16x16x32_bf16 v[56:59], a[88:91], a[208:211], v[56:59]
    ds_read_b64_tr_b16 a[78:79], v5 offset:41984
    v_mfma_f32_16x16x32_bf16 v[52:55], a[88:91], a[200:203], v[52:55]
    v_add_u32 v5, 131072, v5
    v_mfma_f32_16x16x32_bf16 v[52:55], a[92:95], a[204:207], v[52:55]
    buffer_load_dwordx4 v15, s[20:23], s7 offen lds
    v_mfma_f32_16x16x32_bf16 v[48:51], a[92:95], a[196:199], v[48:51]
    v_mfma_f32_16x16x32_bf16 v[48:51], a[88:91], a[192:195], v[48:51]
    s_waitcnt lgkmcnt(2)
    v_mfma_f32_16x16x32_bf16 v[64:67], a[64:67], a[192:195], v[64:67]
    s_xor_b32 m0, s90, 3072
    s_xor_b32 s7, s0, 98304
    v_mfma_f32_16x16x32_bf16 v[64:67], a[68:71], a[196:199], v[64:67]
    ds_read_b64_tr_b16 a[80:81], v6 offset:32768
    v_mfma_f32_16x16x32_bf16 v[68:71], a[68:71], a[204:207], v[68:71]
    ds_read_b64_tr_b16 a[82:83], v6 offset:33792
    v_mfma_f32_16x16x32_bf16 v[68:71], a[64:67], a[200:203], v[68:71]
    ds_read_b64_tr_b16 a[84:85], v6 offset:40960
    v_mfma_f32_16x16x32_bf16 v[72:75], a[64:67], a[208:211], v[72:75]
    buffer_load_dwordx4 v15, s[20:23], s7 offen lds
    v_mfma_f32_16x16x32_bf16 v[72:75], a[68:71], a[212:215], v[72:75]
    ds_read_b64_tr_b16 a[86:87], v6 offset:41984
    v_add_u32 v6, 131072, v6
    v_mfma_f32_16x16x32_bf16 v[76:79], a[68:71], a[220:223], v[76:79]
    v_mfma_f32_16x16x32_bf16 v[76:79], a[64:67], a[216:219], v[76:79]
    s_add_u32 s7, s60, 1024
    v_mfma_f32_16x16x32_bf16 v[92:95], a[72:75], a[216:219], v[92:95]
    ds_read_b64_tr_b16 a[88:89], v7 offset:32768
    s_waitcnt lgkmcnt(3)
    v_mfma_f32_16x16x32_bf16 v[92:95], a[76:79], a[220:223], v[92:95]
    ds_read_b64_tr_b16 a[90:91], v7 offset:33792
    v_mfma_f32_16x16x32_bf16 v[88:91], a[76:79], a[212:215], v[88:91]
    buffer_store_dwordx4 a[4:7], v1, s[8:11], s7 offen sc1
    v_mfma_f32_16x16x32_bf16 v[88:91], a[72:75], a[208:211], v[88:91]
    s_add_u32 s0, s63, 528384
    ds_read_b64_tr_b16 a[92:93], v7 offset:40960
    s_add_u32 m0, s91, 0
    v_mfma_f32_16x16x32_bf16 v[84:87], a[72:75], a[200:203], v[84:87]
    s_add_u32 s7, s0, 0
    ds_read_b64_tr_b16 a[94:95], v7 offset:41984
    v_add_u32 v7, 131072, v7
    v_mfma_f32_16x16x32_bf16 v[84:87], a[76:79], a[204:207], v[84:87]
    v_mfma_f32_16x16x32_bf16 v[80:83], a[76:79], a[196:199], v[80:83]
    v_mfma_f32_16x16x32_bf16 v[80:83], a[72:75], a[192:195], v[80:83]
    v_mfma_f32_16x16x32_bf16 v[96:99], a[80:83], a[192:195], v[96:99]
    buffer_load_dwordx4 v19, s[24:27], s7 offen lds
    s_waitcnt lgkmcnt(2)
    v_mfma_f32_16x16x32_bf16 v[96:99], a[84:87], a[196:199], v[96:99]
    ds_read_b64_tr_b16 a[64:65], v8 offset:32768
    v_mfma_f32_16x16x32_bf16 v[100:103], a[84:87], a[204:207], v[100:103]
    ds_read_b64_tr_b16 a[66:67], v8 offset:33792
    v_mfma_f32_16x16x32_bf16 v[100:103], a[80:83], a[200:203], v[100:103]
    s_add_u32 m0, s91, 1024
    ds_read_b64_tr_b16 a[68:69], v8 offset:40960
    s_add_u32 s7, s0, 22016
    v_mfma_f32_16x16x32_bf16 v[104:107], a[80:83], a[208:211], v[104:107]
    ds_read_b64_tr_b16 a[70:71], v8 offset:41984
    v_add_u32 v8, 131072, v8
    v_mfma_f32_16x16x32_bf16 v[104:107], a[84:87], a[212:215], v[104:107]
    v_mfma_f32_16x16x32_bf16 v[108:111], a[84:87], a[220:223], v[108:111]
    v_mfma_f32_16x16x32_bf16 v[108:111], a[80:83], a[216:219], v[108:111]
    buffer_load_dwordx4 v20, s[24:27], s7 offen lds
    v_mfma_f32_16x16x32_bf16 v[124:127], a[88:91], a[216:219], v[124:127]
    ds_read_b64_tr_b16 a[72:73], v9 offset:32768
    s_waitcnt lgkmcnt(3)
    v_mfma_f32_16x16x32_bf16 v[124:127], a[92:95], a[220:223], v[124:127]
    s_add_u32 m0, s91, 8192
    ds_read_b64_tr_b16 a[74:75], v9 offset:33792
    s_add_u32 s7, s0, 0
    v_mfma_f32_16x16x32_bf16 v[120:123], a[92:95], a[212:215], v[120:123]
    ds_read_b64_tr_b16 a[76:77], v9 offset:40960
    v_mfma_f32_16x16x32_bf16 v[120:123], a[88:91], a[208:211], v[120:123]
    ds_read_b64_tr_b16 a[78:79], v9 offset:41984
    v_mfma_f32_16x16x32_bf16 v[116:119], a[88:91], a[200:203], v[116:119]
    v_add_u32 v9, 131072, v9
    v_mfma_f32_16x16x32_bf16 v[116:119], a[92:95], a[204:207], v[116:119]
    buffer_load_dwordx4 v19, s[28:31], s7 offen lds
    v_mfma_f32_16x16x32_bf16 v[112:115], a[92:95], a[196:199], v[112:115]
    v_mfma_f32_16x16x32_bf16 v[112:115], a[88:91], a[192:195], v[112:115]
    s_add_u32 m0, s91, 9216
    s_add_u32 s7, s0, 22016
    v_mfma_f32_16x16x32_bf16 v[128:131], a[64:67], a[192:195], v[128:131]
    ds_read_b64_tr_b16 a[80:81], v16 offset:49152
    s_waitcnt lgkmcnt(2)
    v_mfma_f32_16x16x32_bf16 v[128:131], a[68:71], a[196:199], v[128:131]
    ds_read_b64_tr_b16 a[82:83], v16 offset:49664
    v_mfma_f32_16x16x32_bf16 v[132:135], a[68:71], a[204:207], v[132:135]
    ds_read_b64_tr_b16 a[84:85], v16 offset:53248
    v_mfma_f32_16x16x32_bf16 v[132:135], a[64:67], a[200:203], v[132:135]
    buffer_load_dwordx4 v20, s[28:31], s7 offen lds
    v_mfma_f32_16x16x32_bf16 v[136:139], a[64:67], a[208:211], v[136:139]
    ds_read_b64_tr_b16 a[86:87], v16 offset:53760
    v_mfma_f32_16x16x32_bf16 v[136:139], a[68:71], a[212:215], v[136:139]
    v_mfma_f32_16x16x32_bf16 v[140:143], a[68:71], a[220:223], v[140:143]
    s_add_u32 s0, s61, 8192
    s_add_u32 s7, s0, 0
    v_mfma_f32_16x16x32_bf16 v[140:143], a[64:67], a[216:219], v[140:143]
    v_mfma_f32_16x16x32_bf16 v[156:159], a[72:75], a[216:219], v[156:159]
    ds_read_b64_tr_b16 a[88:89], v16 offset:57344
    s_waitcnt lgkmcnt(2)
    v_mfma_f32_16x16x32_bf16 v[156:159], a[76:79], a[220:223], v[156:159]
    ds_read_b64_tr_b16 a[90:91], v16 offset:57856
    v_mfma_f32_16x16x32_bf16 v[152:155], a[76:79], a[212:215], v[152:155]
    buffer_load_dwordx4 a[160:163], v1, s[8:11], s7 offen offset:0 sc1
    v_mfma_f32_16x16x32_bf16 v[152:155], a[72:75], a[208:211], v[152:155]
    ds_read_b64_tr_b16 a[92:93], v16 offset:61440
    v_mfma_f32_16x16x32_bf16 v[148:151], a[72:75], a[200:203], v[148:151]
    ds_read_b64_tr_b16 a[94:95], v16 offset:61952
    v_add_u32 v16, 131072, v16
    v_mfma_f32_16x16x32_bf16 v[148:151], a[76:79], a[204:207], v[148:151]
    v_mfma_f32_16x16x32_bf16 v[144:147], a[76:79], a[196:199], v[144:147]
    v_mfma_f32_16x16x32_bf16 v[144:147], a[72:75], a[192:195], v[144:147]
    v_mfma_f32_16x16x32_bf16 v[160:163], a[80:83], a[192:195], v[160:163]
    buffer_load_dwordx4 a[164:167], v1, s[8:11], s7 offen offset:1024 sc1
    s_waitcnt lgkmcnt(2)
    v_mfma_f32_16x16x32_bf16 v[160:163], a[84:87], a[196:199], v[160:163]
    ds_read_b64_tr_b16 a[64:65], v17 offset:49152
    v_mfma_f32_16x16x32_bf16 v[164:167], a[84:87], a[204:207], v[164:167]
    ds_read_b64_tr_b16 a[66:67], v17 offset:49664
    v_mfma_f32_16x16x32_bf16 v[164:167], a[80:83], a[200:203], v[164:167]
    s_add_u32 s7, s60, 2048
    ds_read_b64_tr_b16 a[68:69], v17 offset:53248
    v_mfma_f32_16x16x32_bf16 v[168:171], a[80:83], a[208:211], v[168:171]
    ds_read_b64_tr_b16 a[70:71], v17 offset:53760
    v_mfma_f32_16x16x32_bf16 v[168:171], a[84:87], a[212:215], v[168:171]
    v_mfma_f32_16x16x32_bf16 v[172:175], a[84:87], a[220:223], v[172:175]
    buffer_store_dwordx4 a[8:11], v1, s[8:11], s7 offen sc1
    v_mfma_f32_16x16x32_bf16 v[172:175], a[80:83], a[216:219], v[172:175]
    v_mfma_f32_16x16x32_bf16 v[188:191], a[88:91], a[216:219], v[188:191]
    ds_read_b64_tr_b16 a[72:73], v17 offset:57344
    s_waitcnt lgkmcnt(3)
    v_mfma_f32_16x16x32_bf16 v[188:191], a[92:95], a[220:223], v[188:191]
    ds_read_b64_tr_b16 a[74:75], v17 offset:57856
    v_mfma_f32_16x16x32_bf16 v[184:187], a[92:95], a[212:215], v[184:187]
    s_add_u32 s7, s0, 16384
    ds_read_b64_tr_b16 a[76:77], v17 offset:61440
    v_mfma_f32_16x16x32_bf16 v[184:187], a[88:91], a[208:211], v[184:187]
    ds_read_b64_tr_b16 a[78:79], v17 offset:61952
    v_mfma_f32_16x16x32_bf16 v[180:183], a[88:91], a[200:203], v[180:183]
    v_add_u32 v17, 131072, v17
    v_mfma_f32_16x16x32_bf16 v[180:183], a[92:95], a[204:207], v[180:183]
    buffer_load_dwordx4 a[168:171], v1, s[8:11], s7 offen offset:0 sc1
    v_mfma_f32_16x16x32_bf16 v[176:179], a[92:95], a[196:199], v[176:179]
    v_mfma_f32_16x16x32_bf16 v[176:179], a[88:91], a[192:195], v[176:179]
    v_mfma_f32_16x16x32_bf16 v[192:195], a[64:67], a[192:195], v[192:195]
    ds_read_b64_tr_b16 a[80:81], v18 offset:49152
    s_waitcnt lgkmcnt(3)
    v_mfma_f32_16x16x32_bf16 v[192:195], a[68:71], a[196:199], v[192:195]
    ds_read_b64_tr_b16 a[82:83], v18 offset:49664
    v_mfma_f32_16x16x32_bf16 v[196:199], a[68:71], a[204:207], v[196:199]
    ds_read_b64_tr_b16 a[84:85], v18 offset:53248
    v_mfma_f32_16x16x32_bf16 v[196:199], a[64:67], a[200:203], v[196:199]
    buffer_load_dwordx4 a[172:175], v1, s[8:11], s7 offen offset:1024 sc1
    v_mfma_f32_16x16x32_bf16 v[200:203], a[64:67], a[208:211], v[200:203]
    ds_read_b64_tr_b16 a[86:87], v18 offset:53760
    v_mfma_f32_16x16x32_bf16 v[200:203], a[68:71], a[212:215], v[200:203]
    v_mfma_f32_16x16x32_bf16 v[204:207], a[68:71], a[220:223], v[204:207]
    s_add_u32 s7, s0, 32768
    v_mfma_f32_16x16x32_bf16 v[204:207], a[64:67], a[216:219], v[204:207]
    v_mfma_f32_16x16x32_bf16 v[220:223], a[72:75], a[216:219], v[220:223]
    ds_read_b64_tr_b16 a[88:89], v18 offset:57344
    s_waitcnt lgkmcnt(3)
    v_mfma_f32_16x16x32_bf16 v[220:223], a[76:79], a[220:223], v[220:223]
    buffer_load_dwordx4 a[176:179], v1, s[8:11], s7 offen offset:0 sc1
    v_mfma_f32_16x16x32_bf16 v[216:219], a[76:79], a[212:215], v[216:219]
    ds_read_b64_tr_b16 a[90:91], v18 offset:57856
    v_mfma_f32_16x16x32_bf16 v[216:219], a[72:75], a[208:211], v[216:219]
    ds_read_b64_tr_b16 a[92:93], v18 offset:61440
    v_mfma_f32_16x16x32_bf16 v[212:215], a[72:75], a[200:203], v[212:215]
    ds_read_b64_tr_b16 a[94:95], v18 offset:61952
    v_add_u32 v18, 131072, v18
    v_mfma_f32_16x16x32_bf16 v[212:215], a[76:79], a[204:207], v[212:215]
    v_mfma_f32_16x16x32_bf16 v[208:211], a[76:79], a[196:199], v[208:211]
    v_mfma_f32_16x16x32_bf16 v[208:211], a[72:75], a[192:195], v[208:211]
    v_mfma_f32_16x16x32_bf16 v[224:227], a[80:83], a[192:195], v[224:227]
    s_waitcnt lgkmcnt(3)
    v_mfma_f32_16x16x32_bf16 v[224:227], a[84:87], a[196:199], v[224:227]
    s_waitcnt vmcnt(15) lgkmcnt(0)
    s_barrier
    v_mfma_f32_16x16x32_bf16 v[228:231], a[84:87], a[204:207], v[228:231]
    ds_read_b64_tr_b16 a[64:65], v2 offset:0
    v_mfma_f32_16x16x32_bf16 v[228:231], a[80:83], a[200:203], v[228:231]
    ds_read_b64_tr_b16 a[66:67], v2 offset:1024
    v_mfma_f32_16x16x32_bf16 v[232:235], a[80:83], a[208:211], v[232:235]
    ds_read_b64_tr_b16 a[68:69], v2 offset:8192
    v_mfma_f32_16x16x32_bf16 v[232:235], a[84:87], a[212:215], v[232:235]
    ds_read_b64_tr_b16 a[70:71], v2 offset:9216
    v_mfma_f32_16x16x32_bf16 v[236:239], a[84:87], a[220:223], v[236:239]
    buffer_load_dwordx4 a[180:183], v1, s[8:11], s7 offen offset:1024 sc1
    v_mfma_f32_16x16x32_bf16 v[236:239], a[80:83], a[216:219], v[236:239]
    s_add_u32 s7, s0, 49152
    v_add_u32 v2, 4294836224, v2
    v_mfma_f32_16x16x32_bf16 v[252:255], a[88:91], a[216:219], v[252:255]
    buffer_load_dwordx4 a[184:187], v1, s[8:11], s7 offen offset:0 sc1
    v_mfma_f32_16x16x32_bf16 v[252:255], a[92:95], a[220:223], v[252:255]
    ds_read_b64_tr_b16 a[72:73], v3 offset:0
    v_mfma_f32_16x16x32_bf16 v[248:251], a[92:95], a[212:215], v[248:251]
    ds_read_b64_tr_b16 a[74:75], v3 offset:1024
    v_mfma_f32_16x16x32_bf16 v[248:251], a[88:91], a[208:211], v[248:251]
    buffer_load_dwordx4 a[188:191], v1, s[8:11], s7 offen offset:1024 sc1
    v_mfma_f32_16x16x32_bf16 v[244:247], a[88:91], a[200:203], v[244:247]
    ds_read_b64_tr_b16 a[76:77], v3 offset:8192
    v_mfma_f32_16x16x32_bf16 v[244:247], a[92:95], a[204:207], v[244:247]
    ds_read_b64_tr_b16 a[78:79], v3 offset:9216
    v_add_u32 v3, 4294836224, v3
    v_mfma_f32_16x16x32_bf16 v[240:243], a[92:95], a[196:199], v[240:243]
    v_mfma_f32_16x16x32_bf16 v[240:243], a[88:91], a[192:195], v[240:243]
    s_waitcnt lgkmcnt(3)
    v_mfma_f32_16x16x32_bf16 v[32:35], a[64:67], a[224:227], v[32:35]
    s_add_u32 s0, s62, 2097152
    s_xor_b32 m0, s90, 32768
    s_xor_b32 s7, s0, 0
    v_mfma_f32_16x16x32_bf16 v[32:35], a[68:71], a[228:231], v[32:35]
    buffer_load_dwordx4 v14, s[20:23], s7 offen lds
    v_mfma_f32_16x16x32_bf16 v[36:39], a[68:71], a[236:239], v[36:39]
    s_xor_b32 m0, s90, 33792
    ds_read_b64_tr_b16 a[80:81], v4 offset:0
    s_xor_b32 s7, s0, 32768
    v_mfma_f32_16x16x32_bf16 v[36:39], a[64:67], a[232:235], v[36:39]
    ds_read_b64_tr_b16 a[82:83], v4 offset:1024
    v_mfma_f32_16x16x32_bf16 v[40:43], a[64:67], a[240:243], v[40:43]
    ds_read_b64_tr_b16 a[84:85], v4 offset:8192
    v_mfma_f32_16x16x32_bf16 v[40:43], a[68:71], a[244:247], v[40:43]
    ds_read_b64_tr_b16 a[86:87], v4 offset:9216
    v_add_u32 v4, 4294836224, v4
    v_mfma_f32_16x16x32_bf16 v[44:47], a[68:71], a[252:255], v[44:47]
    buffer_load_dwordx4 v14, s[20:23], s7 offen lds
    v_mfma_f32_16x16x32_bf16 v[44:47], a[64:67], a[248:251], v[44:47]
    s_waitcnt lgkmcnt(3)
    v_mfma_f32_16x16x32_bf16 v[60:63], a[72:75], a[248:251], v[60:63]
    s_xor_b32 m0, s90, 34816
    s_xor_b32 s7, s0, 65536
    v_mfma_f32_16x16x32_bf16 v[60:63], a[76:79], a[252:255], v[60:63]
    ds_read_b64_tr_b16 a[88:89], v5 offset:0
    v_mfma_f32_16x16x32_bf16 v[56:59], a[76:79], a[244:247], v[56:59]
    ds_read_b64_tr_b16 a[90:91], v5 offset:1024
    v_mfma_f32_16x16x32_bf16 v[56:59], a[72:75], a[240:243], v[56:59]
    ds_read_b64_tr_b16 a[92:93], v5 offset:8192
    v_mfma_f32_16x16x32_bf16 v[52:55], a[72:75], a[232:235], v[52:55]
    buffer_load_dwordx4 v15, s[20:23], s7 offen lds
    v_mfma_f32_16x16x32_bf16 v[52:55], a[76:79], a[236:239], v[52:55]
    ds_read_b64_tr_b16 a[94:95], v5 offset:9216
    v_add_u32 v5, 4294836224, v5
    v_mfma_f32_16x16x32_bf16 v[48:51], a[76:79], a[228:231], v[48:51]
    s_xor_b32 m0, s90, 35840
    s_xor_b32 s7, s0, 98304
    v_mfma_f32_16x16x32_bf16 v[48:51], a[72:75], a[224:227], v[48:51]
    s_waitcnt lgkmcnt(2)
    v_mfma_f32_16x16x32_bf16 v[64:67], a[80:83], a[224:227], v[64:67]
    ds_read_b64_tr_b16 a[64:65], v6 offset:0
    v_mfma_f32_16x16x32_bf16 v[64:67], a[84:87], a[228:231], v[64:67]
    ds_read_b64_tr_b16 a[66:67], v6 offset:1024
    v_mfma_f32_16x16x32_bf16 v[68:71], a[84:87], a[236:239], v[68:71]
    buffer_load_dwordx4 v15, s[20:23], s7 offen lds
    v_mfma_f32_16x16x32_bf16 v[68:71], a[80:83], a[232:235], v[68:71]
    ds_read_b64_tr_b16 a[68:69], v6 offset:8192
    v_mfma_f32_16x16x32_bf16 v[72:75], a[80:83], a[240:243], v[72:75]
    ds_read_b64_tr_b16 a[70:71], v6 offset:9216
    v_add_u32 v6, 4294836224, v6
    v_mfma_f32_16x16x32_bf16 v[72:75], a[84:87], a[244:247], v[72:75]
    s_add_u32 s7, s60, 3072
    v_mfma_f32_16x16x32_bf16 v[76:79], a[84:87], a[252:255], v[76:79]
    v_mfma_f32_16x16x32_bf16 v[76:79], a[80:83], a[248:251], v[76:79]
    v_mfma_f32_16x16x32_bf16 v[92:95], a[88:91], a[248:251], v[92:95]
    buffer_store_dwordx4 a[12:15], v1, s[8:11], s7 offen sc1
    s_waitcnt lgkmcnt(2)
    v_mfma_f32_16x16x32_bf16 v[92:95], a[92:95], a[252:255], v[92:95]
    s_add_u32 s0, s63, 704512
    ds_read_b64_tr_b16 a[72:73], v7 offset:0
    s_add_u32 m0, s91, 32768
    v_mfma_f32_16x16x32_bf16 v[88:91], a[92:95], a[244:247], v[88:91]
    s_add_u32 s7, s0, 0
    ds_read_b64_tr_b16 a[74:75], v7 offset:1024
    v_mfma_f32_16x16x32_bf16 v[88:91], a[88:91], a[240:243], v[88:91]
    ds_read_b64_tr_b16 a[76:77], v7 offset:8192
    v_mfma_f32_16x16x32_bf16 v[84:87], a[88:91], a[232:235], v[84:87]
    ds_read_b64_tr_b16 a[78:79], v7 offset:9216
    v_add_u32 v7, 4294836224, v7
    v_mfma_f32_16x16x32_bf16 v[84:87], a[92:95], a[236:239], v[84:87]
    v_mfma_f32_16x16x32_bf16 v[80:83], a[92:95], a[228:231], v[80:83]
    buffer_load_dwordx4 v19, s[24:27], s7 offen lds
    v_mfma_f32_16x16x32_bf16 v[80:83], a[88:91], a[224:227], v[80:83]
    v_mfma_f32_16x16x32_bf16 v[96:99], a[64:67], a[224:227], v[96:99]
    s_add_u32 m0, s91, 33792
    s_add_u32 s7, s0, 22016
    s_waitcnt lgkmcnt(2)
    v_mfma_f32_16x16x32_bf16 v[96:99], a[68:71], a[228:231], v[96:99]
    ds_read_b64_tr_b16 a[80:81], v8 offset:0
    v_mfma_f32_16x16x32_bf16 v[100:103], a[68:71], a[236:239], v[100:103]
    ds_read_b64_tr_b16 a[82:83], v8 offset:1024
    v_mfma_f32_16x16x32_bf16 v[100:103], a[64:67], a[232:235], v[100:103]
    ds_read_b64_tr_b16 a[84:85], v8 offset:8192
    v_mfma_f32_16x16x32_bf16 v[104:107], a[64:67], a[240:243], v[104:107]
    buffer_load_dwordx4 v20, s[24:27], s7 offen lds
    v_mfma_f32_16x16x32_bf16 v[104:107], a[68:71], a[244:247], v[104:107]
    ds_read_b64_tr_b16 a[86:87], v8 offset:9216
    v_add_u32 v8, 4294836224, v8
    v_mfma_f32_16x16x32_bf16 v[108:111], a[68:71], a[252:255], v[108:111]
    s_add_u32 m0, s91, 40960
    s_add_u32 s7, s0, 0
    v_mfma_f32_16x16x32_bf16 v[108:111], a[64:67], a[248:251], v[108:111]
    v_mfma_f32_16x16x32_bf16 v[124:127], a[72:75], a[248:251], v[124:127]
    ds_read_b64_tr_b16 a[88:89], v9 offset:0
    s_waitcnt lgkmcnt(2)
    v_mfma_f32_16x16x32_bf16 v[124:127], a[76:79], a[252:255], v[124:127]
    ds_read_b64_tr_b16 a[90:91], v9 offset:1024
    v_mfma_f32_16x16x32_bf16 v[120:123], a[76:79], a[244:247], v[120:123]
    buffer_load_dwordx4 v19, s[28:31], s7 offen lds
    v_mfma_f32_16x16x32_bf16 v[120:123], a[72:75], a[240:243], v[120:123]
    ds_read_b64_tr_b16 a[92:93], v9 offset:8192
    v_mfma_f32_16x16x32_bf16 v[116:119], a[72:75], a[232:235], v[116:119]
    s_add_u32 m0, s91, 41984
    ds_read_b64_tr_b16 a[94:95], v9 offset:9216
    v_add_u32 v9, 4294836224, v9
    v_mfma_f32_16x16x32_bf16 v[116:119], a[76:79], a[236:239], v[116:119]
    s_add_u32 s7, s0, 22016
    v_mfma_f32_16x16x32_bf16 v[112:115], a[76:79], a[228:231], v[112:115]
    v_mfma_f32_16x16x32_bf16 v[112:115], a[72:75], a[224:227], v[112:115]
    v_mfma_f32_16x16x32_bf16 v[128:131], a[80:83], a[224:227], v[128:131]
    buffer_load_dwordx4 v20, s[28:31], s7 offen lds
    s_waitcnt lgkmcnt(2)
    v_mfma_f32_16x16x32_bf16 v[128:131], a[84:87], a[228:231], v[128:131]
    ds_read_b64_tr_b16 a[64:65], v16 offset:16384
    v_mfma_f32_16x16x32_bf16 v[132:135], a[84:87], a[236:239], v[132:135]
    ds_read_b64_tr_b16 a[66:67], v16 offset:16896
    v_mfma_f32_16x16x32_bf16 v[132:135], a[80:83], a[232:235], v[132:135]
    s_add_u32 s7, s95, 0
    ds_read_b64_tr_b16 a[68:69], v16 offset:20480
    v_mfma_f32_16x16x32_bf16 v[136:139], a[80:83], a[240:243], v[136:139]
    ds_read_b64_tr_b16 a[70:71], v16 offset:20992
    v_mfma_f32_16x16x32_bf16 v[136:139], a[84:87], a[244:247], v[136:139]
    v_mfma_f32_16x16x32_bf16 v[140:143], a[84:87], a[252:255], v[140:143]
    buffer_store_dwordx4 a[16:19], v1, s[8:11], s7 offen sc1
    v_mfma_f32_16x16x32_bf16 v[140:143], a[80:83], a[248:251], v[140:143]
    v_mfma_f32_16x16x32_bf16 v[156:159], a[88:91], a[248:251], v[156:159]
    s_add_u32 s0, s61, 10240
    s_add_u32 s7, s0, 0
    s_waitcnt lgkmcnt(2)
    v_mfma_f32_16x16x32_bf16 v[156:159], a[92:95], a[252:255], v[156:159]
    ds_read_b64_tr_b16 a[72:73], v16 offset:24576
    v_mfma_f32_16x16x32_bf16 v[152:155], a[92:95], a[244:247], v[152:155]
    ds_read_b64_tr_b16 a[74:75], v16 offset:25088
    v_mfma_f32_16x16x32_bf16 v[152:155], a[88:91], a[240:243], v[152:155]
    ds_read_b64_tr_b16 a[76:77], v16 offset:28672
    v_mfma_f32_16x16x32_bf16 v[148:151], a[88:91], a[232:235], v[148:151]
    buffer_load_dwordx4 a[192:195], v1, s[8:11], s7 offen offset:0 sc1
    v_mfma_f32_16x16x32_bf16 v[148:151], a[92:95], a[236:239], v[148:151]
    ds_read_b64_tr_b16 a[78:79], v16 offset:29184
    v_add_u32 v16, 4294836224, v16
    v_mfma_f32_16x16x32_bf16 v[144:147], a[92:95], a[228:231], v[144:147]
    v_mfma_f32_16x16x32_bf16 v[144:147], a[88:91], a[224:227], v[144:147]
    v_mfma_f32_16x16x32_bf16 v[160:163], a[64:67], a[224:227], v[160:163]
    ds_read_b64_tr_b16 a[80:81], v17 offset:16384
    s_waitcnt lgkmcnt(3)
    v_mfma_f32_16x16x32_bf16 v[160:163], a[68:71], a[228:231], v[160:163]
    ds_read_b64_tr_b16 a[82:83], v17 offset:16896
    v_mfma_f32_16x16x32_bf16 v[164:167], a[68:71], a[236:239], v[164:167]
    buffer_load_dwordx4 a[196:199], v1, s[8:11], s7 offen offset:1024 sc1
    v_mfma_f32_16x16x32_bf16 v[164:167], a[64:67], a[232:235], v[164:167]
    ds_read_b64_tr_b16 a[84:85], v17 offset:20480
    v_mfma_f32_16x16x32_bf16 v[168:171], a[64:67], a[240:243], v[168:171]
    ds_read_b64_tr_b16 a[86:87], v17 offset:20992
    v_mfma_f32_16x16x32_bf16 v[168:171], a[68:71], a[244:247], v[168:171]
    s_add_u32 s7, s0, 16384
    v_mfma_f32_16x16x32_bf16 v[172:175], a[68:71], a[252:255], v[172:175]
    v_mfma_f32_16x16x32_bf16 v[172:175], a[64:67], a[248:251], v[172:175]
    v_mfma_f32_16x16x32_bf16 v[188:191], a[72:75], a[248:251], v[188:191]
    buffer_load_dwordx4 a[200:203], v1, s[8:11], s7 offen offset:0 sc1
    s_waitcnt lgkmcnt(2)
    v_mfma_f32_16x16x32_bf16 v[188:191], a[76:79], a[252:255], v[188:191]
    ds_read_b64_tr_b16 a[88:89], v17 offset:24576
    v_mfma_f32_16x16x32_bf16 v[184:187], a[76:79], a[244:247], v[184:187]
    ds_read_b64_tr_b16 a[90:91], v17 offset:25088
    v_mfma_f32_16x16x32_bf16 v[184:187], a[72:75], a[240:243], v[184:187]
    ds_read_b64_tr_b16 a[92:93], v17 offset:28672
    v_mfma_f32_16x16x32_bf16 v[180:183], a[72:75], a[232:235], v[180:183]
    ds_read_b64_tr_b16 a[94:95], v17 offset:29184
    v_add_u32 v17, 4294836224, v17
    v_mfma_f32_16x16x32_bf16 v[180:183], a[76:79], a[236:239], v[180:183]
    v_mfma_f32_16x16x32_bf16 v[176:179], a[76:79], a[228:231], v[176:179]
    buffer_load_dwordx4 a[204:207], v1, s[8:11], s7 offen offset:1024 sc1
    v_mfma_f32_16x16x32_bf16 v[176:179], a[72:75], a[224:227], v[176:179]
    v_mfma_f32_16x16x32_bf16 v[192:195], a[80:83], a[224:227], v[192:195]
    ds_read_b64_tr_b16 a[64:65], v18 offset:16384
    s_waitcnt lgkmcnt(3)
    v_mfma_f32_16x16x32_bf16 v[192:195], a[84:87], a[228:231], v[192:195]
    s_add_u32 s7, s95, 1024
    ds_read_b64_tr_b16 a[66:67], v18 offset:16896
    v_mfma_f32_16x16x32_bf16 v[196:199], a[84:87], a[236:239], v[196:199]
    ds_read_b64_tr_b16 a[68:69], v18 offset:20480
    v_mfma_f32_16x16x32_bf16 v[196:199], a[80:83], a[232:235], v[196:199]
    ds_read_b64_tr_b16 a[70:71], v18 offset:20992
    v_mfma_f32_16x16x32_bf16 v[200:203], a[80:83], a[240:243], v[200:203]
    buffer_store_dwordx4 a[20:23], v1, s[8:11], s7 offen sc1
    v_mfma_f32_16x16x32_bf16 v[200:203], a[84:87], a[244:247], v[200:203]
    v_mfma_f32_16x16x32_bf16 v[204:207], a[84:87], a[252:255], v[204:207]
    v_mfma_f32_16x16x32_bf16 v[204:207], a[80:83], a[248:251], v[204:207]
    s_add_u32 s7, s0, 32768
    v_mfma_f32_16x16x32_bf16 v[220:223], a[88:91], a[248:251], v[220:223]
    ds_read_b64_tr_b16 a[72:73], v18 offset:24576
    s_waitcnt lgkmcnt(3)
    v_mfma_f32_16x16x32_bf16 v[220:223], a[92:95], a[252:255], v[220:223]
    ds_read_b64_tr_b16 a[74:75], v18 offset:25088
    v_mfma_f32_16x16x32_bf16 v[216:219], a[92:95], a[244:247], v[216:219]
    buffer_load_dwordx4 a[208:211], v1, s[8:11], s7 offen offset:0 sc1
    v_mfma_f32_16x16x32_bf16 v[216:219], a[88:91], a[240:243], v[216:219]
    ds_read_b64_tr_b16 a[76:77], v18 offset:28672
    v_mfma_f32_16x16x32_bf16 v[212:215], a[88:91], a[232:235], v[212:215]
    ds_read_b64_tr_b16 a[78:79], v18 offset:29184
    v_add_u32 v18, 4294836224, v18
    v_mfma_f32_16x16x32_bf16 v[212:215], a[92:95], a[236:239], v[212:215]
    v_mfma_f32_16x16x32_bf16 v[208:211], a[92:95], a[228:231], v[208:211]
    v_mfma_f32_16x16x32_bf16 v[208:211], a[88:91], a[224:227], v[208:211]
    v_mfma_f32_16x16x32_bf16 v[224:227], a[64:67], a[224:227], v[224:227]
    s_waitcnt lgkmcnt(2)
    v_mfma_f32_16x16x32_bf16 v[224:227], a[68:71], a[228:231], v[224:227]
    s_waitcnt vmcnt(16) lgkmcnt(0)
    s_barrier
    v_mfma_f32_16x16x32_bf16 v[228:231], a[68:71], a[236:239], v[228:231]
    ds_read_b64_tr_b16 a[80:81], v2 offset:0
    v_mfma_f32_16x16x32_bf16 v[228:231], a[64:67], a[232:235], v[228:231]
    ds_read_b64_tr_b16 a[82:83], v2 offset:1024
    v_mfma_f32_16x16x32_bf16 v[232:235], a[64:67], a[240:243], v[232:235]
    ds_read_b64_tr_b16 a[84:85], v2 offset:8192
    v_mfma_f32_16x16x32_bf16 v[232:235], a[68:71], a[244:247], v[232:235]
    ds_read_b64_tr_b16 a[86:87], v2 offset:9216
    v_mfma_f32_16x16x32_bf16 v[236:239], a[68:71], a[252:255], v[236:239]
    buffer_load_dwordx4 a[212:215], v1, s[8:11], s7 offen offset:1024 sc1
    v_mfma_f32_16x16x32_bf16 v[236:239], a[64:67], a[248:251], v[236:239]
    s_add_u32 s7, s0, 49152
    v_mfma_f32_16x16x32_bf16 v[252:255], a[72:75], a[248:251], v[252:255]
    buffer_load_dwordx4 a[216:219], v1, s[8:11], s7 offen offset:0 sc1
    v_mfma_f32_16x16x32_bf16 v[252:255], a[76:79], a[252:255], v[252:255]
    ds_read_b64_tr_b16 a[88:89], v3 offset:0
    v_mfma_f32_16x16x32_bf16 v[248:251], a[76:79], a[244:247], v[248:251]
    ds_read_b64_tr_b16 a[90:91], v3 offset:1024
    v_mfma_f32_16x16x32_bf16 v[248:251], a[72:75], a[240:243], v[248:251]
    buffer_load_dwordx4 a[220:223], v1, s[8:11], s7 offen offset:1024 sc1
    v_mfma_f32_16x16x32_bf16 v[244:247], a[72:75], a[232:235], v[244:247]
    ds_read_b64_tr_b16 a[92:93], v3 offset:8192
    v_mfma_f32_16x16x32_bf16 v[244:247], a[76:79], a[236:239], v[244:247]
L_tp12:
    s_cbranch_execz L_tp16
    ds_read_b64_tr_b16 a[94:95], v3 offset:9216
    v_mfma_f32_16x16x32_bf16 v[240:243], a[76:79], a[228:231], v[240:243]
    v_mfma_f32_16x16x32_bf16 v[240:243], a[72:75], a[224:227], v[240:243]
    s_waitcnt lgkmcnt(4)
    v_mfma_f32_16x16x32_bf16 v[32:35], a[80:83], a[128:131], v[32:35]
    s_add_u32 s0, s62, 2621440
    s_xor_b32 m0, s90, 131072
    s_xor_b32 s7, s0, 0
    v_mfma_f32_16x16x32_bf16 v[32:35], a[84:87], a[132:135], v[32:35]
    buffer_load_dwordx4 v14, s[20:23], s7 offen lds
    v_mfma_f32_16x16x32_bf16 v[36:39], a[84:87], a[140:143], v[36:39]
    ds_read_b64_tr_b16 a[64:65], v4 offset:0
    v_mfma_f32_16x16x32_bf16 v[36:39], a[80:83], a[136:139], v[36:39]
    s_xor_b32 m0, s90, 132096
    ds_read_b64_tr_b16 a[66:67], v4 offset:1024
    s_xor_b32 s7, s0, 32768
    v_mfma_f32_16x16x32_bf16 v[40:43], a[80:83], a[144:147], v[40:43]
    ds_read_b64_tr_b16 a[68:69], v4 offset:8192
    v_mfma_f32_16x16x32_bf16 v[40:43], a[84:87], a[148:151], v[40:43]
    ds_read_b64_tr_b16 a[70:71], v4 offset:9216
    v_mfma_f32_16x16x32_bf16 v[44:47], a[84:87], a[156:159], v[44:47]
    v_mfma_f32_16x16x32_bf16 v[44:47], a[80:83], a[152:155], v[44:47]
    buffer_load_dwordx4 v14, s[20:23], s7 offen lds
    s_waitcnt lgkmcnt(3)
    v_mfma_f32_16x16x32_bf16 v[60:63], a[88:91], a[152:155], v[60:63]
    ds_read_b64_tr_b16 a[72:73], v5 offset:0
    v_mfma_f32_16x16x32_bf16 v[60:63], a[92:95], a[156:159], v[60:63]
    s_xor_b32 m0, s90, 133120
    ds_read_b64_tr_b16 a[74:75], v5 offset:1024
    s_xor_b32 s7, s0, 65536
    v_mfma_f32_16x16x32_bf16 v[56:59], a[92:95], a[148:151], v[56:59]
    ds_read_b64_tr_b16 a[76:77], v5 offset:8192
    v_mfma_f32_16x16x32_bf16 v[56:59], a[88:91], a[144:147], v[56:59]
    ds_read_b64_tr_b16 a[78:79], v5 offset:9216
    v_mfma_f32_16x16x32_bf16 v[52:55], a[88:91], a[136:139], v[52:55]
    v_mfma_f32_16x16x32_bf16 v[52:55], a[92:95], a[140:143], v[52:55]
    buffer_load_dwordx4 v15, s[20:23], s7 offen lds
    v_mfma_f32_16x16x32_bf16 v[48:51], a[92:95], a[132:135], v[48:51]
    v_mfma_f32_16x16x32_bf16 v[48:51], a[88:91], a[128:131], v[48:51]
    s_waitcnt lgkmcnt(3)
    v_mfma_f32_16x16x32_bf16 v[64:67], a[64:67], a[128:131], v[64:67]
    s_xor_b32 m0, s90, 134144
    s_xor_b32 s7, s0, 98304
    v_mfma_f32_16x16x32_bf16 v[64:67], a[68:71], a[132:135], v[64:67]
    ds_read_b64_tr_b16 a[80:81], v6 offset:0
    v_mfma_f32_16x16x32_bf16 v[68:71], a[68:71], a[140:143], v[68:71]
    ds_read_b64_tr_b16 a[82:83], v6 offset:1024
    v_mfma_f32_16x16x32_bf16 v[68:71], a[64:67], a[136:139], v[68:71]
    ds_read_b64_tr_b16 a[84:85], v6 offset:8192
    v_mfma_f32_16x16x32_bf16 v[72:75], a[64:67], a[144:147], v[72:75]
    buffer_load_dwordx4 v15, s[20:23], s7 offen lds
    v_mfma_f32_16x16x32_bf16 v[72:75], a[68:71], a[148:151], v[72:75]
    ds_read_b64_tr_b16 a[86:87], v6 offset:9216
    v_mfma_f32_16x16x32_bf16 v[76:79], a[68:71], a[156:159], v[76:79]
    v_mfma_f32_16x16x32_bf16 v[76:79], a[64:67], a[152:155], v[76:79]
    s_add_u32 s7, s95, 2048
    s_waitcnt lgkmcnt(3)
    v_mfma_f32_16x16x32_bf16 v[92:95], a[72:75], a[152:155], v[92:95]
    ds_read_b64_tr_b16 a[88:89], v7 offset:0
    v_mfma_f32_16x16x32_bf16 v[92:95], a[76:79], a[156:159], v[92:95]
    ds_read_b64_tr_b16 a[90:91], v7 offset:1024
    v_mfma_f32_16x16x32_bf16 v[88:91], a[76:79], a[148:151], v[88:91]
    buffer_store_dwordx4 a[24:27], v1, s[8:11], s7 offen sc1
    v_mfma_f32_16x16x32_bf16 v[88:91], a[72:75], a[144:147], v[88:91]
    s_add_u32 s0, s63, 880640
    ds_read_b64_tr_b16 a[92:93], v7 offset:8192
    s_add_u32 m0, s91, 131072
    v_mfma_f32_16x16x32_bf16 v[84:87], a[72:75], a[136:139], v[84:87]
    s_add_u32 s7, s0, 0
    ds_read_b64_tr_b16 a[94:95], v7 offset:9216
    v_mfma_f32_16x16x32_bf16 v[84:87], a[76:79], a[140:143], v[84:87]
    v_mfma_f32_16x16x32_bf16 v[80:83], a[76:79], a[132:135], v[80:83]
    v_mfma_f32_16x16x32_bf16 v[80:83], a[72:75], a[128:131], v[80:83]
    s_waitcnt lgkmcnt(2)
    v_mfma_f32_16x16x32_bf16 v[96:99], a[80:83], a[128:131], v[96:99]
    buffer_load_dwordx4 v19, s[24:27], s7 offen lds
    v_mfma_f32_16x16x32_bf16 v[96:99], a[84:87], a[132:135], v[96:99]
    ds_read_b64_tr_b16 a[64:65], v8 offset:0
    v_mfma_f32_16x16x32_bf16 v[100:103], a[84:87], a[140:143], v[100:103]
    ds_read_b64_tr_b16 a[66:67], v8 offset:1024
    v_mfma_f32_16x16x32_bf16 v[100:103], a[80:83], a[136:139], v[100:103]
    s_add_u32 m0, s91, 132096
    ds_read_b64_tr_b16 a[68:69], v8 offset:8192
    s_add_u32 s7, s0, 22016
    v_mfma_f32_16x16x32_bf16 v[104:107], a[80:83], a[144:147], v[104:107]
    ds_read_b64_tr_b16 a[70:71], v8 offset:9216
    v_mfma_f32_16x16x32_bf16 v[104:107], a[84:87], a[148:151], v[104:107]
    v_mfma_f32_16x16x32_bf16 v[108:111], a[84:87], a[156:159], v[108:111]
    v_mfma_f32_16x16x32_bf16 v[108:111], a[80:83], a[152:155], v[108:111]
    buffer_load_dwordx4 v20, s[24:27], s7 offen lds
    v_mfma_f32_16x16x32_bf16 v[124:127], a[88:91], a[152:155], v[124:127]
    ds_read_b64_tr_b16 a[72:73], v9 offset:0
    s_waitcnt lgkmcnt(3)
    v_mfma_f32_16x16x32_bf16 v[124:127], a[92:95], a[156:159], v[124:127]
    s_add_u32 m0, s91, 139264
    ds_read_b64_tr_b16 a[74:75], v9 offset:1024
    s_add_u32 s7, s0, 0
    v_mfma_f32_16x16x32_bf16 v[120:123], a[92:95], a[148:151], v[120:123]
    ds_read_b64_tr_b16 a[76:77], v9 offset:8192
    v_mfma_f32_16x16x32_bf16 v[120:123], a[88:91], a[144:147], v[120:123]
    ds_read_b64_tr_b16 a[78:79], v9 offset:9216
    v_mfma_f32_16x16x32_bf16 v[116:119], a[88:91], a[136:139], v[116:119]
    v_mfma_f32_16x16x32_bf16 v[116:119], a[92:95], a[140:143], v[116:119]
    buffer_load_dwordx4 v19, s[28:31], s7 offen lds
    v_mfma_f32_16x16x32_bf16 v[112:115], a[92:95], a[132:135], v[112:115]
    v_mfma_f32_16x16x32_bf16 v[112:115], a[88:91], a[128:131], v[112:115]
    s_add_u32 m0, s91, 140288
    s_add_u32 s7, s0, 22016
    v_mfma_f32_16x16x32_bf16 v[128:131], a[64:67], a[128:131], v[128:131]
    ds_read_b64_tr_b16 a[80:81], v16 offset:16384
    s_waitcnt lgkmcnt(2)
    v_mfma_f32_16x16x32_bf16 v[128:131], a[68:71], a[132:135], v[128:131]
    ds_read_b64_tr_b16 a[82:83], v16 offset:16896
    v_mfma_f32_16x16x32_bf16 v[132:135], a[68:71], a[140:143], v[132:135]
    ds_read_b64_tr_b16 a[84:85], v16 offset:20480
    v_mfma_f32_16x16x32_bf16 v[132:135], a[64:67], a[136:139], v[132:135]
    buffer_load_dwordx4 v20, s[28:31], s7 offen lds
    v_mfma_f32_16x16x32_bf16 v[136:139], a[64:67], a[144:147], v[136:139]
    ds_read_b64_tr_b16 a[86:87], v16 offset:20992
    v_mfma_f32_16x16x32_bf16 v[136:139], a[68:71], a[148:151], v[136:139]
    v_mfma_f32_16x16x32_bf16 v[140:143], a[68:71], a[156:159], v[140:143]
    s_add_u32 s0, s61, 12288
    s_add_u32 s7, s0, 0
    v_mfma_f32_16x16x32_bf16 v[140:143], a[64:67], a[152:155], v[140:143]
    v_mfma_f32_16x16x32_bf16 v[156:159], a[72:75], a[152:155], v[156:159]
    ds_read_b64_tr_b16 a[88:89], v16 offset:24576
    s_waitcnt lgkmcnt(2)
    v_mfma_f32_16x16x32_bf16 v[156:159], a[76:79], a[156:159], v[156:159]
    ds_read_b64_tr_b16 a[90:91], v16 offset:25088
    v_mfma_f32_16x16x32_bf16 v[152:155], a[76:79], a[148:151], v[152:155]
    buffer_load_dwordx4 a[224:227], v1, s[8:11], s7 offen offset:0 sc1
    v_mfma_f32_16x16x32_bf16 v[152:155], a[72:75], a[144:147], v[152:155]
    ds_read_b64_tr_b16 a[92:93], v16 offset:28672
    v_mfma_f32_16x16x32_bf16 v[148:151], a[72:75], a[136:139], v[148:151]
    ds_read_b64_tr_b16 a[94:95], v16 offset:29184
    v_mfma_f32_16x16x32_bf16 v[148:151], a[76:79], a[140:143], v[148:151]
    v_mfma_f32_16x16x32_bf16 v[144:147], a[76:79], a[132:135], v[144:147]
    v_mfma_f32_16x16x32_bf16 v[144:147], a[72:75], a[128:131], v[144:147]
    v_mfma_f32_16x16x32_bf16 v[160:163], a[80:83], a[128:131], v[160:163]
    buffer_load_dwordx4 a[228:231], v1, s[8:11], s7 offen offset:1024 sc1
    s_waitcnt lgkmcnt(2)
    v_mfma_f32_16x16x32_bf16 v[160:163], a[84:87], a[132:135], v[160:163]
    ds_read_b64_tr_b16 a[64:65], v17 offset:16384
    v_mfma_f32_16x16x32_bf16 v[164:167], a[84:87], a[140:143], v[164:167]
    ds_read_b64_tr_b16 a[66:67], v17 offset:16896
    v_mfma_f32_16x16x32_bf16 v[164:167], a[80:83], a[136:139], v[164:167]
    s_add_u32 s7, s95, 3072
    ds_read_b64_tr_b16 a[68:69], v17 offset:20480
    v_mfma_f32_16x16x32_bf16 v[168:171], a[80:83], a[144:147], v[168:171]
    ds_read_b64_tr_b16 a[70:71], v17 offset:20992
    v_mfma_f32_16x16x32_bf16 v[168:171], a[84:87], a[148:151], v[168:171]
    v_mfma_f32_16x16x32_bf16 v[172:175], a[84:87], a[156:159], v[172:175]
    buffer_store_dwordx4 a[28:31], v1, s[8:11], s7 offen sc1
    v_mfma_f32_16x16x32_bf16 v[172:175], a[80:83], a[152:155], v[172:175]
    v_mfma_f32_16x16x32_bf16 v[188:191], a[88:91], a[152:155], v[188:191]
    ds_read_b64_tr_b16 a[72:73], v17 offset:24576
    s_waitcnt lgkmcnt(3)
    v_mfma_f32_16x16x32_bf16 v[188:191], a[92:95], a[156:159], v[188:191]
    ds_read_b64_tr_b16 a[74:75], v17 offset:25088
    v_mfma_f32_16x16x32_bf16 v[184:187], a[92:95], a[148:151], v[184:187]
    s_add_u32 s7, s0, 16384
    ds_read_b64_tr_b16 a[76:77], v17 offset:28672
    v_mfma_f32_16x16x32_bf16 v[184:187], a[88:91], a[144:147], v[184:187]
    ds_read_b64_tr_b16 a[78:79], v17 offset:29184
    v_mfma_f32_16x16x32_bf16 v[180:183], a[88:91], a[136:139], v[180:183]
    v_mfma_f32_16x16x32_bf16 v[180:183], a[92:95], a[140:143], v[180:183]
    buffer_load_dwordx4 a[232:235], v1, s[8:11], s7 offen offset:0 sc1
    v_mfma_f32_16x16x32_bf16 v[176:179], a[92:95], a[132:135], v[176:179]
    v_mfma_f32_16x16x32_bf16 v[176:179], a[88:91], a[128:131], v[176:179]
    v_mfma_f32_16x16x32_bf16 v[192:195], a[64:67], a[128:131], v[192:195]
    ds_read_b64_tr_b16 a[80:81], v18 offset:16384
    s_waitcnt lgkmcnt(3)
    v_mfma_f32_16x16x32_bf16 v[192:195], a[68:71], a[132:135], v[192:195]
    ds_read_b64_tr_b16 a[82:83], v18 offset:16896
    v_mfma_f32_16x16x32_bf16 v[196:199], a[68:71], a[140:143], v[196:199]
    ds_read_b64_tr_b16 a[84:85], v18 offset:20480
    v_mfma_f32_16x16x32_bf16 v[196:199], a[64:67], a[136:139], v[196:199]
    buffer_load_dwordx4 a[236:239], v1, s[8:11], s7 offen offset:1024 sc1
    v_mfma_f32_16x16x32_bf16 v[200:203], a[64:67], a[144:147], v[200:203]
    ds_read_b64_tr_b16 a[86:87], v18 offset:20992
    v_mfma_f32_16x16x32_bf16 v[200:203], a[68:71], a[148:151], v[200:203]
    v_mfma_f32_16x16x32_bf16 v[204:207], a[68:71], a[156:159], v[204:207]
    s_add_u32 s7, s0, 32768
    v_mfma_f32_16x16x32_bf16 v[204:207], a[64:67], a[152:155], v[204:207]
    v_mfma_f32_16x16x32_bf16 v[220:223], a[72:75], a[152:155], v[220:223]
    ds_read_b64_tr_b16 a[88:89], v18 offset:24576
    s_waitcnt lgkmcnt(3)
    v_mfma_f32_16x16x32_bf16 v[220:223], a[76:79], a[156:159], v[220:223]
    buffer_load_dwordx4 a[240:243], v1, s[8:11], s7 offen offset:0 sc1
    v_mfma_f32_16x16x32_bf16 v[216:219], a[76:79], a[148:151], v[216:219]
    ds_read_b64_tr_b16 a[90:91], v18 offset:25088
    v_mfma_f32_16x16x32_bf16 v[216:219], a[72:75], a[144:147], v[216:219]
    ds_read_b64_tr_b16 a[92:93], v18 offset:28672
    v_mfma_f32_16x16x32_bf16 v[212:215], a[72:75], a[136:139], v[212:215]
    ds_read_b64_tr_b16 a[94:95], v18 offset:29184
    v_mfma_f32_16x16x32_bf16 v[212:215], a[76:79], a[140:143], v[212:215]
    v_mfma_f32_16x16x32_bf16 v[208:211], a[76:79], a[132:135], v[208:211]
    v_mfma_f32_16x16x32_bf16 v[208:211], a[72:75], a[128:131], v[208:211]
    v_mfma_f32_16x16x32_bf16 v[224:227], a[80:83], a[128:131], v[224:227]
    s_waitcnt lgkmcnt(3)
    v_mfma_f32_16x16x32_bf16 v[224:227], a[84:87], a[132:135], v[224:227]
    s_waitcnt vmcnt(15) lgkmcnt(0)
    s_barrier
    v_mfma_f32_16x16x32_bf16 v[228:231], a[84:87], a[140:143], v[228:231]
    ds_read_b64_tr_b16 a[64:65], v2 offset:32768
    v_mfma_f32_16x16x32_bf16 v[228:231], a[80:83], a[136:139], v[228:231]
    ds_read_b64_tr_b16 a[66:67], v2 offset:33792
    v_mfma_f32_16x16x32_bf16 v[232:235], a[80:83], a[144:147], v[232:235]
    ds_read_b64_tr_b16 a[68:69], v2 offset:40960
    v_mfma_f32_16x16x32_bf16 v[232:235], a[84:87], a[148:151], v[232:235]
    ds_read_b64_tr_b16 a[70:71], v2 offset:41984
    v_mfma_f32_16x16x32_bf16 v[236:239], a[84:87], a[156:159], v[236:239]
    buffer_load_dwordx4 a[244:247], v1, s[8:11], s7 offen offset:1024 sc1
    v_mfma_f32_16x16x32_bf16 v[236:239], a[80:83], a[152:155], v[236:239]
    s_add_u32 s7, s0, 49152
    v_add_u32 v2, 131072, v2
    v_mfma_f32_16x16x32_bf16 v[252:255], a[88:91], a[152:155], v[252:255]
    buffer_load_dwordx4 a[248:251], v1, s[8:11], s7 offen offset:0 sc1
    v_mfma_f32_16x16x32_bf16 v[252:255], a[92:95], a[156:159], v[252:255]
    ds_read_b64_tr_b16 a[72:73], v3 offset:32768
    v_mfma_f32_16x16x32_bf16 v[248:251], a[92:95], a[148:151], v[248:251]
    ds_read_b64_tr_b16 a[74:75], v3 offset:33792
    v_mfma_f32_16x16x32_bf16 v[248:251], a[88:91], a[144:147], v[248:251]
    buffer_load_dwordx4 a[252:255], v1, s[8:11], s7 offen offset:1024 sc1
    v_mfma_f32_16x16x32_bf16 v[244:247], a[88:91], a[136:139], v[244:247]
    ds_read_b64_tr_b16 a[76:77], v3 offset:40960
    v_mfma_f32_16x16x32_bf16 v[244:247], a[92:95], a[140:143], v[244:247]
    ds_read_b64_tr_b16 a[78:79], v3 offset:41984
    v_add_u32 v3, 131072, v3
    v_mfma_f32_16x16x32_bf16 v[240:243], a[92:95], a[132:135], v[240:243]
    v_mfma_f32_16x16x32_bf16 v[240:243], a[88:91], a[128:131], v[240:243]
    s_waitcnt lgkmcnt(3)
    v_mfma_f32_16x16x32_bf16 v[32:35], a[64:67], a[160:163], v[32:35]
    s_add_u32 s0, s62, 3145728
    s_xor_b32 m0, s90, 0
    s_xor_b32 s7, s0, 0
    v_mfma_f32_16x16x32_bf16 v[32:35], a[68:71], a[164:167], v[32:35]
    buffer_load_dwordx4 v14, s[20:23], s7 offen lds
    v_mfma_f32_16x16x32_bf16 v[36:39], a[68:71], a[172:175], v[36:39]
    s_xor_b32 m0, s90, 1024
    ds_read_b64_tr_b16 a[80:81], v4 offset:32768
    s_xor_b32 s7, s0, 32768
    v_mfma_f32_16x16x32_bf16 v[36:39], a[64:67], a[168:171], v[36:39]
    ds_read_b64_tr_b16 a[82:83], v4 offset:33792
    v_mfma_f32_16x16x32_bf16 v[40:43], a[64:67], a[176:179], v[40:43]
    ds_read_b64_tr_b16 a[84:85], v4 offset:40960
    v_mfma_f32_16x16x32_bf16 v[40:43], a[68:71], a[180:183], v[40:43]
    ds_read_b64_tr_b16 a[86:87], v4 offset:41984
    v_add_u32 v4, 131072, v4
    v_mfma_f32_16x16x32_bf16 v[44:47], a[68:71], a[188:191], v[44:47]
    buffer_load_dwordx4 v14, s[20:23], s7 offen lds
    v_mfma_f32_16x16x32_bf16 v[44:47], a[64:67], a[184:187], v[44:47]
    s_waitcnt lgkmcnt(3)
    v_mfma_f32_16x16x32_bf16 v[60:63], a[72:75], a[184:187], v[60:63]
    s_xor_b32 m0, s90, 2048
    s_xor_b32 s7, s0, 65536
    v_mfma_f32_16x16x32_bf16 v[60:63], a[76:79], a[188:191], v[60:63]
    ds_read_b64_tr_b16 a[88:89], v5 offset:32768
    v_mfma_f32_16x16x32_bf16 v[56:59], a[76:79], a[180:183], v[56:59]
    ds_read_b64_tr_b16 a[90:91], v5 offset:33792
    v_mfma_f32_16x16x32_bf16 v[56:59], a[72:75], a[176:179], v[56:59]
    ds_read_b64_tr_b16 a[92:93], v5 offset:40960
    v_mfma_f32_16x16x32_bf16 v[52:55], a[72:75], a[168:171], v[52:55]
    buffer_load_dwordx4 v15, s[20:23], s7 offen lds
    v_mfma_f32_16x16x32_bf16 v[52:55], a[76:79], a[172:175], v[52:55]
    ds_read_b64_tr_b16 a[94:95], v5 offset:41984
    v_add_u32 v5, 131072, v5
    v_mfma_f32_16x16x32_bf16 v[48:51], a[76:79], a[164:167], v[48:51]
    s_xor_b32 m0, s90, 3072
    s_xor_b32 s7, s0, 98304
    v_mfma_f32_16x16x32_bf16 v[48:51], a[72:75], a[160:163], v[48:51]
    s_waitcnt lgkmcnt(2)
    v_mfma_f32_16x16x32_bf16 v[64:67], a[80:83], a[160:163], v[64:67]
    ds_read_b64_tr_b16 a[64:65], v6 offset:32768
    v_mfma_f32_16x16x32_bf16 v[64:67], a[84:87], a[164:167], v[64:67]
    ds_read_b64_tr_b16 a[66:67], v6 offset:33792
    v_mfma_f32_16x16x32_bf16 v[68:71], a[84:87], a[172:175], v[68:71]
    buffer_load_dwordx4 v15, s[20:23], s7 offen lds
    v_mfma_f32_16x16x32_bf16 v[68:71], a[80:83], a[168:171], v[68:71]
    s_xor_b32 s60, s60, 0xf0000
    ds_read_b64_tr_b16 a[68:69], v6 offset:40960
    s_xor_b32 s95, s95, 0xf0000
    v_mfma_f32_16x16x32_bf16 v[72:75], a[80:83], a[176:179], v[72:75]
    s_add_u32 s7, s60, 0
    ds_read_b64_tr_b16 a[70:71], v6 offset:41984
    v_add_u32 v6, 131072, v6
    v_mfma_f32_16x16x32_bf16 v[72:75], a[84:87], a[180:183], v[72:75]
    v_mfma_f32_16x16x32_bf16 v[76:79], a[84:87], a[188:191], v[76:79]
    v_mfma_f32_16x16x32_bf16 v[76:79], a[80:83], a[184:187], v[76:79]
    v_mfma_f32_16x16x32_bf16 v[92:95], a[88:91], a[184:187], v[92:95]
    buffer_store_dwordx4 a[32:35], v1, s[8:11], s7 offen sc1
    s_waitcnt lgkmcnt(2)
    v_mfma_f32_16x16x32_bf16 v[92:95], a[92:95], a[188:191], v[92:95]
    s_add_u32 s0, s63, 1056768
    ds_read_b64_tr_b16 a[72:73], v7 offset:32768
    s_add_u32 m0, s91, 0
    v_mfma_f32_16x16x32_bf16 v[88:91], a[92:95], a[180:183], v[88:91]
    s_add_u32 s7, s0, 0
    ds_read_b64_tr_b16 a[74:75], v7 offset:33792
    v_mfma_f32_16x16x32_bf16 v[88:91], a[88:91], a[176:179], v[88:91]
    ds_read_b64_tr_b16 a[76:77], v7 offset:40960
    v_mfma_f32_16x16x32_bf16 v[84:87], a[88:91], a[168:171], v[84:87]
    ds_read_b64_tr_b16 a[78:79], v7 offset:41984
    v_add_u32 v7, 131072, v7
    v_mfma_f32_16x16x32_bf16 v[84:87], a[92:95], a[172:175], v[84:87]
    v_mfma_f32_16x16x32_bf16 v[80:83], a[92:95], a[164:167], v[80:83]
    buffer_load_dwordx4 v19, s[24:27], s7 offen lds
    v_mfma_f32_16x16x32_bf16 v[80:83], a[88:91], a[160:163], v[80:83]
    v_mfma_f32_16x16x32_bf16 v[96:99], a[64:67], a[160:163], v[96:99]
    s_add_u32 m0, s91, 1024
    s_add_u32 s7, s0, 22016
    s_waitcnt lgkmcnt(2)
    v_mfma_f32_16x16x32_bf16 v[96:99], a[68:71], a[164:167], v[96:99]
    ds_read_b64_tr_b16 a[80:81], v8 offset:32768
    v_mfma_f32_16x16x32_bf16 v[100:103], a[68:71], a[172:175], v[100:103]
    ds_read_b64_tr_b16 a[82:83], v8 offset:33792
    v_mfma_f32_16x16x32_bf16 v[100:103], a[64:67], a[168:171], v[100:103]
    ds_read_b64_tr_b16 a[84:85], v8 offset:40960
    v_mfma_f32_16x16x32_bf16 v[104:107], a[64:67], a[176:179], v[104:107]
    buffer_load_dwordx4 v20, s[24:27], s7 offen lds
    v_mfma_f32_16x16x32_bf16 v[104:107], a[68:71], a[180:183], v[104:107]
    ds_read_b64_tr_b16 a[86:87], v8 offset:41984
    v_add_u32 v8, 131072, v8
    v_mfma_f32_16x16x32_bf16 v[108:111], a[68:71], a[188:191], v[108:111]
    s_add_u32 m0, s91, 8192
    s_add_u32 s7, s0, 0
    v_mfma_f32_16x16x32_bf16 v[108:111], a[64:67], a[184:187], v[108:111]
    v_mfma_f32_16x16x32_bf16 v[124:127], a[72:75], a[184:187], v[124:127]
    ds_read_b64_tr_b16 a[88:89], v9 offset:32768
    s_waitcnt lgkmcnt(2)
    v_mfma_f32_16x16x32_bf16 v[124:127], a[76:79], a[188:191], v[124:127]
    ds_read_b64_tr_b16 a[90:91], v9 offset:33792
    v_mfma_f32_16x16x32_bf16 v[120:123], a[76:79], a[180:183], v[120:123]
    buffer_load_dwordx4 v19, s[28:31], s7 offen lds
    v_mfma_f32_16x16x32_bf16 v[120:123], a[72:75], a[176:179], v[120:123]
    ds_read_b64_tr_b16 a[92:93], v9 offset:40960
    v_mfma_f32_16x16x32_bf16 v[116:119], a[72:75], a[168:171], v[116:119]
    s_add_u32 m0, s91, 9216
    ds_read_b64_tr_b16 a[94:95], v9 offset:41984
    v_add_u32 v9, 131072, v9
    v_mfma_f32_16x16x32_bf16 v[116:119], a[76:79], a[172:175], v[116:119]
    s_add_u32 s7, s0, 22016
    v_mfma_f32_16x16x32_bf16 v[112:115], a[76:79], a[164:167], v[112:115]
    v_mfma_f32_16x16x32_bf16 v[112:115], a[72:75], a[160:163], v[112:115]
    v_mfma_f32_16x16x32_bf16 v[128:131], a[80:83], a[160:163], v[128:131]
    buffer_load_dwordx4 v20, s[28:31], s7 offen lds
    s_waitcnt lgkmcnt(2)
    v_mfma_f32_16x16x32_bf16 v[128:131], a[84:87], a[164:167], v[128:131]
    ds_read_b64_tr_b16 a[64:65], v16 offset:49152
    v_mfma_f32_16x16x32_bf16 v[132:135], a[84:87], a[172:175], v[132:135]
    ds_read_b64_tr_b16 a[66:67], v16 offset:49664
    v_mfma_f32_16x16x32_bf16 v[132:135], a[80:83], a[168:171], v[132:135]
    s_add_u32 s7, s60, 1024
    ds_read_b64_tr_b16 a[68:69], v16 offset:53248
    v_mfma_f32_16x16x32_bf16 v[136:139], a[80:83], a[176:179], v[136:139]
    ds_read_b64_tr_b16 a[70:71], v16 offset:53760
    v_mfma_f32_16x16x32_bf16 v[136:139], a[84:87], a[180:183], v[136:139]
    v_mfma_f32_16x16x32_bf16 v[140:143], a[84:87], a[188:191], v[140:143]
    buffer_store_dwordx4 a[36:39], v1, s[8:11], s7 offen sc1
    v_mfma_f32_16x16x32_bf16 v[140:143], a[80:83], a[184:187], v[140:143]
    v_mfma_f32_16x16x32_bf16 v[156:159], a[88:91], a[184:187], v[156:159]
    s_add_u32 s0, s61, 14336
    s_add_u32 s7, s0, 0
    s_waitcnt lgkmcnt(2)
    v_mfma_f32_16x16x32_bf16 v[156:159], a[92:95], a[188:191], v[156:159]
    ds_read_b64_tr_b16 a[72:73], v16 offset:57344
    v_mfma_f32_16x16x32_bf16 v[152:155], a[92:95], a[180:183], v[152:155]
    ds_read_b64_tr_b16 a[74:75], v16 offset:57856
    v_mfma_f32_16x16x32_bf16 v[152:155], a[88:91], a[176:179], v[152:155]
    ds_read_b64_tr_b16 a[76:77], v16 offset:61440
    v_mfma_f32_16x16x32_bf16 v[148:151], a[88:91], a[168:171], v[148:151]
    buffer_load_dwordx4 a[128:131], v1, s[8:11], s7 offen offset:0 sc1
    v_mfma_f32_16x16x32_bf16 v[148:151], a[92:95], a[172:175], v[148:151]
    ds_read_b64_tr_b16 a[78:79], v16 offset:61952
    v_add_u32 v16, 131072, v16
    v_mfma_f32_16x16x32_bf16 v[144:147], a[92:95], a[164:167], v[144:147]
    v_mfma_f32_16x16x32_bf16 v[144:147], a[88:91], a[160:163], v[144:147]
    v_mfma_f32_16x16x32_bf16 v[160:163], a[64:67], a[160:163], v[160:163]
    ds_read_b64_tr_b16 a[80:81], v17 offset:49152
    s_waitcnt lgkmcnt(3)
    v_mfma_f32_16x16x32_bf16 v[160:163], a[68:71], a[164:167], v[160:163]
    ds_read_b64_tr_b16 a[82:83], v17 offset:49664
    v_mfma_f32_16x16x32_bf16 v[164:167], a[68:71], a[172:175], v[164:167]
    buffer_load_dwordx4 a[132:135], v1, s[8:11], s7 offen offset:1024 sc1
    v_mfma_f32_16x16x32_bf16 v[164:167], a[64:67], a[168:171], v[164:167]
    ds_read_b64_tr_b16 a[84:85], v17 offset:53248
    v_mfma_f32_16x16x32_bf16 v[168:171], a[64:67], a[176:179], v[168:171]
    ds_read_b64_tr_b16 a[86:87], v17 offset:53760
    v_mfma_f32_16x16x32_bf16 v[168:171], a[68:71], a[180:183], v[168:171]
    s_add_u32 s7, s0, 16384
    v_mfma_f32_16x16x32_bf16 v[172:175], a[68:71], a[188:191], v[172:175]
    v_mfma_f32_16x16x32_bf16 v[172:175], a[64:67], a[184:187], v[172:175]
    v_mfma_f32_16x16x32_bf16 v[188:191], a[72:75], a[184:187], v[188:191]
    buffer_load_dwordx4 a[136:139], v1, s[8:11], s7 offen offset:0 sc1
    s_waitcnt lgkmcnt(2)
    v_mfma_f32_16x16x32_bf16 v[188:191], a[76:79], a[188:191], v[188:191]
    ds_read_b64_tr_b16 a[88:89], v17 offset:57344
    v_mfma_f32_16x16x32_bf16 v[184:187], a[76:79], a[180:183], v[184:187]
    ds_read_b64_tr_b16 a[90:91], v17 offset:57856
    v_mfma_f32_16x16x32_bf16 v[184:187], a[72:75], a[176:179], v[184:187]
    ds_read_b64_tr_b16 a[92:93], v17 offset:61440
    v_mfma_f32_16x16x32_bf16 v[180:183], a[72:75], a[168:171], v[180:183]
    ds_read_b64_tr_b16 a[94:95], v17 offset:61952
    v_add_u32 v17, 131072, v17
    v_mfma_f32_16x16x32_bf16 v[180:183], a[76:79], a[172:175], v[180:183]
    v_mfma_f32_16x16x32_bf16 v[176:179], a[76:79], a[164:167], v[176:179]
    buffer_load_dwordx4 a[140:143], v1, s[8:11], s7 offen offset:1024 sc1
    v_mfma_f32_16x16x32_bf16 v[176:179], a[72:75], a[160:163], v[176:179]
    v_mfma_f32_16x16x32_bf16 v[192:195], a[80:83], a[160:163], v[192:195]
    ds_read_b64_tr_b16 a[64:65], v18 offset:49152
    s_waitcnt lgkmcnt(3)
    v_mfma_f32_16x16x32_bf16 v[192:195], a[84:87], a[164:167], v[192:195]
    s_add_u32 s7, s60, 2048
    ds_read_b64_tr_b16 a[66:67], v18 offset:49664
    v_mfma_f32_16x16x32_bf16 v[196:199], a[84:87], a[172:175], v[196:199]
    ds_read_b64_tr_b16 a[68:69], v18 offset:53248
    v_mfma_f32_16x16x32_bf16 v[196:199], a[80:83], a[168:171], v[196:199]
    ds_read_b64_tr_b16 a[70:71], v18 offset:53760
    v_mfma_f32_16x16x32_bf16 v[200:203], a[80:83], a[176:179], v[200:203]
    buffer_store_dwordx4 a[40:43], v1, s[8:11], s7 offen sc1
    v_mfma_f32_16x16x32_bf16 v[200:203], a[84:87], a[180:183], v[200:203]
    v_mfma_f32_16x16x32_bf16 v[204:207], a[84:87], a[188:191], v[204:207]
    v_mfma_f32_16x16x32_bf16 v[204:207], a[80:83], a[184:187], v[204:207]
    s_add_u32 s7, s0, 32768
    v_mfma_f32_16x16x32_bf16 v[220:223], a[88:91], a[184:187], v[220:223]
    ds_read_b64_tr_b16 a[72:73], v18 offset:57344
    s_waitcnt lgkmcnt(3)
    v_mfma_f32_16x16x32_bf16 v[220:223], a[92:95], a[188:191], v[220:223]
    ds_read_b64_tr_b16 a[74:75], v18 offset:57856
    v_mfma_f32_16x16x32_bf16 v[216:219], a[92:95], a[180:183], v[216:219]
    buffer_load_dwordx4 a[144:147], v1, s[8:11], s7 offen offset:0 sc1
    v_mfma_f32_16x16x32_bf16 v[216:219], a[88:91], a[176:179], v[216:219]
    ds_read_b64_tr_b16 a[76:77], v18 offset:61440
    v_mfma_f32_16x16x32_bf16 v[212:215], a[88:91], a[168:171], v[212:215]
    ds_read_b64_tr_b16 a[78:79], v18 offset:61952
    v_add_u32 v18, 131072, v18
    v_mfma_f32_16x16x32_bf16 v[212:215], a[92:95], a[172:175], v[212:215]
    v_mfma_f32_16x16x32_bf16 v[208:211], a[92:95], a[164:167], v[208:211]
    v_mfma_f32_16x16x32_bf16 v[208:211], a[88:91], a[160:163], v[208:211]
    v_mfma_f32_16x16x32_bf16 v[224:227], a[64:67], a[160:163], v[224:227]
    s_waitcnt lgkmcnt(2)
    v_mfma_f32_16x16x32_bf16 v[224:227], a[68:71], a[164:167], v[224:227]
    s_waitcnt vmcnt(16) lgkmcnt(0)
    s_barrier
    v_mfma_f32_16x16x32_bf16 v[228:231], a[68:71], a[172:175], v[228:231]
    buffer_store_dword v25, v22, s[8:11], s66 offen sc1
    v_mfma_f32_16x16x32_bf16 v[228:231], a[64:67], a[168:171], v[228:231]
    ds_read_b64_tr_b16 a[80:81], v2 offset:0
    v_mfma_f32_16x16x32_bf16 v[232:235], a[64:67], a[176:179], v[232:235]
    ds_read_b64_tr_b16 a[82:83], v2 offset:1024
    v_mfma_f32_16x16x32_bf16 v[232:235], a[68:71], a[180:183], v[232:235]
    ds_read_b64_tr_b16 a[84:85], v2 offset:8192
    v_mfma_f32_16x16x32_bf16 v[236:239], a[68:71], a[188:191], v[236:239]
    ds_read_b64_tr_b16 a[86:87], v2 offset:9216
    buffer_load_dwordx4 a[148:151], v1, s[8:11], s7 offen offset:1024 sc1
    v_mfma_f32_16x16x32_bf16 v[236:239], a[64:67], a[184:187], v[236:239]
    s_add_u32 s7, s0, 49152
    v_add_u32 v2, 4294836224, v2
    v_mfma_f32_16x16x32_bf16 v[252:255], a[72:75], a[184:187], v[252:255]
    buffer_load_dwordx4 a[152:155], v1, s[8:11], s7 offen offset:0 sc1
    v_mfma_f32_16x16x32_bf16 v[252:255], a[76:79], a[188:191], v[252:255]
    ds_read_b64_tr_b16 a[88:89], v3 offset:0
    v_mfma_f32_16x16x32_bf16 v[248:251], a[76:79], a[180:183], v[248:251]
    ds_read_b64_tr_b16 a[90:91], v3 offset:1024
    v_mfma_f32_16x16x32_bf16 v[248:251], a[72:75], a[176:179], v[248:251]
    buffer_load_dwordx4 a[156:159], v1, s[8:11], s7 offen offset:1024 sc1
    v_mfma_f32_16x16x32_bf16 v[244:247], a[72:75], a[168:171], v[244:247]
    ds_read_b64_tr_b16 a[92:93], v3 offset:8192
    v_mfma_f32_16x16x32_bf16 v[244:247], a[76:79], a[172:175], v[244:247]
    ds_read_b64_tr_b16 a[94:95], v3 offset:9216
    v_add_u32 v3, 4294836224, v3
    v_mfma_f32_16x16x32_bf16 v[240:243], a[76:79], a[164:167], v[240:243]
    v_mfma_f32_16x16x32_bf16 v[240:243], a[72:75], a[160:163], v[240:243]
    s_waitcnt lgkmcnt(3)
    v_mfma_f32_16x16x32_bf16 v[32:35], a[80:83], a[192:195], v[32:35]
    s_add_u32 s0, s62, 3670016
    s_xor_b32 m0, s90, 32768
    s_xor_b32 s7, s0, 0
    v_mfma_f32_16x16x32_bf16 v[32:35], a[84:87], a[196:199], v[32:35]
    buffer_load_dwordx4 v14, s[20:23], s7 offen lds
    v_mfma_f32_16x16x32_bf16 v[36:39], a[84:87], a[204:207], v[36:39]
    s_xor_b32 m0, s90, 33792
    ds_read_b64_tr_b16 a[64:65], v4 offset:0
    s_xor_b32 s7, s0, 32768
    v_mfma_f32_16x16x32_bf16 v[36:39], a[80:83], a[200:203], v[36:39]
    ds_read_b64_tr_b16 a[66:67], v4 offset:1024
    v_mfma_f32_16x16x32_bf16 v[40:43], a[80:83], a[208:211], v[40:43]
    ds_read_b64_tr_b16 a[68:69], v4 offset:8192
    v_mfma_f32_16x16x32_bf16 v[40:43], a[84:87], a[212:215], v[40:43]
    ds_read_b64_tr_b16 a[70:71], v4 offset:9216
    v_add_u32 v4, 4294836224, v4
    v_mfma_f32_16x16x32_bf16 v[44:47], a[84:87], a[220:223], v[44:47]
    buffer_load_dwordx4 v14, s[20:23], s7 offen lds
    v_mfma_f32_16x16x32_bf16 v[44:47], a[80:83], a[216:219], v[44:47]
    s_xor_b32 m0, s90, 34816
    s_xor_b32 s7, s0, 65536
    s_waitcnt lgkmcnt(3)
    v_mfma_f32_16x16x32_bf16 v[60:63], a[88:91], a[216:219], v[60:63]
    ds_read_b64_tr_b16 a[72:73], v5 offset:0
    v_mfma_f32_16x16x32_bf16 v[60:63], a[92:95], a[220:223], v[60:63]
    ds_read_b64_tr_b16 a[74:75], v5 offset:1024
    v_mfma_f32_16x16x32_bf16 v[56:59], a[92:95], a[212:215], v[56:59]
    ds_read_b64_tr_b16 a[76:77], v5 offset:8192
    v_mfma_f32_16x16x32_bf16 v[56:59], a[88:91], a[208:211], v[56:59]
    buffer_load_dwordx4 v15, s[20:23], s7 offen lds
    v_mfma_f32_16x16x32_bf16 v[52:55], a[88:91], a[200:203], v[52:55]
    s_xor_b32 m0, s90, 35840
    ds_read_b64_tr_b16 a[78:79], v5 offset:9216
    v_add_u32 v5, 4294836224, v5
    v_mfma_f32_16x16x32_bf16 v[52:55], a[92:95], a[204:207], v[52:55]
    s_xor_b32 s7, s0, 98304
    v_mfma_f32_16x16x32_bf16 v[48:51], a[92:95], a[196:199], v[48:51]
    v_mfma_f32_16x16x32_bf16 v[48:51], a[88:91], a[192:195], v[48:51]
    s_waitcnt lgkmcnt(2)
    v_mfma_f32_16x16x32_bf16 v[64:67], a[64:67], a[192:195], v[64:67]
    buffer_load_dwordx4 v15, s[20:23], s7 offen lds
    v_mfma_f32_16x16x32_bf16 v[64:67], a[68:71], a[196:199], v[64:67]
    s_add_u32 s0, s63, 1232896
    ds_read_b64_tr_b16 a[80:81], v6 offset:0
    s_add_u32 m0, s91, 32768
    v_mfma_f32_16x16x32_bf16 v[68:71], a[68:71], a[204:207], v[68:71]
    s_add_u32 s7, s0, 0
    ds_read_b64_tr_b16 a[82:83], v6 offset:1024
    v_mfma_f32_16x16x32_bf16 v[68:71], a[64:67], a[200:203], v[68:71]
    ds_read_b64_tr_b16 a[84:85], v6 offset:8192
    v_mfma_f32_16x16x32_bf16 v[72:75], a[64:67], a[208:211], v[72:75]
    ds_read_b64_tr_b16 a[86:87], v6 offset:9216
    v_add_u32 v6, 4294836224, v6
    v_mfma_f32_16x16x32_bf16 v[72:75], a[68:71], a[212:215], v[72:75]
    buffer_load_dwordx4 v19, s[24:27], s7 offen lds
    v_mfma_f32_16x16x32_bf16 v[76:79], a[68:71], a[220:223], v[76:79]
    s_add_u32 m0, s91, 33792
    s_add_u32 s7, s0, 22016
    v_mfma_f32_16x16x32_bf16 v[76:79], a[64:67], a[216:219], v[76:79]
    v_mfma_f32_16x16x32_bf16 v[92:95], a[72:75], a[216:219], v[92:95]
L_tp13:
    s_cbranch_execz L_tp17
    ds_read_b64_tr_b16 a[88:89], v7 offset:0
    s_waitcnt lgkmcnt(2)
    v_mfma_f32_16x16x32_bf16 v[92:95], a[76:79], a[220:223], v[92:95]
    ds_read_b64_tr_b16 a[90:91], v7 offset:1024
    v_mfma_f32_16x16x32_bf16 v[88:91], a[76:79], a[212:215], v[88:91]
    buffer_load_dwordx4 v20, s[24:27], s7 offen lds
    v_mfma_f32_16x16x32_bf16 v[88:91], a[72:75], a[208:211], v[88:91]
    s_add_u32 m0, s91, 40960
    ds_read_b64_tr_b16 a[92:93], v7 offset:8192
    s_add_u32 s7, s0, 0
    v_mfma_f32_16x16x32_bf16 v[84:87], a[72:75], a[200:203], v[84:87]
    ds_read_b64_tr_b16 a[94:95], v7 offset:9216
    v_add_u32 v7, 4294836224, v7
    v_mfma_f32_16x16x32_bf16 v[84:87], a[76:79], a[204:207], v[84:87]
    v_mfma_f32_16x16x32_bf16 v[80:83], a[76:79], a[196:199], v[80:83]
    v_mfma_f32_16x16x32_bf16 v[80:83], a[72:75], a[192:195], v[80:83]
    buffer_load_dwordx4 v19, s[28:31], s7 offen lds
    v_mfma_f32_16x16x32_bf16 v[96:99], a[80:83], a[192:195], v[96:99]
    s_add_u32 m0, s91, 41984
    s_add_u32 s7, s0, 22016
    s_waitcnt lgkmcnt(1)
    v_mfma_f32_16x16x32_bf16 v[96:99], a[84:87], a[196:199], v[96:99]
    ds_read_b64_tr_b16 a[64:65], v8 offset:0
    v_mfma_f32_16x16x32_bf16 v[100:103], a[84:87], a[204:207], v[100:103]
    ds_read_b64_tr_b16 a[66:67], v8 offset:1024
    v_mfma_f32_16x16x32_bf16 v[100:103], a[80:83], a[200:203], v[100:103]
    ds_read_b64_tr_b16 a[68:69], v8 offset:8192
    v_mfma_f32_16x16x32_bf16 v[104:107], a[80:83], a[208:211], v[104:107]
    buffer_load_dwordx4 v20, s[28:31], s7 offen lds
    v_mfma_f32_16x16x32_bf16 v[104:107], a[84:87], a[212:215], v[104:107]
    ds_read_b64_tr_b16 a[70:71], v8 offset:9216
    v_add_u32 v8, 4294836224, v8
    v_mfma_f32_16x16x32_bf16 v[108:111], a[84:87], a[220:223], v[108:111]
    v_mfma_f32_16x16x32_bf16 v[108:111], a[80:83], a[216:219], v[108:111]
    v_mfma_f32_16x16x32_bf16 v[124:127], a[88:91], a[216:219], v[124:127]
    ds_read_b64_tr_b16 a[72:73], v9 offset:0
    s_waitcnt lgkmcnt(3)
    v_mfma_f32_16x16x32_bf16 v[124:127], a[92:95], a[220:223], v[124:127]
    ds_read_b64_tr_b16 a[74:75], v9 offset:1024
    v_mfma_f32_16x16x32_bf16 v[120:123], a[92:95], a[212:215], v[120:123]
    ds_read_b64_tr_b16 a[76:77], v9 offset:8192
    v_mfma_f32_16x16x32_bf16 v[120:123], a[88:91], a[208:211], v[120:123]
    ds_read_b64_tr_b16 a[78:79], v9 offset:9216
    v_mfma_f32_16x16x32_bf16 v[116:119], a[88:91], a[200:203], v[116:119]
    v_add_u32 v9, 4294836224, v9
    v_mfma_f32_16x16x32_bf16 v[116:119], a[92:95], a[204:207], v[116:119]
    s_add_u32 s7, s60, 3072
    v_mfma_f32_16x16x32_bf16 v[112:115], a[92:95], a[196:199], v[112:115]
    buffer_store_dwordx4 a[44:47], v1, s[8:11], s7 offen sc1
    v_mfma_f32_16x16x32_bf16 v[112:115], a[88:91], a[192:195], v[112:115]
    v_mfma_f32_16x16x32_bf16 v[128:131], a[64:67], a[192:195], v[128:131]
    ds_read_b64_tr_b16 a[80:81], v16 offset:16384
    s_waitcnt lgkmcnt(2)
    v_mfma_f32_16x16x32_bf16 v[128:131], a[68:71], a[196:199], v[128:131]
    ds_read_b64_tr_b16 a[82:83], v16 offset:16896
    v_mfma_f32_16x16x32_bf16 v[132:135], a[68:71], a[204:207], v[132:135]
    ds_read_b64_tr_b16 a[84:85], v16 offset:20480
    v_mfma_f32_16x16x32_bf16 v[132:135], a[64:67], a[200:203], v[132:135]
    s_add_u32 s7, s95, 0
    ds_read_b64_tr_b16 a[86:87], v16 offset:20992
    v_mfma_f32_16x16x32_bf16 v[136:139], a[64:67], a[208:211], v[136:139]
    v_mfma_f32_16x16x32_bf16 v[136:139], a[68:71], a[212:215], v[136:139]
    v_mfma_f32_16x16x32_bf16 v[140:143], a[68:71], a[220:223], v[140:143]
    buffer_store_dwordx4 a[48:51], v1, s[8:11], s7 offen sc1
    v_mfma_f32_16x16x32_bf16 v[140:143], a[64:67], a[216:219], v[140:143]
    v_mfma_f32_16x16x32_bf16 v[156:159], a[72:75], a[216:219], v[156:159]
    ds_read_b64_tr_b16 a[88:89], v16 offset:24576
    s_waitcnt lgkmcnt(3)
    v_mfma_f32_16x16x32_bf16 v[156:159], a[76:79], a[220:223], v[156:159]
    ds_read_b64_tr_b16 a[90:91], v16 offset:25088
    v_mfma_f32_16x16x32_bf16 v[152:155], a[76:79], a[212:215], v[152:155]
    ds_read_b64_tr_b16 a[92:93], v16 offset:28672
    v_mfma_f32_16x16x32_bf16 v[152:155], a[72:75], a[208:211], v[152:155]
    ds_read_b64_tr_b16 a[94:95], v16 offset:29184
    v_mfma_f32_16x16x32_bf16 v[148:151], a[72:75], a[200:203], v[148:151]
    s_add_u32 s7, s95, 1024
    v_add_u32 v16, 4294836224, v16
    v_mfma_f32_16x16x32_bf16 v[148:151], a[76:79], a[204:207], v[148:151]
    v_mfma_f32_16x16x32_bf16 v[144:147], a[76:79], a[196:199], v[144:147]
    v_mfma_f32_16x16x32_bf16 v[144:147], a[72:75], a[192:195], v[144:147]
    buffer_store_dwordx4 a[52:55], v1, s[8:11], s7 offen sc1
    v_mfma_f32_16x16x32_bf16 v[160:163], a[80:83], a[192:195], v[160:163]
    ds_read_b64_tr_b16 a[64:65], v17 offset:16384
    s_waitcnt lgkmcnt(2)
    v_mfma_f32_16x16x32_bf16 v[160:163], a[84:87], a[196:199], v[160:163]
    ds_read_b64_tr_b16 a[66:67], v17 offset:16896
    v_mfma_f32_16x16x32_bf16 v[164:167], a[84:87], a[204:207], v[164:167]
    ds_read_b64_tr_b16 a[68:69], v17 offset:20480
    v_mfma_f32_16x16x32_bf16 v[164:167], a[80:83], a[200:203], v[164:167]
    ds_read_b64_tr_b16 a[70:71], v17 offset:20992
    v_mfma_f32_16x16x32_bf16 v[168:171], a[80:83], a[208:211], v[168:171]
    v_mfma_f32_16x16x32_bf16 v[168:171], a[84:87], a[212:215], v[168:171]
    s_add_u32 s7, s95, 2048
    v_mfma_f32_16x16x32_bf16 v[172:175], a[84:87], a[220:223], v[172:175]
    v_mfma_f32_16x16x32_bf16 v[172:175], a[80:83], a[216:219], v[172:175]
    v_mfma_f32_16x16x32_bf16 v[188:191], a[88:91], a[216:219], v[188:191]
    buffer_store_dwordx4 a[56:59], v1, s[8:11], s7 offen sc1
    s_waitcnt lgkmcnt(2)
    v_mfma_f32_16x16x32_bf16 v[188:191], a[92:95], a[220:223], v[188:191]
    ds_read_b64_tr_b16 a[72:73], v17 offset:24576
    v_mfma_f32_16x16x32_bf16 v[184:187], a[92:95], a[212:215], v[184:187]
    ds_read_b64_tr_b16 a[74:75], v17 offset:25088
    v_mfma_f32_16x16x32_bf16 v[184:187], a[88:91], a[208:211], v[184:187]
    ds_read_b64_tr_b16 a[76:77], v17 offset:28672
    v_mfma_f32_16x16x32_bf16 v[180:183], a[88:91], a[200:203], v[180:183]
    ds_read_b64_tr_b16 a[78:79], v17 offset:29184
    v_add_u32 v17, 4294836224, v17
    v_mfma_f32_16x16x32_bf16 v[180:183], a[92:95], a[204:207], v[180:183]
    v_mfma_f32_16x16x32_bf16 v[176:179], a[92:95], a[196:199], v[176:179]
    s_add_u32 s7, s95, 3072
    v_mfma_f32_16x16x32_bf16 v[176:179], a[88:91], a[192:195], v[176:179]
    v_mfma_f32_16x16x32_bf16 v[192:195], a[64:67], a[192:195], v[192:195]
    ds_read_b64_tr_b16 a[80:81], v18 offset:16384
    s_waitcnt lgkmcnt(3)
    v_mfma_f32_16x16x32_bf16 v[192:195], a[68:71], a[196:199], v[192:195]
    buffer_store_dwordx4 a[60:63], v1, s[8:11], s7 offen sc1
    v_mfma_f32_16x16x32_bf16 v[196:199], a[68:71], a[204:207], v[196:199]
    ds_read_b64_tr_b16 a[82:83], v18 offset:16896
    v_mfma_f32_16x16x32_bf16 v[196:199], a[64:67], a[200:203], v[196:199]
    ds_read_b64_tr_b16 a[84:85], v18 offset:20480
    v_mfma_f32_16x16x32_bf16 v[200:203], a[64:67], a[208:211], v[200:203]
    ds_read_b64_tr_b16 a[86:87], v18 offset:20992
    v_mfma_f32_16x16x32_bf16 v[200:203], a[68:71], a[212:215], v[200:203]
    v_mfma_f32_16x16x32_bf16 v[204:207], a[68:71], a[220:223], v[204:207]
    v_mfma_f32_16x16x32_bf16 v[204:207], a[64:67], a[216:219], v[204:207]
    v_mfma_f32_16x16x32_bf16 v[220:223], a[72:75], a[216:219], v[220:223]
    ds_read_b64_tr_b16 a[88:89], v18 offset:24576
    s_waitcnt lgkmcnt(4)
    v_mfma_f32_16x16x32_bf16 v[220:223], a[76:79], a[220:223], v[220:223]
    ds_read_b64_tr_b16 a[90:91], v18 offset:25088
    v_mfma_f32_16x16x32_bf16 v[216:219], a[76:79], a[212:215], v[216:219]
    ds_read_b64_tr_b16 a[92:93], v18 offset:28672
    v_mfma_f32_16x16x32_bf16 v[216:219], a[72:75], a[208:211], v[216:219]
    ds_read_b64_tr_b16 a[94:95], v18 offset:29184
    v_mfma_f32_16x16x32_bf16 v[212:215], a[72:75], a[200:203], v[212:215]
    v_add_u32 v18, 4294836224, v18
    v_mfma_f32_16x16x32_bf16 v[212:215], a[76:79], a[204:207], v[212:215]
    v_mfma_f32_16x16x32_bf16 v[208:211], a[76:79], a[196:199], v[208:211]
    v_mfma_f32_16x16x32_bf16 v[208:211], a[72:75], a[192:195], v[208:211]
    s_waitcnt lgkmcnt(3)
    v_mfma_f32_16x16x32_bf16 v[224:227], a[80:83], a[192:195], v[224:227]
    v_mfma_f32_16x16x32_bf16 v[224:227], a[84:87], a[196:199], v[224:227]
    s_waitcnt vmcnt(5) lgkmcnt(0)
    s_barrier
    v_mfma_f32_16x16x32_bf16 v[228:231], a[84:87], a[204:207], v[228:231]
    ds_read_b64_tr_b16 a[64:65], v17 offset:16384
    v_mfma_f32_16x16x32_bf16 v[228:231], a[80:83], a[200:203], v[228:231]
    s_and_b32 s94, s6, 1
    ds_read_b64_tr_b16 a[66:67], v17 offset:16896
    s_lshl_b32 s94, s94, 15
    v_mfma_f32_16x16x32_bf16 v[232:235], a[80:83], a[208:211], v[232:235]
    s_lshr_b32 s7, s94, 1
    ds_read_b64_tr_b16 a[68:69], v17 offset:20480
    s_add_u32 s7, s7, 131072
    v_mfma_f32_16x16x32_bf16 v[232:235], a[84:87], a[212:215], v[232:235]
    s_cmp_lt_u32 s6, 2
    ds_read_b64_tr_b16 a[70:71], v17 offset:20992
    s_cselect_b32 s94, s94, s7
    v_mfma_f32_16x16x32_bf16 v[236:239], a[84:87], a[220:223], v[236:239]
    ds_read_b64_tr_b16 a[72:73], v17 offset:49152
    v_add_u32 v26, s94, v1
    v_mfma_f32_16x16x32_bf16 v[236:239], a[80:83], a[216:219], v[236:239]
    ds_read_b64_tr_b16 a[74:75], v17 offset:49664
    v_lshrrev_b32 v23, 3, v23
    v_mfma_f32_16x16x32_bf16 v[252:255], a[88:91], a[216:219], v[252:255]
    s_and_b32 s93, s66, 0xffffff80
    ds_read_b64_tr_b16 a[76:77], v17 offset:53248
    s_lshl_b32 s57, s4, 20
    v_mfma_f32_16x16x32_bf16 v[252:255], a[92:95], a[220:223], v[252:255]
    s_lshl_b32 s59, s6, 14
    ds_read_b64_tr_b16 a[78:79], v17 offset:53760
    s_add_u32 s57, s57, s59
    v_mfma_f32_16x16x32_bf16 v[248:251], a[92:95], a[212:215], v[248:251]
    s_add_u32 s57, s57, 4194304
    s_add_u32 s59, s59, 65536
    s_lshl_b32 s58, s5, 16
    v_mfma_f32_16x16x32_bf16 v[248:251], a[88:91], a[208:211], v[248:251]
    s_sub_u32 s71, 983040, s58
    s_add_u32 s71, s71, s57
    s_add_u32 s58, s58, s57
    v_mfma_f32_16x16x32_bf16 v[244:247], a[88:91], a[200:203], v[244:247]
    s_cmp_eq_u32 s6, 3
    s_cselect_b32 s56, 2147483648, s71
    s_lshr_b32 s91, s6, 1
    v_mfma_f32_16x16x32_bf16 v[244:247], a[92:95], a[204:207], v[244:247]
    s_and_b32 s7, s6, 1
    s_lshl_b32 s7, s7, 12
    s_lshl_b32 s72, s91, 15
    v_mfma_f32_16x16x32_bf16 v[240:243], a[92:95], a[196:199], v[240:243]
    s_add_u32 s7, s7, s72
    v_add_u32 v27, s7, v1
    v_xor_b32 v28, 0x8000, v27
    v_mfma_f32_16x16x32_bf16 v[240:243], a[88:91], a[192:195], v[240:243]
    s_waitcnt lgkmcnt(0)
    v_mfma_f32_16x16x32_bf16 v[192:195], a[64:67], a[224:227], v[192:195]
    ds_read_b64_tr_b16 a[80:81], v17 offset:24576
    v_mfma_f32_16x16x32_bf16 v[192:195], a[68:71], a[228:231], v[192:195]
    ds_read_b64_tr_b16 a[82:83], v17 offset:25088
    v_lshrrev_b32 v10, 4, v1
    v_mfma_f32_16x16x32_bf16 v[192:195], a[72:75], a[128:131], v[192:195]
    ds_read_b64_tr_b16 a[84:85], v17 offset:28672
    v_and_b32 v11, 15, v10
    v_mfma_f32_16x16x32_bf16 v[192:195], a[76:79], a[132:135], v[192:195]
    ds_read_b64_tr_b16 a[86:87], v17 offset:29184
    v_lshrrev_b32 v10, 4, v10
    v_mfma_f32_16x16x32_bf16 v[196:199], a[76:79], a[140:143], v[196:199]
    ds_read_b64_tr_b16 a[88:89], v17 offset:57344
    v_lshlrev_b32 v10, 2, v10
    v_mfma_f32_16x16x32_bf16 v[196:199], a[72:75], a[136:139], v[196:199]
    s_add_u32 s7, s60, 4096
    ds_read_b64_tr_b16 a[90:91], v17 offset:57856
    v_sub_u32 v10, v11, v10
    v_mfma_f32_16x16x32_bf16 v[196:199], a[68:71], a[236:239], v[196:199]
    buffer_store_dwordx4 a[96:99], v1, s[8:11], s7 offen sc1
    v_mfma_f32_16x16x32_bf16 v[196:199], a[64:67], a[232:235], v[196:199]
    ds_read_b64_tr_b16 a[92:93], v17 offset:61440
    v_and_b32 v11, 1, v10
    v_mfma_f32_16x16x32_bf16 v[200:203], a[64:67], a[240:243], v[200:203]
    ds_read_b64_tr_b16 a[94:95], v17 offset:61952
    v_lshlrev_b32 v11, 4, v11
    v_mfma_f32_16x16x32_bf16 v[200:203], a[68:71], a[244:247], v[200:203]
    s_add_u32 m0, s59, 0
    s_add_u32 s0, s56, 0
    v_mov_b32 v12, 0x3f80
    v_mfma_f32_16x16x32_bf16 v[200:203], a[72:75], a[144:147], v[200:203]
    buffer_load_dwordx4 v1, s[8:11], s0 offen offset:0 sc1 lds
    v_mfma_f32_16x16x32_bf16 v[200:203], a[76:79], a[148:151], v[200:203]
    v_lshlrev_b32 v11, v11, v12
    v_lshrrev_b32 v12, 1, v10
    v_mfma_f32_16x16x32_bf16 v[204:207], a[76:79], a[156:159], v[204:207]
    v_cmp_eq_u32 vcc, 0, v12
    v_cmp_eq_u32 s[74:75], 1, v12
    v_mfma_f32_16x16x32_bf16 v[204:207], a[72:75], a[152:155], v[204:207]
    v_accvgpr_write_b32 a180, 0
    v_accvgpr_write_b32 a181, 0
    v_mfma_f32_16x16x32_bf16 v[204:207], a[68:71], a[252:255], v[204:207]
    v_cndmask_b32 v12, 0, v11, vcc
    v_cndmask_b32 v11, 0, v11, s[74:75]
    v_mfma_f32_16x16x32_bf16 v[204:207], a[64:67], a[248:251], v[204:207]
    s_waitcnt lgkmcnt(0)
    v_accvgpr_write_b32 a182, v12
    v_accvgpr_write_b32 a183, v11
    v_mfma_f32_16x16x32_bf16 v[220:223], a[80:83], a[248:251], v[220:223]
    ds_read_b64_tr_b16 a[64:65], v2 offset:0
    v_accvgpr_write_b32 a184, 0
    v_mfma_f32_16x16x32_bf16 v[220:223], a[84:87], a[252:255], v[220:223]
    ds_read_b64_tr_b16 a[66:67], v2 offset:1024
    v_accvgpr_write_b32 a185, 0
    v_mfma_f32_16x16x32_bf16 v[220:223], a[88:91], a[152:155], v[220:223]
    ds_read_b64_tr_b16 a[68:69], v2 offset:8192
    v_bfe_u32 v11, v0, 6, 1
    v_mfma_f32_16x16x32_bf16 v[220:223], a[92:95], a[156:159], v[220:223]
    ds_read_b64_tr_b16 a[70:71], v2 offset:9216
    v_lshl_add_u32 v10, v11, 4, v10
    v_mfma_f32_16x16x32_bf16 v[216:219], a[92:95], a[148:151], v[216:219]
    ds_read_b64_tr_b16 a[72:73], v2 offset:32768
    v_mov_b32 v11, 0x3f803f80
    v_mfma_f32_16x16x32_bf16 v[216:219], a[88:91], a[144:147], v[216:219]
    ds_read_b64_tr_b16 a[74:75], v2 offset:33792
    v_accvgpr_write_b32 a176, v11
    v_mfma_f32_16x16x32_bf16 v[216:219], a[84:87], a[244:247], v[216:219]
    s_add_u32 s7, s60, 5120
    ds_read_b64_tr_b16 a[76:77], v2 offset:40960
    v_accvgpr_write_b32 a177, v11
    v_mfma_f32_16x16x32_bf16 v[216:219], a[80:83], a[240:243], v[216:219]
    buffer_store_dwordx4 a[100:103], v1, s[8:11], s7 offen sc1
    v_mfma_f32_16x16x32_bf16 v[212:215], a[80:83], a[232:235], v[212:215]
    ds_read_b64_tr_b16 a[78:79], v2 offset:41984
    v_accvgpr_write_b32 a178, v11
    v_mfma_f32_16x16x32_bf16 v[212:215], a[84:87], a[236:239], v[212:215]
    v_accvgpr_write_b32 a179, v11
    v_mov_b32 v11, 0xff800000
    v_mfma_f32_16x16x32_bf16 v[212:215], a[88:91], a[136:139], v[212:215]
    v_mfma_f32_16x16x32_bf16 v[212:215], a[92:95], a[140:143], v[212:215]
    v_mfma_f32_16x16x32_bf16 v[208:211], a[92:95], a[132:135], v[208:211]
    v_mfma_f32_16x16x32_bf16 v[208:211], a[88:91], a[128:131], v[208:211]
    buffer_load_dwordx4 v1, s[8:11], s0 offen offset:1024 sc1 lds
    v_mfma_f32_16x16x32_bf16 v[208:211], a[84:87], a[228:231], v[208:211]
    v_mfma_f32_16x16x32_bf16 v[208:211], a[80:83], a[224:227], v[208:211]
    s_waitcnt lgkmcnt(0)
    v_mfma_f32_16x16x32_bf16 v[32:35], a[64:67], a[224:227], v[32:35]
    ds_read_b64_tr_b16 a[80:81], v3 offset:0
    v_mfma_f32_16x16x32_bf16 v[32:35], a[68:71], a[228:231], v[32:35]
    ds_read_b64_tr_b16 a[82:83], v3 offset:1024
    v_mfma_f32_16x16x32_bf16 v[32:35], a[72:75], a[128:131], v[32:35]
    ds_read_b64_tr_b16 a[84:85], v3 offset:8192
    v_mfma_f32_16x16x32_bf16 v[32:35], a[76:79], a[132:135], v[32:35]
    ds_read_b64_tr_b16 a[86:87], v3 offset:9216
    v_mfma_f32_16x16x32_bf16 v[36:39], a[76:79], a[140:143], v[36:39]
    ds_read_b64_tr_b16 a[88:89], v3 offset:32768
    v_mul_f32 v192, s98, v192
    v_mfma_f32_16x16x32_bf16 v[36:39], a[72:75], a[136:139], v[36:39]
    ds_read_b64_tr_b16 a[90:91], v3 offset:33792
    v_mul_f32 v193, s98, v193
    v_mfma_f32_16x16x32_bf16 v[36:39], a[68:71], a[236:239], v[36:39]
    ds_read_b64_tr_b16 a[92:93], v3 offset:40960
    v_mul_f32 v194, s98, v194
    v_mfma_f32_16x16x32_bf16 v[36:39], a[64:67], a[232:235], v[36:39]
    s_add_u32 s7, s60, 6144
    ds_read_b64_tr_b16 a[94:95], v3 offset:41984
    v_mul_f32 v195, s98, v195
    v_mfma_f32_16x16x32_bf16 v[40:43], a[64:67], a[240:243], v[40:43]
    buffer_store_dwordx4 a[104:107], v1, s[8:11], s7 offen sc1
    v_mfma_f32_16x16x32_bf16 v[40:43], a[68:71], a[244:247], v[40:43]
    v_exp_f32 v192, v192
    v_mfma_f32_16x16x32_bf16 v[40:43], a[72:75], a[144:147], v[40:43]
    v_exp_f32 v193, v193
    v_mfma_f32_16x16x32_bf16 v[40:43], a[76:79], a[148:151], v[40:43]
    v_exp_f32 v194, v194
    v_mfma_f32_16x16x32_bf16 v[44:47], a[76:79], a[156:159], v[44:47]
    v_exp_f32 v195, v195
    v_mfma_f32_16x16x32_bf16 v[44:47], a[72:75], a[152:155], v[44:47]
    v_fma_f32 v192, v192, s96, s96
    v_fma_f32 v193, v193, s96, s96
    v_mfma_f32_16x16x32_bf16 v[44:47], a[68:71], a[252:255], v[44:47]
    v_fma_f32 v194, v194, s96, s96
    v_fma_f32 v195, v195, s96, s96
    v_mfma_f32_16x16x32_bf16 v[44:47], a[64:67], a[248:251], v[44:47]
    s_waitcnt lgkmcnt(0)
    v_rcp_f32 v192, v192
    v_mfma_f32_16x16x32_bf16 v[60:63], a[80:83], a[248:251], v[60:63]
    buffer_load_dwordx4 v1, s[8:11], s0 offen offset:2048 sc1 lds
    v_mfma_f32_16x16x32_bf16 v[60:63], a[84:87], a[252:255], v[60:63]
    ds_read_b64_tr_b16 a[64:65], v4 offset:0
    v_mfma_f32_16x16x32_bf16 v[60:63], a[88:91], a[152:155], v[60:63]
    ds_read_b64_tr_b16 a[66:67], v4 offset:1024
    v_mfma_f32_16x16x32_bf16 v[60:63], a[92:95], a[156:159], v[60:63]
    ds_read_b64_tr_b16 a[68:69], v4 offset:8192
    v_mfma_f32_16x16x32_bf16 v[56:59], a[92:95], a[148:151], v[56:59]
    ds_read_b64_tr_b16 a[70:71], v4 offset:9216
    v_mfma_f32_16x16x32_bf16 v[56:59], a[88:91], a[144:147], v[56:59]
    ds_read_b64_tr_b16 a[72:73], v4 offset:32768
    v_mfma_f32_16x16x32_bf16 v[56:59], a[84:87], a[244:247], v[56:59]
    ds_read_b64_tr_b16 a[74:75], v4 offset:33792
    v_mfma_f32_16x16x32_bf16 v[56:59], a[80:83], a[240:243], v[56:59]
    ds_read_b64_tr_b16 a[76:77], v4 offset:40960
    v_mfma_f32_16x16x32_bf16 v[52:55], a[80:83], a[232:235], v[52:55]
    ds_read_b64_tr_b16 a[78:79], v4 offset:41984
    v_mfma_f32_16x16x32_bf16 v[52:55], a[84:87], a[236:239], v[52:55]
    s_add_u32 s7, s60, 7168
    v_rcp_f32 v193, v193
    v_mfma_f32_16x16x32_bf16 v[52:55], a[88:91], a[136:139], v[52:55]
    buffer_store_dwordx4 a[108:111], v1, s[8:11], s7 offen sc1
    v_mfma_f32_16x16x32_bf16 v[52:55], a[92:95], a[140:143], v[52:55]
    v_rcp_f32 v194, v194
    v_mfma_f32_16x16x32_bf16 v[48:51], a[92:95], a[132:135], v[48:51]
    v_rcp_f32 v195, v195
    v_mfma_f32_16x16x32_bf16 v[48:51], a[88:91], a[128:131], v[48:51]
    v_mul_f32 v192, v192, v208
    v_mul_f32 v193, v193, v209
    v_mfma_f32_16x16x32_bf16 v[48:51], a[84:87], a[228:231], v[48:51]
    v_mul_f32 v194, v194, v210
    v_mul_f32 v195, v195, v211
    v_mfma_f32_16x16x32_bf16 v[48:51], a[80:83], a[224:227], v[48:51]
    s_waitcnt lgkmcnt(0)
    v_cvt_pk_bf16_f32 v192, v192, v193
    v_cvt_pk_bf16_f32 v193, v194, v195
    v_mfma_f32_16x16x32_bf16 v[64:67], a[64:67], a[224:227], v[64:67]
    ds_read_b64_tr_b16 a[80:81], v5 offset:0
    v_mul_f32 v196, s98, v196
    v_mfma_f32_16x16x32_bf16 v[64:67], a[68:71], a[228:231], v[64:67]
    ds_read_b64_tr_b16 a[82:83], v5 offset:1024
    v_mul_f32 v197, s98, v197
    v_mfma_f32_16x16x32_bf16 v[64:67], a[72:75], a[128:131], v[64:67]
    ds_read_b64_tr_b16 a[84:85], v5 offset:8192
    v_mul_f32 v198, s98, v198
    v_mfma_f32_16x16x32_bf16 v[64:67], a[76:79], a[132:135], v[64:67]
    buffer_load_dwordx4 v1, s[8:11], s0 offen offset:3072 sc1 lds
    v_mfma_f32_16x16x32_bf16 v[68:71], a[76:79], a[140:143], v[68:71]
    ds_read_b64_tr_b16 a[86:87], v5 offset:9216
    v_mul_f32 v199, s98, v199
    v_mfma_f32_16x16x32_bf16 v[68:71], a[72:75], a[136:139], v[68:71]
    ds_read_b64_tr_b16 a[88:89], v5 offset:32768
    v_mfma_f32_16x16x32_bf16 v[68:71], a[68:71], a[236:239], v[68:71]
    ds_read_b64_tr_b16 a[90:91], v5 offset:33792
    v_mfma_f32_16x16x32_bf16 v[68:71], a[64:67], a[232:235], v[68:71]
    ds_read_b64_tr_b16 a[92:93], v5 offset:40960
    v_mfma_f32_16x16x32_bf16 v[72:75], a[64:67], a[240:243], v[72:75]
    ds_read_b64_tr_b16 a[94:95], v5 offset:41984
    v_mfma_f32_16x16x32_bf16 v[72:75], a[68:71], a[244:247], v[72:75]
    v_exp_f32 v196, v196
    v_mfma_f32_16x16x32_bf16 v[72:75], a[72:75], a[144:147], v[72:75]
    s_add_u32 s7, s95, 4096
    v_exp_f32 v197, v197
    v_mfma_f32_16x16x32_bf16 v[72:75], a[76:79], a[148:151], v[72:75]
    buffer_store_dwordx4 a[112:115], v1, s[8:11], s7 offen sc1
    v_mfma_f32_16x16x32_bf16 v[76:79], a[76:79], a[156:159], v[76:79]
    v_exp_f32 v198, v198
    v_mfma_f32_16x16x32_bf16 v[76:79], a[72:75], a[152:155], v[76:79]
    v_exp_f32 v199, v199
    v_mfma_f32_16x16x32_bf16 v[76:79], a[68:71], a[252:255], v[76:79]
    v_fma_f32 v196, v196, s96, s96
    v_fma_f32 v197, v197, s96, s96
    v_mfma_f32_16x16x32_bf16 v[76:79], a[64:67], a[248:251], v[76:79]
    s_waitcnt lgkmcnt(0)
    v_fma_f32 v198, v198, s96, s96
    v_fma_f32 v199, v199, s96, s96
    v_mfma_f32_16x16x32_bf16 v[92:95], a[80:83], a[248:251], v[92:95]
    ds_read_b64_tr_b16 a[64:65], v6 offset:0
    v_mfma_f32_16x16x32_bf16 v[92:95], a[84:87], a[252:255], v[92:95]
    ds_read_b64_tr_b16 a[66:67], v6 offset:1024
    v_mfma_f32_16x16x32_bf16 v[92:95], a[88:91], a[152:155], v[92:95]
    ds_read_b64_tr_b16 a[68:69], v6 offset:8192
    v_mfma_f32_16x16x32_bf16 v[92:95], a[92:95], a[156:159], v[92:95]
    ds_read_b64_tr_b16 a[70:71], v6 offset:9216
    v_mfma_f32_16x16x32_bf16 v[88:91], a[92:95], a[148:151], v[88:91]
    ds_read_b64_tr_b16 a[72:73], v6 offset:32768
    v_mfma_f32_16x16x32_bf16 v[88:91], a[88:91], a[144:147], v[88:91]
    s_add_u32 m0, s59, 4096
    s_add_u32 s0, s56, 4096
    v_mfma_f32_16x16x32_bf16 v[88:91], a[84:87], a[244:247], v[88:91]
    buffer_load_dwordx4 v1, s[8:11], s0 offen offset:0 sc1 lds
    v_mfma_f32_16x16x32_bf16 v[88:91], a[80:83], a[240:243], v[88:91]
    ds_read_b64_tr_b16 a[74:75], v6 offset:33792
    v_mfma_f32_16x16x32_bf16 v[84:87], a[80:83], a[232:235], v[84:87]
    ds_read_b64_tr_b16 a[76:77], v6 offset:40960
    v_mfma_f32_16x16x32_bf16 v[84:87], a[84:87], a[236:239], v[84:87]
    ds_read_b64_tr_b16 a[78:79], v6 offset:41984
    v_mfma_f32_16x16x32_bf16 v[84:87], a[88:91], a[136:139], v[84:87]
    v_rcp_f32 v196, v196
    v_mfma_f32_16x16x32_bf16 v[84:87], a[92:95], a[140:143], v[84:87]
    s_add_u32 s7, s95, 5120
    v_rcp_f32 v197, v197
    v_mfma_f32_16x16x32_bf16 v[80:83], a[92:95], a[132:135], v[80:83]
    buffer_store_dwordx4 a[116:119], v1, s[8:11], s7 offen sc1
    v_mfma_f32_16x16x32_bf16 v[80:83], a[88:91], a[128:131], v[80:83]
    v_rcp_f32 v198, v198
    v_mfma_f32_16x16x32_bf16 v[80:83], a[84:87], a[228:231], v[80:83]
    v_rcp_f32 v199, v199
    v_mfma_f32_16x16x32_bf16 v[80:83], a[80:83], a[224:227], v[80:83]
    s_waitcnt lgkmcnt(0)
    v_mul_f32 v196, v196, v212
    v_mul_f32 v197, v197, v213
    v_mfma_f32_16x16x32_bf16 v[96:99], a[64:67], a[224:227], v[96:99]
    ds_read_b64_tr_b16 a[80:81], v7 offset:0
    v_mul_f32 v198, v198, v214
    v_mfma_f32_16x16x32_bf16 v[96:99], a[68:71], a[228:231], v[96:99]
    ds_read_b64_tr_b16 a[82:83], v7 offset:1024
    v_mul_f32 v199, v199, v215
    v_mfma_f32_16x16x32_bf16 v[96:99], a[72:75], a[128:131], v[96:99]
    ds_read_b64_tr_b16 a[84:85], v7 offset:8192
    v_cvt_pk_bf16_f32 v194, v196, v197
    v_mfma_f32_16x16x32_bf16 v[96:99], a[76:79], a[132:135], v[96:99]
    ds_read_b64_tr_b16 a[86:87], v7 offset:9216
    v_cvt_pk_bf16_f32 v195, v198, v199
    v_mfma_f32_16x16x32_bf16 v[100:103], a[76:79], a[140:143], v[100:103]
    ds_read_b64_tr_b16 a[88:89], v7 offset:32768
    v_mul_f32 v200, s98, v200
    v_mfma_f32_16x16x32_bf16 v[100:103], a[72:75], a[136:139], v[100:103]
    ds_read_b64_tr_b16 a[90:91], v7 offset:33792
    v_mul_f32 v201, s98, v201
    v_mfma_f32_16x16x32_bf16 v[100:103], a[68:71], a[236:239], v[100:103]
    ds_read_b64_tr_b16 a[92:93], v7 offset:40960
    v_mul_f32 v202, s98, v202
    v_mfma_f32_16x16x32_bf16 v[100:103], a[64:67], a[232:235], v[100:103]
    ds_read_b64_tr_b16 a[94:95], v7 offset:41984
    v_mul_f32 v203, s98, v203
    v_mfma_f32_16x16x32_bf16 v[104:107], a[64:67], a[240:243], v[104:107]
    v_exp_f32 v200, v200
    v_mfma_f32_16x16x32_bf16 v[104:107], a[68:71], a[244:247], v[104:107]
    v_exp_f32 v201, v201
    v_mfma_f32_16x16x32_bf16 v[104:107], a[72:75], a[144:147], v[104:107]
    buffer_load_dwordx4 v1, s[8:11], s0 offen offset:1024 sc1 lds
    v_mfma_f32_16x16x32_bf16 v[104:107], a[76:79], a[148:151], v[104:107]
    v_exp_f32 v202, v202
    v_mfma_f32_16x16x32_bf16 v[108:111], a[76:79], a[156:159], v[108:111]
    v_exp_f32 v203, v203
    v_mfma_f32_16x16x32_bf16 v[108:111], a[72:75], a[152:155], v[108:111]
    s_add_u32 s7, s95, 6144
    v_fma_f32 v200, v200, s96, s96
    v_fma_f32 v201, v201, s96, s96
    v_mfma_f32_16x16x32_bf16 v[108:111], a[68:71], a[252:255], v[108:111]
    buffer_store_dwordx4 a[120:123], v1, s[8:11], s7 offen sc1
    v_mfma_f32_16x16x32_bf16 v[108:111], a[64:67], a[248:251], v[108:111]
    s_waitcnt lgkmcnt(0)
    v_fma_f32 v202, v202, s96, s96
    v_fma_f32 v203, v203, s96, s96
    v_mfma_f32_16x16x32_bf16 v[124:127], a[80:83], a[248:251], v[124:127]
    ds_read_b64_tr_b16 a[64:65], v8 offset:0
    v_mfma_f32_16x16x32_bf16 v[124:127], a[84:87], a[252:255], v[124:127]
    ds_read_b64_tr_b16 a[66:67], v8 offset:1024
    v_mfma_f32_16x16x32_bf16 v[124:127], a[88:91], a[152:155], v[124:127]
    ds_read_b64_tr_b16 a[68:69], v8 offset:8192
    v_mfma_f32_16x16x32_bf16 v[124:127], a[92:95], a[156:159], v[124:127]
    ds_read_b64_tr_b16 a[70:71], v8 offset:9216
    v_mfma_f32_16x16x32_bf16 v[120:123], a[92:95], a[148:151], v[120:123]
    ds_read_b64_tr_b16 a[72:73], v8 offset:32768
    v_mfma_f32_16x16x32_bf16 v[120:123], a[88:91], a[144:147], v[120:123]
    ds_read_b64_tr_b16 a[74:75], v8 offset:33792
    v_mfma_f32_16x16x32_bf16 v[120:123], a[84:87], a[244:247], v[120:123]
    ds_read_b64_tr_b16 a[76:77], v8 offset:40960
    v_mfma_f32_16x16x32_bf16 v[120:123], a[80:83], a[240:243], v[120:123]
    ds_read_b64_tr_b16 a[78:79], v8 offset:41984
    v_mfma_f32_16x16x32_bf16 v[116:119], a[80:83], a[232:235], v[116:119]
    buffer_load_dword v24, v23, s[8:11], s93 offen sc1
    v_mfma_f32_16x16x32_bf16 v[116:119], a[84:87], a[236:239], v[116:119]
    v_rcp_f32 v200, v200
    v_mfma_f32_16x16x32_bf16 v[116:119], a[88:91], a[136:139], v[116:119]
    v_rcp_f32 v201, v201
    v_mfma_f32_16x16x32_bf16 v[116:119], a[92:95], a[140:143], v[116:119]
    v_rcp_f32 v202, v202
    v_mfma_f32_16x16x32_bf16 v[112:115], a[92:95], a[132:135], v[112:115]
    v_rcp_f32 v203, v203
    v_mfma_f32_16x16x32_bf16 v[112:115], a[88:91], a[128:131], v[112:115]
    buffer_load_dwordx4 v1, s[8:11], s0 offen offset:2048 sc1 lds
    v_mfma_f32_16x16x32_bf16 v[112:115], a[84:87], a[228:231], v[112:115]
    v_mul_f32 v200, v200, v216
    v_mul_f32 v201, v201, v217
    v_mfma_f32_16x16x32_bf16 v[112:115], a[80:83], a[224:227], v[112:115]
    s_add_u32 s7, s95, 7168
    s_waitcnt lgkmcnt(0)
    v_mul_f32 v202, v202, v218
    v_mul_f32 v203, v203, v219
    v_mfma_f32_16x16x32_bf16 v[128:131], a[64:67], a[224:227], v[128:131]
    buffer_store_dwordx4 a[124:127], v1, s[8:11], s7 offen sc1
    v_mfma_f32_16x16x32_bf16 v[128:131], a[68:71], a[228:231], v[128:131]
    ds_read_b64_tr_b16 a[80:81], v9 offset:0
    v_cvt_pk_bf16_f32 v196, v200, v201
    v_mfma_f32_16x16x32_bf16 v[128:131], a[72:75], a[128:131], v[128:131]
    ds_read_b64_tr_b16 a[82:83], v9 offset:1024
    v_cvt_pk_bf16_f32 v197, v202, v203
    v_mfma_f32_16x16x32_bf16 v[128:131], a[76:79], a[132:135], v[128:131]
    ds_read_b64_tr_b16 a[84:85], v9 offset:8192
    v_mul_f32 v204, s98, v204
    v_mfma_f32_16x16x32_bf16 v[132:135], a[76:79], a[140:143], v[132:135]
    ds_read_b64_tr_b16 a[86:87], v9 offset:9216
    v_mul_f32 v205, s98, v205
    v_mfma_f32_16x16x32_bf16 v[132:135], a[72:75], a[136:139], v[132:135]
    ds_read_b64_tr_b16 a[88:89], v9 offset:32768
    v_mul_f32 v206, s98, v206
    v_mfma_f32_16x16x32_bf16 v[132:135], a[68:71], a[236:239], v[132:135]
    ds_read_b64_tr_b16 a[90:91], v9 offset:33792
    v_mul_f32 v207, s98, v207
    v_mfma_f32_16x16x32_bf16 v[132:135], a[64:67], a[232:235], v[132:135]
    ds_read_b64_tr_b16 a[92:93], v9 offset:40960
    v_mfma_f32_16x16x32_bf16 v[136:139], a[64:67], a[240:243], v[136:139]
    ds_read_b64_tr_b16 a[94:95], v9 offset:41984
    v_mfma_f32_16x16x32_bf16 v[136:139], a[68:71], a[244:247], v[136:139]
    v_exp_f32 v204, v204
    v_mfma_f32_16x16x32_bf16 v[136:139], a[72:75], a[144:147], v[136:139]
    v_exp_f32 v205, v205
    v_mfma_f32_16x16x32_bf16 v[136:139], a[76:79], a[148:151], v[136:139]
    v_exp_f32 v206, v206
    v_mfma_f32_16x16x32_bf16 v[140:143], a[76:79], a[156:159], v[140:143]
    v_exp_f32 v207, v207
    v_mfma_f32_16x16x32_bf16 v[140:143], a[72:75], a[152:155], v[140:143]
    v_fma_f32 v204, v204, s96, s96
    v_fma_f32 v205, v205, s96, s96
    v_mfma_f32_16x16x32_bf16 v[140:143], a[68:71], a[252:255], v[140:143]
    v_fma_f32 v206, v206, s96, s96
    v_fma_f32 v207, v207, s96, s96
    v_mfma_f32_16x16x32_bf16 v[140:143], a[64:67], a[248:251], v[140:143]
    s_waitcnt lgkmcnt(0)
    v_rcp_f32 v204, v204
    v_mfma_f32_16x16x32_bf16 v[156:159], a[80:83], a[248:251], v[156:159]
    s_waitcnt lgkmcnt(0)
    s_barrier
    v_mfma_f32_16x16x32_bf16 v[156:159], a[84:87], a[252:255], v[156:159]
    buffer_load_dwordx4 v1, s[8:11], s0 offen offset:3072 sc1 lds
    v_mfma_f32_16x16x32_bf16 v[156:159], a[88:91], a[152:155], v[156:159]
    ds_read_b64_tr_b16 a[64:65], v16 offset:16384
    v_mfma_f32_16x16x32_bf16 v[156:159], a[92:95], a[156:159], v[156:159]
    ds_read_b64_tr_b16 a[66:67], v16 offset:16896
    v_mfma_f32_16x16x32_bf16 v[152:155], a[92:95], a[148:151], v[152:155]
    ds_read_b64_tr_b16 a[68:69], v16 offset:20480
    ds_read_b64_tr_b16 a[70:71], v16 offset:20992
    v_mfma_f32_16x16x32_bf16 v[152:155], a[88:91], a[144:147], v[152:155]
    ds_read_b64_tr_b16 a[72:73], v16 offset:49152
    v_mfma_f32_16x16x32_bf16 v[152:155], a[84:87], a[244:247], v[152:155]
L_tp14:
    s_cbranch_execz L_tp18
    ds_read_b64_tr_b16 a[74:75], v16 offset:49664
    v_mfma_f32_16x16x32_bf16 v[152:155], a[80:83], a[240:243], v[152:155]
    ds_read_b64_tr_b16 a[76:77], v16 offset:53248
    v_mfma_f32_16x16x32_bf16 v[148:151], a[80:83], a[232:235], v[148:151]
    ds_read_b64_tr_b16 a[78:79], v16 offset:53760
    v_rcp_f32 v205, v205
    v_rcp_f32 v206, v206
    v_rcp_f32 v207, v207
    v_mul_f32 v204, v204, v220
    v_mul_f32 v205, v205, v221
    v_mul_f32 v206, v206, v222
    v_mul_f32 v207, v207, v223
    v_cvt_pk_bf16_f32 v198, v204, v205
    v_cvt_pk_bf16_f32 v199, v206, v207
    v_cvt_pk_bf16_f32 v32, v32, v33
    v_cvt_pk_bf16_f32 v33, v34, v35
    v_cvt_pk_bf16_f32 v34, v48, v49
    v_cvt_pk_bf16_f32 v35, v50, v51
    v_mfma_f32_16x16x32_bf16 v[148:151], a[84:87], a[236:239], v[148:151]
    ds_write_b128 v26, v[32:35] offset:0
    v_mfma_f32_16x16x32_bf16 v[148:151], a[88:91], a[136:139], v[148:151]
    v_cvt_pk_bf16_f32 v36, v36, v37
    v_cvt_pk_bf16_f32 v37, v38, v39
    v_mfma_f32_16x16x32_bf16 v[148:151], a[92:95], a[140:143], v[148:151]
    v_cvt_pk_bf16_f32 v38, v52, v53
    v_cvt_pk_bf16_f32 v39, v54, v55
    v_mfma_f32_16x16x32_bf16 v[144:147], a[92:95], a[132:135], v[144:147]
    ds_write_b128 v26, v[36:39] offset:4096
    v_mfma_f32_16x16x32_bf16 v[144:147], a[88:91], a[128:131], v[144:147]
    v_cvt_pk_bf16_f32 v40, v40, v41
    v_cvt_pk_bf16_f32 v41, v42, v43
    v_mfma_f32_16x16x32_bf16 v[144:147], a[84:87], a[228:231], v[144:147]
    v_cvt_pk_bf16_f32 v42, v56, v57
    v_cvt_pk_bf16_f32 v43, v58, v59
    v_mfma_f32_16x16x32_bf16 v[144:147], a[80:83], a[224:227], v[144:147]
    ds_write_b128 v26, v[40:43] offset:8192
    s_waitcnt lgkmcnt(2)
    v_mfma_f32_16x16x32_bf16 v[160:163], a[64:67], a[224:227], v[160:163]
    ds_read_b64_tr_b16 a[80:81], v16 offset:24576
    v_cvt_pk_bf16_f32 v44, v44, v45
    v_mfma_f32_16x16x32_bf16 v[160:163], a[68:71], a[228:231], v[160:163]
    ds_read_b64_tr_b16 a[82:83], v16 offset:25088
    v_cvt_pk_bf16_f32 v45, v46, v47
    v_mfma_f32_16x16x32_bf16 v[160:163], a[72:75], a[128:131], v[160:163]
    s_add_u32 m0, s59, 8192
    ds_read_b64_tr_b16 a[84:85], v16 offset:28672
    s_add_u32 s0, s56, 8192
    v_mfma_f32_16x16x32_bf16 v[160:163], a[76:79], a[132:135], v[160:163]
    ds_read_b64_tr_b16 a[86:87], v16 offset:29184
    v_cvt_pk_bf16_f32 v46, v60, v61
    v_mfma_f32_16x16x32_bf16 v[164:167], a[76:79], a[140:143], v[164:167]
    buffer_load_dwordx4 v1, s[8:11], s0 offen offset:0 sc1 lds
    v_mfma_f32_16x16x32_bf16 v[164:167], a[72:75], a[136:139], v[164:167]
    ds_read_b64_tr_b16 a[88:89], v16 offset:57344
    v_cvt_pk_bf16_f32 v47, v62, v63
    v_mfma_f32_16x16x32_bf16 v[164:167], a[68:71], a[236:239], v[164:167]
    ds_read_b64_tr_b16 a[90:91], v16 offset:57856
    v_cvt_pk_bf16_f32 v64, v64, v65
    v_mfma_f32_16x16x32_bf16 v[164:167], a[64:67], a[232:235], v[164:167]
    ds_read_b64_tr_b16 a[92:93], v16 offset:61440
    v_cvt_pk_bf16_f32 v65, v66, v67
    v_mfma_f32_16x16x32_bf16 v[168:171], a[64:67], a[240:243], v[168:171]
    ds_read_b64_tr_b16 a[94:95], v16 offset:61952
    v_cvt_pk_bf16_f32 v66, v80, v81
    v_mfma_f32_16x16x32_bf16 v[168:171], a[68:71], a[244:247], v[168:171]
    ds_write_b128 v26, v[44:47] offset:12288
    v_mfma_f32_16x16x32_bf16 v[168:171], a[72:75], a[144:147], v[168:171]
    v_cvt_pk_bf16_f32 v67, v82, v83
    v_cvt_pk_bf16_f32 v68, v68, v69
    v_mfma_f32_16x16x32_bf16 v[168:171], a[76:79], a[148:151], v[168:171]
    v_cvt_pk_bf16_f32 v69, v70, v71
    v_cvt_pk_bf16_f32 v70, v84, v85
    v_mfma_f32_16x16x32_bf16 v[172:175], a[76:79], a[156:159], v[172:175]
    ds_write_b128 v26, v[64:67] offset:1024
    v_mfma_f32_16x16x32_bf16 v[172:175], a[72:75], a[152:155], v[172:175]
    v_cvt_pk_bf16_f32 v71, v86, v87
    v_cvt_pk_bf16_f32 v72, v72, v73
    v_mfma_f32_16x16x32_bf16 v[172:175], a[68:71], a[252:255], v[172:175]
    v_cvt_pk_bf16_f32 v73, v74, v75
    v_cvt_pk_bf16_f32 v74, v88, v89
    v_mfma_f32_16x16x32_bf16 v[172:175], a[64:67], a[248:251], v[172:175]
    ds_write_b128 v26, v[68:71] offset:5120
    s_waitcnt lgkmcnt(2)
    v_mfma_f32_16x16x32_bf16 v[188:191], a[80:83], a[248:251], v[188:191]
    ds_read_b64_tr_b16 a[64:65], v18 offset:16384
    v_cvt_pk_bf16_f32 v75, v90, v91
    v_mfma_f32_16x16x32_bf16 v[188:191], a[84:87], a[252:255], v[188:191]
    ds_read_b64_tr_b16 a[66:67], v18 offset:16896
    v_cvt_pk_bf16_f32 v76, v76, v77
    v_mfma_f32_16x16x32_bf16 v[188:191], a[88:91], a[152:155], v[188:191]
    ds_read_b64_tr_b16 a[68:69], v18 offset:20480
    v_cvt_pk_bf16_f32 v77, v78, v79
    v_mfma_f32_16x16x32_bf16 v[188:191], a[92:95], a[156:159], v[188:191]
    ds_read_b64_tr_b16 a[70:71], v18 offset:20992
    v_cvt_pk_bf16_f32 v78, v92, v93
    v_mfma_f32_16x16x32_bf16 v[184:187], a[92:95], a[148:151], v[184:187]
    ds_read_b64_tr_b16 a[72:73], v18 offset:49152
    v_cvt_pk_bf16_f32 v79, v94, v95
    v_mfma_f32_16x16x32_bf16 v[184:187], a[88:91], a[144:147], v[184:187]
    ds_read_b64_tr_b16 a[74:75], v18 offset:49664
    v_cvt_pk_bf16_f32 v96, v96, v97
    v_mfma_f32_16x16x32_bf16 v[184:187], a[84:87], a[244:247], v[184:187]
    buffer_load_dwordx4 v1, s[8:11], s0 offen offset:1024 sc1 lds
    v_mfma_f32_16x16x32_bf16 v[184:187], a[80:83], a[240:243], v[184:187]
    s_add_u32 s94, s66, 32
    ds_read_b64_tr_b16 a[76:77], v18 offset:53248
    v_cvt_pk_bf16_f32 v97, v98, v99
    v_mfma_f32_16x16x32_bf16 v[180:183], a[80:83], a[232:235], v[180:183]
    s_mov_b32 s28, s56
    ds_read_b64_tr_b16 a[78:79], v18 offset:53760
    v_cvt_pk_bf16_f32 v98, v112, v113
    v_mfma_f32_16x16x32_bf16 v[180:183], a[84:87], a[236:239], v[180:183]
    s_mov_b32 s29, s59
    ds_write_b128 v26, v[72:75] offset:9216
    v_mfma_f32_16x16x32_bf16 v[180:183], a[88:91], a[136:139], v[180:183]
    s_sub_u32 s7, s71, 65536
    v_cvt_pk_bf16_f32 v99, v114, v115
    v_cvt_pk_bf16_f32 v100, v100, v101
    v_mfma_f32_16x16x32_bf16 v[180:183], a[92:95], a[140:143], v[180:183]
    s_cmp_eq_u32 s6, 3
    v_cvt_pk_bf16_f32 v101, v102, v103
    v_cvt_pk_bf16_f32 v102, v116, v117
    v_mfma_f32_16x16x32_bf16 v[176:179], a[92:95], a[132:135], v[176:179]
    s_cselect_b32 s56, s71, s7
    ds_write_b128 v26, v[76:79] offset:13312
    v_mfma_f32_16x16x32_bf16 v[176:179], a[88:91], a[128:131], v[176:179]
    s_xor_b32 s59, s59, 65536
    v_cvt_pk_bf16_f32 v103, v118, v119
    v_cvt_pk_bf16_f32 v104, v104, v105
    v_mfma_f32_16x16x32_bf16 v[176:179], a[84:87], a[228:231], v[176:179]
    s_mov_b32 s90, 65536
    v_cvt_pk_bf16_f32 v105, v106, v107
    v_cvt_pk_bf16_f32 v106, v120, v121
    v_mfma_f32_16x16x32_bf16 v[176:179], a[80:83], a[224:227], v[176:179]
    s_sub_u32 s70, 16, s5
    ds_write_b128 v26, v[96:99] offset:2048
    s_waitcnt lgkmcnt(1)
    v_mfma_f32_16x16x32_bf16 v[224:227], a[64:67], a[224:227], v[224:227]
    s_mov_b32 s60, 0
    ds_read_b64_tr_b16 a[80:81], v18 offset:24576
    v_cvt_pk_bf16_f32 v107, v122, v123
    v_mfma_f32_16x16x32_bf16 v[224:227], a[68:71], a[228:231], v[224:227]
    s_sub_u32 s63, 14, s5
    ds_read_b64_tr_b16 a[82:83], v18 offset:25088
    v_cvt_pk_bf16_f32 v108, v108, v109
    v_mfma_f32_16x16x32_bf16 v[224:227], a[72:75], a[128:131], v[224:227]
    s_sub_u32 s7, 15, s5
    ds_read_b64_tr_b16 a[84:85], v18 offset:28672
    v_cvt_pk_bf16_f32 v109, v110, v111
    v_mfma_f32_16x16x32_bf16 v[224:227], a[76:79], a[132:135], v[224:227]
    s_bitcmp0_b32 s69, 9
    ds_read_b64_tr_b16 a[86:87], v18 offset:29184
    v_cvt_pk_bf16_f32 v110, v124, v125
    v_mfma_f32_16x16x32_bf16 v[228:231], a[76:79], a[140:143], v[228:231]
    s_cselect_b32 s7, s7, s5
    ds_read_b64_tr_b16 a[88:89], v18 offset:57344
    v_cvt_pk_bf16_f32 v111, v126, v127
    v_mfma_f32_16x16x32_bf16 v[228:231], a[72:75], a[136:139], v[228:231]
    s_mul_i32 s62, s7, 1441792
    ds_read_b64_tr_b16 a[90:91], v18 offset:57856
    v_mov_b32 v12, s91
    v_mfma_f32_16x16x32_bf16 v[228:231], a[68:71], a[236:239], v[228:231]
    s_bitcmp1_b32 s4, 2
    ds_read_b64_tr_b16 a[92:93], v18 offset:61440
    v_lshl_add_u32 v2, v12, 13, v1
    v_mfma_f32_16x16x32_bf16 v[228:231], a[64:67], a[232:235], v[228:231]
    s_cselect_b32 s31, 7, 4
    ds_read_b64_tr_b16 a[94:95], v18 offset:61952
    v_add_u32 v2, 0x10000, v2
    v_mfma_f32_16x16x32_bf16 v[232:235], a[64:67], a[240:243], v[232:235]
    s_bitcmp1_b32 s67, 0
    v_mov_b32 v12, s5
    v_and_b32 v12, 1, v12
    v_mfma_f32_16x16x32_bf16 v[232:235], a[68:71], a[244:247], v[232:235]
    s_cselect_b32 s31, s31, 0
    ds_write_b128 v26, v[100:103] offset:6144
    v_mfma_f32_16x16x32_bf16 v[232:235], a[72:75], a[144:147], v[232:235]
    s_lshr_b32 s7, s67, 1
    v_lshlrev_b32 v12, 16, v12
    v_lshrrev_b32 v13, 6, v0
    v_mfma_f32_16x16x32_bf16 v[232:235], a[76:79], a[148:151], v[232:235]
    s_mul_i32 s7, s7, 11
    v_lshl_add_u32 v5, v13, 13, v12
    v_add_u32 v5, v5, v1
    v_mfma_f32_16x16x32_bf16 v[236:239], a[76:79], a[156:159], v[236:239]
    s_add_u32 s31, s31, s7
    ds_write_b128 v26, v[104:107] offset:10240
    v_mfma_f32_16x16x32_bf16 v[236:239], a[72:75], a[152:155], v[236:239]
    s_lshl_b32 s7, s31, 14
    v_xor_b32 v6, 0x4000, v5
    v_add_u32 v12, 0x8000, v12
    v_mfma_f32_16x16x32_bf16 v[236:239], a[68:71], a[252:255], v[236:239]
    s_add_u32 s62, s62, s7
    v_lshrrev_b32 v8, 2, v1
    v_and_b32 v9, 63, v8
    v_mfma_f32_16x16x32_bf16 v[236:239], a[64:67], a[248:251], v[236:239]
    s_add_u32 s62, s62, 38797312
    ds_write_b128 v26, v[108:111] offset:14336
    s_waitcnt lgkmcnt(1)
    v_mfma_f32_16x16x32_bf16 v[252:255], a[80:83], a[248:251], v[252:255]
    s_lshl_b32 s95, s6, 14
    v_add_u32 v8, v12, v8
    v_and_b32 v14, 0x80, v0
    v_mfma_f32_16x16x32_bf16 v[252:255], a[84:87], a[252:255], v[252:255]
    s_xor_b32 s7, s95, 16384
    v_xor_b32 v7, v14, v8
    v_lshl_add_u32 v7, v13, 8, v7
    v_add3_u32 v9, v9, v12, v14
    v_and_b32 v13, 1, v13
    v_lshl_add_u32 v9, v13, 8, v9
    v_lshrrev_b32 v13, 8, v1
    v_lshlrev_b32 v12, 5, v13
    v_and_b32 v3, 0xf0, v1
    v_xor_b32 v12, v12, v3
    v_lshl_add_u32 v3, v13, 10, v12
    v_xor_b32 v4, 0x80, v3
    v_cvt_pk_bf16_f32 v128, v128, v129
    v_cvt_pk_bf16_f32 v129, v130, v131
    v_cvt_pk_bf16_f32 v130, v144, v145
    v_cvt_pk_bf16_f32 v131, v146, v147
    v_mfma_f32_16x16x32_bf16 v[252:255], a[88:91], a[152:155], v[252:255]
    s_cmp_lt_u32 s6, 2
    ds_write_b128 v26, v[128:131] offset:3072
    v_mfma_f32_16x16x32_bf16 v[252:255], a[92:95], a[156:159], v[252:255]
    s_cselect_b32 s7, s7, s95
    v_cvt_pk_bf16_f32 v132, v132, v133
    v_cvt_pk_bf16_f32 v133, v134, v135
    v_mfma_f32_16x16x32_bf16 v[248:251], a[92:95], a[148:151], v[248:251]
    s_add_u32 s62, s62, s7
    v_cvt_pk_bf16_f32 v134, v148, v149
    v_cvt_pk_bf16_f32 v135, v150, v151
    v_mfma_f32_16x16x32_bf16 v[248:251], a[88:91], a[144:147], v[248:251]
    s_cmp_eq_u32 s6, 1
    v_cvt_pk_bf16_f32 v136, v136, v137
    v_cvt_pk_bf16_f32 v137, v138, v139
    v_mfma_f32_16x16x32_bf16 v[248:251], a[84:87], a[244:247], v[248:251]
    s_cselect_b32 s95, 131072, s95
    ds_write_b128 v26, v[132:135] offset:7168
    v_mfma_f32_16x16x32_bf16 v[248:251], a[80:83], a[240:243], v[248:251]
    s_sub_u32 s61, s70, 1
    v_cvt_pk_bf16_f32 v138, v152, v153
    v_cvt_pk_bf16_f32 v139, v154, v155
    v_mfma_f32_16x16x32_bf16 v[244:247], a[80:83], a[232:235], v[244:247]
    s_mul_i32 s61, s61, 1441792
    v_cvt_pk_bf16_f32 v140, v140, v141
    v_cvt_pk_bf16_f32 v141, v142, v143
    v_mfma_f32_16x16x32_bf16 v[244:247], a[84:87], a[236:239], v[244:247]
    s_lshl_b32 s7, s4, 15
    v_cvt_pk_bf16_f32 v142, v156, v157
    v_cvt_pk_bf16_f32 v143, v158, v159
    v_mfma_f32_16x16x32_bf16 v[244:247], a[88:91], a[136:139], v[244:247]
    s_add_u32 s61, s61, s7
    ds_write_b128 v26, v[136:139] offset:11264
    v_mfma_f32_16x16x32_bf16 v[244:247], a[92:95], a[140:143], v[244:247]
    s_lshl_b32 s7, s91, 12
    s_add_u32 s61, s61, s7
    s_and_b32 s7, s6, 1
    v_mfma_f32_16x16x32_bf16 v[240:243], a[92:95], a[132:135], v[240:243]
    s_lshl_b32 s7, s7, 10
    s_add_u32 s61, s61, s7
    s_add_u32 s61, s61, 37748736
    v_mfma_f32_16x16x32_bf16 v[240:243], a[88:91], a[128:131], v[240:243]
    s_mov_b32 s3, s70
    s_mov_b32 s71, s56
    s_mov_b32 s72, s90
    v_mfma_f32_16x16x32_bf16 v[240:243], a[84:87], a[228:231], v[240:243]
    s_mov_b32 s73, s58
    ds_write_b128 v26, v[140:143] offset:15360
    v_mfma_f32_16x16x32_bf16 v[240:243], a[80:83], a[224:227], v[240:243]
    v_cmp_le_i32 vcc, 0, v10
    v_cmp_le_i32 s[74:75], 16, v10
    v_mov_b32 v32, 0
    v_cndmask_b32 v40, v11, v32, vcc
    v_cndmask_b32 v44, v11, v32, s[74:75]
    v_cmp_le_i32 vcc, 1, v10
    v_cmp_le_i32 s[74:75], 17, v10
    v_mov_b32 v33, 0
    v_cndmask_b32 v41, v11, v32, vcc
    v_cndmask_b32 v45, v11, v32, s[74:75]
    v_cmp_le_i32 vcc, 2, v10
    v_cmp_le_i32 s[74:75], 18, v10
    v_mov_b32 v34, 0
    v_cndmask_b32 v42, v11, v32, vcc
    v_cndmask_b32 v46, v11, v32, s[74:75]
    v_cmp_le_i32 vcc, 3, v10
    v_cmp_le_i32 s[74:75], 19, v10
    v_mov_b32 v35, 0
    v_cndmask_b32 v43, v11, v32, vcc
    v_cndmask_b32 v47, v11, v32, s[74:75]
    s_add_u32 s1, s92, 4096
    buffer_load_dwordx4 v1, s[8:11], s0 offen offset:2048 sc1 lds
    v_pk_mul_f32 v[160:161], v[160:161], s[98:99]
    v_pk_mul_f32 v[162:163], v[162:163], s[98:99]
    v_exp_f32 v160, v160
    v_exp_f32 v161, v161
    v_exp_f32 v162, v162
    v_exp_f32 v163, v163
    v_pk_fma_f32 v[160:161], v[160:161], s[96:97], s[96:97]
    v_pk_fma_f32 v[162:163], v[162:163], s[96:97], s[96:97]
    v_rcp_f32 v160, v160
    v_rcp_f32 v161, v161
    v_rcp_f32 v162, v162
    v_rcp_f32 v163, v163
    buffer_load_dwordx4 v1, s[8:11], s0 offen offset:3072 sc1 lds
    v_pk_mul_f32 v[160:161], v[160:161], v[176:177]
    v_pk_mul_f32 v[162:163], v[162:163], v[178:179]
    v_cvt_pk_bf16_f32 v200, v160, v161
    v_cvt_pk_bf16_f32 v201, v162, v163
    v_pk_mul_f32 v[164:165], v[164:165], s[98:99]
    v_pk_mul_f32 v[166:167], v[166:167], s[98:99]
    v_exp_f32 v164, v164
    v_exp_f32 v165, v165
    v_exp_f32 v166, v166
    v_exp_f32 v167, v167
    v_pk_fma_f32 v[164:165], v[164:165], s[96:97], s[96:97]
    v_pk_fma_f32 v[166:167], v[166:167], s[96:97], s[96:97]
    s_add_u32 m0, s29, 12288
    s_add_u32 s0, s28, 12288
    buffer_load_dwordx4 v1, s[8:11], s0 offen offset:0 sc1 lds
    v_rcp_f32 v164, v164
    v_rcp_f32 v165, v165
    v_rcp_f32 v166, v166
    v_rcp_f32 v167, v167
    v_pk_mul_f32 v[164:165], v[164:165], v[180:181]
    v_pk_mul_f32 v[166:167], v[166:167], v[182:183]
    s_waitcnt vmcnt(6) lgkmcnt(0)
    s_barrier
    buffer_store_dword v25, v22, s[8:11], s94 offen sc1
    ds_read_b128 a[0:3], v27 offset:0
    ds_read_b128 a[4:7], v27 offset:1024
    ds_read_b128 a[8:11], v27 offset:2048
    buffer_load_dwordx4 v1, s[8:11], s0 offen offset:1024 sc1 lds
    ds_read_b128 a[12:15], v27 offset:3072
    v_cvt_pk_bf16_f32 v202, v164, v165
    v_cvt_pk_bf16_f32 v203, v166, v167
    v_pk_mul_f32 v[168:169], v[168:169], s[98:99]
    v_pk_mul_f32 v[170:171], v[170:171], s[98:99]
    v_exp_f32 v168, v168
    v_exp_f32 v169, v169
    v_exp_f32 v170, v170
    v_exp_f32 v171, v171
    ds_read_b128 a[16:19], v27 offset:8192
    ds_read_b128 a[20:23], v27 offset:9216
    ds_read_b128 a[24:27], v27 offset:10240
    buffer_load_dwordx4 v1, s[8:11], s0 offen offset:2048 sc1 lds
    ds_read_b128 a[28:31], v27 offset:11264
    v_pk_fma_f32 v[168:169], v[168:169], s[96:97], s[96:97]
    v_pk_fma_f32 v[170:171], v[170:171], s[96:97], s[96:97]
    v_rcp_f32 v168, v168
    v_rcp_f32 v169, v169
    v_rcp_f32 v170, v170
    v_rcp_f32 v171, v171
    v_pk_mul_f32 v[168:169], v[168:169], v[184:185]
    v_pk_mul_f32 v[170:171], v[170:171], v[186:187]
    v_cvt_pk_bf16_f32 v204, v168, v169
    ds_read_b128 a[32:35], v28 offset:0
    ds_read_b128 a[36:39], v28 offset:1024
    buffer_load_dwordx4 v1, s[8:11], s0 offen offset:3072 sc1 lds
    ds_read_b128 a[40:43], v28 offset:2048
    ds_read_b128 a[44:47], v28 offset:3072
    v_cvt_pk_bf16_f32 v205, v170, v171
    v_pk_mul_f32 v[172:173], v[172:173], s[98:99]
    v_pk_mul_f32 v[174:175], v[174:175], s[98:99]
    v_exp_f32 v172, v172
    v_exp_f32 v173, v173
    v_exp_f32 v174, v174
    v_exp_f32 v175, v175
    v_pk_fma_f32 v[172:173], v[172:173], s[96:97], s[96:97]
    ds_read_b128 a[48:51], v28 offset:8192
    ds_read_b128 a[52:55], v28 offset:9216
    ds_read_b128 a[56:59], v28 offset:10240
    ds_read_b128 a[60:63], v28 offset:11264
    v_pk_fma_f32 v[174:175], v[174:175], s[96:97], s[96:97]
    v_rcp_f32 v172, v172
    v_rcp_f32 v173, v173
    v_rcp_f32 v174, v174
    v_rcp_f32 v175, v175
    v_pk_mul_f32 v[172:173], v[172:173], v[188:189]
    v_pk_mul_f32 v[174:175], v[174:175], v[190:191]
    v_cvt_pk_bf16_f32 v206, v172, v173
    v_cvt_pk_bf16_f32 v207, v174, v175
    s_lshl_b32 s7, s91, 14
    s_sub_u32 s7, 131072, s7
    v_add_u32 v27, s7, v27
    v_xor_b32 v28, 0x4000, v27
    v_pk_mul_f32 v[224:225], v[224:225], s[98:99]
    v_pk_mul_f32 v[226:227], v[226:227], s[98:99]
    v_exp_f32 v224, v224
    v_exp_f32 v225, v225
    v_exp_f32 v226, v226
    v_exp_f32 v227, v227
    v_pk_fma_f32 v[224:225], v[224:225], s[96:97], s[96:97]
    v_pk_fma_f32 v[226:227], v[226:227], s[96:97], s[96:97]
    v_rcp_f32 v224, v224
    v_rcp_f32 v225, v225
    v_rcp_f32 v226, v226
    v_rcp_f32 v227, v227
    v_pk_mul_f32 v[224:225], v[224:225], v[240:241]
    v_pk_mul_f32 v[226:227], v[226:227], v[242:243]
    v_cvt_pk_bf16_f32 v208, v224, v225
    v_cvt_pk_bf16_f32 v209, v226, v227
    v_pk_mul_f32 v[228:229], v[228:229], s[98:99]
    v_pk_mul_f32 v[230:231], v[230:231], s[98:99]
    v_exp_f32 v228, v228
    v_exp_f32 v229, v229
    v_exp_f32 v230, v230
    buffer_store_dwordx2 v[192:193], v21, s[8:11], s1 offen offset:0 sc1
    v_exp_f32 v231, v231
    v_pk_fma_f32 v[228:229], v[228:229], s[96:97], s[96:97]
    v_pk_fma_f32 v[230:231], v[230:231], s[96:97], s[96:97]
    v_rcp_f32 v228, v228
    v_rcp_f32 v229, v229
    v_rcp_f32 v230, v230
    v_rcp_f32 v231, v231
    v_pk_mul_f32 v[228:229], v[228:229], v[244:245]
    buffer_store_dwordx2 v[194:195], v21, s[8:11], s1 offen offset:512 sc1
    v_pk_mul_f32 v[230:231], v[230:231], v[246:247]
    v_cvt_pk_bf16_f32 v210, v228, v229
    v_cvt_pk_bf16_f32 v211, v230, v231
    v_pk_mul_f32 v[232:233], v[232:233], s[98:99]
    v_pk_mul_f32 v[234:235], v[234:235], s[98:99]
    v_exp_f32 v232, v232
    v_exp_f32 v233, v233
    v_exp_f32 v234, v234
    buffer_store_dwordx2 v[196:197], v21, s[8:11], s1 offen offset:1024 sc1
    v_exp_f32 v235, v235
    v_pk_fma_f32 v[232:233], v[232:233], s[96:97], s[96:97]
    v_pk_fma_f32 v[234:235], v[234:235], s[96:97], s[96:97]
    v_rcp_f32 v232, v232
    v_rcp_f32 v233, v233
    v_rcp_f32 v234, v234
    v_rcp_f32 v235, v235
    v_pk_mul_f32 v[232:233], v[232:233], v[248:249]
    buffer_store_dwordx2 v[198:199], v21, s[8:11], s1 offen offset:1536 sc1
    v_pk_mul_f32 v[234:235], v[234:235], v[250:251]
    v_cvt_pk_bf16_f32 v212, v232, v233
    v_cvt_pk_bf16_f32 v213, v234, v235
    v_pk_mul_f32 v[236:237], v[236:237], s[98:99]
    v_pk_mul_f32 v[238:239], v[238:239], s[98:99]
    v_exp_f32 v236, v236
    v_exp_f32 v237, v237
    v_exp_f32 v238, v238
    s_waitcnt vmcnt(4) lgkmcnt(0)
    s_barrier
    v_cmp_gt_u32 vcc, 1, v24
    s_cbranch_vccnz L_poll_kve
L_back_kve:
    s_add_u32 s93, s93, 32
    s_add_u32 m0, s59, 0
    s_add_u32 s7, s56, 0
    buffer_load_dwordx4 v1, s[8:11], s7 offen offset:0 sc1 lds
    ds_read_b128 a[192:195], v2 offset:0
    ds_read_b128 a[196:199], v2 offset:1024
    ds_read_b128 a[200:203], v2 offset:4096
    v_exp_f32 v239, v239
    v_pk_fma_f32 v[236:237], v[236:237], s[96:97], s[96:97]
    v_pk_fma_f32 v[238:239], v[238:239], s[96:97], s[96:97]
    v_rcp_f32 v236, v236
    v_rcp_f32 v237, v237
    v_rcp_f32 v238, v238
    v_rcp_f32 v239, v239
    v_pk_mul_f32 v[236:237], v[236:237], v[252:253]
    v_pk_mul_f32 v[238:239], v[238:239], v[254:255]
    buffer_load_dwordx4 v1, s[8:11], s7 offen offset:1024 sc1 lds
    ds_read_b128 a[204:207], v2 offset:5120
    ds_read_b128 a[208:211], v2 offset:2048
    ds_read_b128 a[212:215], v2 offset:3072
    v_cvt_pk_bf16_f32 v214, v236, v237
    v_cvt_pk_bf16_f32 v215, v238, v239
    v_mov_b64 v[64:65], 0
    v_mov_b64 v[66:67], 0
    v_mov_b64 v[68:69], 0
    v_mov_b64 v[70:71], 0
    v_mov_b64 v[72:73], 0
    v_mov_b64 v[74:75], 0
    v_mov_b64 v[76:77], 0
    v_mov_b64 v[78:79], 0
    buffer_load_dwordx4 v1, s[8:11], s7 offen offset:2048 sc1 lds
    ds_read_b128 a[216:219], v2 offset:6144
    ds_read_b128 a[220:223], v2 offset:7168
    ds_read_b128 a[224:227], v2 offset:16384
    v_add_f32 v48, v40, v64
    v_add_f32 v49, v41, v65
    v_add_f32 v50, v42, v66
    v_add_f32 v51, v43, v67
    v_add_f32 v52, v44, v64
    v_add_f32 v53, v45, v65
    v_add_f32 v54, v46, v66
    v_add_f32 v55, v47, v67
    v_add_f32 v56, v40, v76
    buffer_load_dwordx4 v1, s[8:11], s7 offen offset:3072 sc1 lds
    ds_read_b128 a[228:231], v2 offset:17408
    ds_read_b128 a[232:235], v2 offset:20480
    ds_read_b128 a[236:239], v2 offset:21504
    v_add_f32 v57, v41, v77
    v_add_f32 v58, v42, v78
    v_add_f32 v59, v43, v79
    v_add_f32 v60, v44, v76
    v_add_f32 v61, v45, v77
    v_add_f32 v62, v46, v78
    v_add_f32 v63, v47, v79
    v_mov_b64 v[36:37], 0
    v_mov_b64 v[38:39], 0
    s_mov_b64 s[96:97], 0
    s_waitcnt lgkmcnt(0)
    s_branch L_setblock
L_diag1:
    v_mfma_f32_16x16x32_bf16 v[112:115], a[192:195], a[0:3], v[48:51]
    s_add_u32 m0, s59, 4096
    s_add_u32 s7, s56, 4096
    ds_read_b128 a[96:99], v2 offset:32768
    v_mfma_f32_16x16x32_bf16 v[112:115], a[196:199], a[4:7], v[112:115]
    buffer_load_dwordx4 v1, s[8:11], s7 offen offset:0 sc1 lds
    v_mfma_f32_16x16x32_bf16 v[112:115], a[200:203], a[8:11], v[112:115]
    ds_read_b128 a[100:103], v2 offset:33792
    ds_read_b128 a[104:107], v2 offset:34816
    v_mfma_f32_16x16x32_bf16 v[112:115], a[204:207], a[12:15], v[112:115]
    ds_read_b128 a[108:111], v2 offset:35840
    ds_read_b128 a[240:243], v2 offset:18432
    v_mfma_f32_16x16x32_bf16 v[116:119], a[204:207], a[28:31], v[68:71]
    buffer_load_dwordx4 v1, s[8:11], s7 offen offset:1024 sc1 lds
    v_mfma_f32_16x16x32_bf16 v[116:119], a[200:203], a[24:27], v[116:119]
    ds_read_b128 a[244:247], v2 offset:19456
    ds_read_b128 a[248:251], v2 offset:22528
    v_mfma_f32_16x16x32_bf16 v[116:119], a[196:199], a[20:23], v[116:119]
    ds_read_b128 a[252:255], v2 offset:23552
    ds_read_b128 a[80:83], v2 offset:36864
    v_mfma_f32_16x16x32_bf16 v[116:119], a[192:195], a[16:19], v[116:119]
    v_exp_f32 v112, v112
    v_mfma_f32_16x16x32_bf16 v[120:123], a[208:211], a[0:3], v[52:55]
    buffer_load_dwordx4 v1, s[8:11], s7 offen offset:2048 sc1 lds
    v_mfma_f32_16x16x32_bf16 v[120:123], a[212:215], a[4:7], v[120:123]
    v_exp_f32 v113, v113
    v_mfma_f32_16x16x32_bf16 v[120:123], a[216:219], a[8:11], v[120:123]
    v_add_f32 v36, v36, v112
    v_add_f32 v36, v36, v113
    v_mfma_f32_16x16x32_bf16 v[120:123], a[220:223], a[12:15], v[120:123]
    buffer_load_dwordx4 v1, s[8:11], s7 offen offset:3072 sc1 lds
    v_mfma_f32_16x16x32_bf16 v[124:127], a[220:223], a[28:31], v[68:71]
    v_exp_f32 v114, v114
    v_mfma_f32_16x16x32_bf16 v[124:127], a[216:219], a[24:27], v[124:127]
    s_add_u32 m0, s59, 8192
    s_add_u32 s7, s56, 8192
    v_cvt_pk_bf16_f32 v96, v112, v113
    v_mfma_f32_16x16x32_bf16 v[124:127], a[212:215], a[20:23], v[124:127]
    ds_read_b128 a[84:87], v2 offset:37888
    v_add_f32 v36, v36, v114
    v_mfma_f32_16x16x32_bf16 v[124:127], a[208:211], a[16:19], v[124:127]
    buffer_load_dwordx4 v1, s[8:11], s7 offen offset:0 sc1 lds
    v_mfma_f32_16x16x32_bf16 v[80:83], a[224:227], a[0:3], v[64:67]
    v_exp_f32 v115, v115
    v_mfma_f32_16x16x32_bf16 v[80:83], a[228:231], a[4:7], v[80:83]
    v_add_f32 v36, v36, v115
    v_cvt_pk_bf16_f32 v97, v114, v115
    v_mfma_f32_16x16x32_bf16 v[80:83], a[232:235], a[8:11], v[80:83]
    buffer_load_dwordx4 v1, s[8:11], s7 offen offset:1024 sc1 lds
    v_mfma_f32_16x16x32_bf16 v[80:83], a[236:239], a[12:15], v[80:83]
    v_exp_f32 v116, v116
    v_mfma_f32_16x16x32_bf16 v[84:87], a[236:239], a[28:31], v[68:71]
    v_add_f32 v37, v37, v116
    v_mov_b32 v104, 0
    v_mfma_f32_16x16x32_bf16 v[84:87], a[232:235], a[24:27], v[84:87]
    v_exp_f32 v117, v117
    v_mfma_f32_16x16x32_bf16 v[84:87], a[228:231], a[20:23], v[84:87]
    buffer_load_dwordx4 v1, s[8:11], s7 offen offset:2048 sc1 lds
    v_mfma_f32_16x16x32_bf16 v[84:87], a[224:227], a[16:19], v[84:87]
    v_exp_f32 v118, v118
    v_mfma_f32_16x16x32_bf16 v[92:95], a[224:227], a[48:51], v[56:59]
    v_exp_f32 v119, v119
    v_mfma_f32_16x16x32_bf16 v[92:95], a[228:231], a[52:55], v[92:95]
    buffer_load_dwordx4 v1, s[8:11], s7 offen offset:3072 sc1 lds
    v_mfma_f32_16x16x32_bf16 v[92:95], a[232:235], a[56:59], v[92:95]
    v_exp_f32 v120, v120
    v_mfma_f32_16x16x32_bf16 v[92:95], a[236:239], a[60:63], v[92:95]
    s_add_u32 m0, s59, 12288
    s_add_u32 s7, s56, 12288
    v_add_f32 v37, v37, v117
    v_mfma_f32_16x16x32_bf16 v[152:155], v[32:35], v[32:35], 0
    v_exp_f32 v121, v121
    v_mfma_f32_16x16x32_bf16 v[156:159], v[32:35], v[32:35], 0
    buffer_load_dwordx4 v1, s[8:11], s7 offen offset:0 sc1 lds
    v_mfma_f32_16x16x32_bf16 v[176:179], v[32:35], v[32:35], 0
    v_exp_f32 v122, v122
    v_mfma_f32_16x16x32_bf16 v[180:183], v[32:35], v[32:35], 0
    v_exp_f32 v123, v123
    v_mfma_f32_16x16x32_bf16 v[184:187], v[32:35], v[32:35], 0
    buffer_load_dwordx4 v1, s[8:11], s7 offen offset:1024 sc1 lds
    v_mfma_f32_16x16x32_bf16 v[188:191], v[32:35], v[32:35], 0
    v_exp_f32 v124, v124
    v_mfma_f32_16x16x32_bf16 v[224:227], v[32:35], v[32:35], 0
    v_cvt_pk_bf16_f32 v100, v116, v117
    v_add_f32 v37, v37, v118
    v_mfma_f32_16x16x32_bf16 v[228:231], v[32:35], v[32:35], 0
    v_exp_f32 v125, v125
    v_mfma_f32_16x16x32_bf16 v[232:235], v[32:35], v[32:35], 0
    buffer_load_dwordx4 v1, s[8:11], s7 offen offset:2048 sc1 lds
    v_mfma_f32_16x16x32_bf16 v[236:239], v[32:35], v[32:35], 0
    v_add_f32 v37, v37, v119
    v_cvt_pk_bf16_f32 v101, v118, v119
    v_mfma_f32_16x16x32_bf16 v[240:243], v[32:35], v[32:35], 0
    v_exp_f32 v126, v126
    v_mfma_f32_16x16x32_bf16 v[244:247], v[32:35], v[32:35], 0
    buffer_load_dwordx4 v1, s[8:11], s7 offen offset:3072 sc1 lds
    v_mfma_f32_16x16x32_bf16 v[248:251], v[32:35], v[32:35], 0
    buffer_load_dword v24, v23, s[8:11], s93 offen sc1
    v_mfma_f32_16x16x32_bf16 v[252:255], v[32:35], v[32:35], 0
    s_sub_u32 s17, 15, s5
    v_exp_f32 v127, v127
    v_mfma_f32_16x16x32_bf16 v[12:15], v[32:35], v[32:35], 0
    s_bitcmp0_b32 s69, 9
    v_add_f32 v36, v36, v120
    v_add_f32 v36, v36, v121
    v_cvt_pk_bf16_f32 v98, v120, v121
    v_add_f32 v36, v36, v122
    v_add_f32 v36, v36, v123
    v_cvt_pk_bf16_f32 v99, v122, v123
    v_add_f32 v37, v37, v124
    v_add_f32 v37, v37, v125
    v_cvt_pk_bf16_f32 v102, v124, v125
    v_add_f32 v37, v37, v126
    v_add_f32 v37, v37, v127
    v_cvt_pk_bf16_f32 v103, v126, v127
    v_mfma_f32_16x16x32_bf16 v[16:19], v[32:35], v[32:35], 0
L_tp15:
    s_cbranch_execz L_walk_end
    s_cselect_b32 s21, s17, s5
    s_waitcnt lgkmcnt(0)
    v_mov_b32 v120, 0
    v_mov_b32 v121, 0
    v_mfma_f32_16x16x32_bf16 v[128:131], a[96:99], v[96:99], 0
    s_mul_i32 s17, s21, 1441792
    v_exp_f32 v80, v80
    v_mfma_f32_16x16x32_bf16 v[160:163], a[96:99], v[100:103], 0
    s_lshl_b32 s14, s6, 12
    v_exp_f32 v81, v81
    v_mfma_f32_16x16x32_bf16 v[164:167], a[100:103], v[100:103], 0
    s_add_u32 s17, s17, s14
    v_add_f32 v36, v36, v80
    v_add_f32 v36, v36, v81
    v_mfma_f32_16x16x32_bf16 v[132:135], a[100:103], v[96:99], 0
    s_add_u32 s17, s17, 37748736
    v_exp_f32 v82, v82
    v_mfma_f32_16x16x32_bf16 v[136:139], a[104:107], v[96:99], 0
    s_lshl_b32 s25, s31, 14
    v_cvt_pk_bf16_f32 v112, v80, v81
    v_add_f32 v36, v36, v82
    v_mfma_f32_16x16x32_bf16 v[168:171], a[104:107], v[100:103], 0
    s_add_u32 s25, s25, s17
    v_exp_f32 v83, v83
    v_mfma_f32_16x16x32_bf16 v[172:175], a[108:111], v[100:103], 0
    s_add_u32 s25, s25, 1048576
    v_exp_f32 v84, v84
    v_mfma_f32_16x16x32_bf16 v[140:143], a[108:111], v[96:99], 0
    s_and_b32 s18, s4, 3
    v_add_f32 v36, v36, v83
    v_cvt_pk_bf16_f32 v113, v82, v83
    v_mfma_f32_16x16x32_bf16 v[80:83], a[240:243], a[0:3], v[64:67]
    s_lshl_b32 s18, s18, 8
    v_exp_f32 v85, v85
    v_mfma_f32_16x16x32_bf16 v[80:83], a[244:247], a[4:7], v[80:83]
    s_lshl_b32 s13, s6, 14
    v_exp_f32 v86, v86
    v_mfma_f32_16x16x32_bf16 v[80:83], a[248:251], a[8:11], v[80:83]
    s_add_u32 s13, s13, s18
    v_exp_f32 v87, v87
    v_mfma_f32_16x16x32_bf16 v[80:83], a[252:255], a[12:15], v[80:83]
    s_lshl_b32 s23, s31, 16
    v_add_f32 v37, v37, v84
    v_add_f32 v37, v37, v85
    v_cvt_pk_bf16_f32 v116, v84, v85
    v_add_f32 v37, v37, v86
    v_add_f32 v37, v37, v87
    v_cvt_pk_bf16_f32 v117, v86, v87
    v_mfma_f32_16x16x32_bf16 v[84:87], a[252:255], a[28:31], v[68:71]
    s_add_u32 s23, s23, s13
    v_exp_f32 v92, v92
    v_mfma_f32_16x16x32_bf16 v[84:87], a[248:251], a[24:27], v[84:87]
    s_sub_u32 s7, s56, 65536
    v_exp_f32 v93, v93
    v_mfma_f32_16x16x32_bf16 v[84:87], a[244:247], a[20:23], v[84:87]
    s_cmp_eq_u32 s56, s57
    v_exp_f32 v94, v94
    v_exp_f32 v95, v95
    v_mfma_f32_16x16x32_bf16 v[84:87], a[240:243], a[16:19], v[84:87]
    s_cselect_b32 s56, s58, s7
    v_cvt_pk_bf16_f32 v124, v92, v93
    v_cvt_pk_bf16_f32 v125, v94, v95
    v_mfma_f32_16x16x32_bf16 v[92:95], a[240:243], a[48:51], v[60:63]
    s_cselect_b32 s58, s62, s58
    v_exp_f32 v80, v80
    v_mfma_f32_16x16x32_bf16 v[92:95], a[244:247], a[52:55], v[92:95]
    s_xor_b32 s59, s59, 65536
    ds_read_b128 a[88:91], v2 offset:38912
    v_mov_b32 v105, 0
    v_mfma_f32_16x16x32_bf16 v[92:95], a[248:251], a[56:59], v[92:95]
    s_cmp_eq_u32 s56, s62
    ds_read_b128 a[92:95], v2 offset:39936
    s_cselect_b32 s59, s95, s59
    v_mfma_f32_16x16x32_bf16 v[92:95], a[252:255], a[60:63], v[92:95]
    s_xor_b32 s90, s90, 65536
    v_mov_b32 v106, 0
    v_mov_b32 v107, 0
    v_mfma_f32_16x16x32_bf16 v[144:147], v[32:35], v[32:35], 0
    s_sub_u32 s3, s3, 1
    v_exp_f32 v81, v81
    v_exp_f32 v82, v82
    v_exp_f32 v83, v83
    v_mfma_f32_16x16x32_bf16 v[148:151], v[32:35], v[32:35], 0
    s_cmp_lg_u32 s60, 0
    v_mov_b32 v108, 0
    v_mov_b32 v109, 0
    v_add_f32 v36, v36, v80
    v_mov_b32 v110, 0
    v_add_f32 v36, v36, v81
    v_cvt_pk_bf16_f32 v114, v80, v81
    v_add_f32 v36, v36, v82
    v_add_f32 v36, v36, v83
    v_cvt_pk_bf16_f32 v115, v82, v83
    v_mov_b32 v111, 0
    v_mov_b32 v88, 0xff800000
    v_mov_b32 v89, 0xff800000
    v_mov_b32 v90, 0xff800000
    v_mov_b32 v91, 0xff800000
    s_cbranch_scc0 L_dend0
L_dend1:
    v_xor_b32 v2, 0x10000, v2
    s_add_u32 s7, s92, 0
    buffer_store_dwordx4 v[192:195], v1, s[8:11], s7 offen offset:0 sc1
    buffer_store_dwordx4 v[196:199], v1, s[8:11], s7 offen offset:2048 sc1
    v_mfma_f32_16x16x32_bf16 v[192:195], v[32:35], v[32:35], 0
    s_add_u32 s7, s92, 8192
    buffer_store_dwordx4 v[200:203], v1, s[8:11], s7 offen offset:0 sc1
    v_mfma_f32_16x16x32_bf16 v[196:199], v[32:35], v[32:35], 0
    buffer_store_dwordx4 v[204:207], v1, s[8:11], s7 offen offset:2048 sc1
    v_mfma_f32_16x16x32_bf16 v[200:203], v[32:35], v[32:35], 0
    s_add_u32 s7, s92, 16384
    buffer_store_dwordx4 v[208:211], v1, s[8:11], s7 offen offset:0 sc1
    v_mfma_f32_16x16x32_bf16 v[204:207], v[32:35], v[32:35], 0
    buffer_store_dwordx4 v[212:215], v1, s[8:11], s7 offen offset:2048 sc1
    v_mfma_f32_16x16x32_bf16 v[208:211], v[32:35], v[32:35], 0
    s_add_u32 s7, s92, 24576
    buffer_store_dwordx4 v[216:219], v1, s[8:11], s7 offen offset:0 sc1
    v_mfma_f32_16x16x32_bf16 v[212:215], v[32:35], v[32:35], 0
    buffer_store_dwordx4 v[220:223], v1, s[8:11], s7 offen offset:2048 sc1
    v_mfma_f32_16x16x32_bf16 v[216:219], v[32:35], v[32:35], 0
    s_mov_b32 s92, 1073741824
    s_cmp_lg_u32 s3, 0
    v_mfma_f32_16x16x32_bf16 v[220:223], v[32:35], v[32:35], 0
    s_waitcnt vmcnt(8) lgkmcnt(0)
    s_barrier
    v_mfma_f32_16x16x32_bf16 v[144:147], a[80:83], v[96:99], v[144:147]
    s_cbranch_scc1 L_loop
    s_branch L_tail
    s_nop 0
    s_nop 0
    s_nop 0
    s_nop 0
    s_nop 0
    s_nop 0
    s_nop 0
    s_nop 0
    s_nop 0
    s_nop 0
    s_nop 0
    s_nop 0
    s_nop 0
    s_nop 0
L_sig:
    buffer_store_dword v25, v22, s[8:11], s68 offen sc1
    s_branch L_sig_back
L_diag0:
L_tp16:
    s_cbranch_execz L_walk_end
    v_mfma_f32_16x16x32_bf16 v[112:115], a[192:195], a[48:51], v[56:59]
    s_add_u32 m0, s59, 4096
    s_add_u32 s7, s56, 4096
    ds_read_b128 a[96:99], v2 offset:32768
    v_mfma_f32_16x16x32_bf16 v[112:115], a[196:199], a[52:55], v[112:115]
    buffer_load_dwordx4 v1, s[8:11], s7 offen offset:0 sc1 lds
    v_mfma_f32_16x16x32_bf16 v[112:115], a[200:203], a[56:59], v[112:115]
    ds_read_b128 a[100:103], v2 offset:33792
    ds_read_b128 a[104:107], v2 offset:34816
    v_mfma_f32_16x16x32_bf16 v[112:115], a[204:207], a[60:63], v[112:115]
    ds_read_b128 a[108:111], v2 offset:35840
    ds_read_b128 a[240:243], v2 offset:18432
    v_mfma_f32_16x16x32_bf16 v[120:123], a[208:211], a[48:51], v[60:63]
    buffer_load_dwordx4 v1, s[8:11], s7 offen offset:1024 sc1 lds
    v_mfma_f32_16x16x32_bf16 v[120:123], a[212:215], a[52:55], v[120:123]
    ds_read_b128 a[244:247], v2 offset:19456
    ds_read_b128 a[248:251], v2 offset:22528
    v_mfma_f32_16x16x32_bf16 v[120:123], a[216:219], a[56:59], v[120:123]
    ds_read_b128 a[252:255], v2 offset:23552
    ds_read_b128 a[80:83], v2 offset:36864
    v_mfma_f32_16x16x32_bf16 v[120:123], a[220:223], a[60:63], v[120:123]
    v_exp_f32 v112, v112
    v_mfma_f32_16x16x32_bf16 v[80:83], a[224:227], a[0:3], v[48:51]
    buffer_load_dwordx4 v1, s[8:11], s7 offen offset:2048 sc1 lds
    v_mfma_f32_16x16x32_bf16 v[80:83], a[228:231], a[4:7], v[80:83]
    v_exp_f32 v113, v113
    v_mfma_f32_16x16x32_bf16 v[80:83], a[232:235], a[8:11], v[80:83]
    ds_read_b128 a[84:87], v2 offset:37888
    v_cvt_pk_bf16_f32 v108, v112, v113
    v_mfma_f32_16x16x32_bf16 v[80:83], a[236:239], a[12:15], v[80:83]
    buffer_load_dwordx4 v1, s[8:11], s7 offen offset:3072 sc1 lds
    v_mfma_f32_16x16x32_bf16 v[84:87], a[236:239], a[28:31], v[68:71]
    v_exp_f32 v114, v114
    v_mfma_f32_16x16x32_bf16 v[84:87], a[232:235], a[24:27], v[84:87]
    s_add_u32 m0, s59, 8192
    s_add_u32 s7, s56, 8192
    v_mov_b32 v96, 0
    v_mfma_f32_16x16x32_bf16 v[84:87], a[228:231], a[20:23], v[84:87]
    v_exp_f32 v115, v115
    v_mfma_f32_16x16x32_bf16 v[84:87], a[224:227], a[16:19], v[84:87]
    buffer_load_dwordx4 v1, s[8:11], s7 offen offset:0 sc1 lds
    v_mfma_f32_16x16x32_bf16 v[88:91], a[224:227], a[32:35], v[72:75]
    ds_read_b128 a[88:91], v2 offset:38912
    v_cvt_pk_bf16_f32 v109, v114, v115
    v_mfma_f32_16x16x32_bf16 v[88:91], a[228:231], a[36:39], v[88:91]
    v_exp_f32 v120, v120
    v_mfma_f32_16x16x32_bf16 v[88:91], a[232:235], a[40:43], v[88:91]
    buffer_load_dwordx4 v1, s[8:11], s7 offen offset:1024 sc1 lds
    v_mfma_f32_16x16x32_bf16 v[88:91], a[236:239], a[44:47], v[88:91]
    v_exp_f32 v121, v121
    v_mfma_f32_16x16x32_bf16 v[92:95], a[236:239], a[60:63], v[76:79]
    v_cvt_pk_bf16_f32 v110, v120, v121
    v_mov_b32 v97, 0
    v_mfma_f32_16x16x32_bf16 v[92:95], a[232:235], a[56:59], v[92:95]
    v_exp_f32 v122, v122
    v_mfma_f32_16x16x32_bf16 v[92:95], a[228:231], a[52:55], v[92:95]
    buffer_load_dwordx4 v1, s[8:11], s7 offen offset:2048 sc1 lds
    v_mfma_f32_16x16x32_bf16 v[92:95], a[224:227], a[48:51], v[92:95]
    v_exp_f32 v123, v123
    v_mfma_f32_16x16x32_bf16 v[136:139], v[32:35], v[32:35], 0
    ds_read_b128 a[92:95], v2 offset:39936
    v_cvt_pk_bf16_f32 v111, v122, v123
    v_mfma_f32_16x16x32_bf16 v[140:143], v[32:35], v[32:35], 0
    buffer_load_dwordx4 v1, s[8:11], s7 offen offset:3072 sc1 lds
    v_mfma_f32_16x16x32_bf16 v[144:147], v[32:35], v[32:35], 0
    v_exp_f32 v80, v80
    v_mfma_f32_16x16x32_bf16 v[148:151], v[32:35], v[32:35], 0
    s_add_u32 m0, s59, 12288
    s_add_u32 s7, s56, 12288
    v_add_f32 v36, v36, v80
    v_mfma_f32_16x16x32_bf16 v[152:155], v[32:35], v[32:35], 0
    v_exp_f32 v81, v81
    v_mfma_f32_16x16x32_bf16 v[156:159], v[32:35], v[32:35], 0
    buffer_load_dwordx4 v1, s[8:11], s7 offen offset:0 sc1 lds
    v_mfma_f32_16x16x32_bf16 v[160:163], v[32:35], v[32:35], 0
    v_add_f32 v36, v36, v81
    v_cvt_pk_bf16_f32 v112, v80, v81
    v_mfma_f32_16x16x32_bf16 v[164:167], v[32:35], v[32:35], 0
    v_exp_f32 v82, v82
    v_mfma_f32_16x16x32_bf16 v[168:171], v[32:35], v[32:35], 0
    buffer_load_dwordx4 v1, s[8:11], s7 offen offset:1024 sc1 lds
    v_mfma_f32_16x16x32_bf16 v[172:175], v[32:35], v[32:35], 0
    v_exp_f32 v83, v83
    v_mfma_f32_16x16x32_bf16 v[176:179], v[32:35], v[32:35], 0
    v_add_f32 v36, v36, v82
    v_add_f32 v36, v36, v83
    v_mfma_f32_16x16x32_bf16 v[180:183], v[32:35], v[32:35], 0
    v_cvt_pk_bf16_f32 v113, v82, v83
    v_mov_b32 v98, 0
    v_mfma_f32_16x16x32_bf16 v[184:187], v[32:35], v[32:35], 0
    buffer_load_dwordx4 v1, s[8:11], s7 offen offset:2048 sc1 lds
    v_mfma_f32_16x16x32_bf16 v[188:191], v[32:35], v[32:35], 0
    v_exp_f32 v84, v84
    v_mfma_f32_16x16x32_bf16 v[240:243], v[32:35], v[32:35], 0
    v_add_f32 v37, v37, v84
    v_mov_b32 v99, 0
    v_mfma_f32_16x16x32_bf16 v[244:247], v[32:35], v[32:35], 0
    buffer_load_dwordx4 v1, s[8:11], s7 offen offset:3072 sc1 lds
    v_mfma_f32_16x16x32_bf16 v[248:251], v[32:35], v[32:35], 0
    buffer_load_dword v24, v23, s[8:11], s93 offen sc1
    v_mfma_f32_16x16x32_bf16 v[252:255], v[32:35], v[32:35], 0
    s_sub_u32 s17, 15, s5
    v_exp_f32 v85, v85
    v_mfma_f32_16x16x32_bf16 v[12:15], v[32:35], v[32:35], 0
    s_bitcmp0_b32 s69, 9
    v_add_f32 v37, v37, v85
    v_cvt_pk_bf16_f32 v116, v84, v85
    v_mfma_f32_16x16x32_bf16 v[16:19], v[32:35], v[32:35], 0
    s_cselect_b32 s21, s17, s5
    s_waitcnt lgkmcnt(0)
    v_exp_f32 v86, v86
    v_mfma_f32_16x16x32_bf16 v[224:227], a[96:99], v[108:111], 0
    s_mul_i32 s17, s21, 1441792
    v_exp_f32 v87, v87
    v_mfma_f32_16x16x32_bf16 v[228:231], a[100:103], v[108:111], 0
    s_lshl_b32 s14, s6, 12
    v_add_f32 v37, v37, v86
    v_add_f32 v37, v37, v87
    v_mfma_f32_16x16x32_bf16 v[232:235], a[104:107], v[108:111], 0
    s_add_u32 s17, s17, s14
    v_cvt_pk_bf16_f32 v117, v86, v87
    v_mov_b32 v100, 0
    v_mfma_f32_16x16x32_bf16 v[236:239], a[108:111], v[108:111], 0
    s_add_u32 s17, s17, 37748736
    v_exp_f32 v88, v88
    v_mfma_f32_16x16x32_bf16 v[80:83], a[240:243], a[0:3], v[52:55]
    s_lshl_b32 s25, s31, 14
    v_exp_f32 v89, v89
    v_mfma_f32_16x16x32_bf16 v[80:83], a[244:247], a[4:7], v[80:83]
    s_add_u32 s25, s25, s17
    v_cvt_pk_bf16_f32 v120, v88, v89
    v_mov_b32 v101, 0
    v_mfma_f32_16x16x32_bf16 v[80:83], a[248:251], a[8:11], v[80:83]
    s_add_u32 s25, s25, 1048576
    v_exp_f32 v90, v90
    v_mfma_f32_16x16x32_bf16 v[80:83], a[252:255], a[12:15], v[80:83]
    s_and_b32 s18, s4, 3
    v_exp_f32 v91, v91
    v_mfma_f32_16x16x32_bf16 v[84:87], a[252:255], a[28:31], v[68:71]
    s_lshl_b32 s18, s18, 8
    v_cvt_pk_bf16_f32 v121, v90, v91
    s_lshl_b32 s13, s6, 14
    v_mfma_f32_16x16x32_bf16 v[84:87], a[248:251], a[24:27], v[84:87]
    s_add_u32 s13, s13, s18
    v_exp_f32 v92, v92
    v_mfma_f32_16x16x32_bf16 v[84:87], a[244:247], a[20:23], v[84:87]
    s_lshl_b32 s23, s31, 16
    v_exp_f32 v93, v93
    v_mfma_f32_16x16x32_bf16 v[84:87], a[240:243], a[16:19], v[84:87]
    s_add_u32 s23, s23, s13
    v_cvt_pk_bf16_f32 v124, v92, v93
    v_mov_b32 v102, 0
    v_mfma_f32_16x16x32_bf16 v[88:91], a[240:243], a[32:35], v[72:75]
    s_sub_u32 s7, s56, 65536
    v_exp_f32 v94, v94
    v_mfma_f32_16x16x32_bf16 v[88:91], a[244:247], a[36:39], v[88:91]
    s_cmp_eq_u32 s56, s57
    v_exp_f32 v95, v95
    v_mfma_f32_16x16x32_bf16 v[88:91], a[248:251], a[40:43], v[88:91]
    s_cselect_b32 s56, s58, s7
    v_exp_f32 v80, v80
    v_mfma_f32_16x16x32_bf16 v[88:91], a[252:255], a[44:47], v[88:91]
    s_cselect_b32 s58, s62, s58
    v_cvt_pk_bf16_f32 v125, v94, v95
    v_add_f32 v36, v36, v80
    v_mfma_f32_16x16x32_bf16 v[92:95], a[252:255], a[60:63], v[76:79]
    s_xor_b32 s59, s59, 65536
    v_exp_f32 v81, v81
    v_mfma_f32_16x16x32_bf16 v[92:95], a[248:251], a[56:59], v[92:95]
    s_cmp_eq_u32 s56, s62
    v_add_f32 v36, v36, v81
    v_cvt_pk_bf16_f32 v114, v80, v81
    v_mfma_f32_16x16x32_bf16 v[92:95], a[244:247], a[52:55], v[92:95]
    s_cselect_b32 s59, s95, s59
    v_mov_b32 v103, 0
    v_mov_b32 v104, 0
    v_mfma_f32_16x16x32_bf16 v[92:95], a[240:243], a[48:51], v[92:95]
    s_xor_b32 s90, s90, 65536
    v_exp_f32 v82, v82
    v_mfma_f32_16x16x32_bf16 v[128:131], v[32:35], v[32:35], 0
    s_sub_u32 s3, s3, 1
    v_exp_f32 v83, v83
    v_mfma_f32_16x16x32_bf16 v[132:135], v[32:35], v[32:35], 0
    s_cmp_lg_u32 s60, 0
    v_add_f32 v36, v36, v82
    v_mov_b32 v105, 0
    v_add_f32 v36, v36, v83
    v_mov_b32 v106, 0
    v_mov_b32 v107, 0
    v_cvt_pk_bf16_f32 v115, v82, v83
    s_cbranch_scc1 L_dend1
L_dend0:
    v_xor_b32 v2, 0x10000, v2
    s_add_u32 s7, s92, 0
    buffer_store_dwordx2 v[200:201], v21, s[8:11], s7 offen offset:0 sc1
    buffer_store_dwordx2 v[202:203], v21, s[8:11], s7 offen offset:512 sc1
    v_mfma_f32_16x16x32_bf16 v[192:195], v[32:35], v[32:35], 0
    buffer_store_dwordx2 v[204:205], v21, s[8:11], s7 offen offset:1024 sc1
    v_mfma_f32_16x16x32_bf16 v[196:199], v[32:35], v[32:35], 0
    buffer_store_dwordx2 v[206:207], v21, s[8:11], s7 offen offset:1536 sc1
    v_mfma_f32_16x16x32_bf16 v[216:219], v[32:35], v[32:35], 0
    s_add_u32 s7, s92, 8192
    buffer_store_dwordx2 v[208:209], v21, s[8:11], s7 offen offset:0 sc1
    v_mfma_f32_16x16x32_bf16 v[220:223], v[32:35], v[32:35], 0
    buffer_store_dwordx2 v[210:211], v21, s[8:11], s7 offen offset:512 sc1
    v_mfma_f32_16x16x32_bf16 v[200:203], v[32:35], v[32:35], 0
    buffer_store_dwordx2 v[212:213], v21, s[8:11], s7 offen offset:1024 sc1
    v_mfma_f32_16x16x32_bf16 v[204:207], v[32:35], v[32:35], 0
    buffer_store_dwordx2 v[214:215], v21, s[8:11], s7 offen offset:1536 sc1
    v_mfma_f32_16x16x32_bf16 v[208:211], v[32:35], v[32:35], 0
    s_mov_b32 s92, 1073741824
    s_cmp_lg_u32 s3, 0
    v_mfma_f32_16x16x32_bf16 v[212:215], v[32:35], v[32:35], 0
    s_waitcnt vmcnt(8) lgkmcnt(0)
    s_barrier
    v_mfma_f32_16x16x32_bf16 v[144:147], a[80:83], v[96:99], v[144:147]
    v_cmp_gt_u32 vcc, 1, v24
    s_cbranch_vccnz L_poll_kvl
L_back_kvl:
L_loop:
    v_mfma_f32_16x16x32_bf16 v[176:179], a[80:83], v[100:103], v[176:179]
    s_add_u32 m0, s59, 0
    v_exp_f32 v84, v84
    v_mfma_f32_16x16x32_bf16 v[180:183], a[84:87], v[100:103], v[180:183]
    s_add_u32 s7, s56, 0
    ds_read_b128 a[64:67], v2 offset:0
    v_add_f32 v37, v37, v84
    v_mfma_f32_16x16x32_bf16 v[148:151], a[84:87], v[96:99], v[148:151]
    buffer_load_dwordx4 v1, s[8:11], s7 offen offset:0 sc1 lds
    v_mfma_f32_16x16x32_bf16 v[152:155], a[88:91], v[96:99], v[152:155]
    v_exp_f32 v85, v85
    v_mfma_f32_16x16x32_bf16 v[156:159], a[92:95], v[96:99], v[156:159]
    ds_read_b128 a[68:71], v2 offset:1024
    v_add_f32 v37, v37, v85
    v_mfma_f32_16x16x32_bf16 v[188:191], a[92:95], v[100:103], v[188:191]
    v_exp_f32 v86, v86
    v_mfma_f32_16x16x32_bf16 v[184:187], a[88:91], v[100:103], v[184:187]
    v_exp_f32 v87, v87
    v_mfma_f32_16x16x32_bf16 v[216:219], a[88:91], v[104:107], v[216:219]
    ds_read_b128 a[72:75], v2 offset:4096
    v_cvt_pk_bf16_f32 v118, v84, v85
    v_mfma_f32_16x16x32_bf16 v[220:223], a[92:95], v[104:107], v[220:223]
    buffer_load_dwordx4 v1, s[8:11], s7 offen offset:1024 sc1 lds
    v_mfma_f32_16x16x32_bf16 v[252:255], a[92:95], v[108:111], v[252:255]
    s_cmp_eq_u32 s3, s63
    ds_read_b128 a[76:79], v2 offset:5120
    v_add_f32 v37, v37, v86
    v_mfma_f32_16x16x32_bf16 v[248:251], a[88:91], v[108:111], v[248:251]
    s_cbranch_scc1 L_sig
L_sig_back:
    v_add_f32 v37, v37, v87
    v_cvt_pk_bf16_f32 v119, v86, v87
    v_mfma_f32_16x16x32_bf16 v[244:247], a[84:87], v[108:111], v[244:247]
    v_exp_f32 v88, v88
    v_mfma_f32_16x16x32_bf16 v[212:215], a[84:87], v[104:107], v[212:215]
    v_exp_f32 v89, v89
    v_mfma_f32_16x16x32_bf16 v[208:211], a[80:83], v[104:107], v[208:211]
    v_exp_f32 v90, v90
    v_mfma_f32_16x16x32_bf16 v[240:243], a[80:83], v[108:111], v[240:243]
    buffer_load_dwordx4 v1, s[8:11], s7 offen offset:2048 sc1 lds
    v_mfma_f32_16x16x32_bf16 v[16:19], a[176:179], v[108:111], v[16:19]
    ds_read_b128 a[80:83], v2 offset:49152
    s_waitcnt lgkmcnt(1)
    v_cvt_pk_bf16_f32 v122, v88, v89
    v_mfma_f32_16x16x32_bf16 v[80:83], a[64:67], a[0:3], v[64:67]
    v_exp_f32 v91, v91
    v_mfma_f32_16x16x32_bf16 v[80:83], a[68:71], a[4:7], v[80:83]
    v_exp_f32 v92, v92
    v_mfma_f32_16x16x32_bf16 v[80:83], a[72:75], a[8:11], v[80:83]
    v_exp_f32 v93, v93
    v_mfma_f32_16x16x32_bf16 v[80:83], a[76:79], a[12:15], v[80:83]
    ds_read_b128 a[84:87], v2 offset:50176
    v_cvt_pk_bf16_f32 v123, v90, v91
    v_mfma_f32_16x16x32_bf16 v[84:87], a[76:79], a[28:31], v[68:71]
    buffer_load_dwordx4 v1, s[8:11], s7 offen offset:3072 sc1 lds
    v_mfma_f32_16x16x32_bf16 v[84:87], a[72:75], a[24:27], v[84:87]
    v_exp_f32 v94, v94
    v_mfma_f32_16x16x32_bf16 v[84:87], a[68:71], a[20:23], v[84:87]
    s_add_u32 m0, s59, 4096
    ds_read_b128 a[88:91], v2 offset:51200
    v_cvt_pk_bf16_f32 v126, v92, v93
    v_mfma_f32_16x16x32_bf16 v[84:87], a[64:67], a[16:19], v[84:87]
    s_add_u32 s7, s56, 4096
    v_exp_f32 v95, v95
    v_mfma_f32_16x16x32_bf16 v[88:91], a[64:67], a[32:35], v[72:75]
    ds_read_b128 a[92:95], v2 offset:52224
    v_cvt_pk_bf16_f32 v127, v94, v95
    v_mfma_f32_16x16x32_bf16 v[88:91], a[68:71], a[36:39], v[88:91]
    v_exp_f32 v80, v80
    v_mfma_f32_16x16x32_bf16 v[88:91], a[72:75], a[40:43], v[88:91]
    buffer_load_dwordx4 v1, s[8:11], s7 offen offset:0 sc1 lds
    v_mfma_f32_16x16x32_bf16 v[88:91], a[76:79], a[44:47], v[88:91]
    v_exp_f32 v81, v81
    v_mfma_f32_16x16x32_bf16 v[92:95], a[76:79], a[60:63], v[76:79]
    v_add_f32 v36, v36, v80
    v_add_f32 v36, v36, v81
    v_mfma_f32_16x16x32_bf16 v[92:95], a[72:75], a[56:59], v[92:95]
    v_exp_f32 v82, v82
    v_mfma_f32_16x16x32_bf16 v[92:95], a[68:71], a[52:55], v[92:95]
    v_exp_f32 v83, v83
    v_mfma_f32_16x16x32_bf16 v[92:95], a[64:67], a[48:51], v[92:95]
    s_waitcnt lgkmcnt(0)
    v_cvt_pk_bf16_f32 v96, v80, v81
    v_add_f32 v36, v36, v82
    v_mfma_f32_16x16x32_bf16 v[128:131], a[80:83], v[112:115], v[128:131]
    buffer_load_dwordx4 v1, s[8:11], s7 offen offset:1024 sc1 lds
    v_mfma_f32_16x16x32_bf16 v[160:163], a[80:83], v[116:119], v[160:163]
    v_exp_f32 v84, v84
    v_mfma_f32_16x16x32_bf16 v[164:167], a[84:87], v[116:119], v[164:167]
    ds_read_b128 a[64:67], v2 offset:2048
    v_add_f32 v36, v36, v83
    v_mfma_f32_16x16x32_bf16 v[132:135], a[84:87], v[112:115], v[132:135]
    v_exp_f32 v85, v85
    v_mfma_f32_16x16x32_bf16 v[136:139], a[88:91], v[112:115], v[136:139]
    ds_read_b128 a[68:71], v2 offset:3072
    v_cvt_pk_bf16_f32 v97, v82, v83
    v_mfma_f32_16x16x32_bf16 v[140:143], a[92:95], v[112:115], v[140:143]
    buffer_load_dwordx4 v1, s[8:11], s7 offen offset:2048 sc1 lds
    v_mfma_f32_16x16x32_bf16 v[172:175], a[92:95], v[116:119], v[172:175]
    v_add_f32 v37, v37, v84
    v_add_f32 v37, v37, v85
    v_mfma_f32_16x16x32_bf16 v[168:171], a[88:91], v[116:119], v[168:171]
    v_exp_f32 v86, v86
    v_mfma_f32_16x16x32_bf16 v[200:203], a[88:91], v[120:123], v[200:203]
    v_exp_f32 v87, v87
    v_mfma_f32_16x16x32_bf16 v[204:207], a[92:95], v[120:123], v[204:207]
    ds_read_b128 a[72:75], v2 offset:6144
    v_cvt_pk_bf16_f32 v100, v84, v85
    v_mfma_f32_16x16x32_bf16 v[236:239], a[92:95], v[124:127], v[236:239]
    ds_read_b128 a[76:79], v2 offset:7168
    v_add_f32 v37, v37, v86
    v_mfma_f32_16x16x32_bf16 v[232:235], a[88:91], v[124:127], v[232:235]
    v_exp_f32 v88, v88
    v_mfma_f32_16x16x32_bf16 v[228:231], a[84:87], v[124:127], v[228:231]
    v_exp_f32 v89, v89
    v_mfma_f32_16x16x32_bf16 v[196:199], a[84:87], v[120:123], v[196:199]
    v_add_f32 v37, v37, v87
    v_cvt_pk_bf16_f32 v101, v86, v87
    v_mfma_f32_16x16x32_bf16 v[192:195], a[80:83], v[120:123], v[192:195]
    buffer_load_dwordx4 v1, s[8:11], s7 offen offset:3072 sc1 lds
    v_mfma_f32_16x16x32_bf16 v[224:227], a[80:83], v[124:127], v[224:227]
    s_add_u32 m0, s59, 8192
    s_add_u32 s7, s56, 8192
    v_cvt_pk_bf16_f32 v104, v88, v89
    v_mfma_f32_16x16x32_bf16 v[12:15], a[176:179], v[120:123], v[12:15]
    s_waitcnt lgkmcnt(0)
    v_exp_f32 v90, v90
    v_mfma_f32_16x16x32_bf16 v[80:83], a[64:67], a[0:3], v[64:67]
    ds_read_b128 a[80:83], v2 offset:53248
    v_mfma_f32_16x16x32_bf16 v[80:83], a[68:71], a[4:7], v[80:83]
    v_exp_f32 v91, v91
    v_mfma_f32_16x16x32_bf16 v[80:83], a[72:75], a[8:11], v[80:83]
    v_exp_f32 v92, v92
    v_mfma_f32_16x16x32_bf16 v[80:83], a[76:79], a[12:15], v[80:83]
    buffer_load_dwordx4 v1, s[8:11], s7 offen offset:0 sc1 lds
    v_mfma_f32_16x16x32_bf16 v[84:87], a[76:79], a[28:31], v[68:71]
    ds_read_b128 a[84:87], v2 offset:54272
    v_cvt_pk_bf16_f32 v105, v90, v91
    v_mfma_f32_16x16x32_bf16 v[84:87], a[72:75], a[24:27], v[84:87]
    v_exp_f32 v93, v93
    v_mfma_f32_16x16x32_bf16 v[84:87], a[68:71], a[20:23], v[84:87]
    v_exp_f32 v94, v94
    v_mfma_f32_16x16x32_bf16 v[84:87], a[64:67], a[16:19], v[84:87]
    ds_read_b128 a[88:91], v2 offset:55296
    v_cvt_pk_bf16_f32 v108, v92, v93
    v_mfma_f32_16x16x32_bf16 v[88:91], a[64:67], a[32:35], v[72:75]
    buffer_load_dwordx4 v1, s[8:11], s7 offen offset:1024 sc1 lds
    v_mfma_f32_16x16x32_bf16 v[88:91], a[68:71], a[36:39], v[88:91]
    v_exp_f32 v95, v95
    v_mfma_f32_16x16x32_bf16 v[88:91], a[72:75], a[40:43], v[88:91]
    v_exp_f32 v80, v80
    v_mfma_f32_16x16x32_bf16 v[88:91], a[76:79], a[44:47], v[88:91]
    ds_read_b128 a[92:95], v2 offset:56320
    v_cvt_pk_bf16_f32 v109, v94, v95
    v_mfma_f32_16x16x32_bf16 v[92:95], a[76:79], a[60:63], v[76:79]
    v_exp_f32 v81, v81
    v_mfma_f32_16x16x32_bf16 v[92:95], a[72:75], a[56:59], v[92:95]
    v_exp_f32 v82, v82
    v_mfma_f32_16x16x32_bf16 v[92:95], a[68:71], a[52:55], v[92:95]
    buffer_load_dwordx4 v1, s[8:11], s7 offen offset:2048 sc1 lds
    v_mfma_f32_16x16x32_bf16 v[92:95], a[64:67], a[48:51], v[92:95]
    s_waitcnt lgkmcnt(0)
    v_add_f32 v36, v36, v80
    v_add_f32 v36, v36, v81
    v_mfma_f32_16x16x32_bf16 v[144:147], a[80:83], v[112:115], v[144:147]
    v_exp_f32 v83, v83
    v_mfma_f32_16x16x32_bf16 v[176:179], a[80:83], v[116:119], v[176:179]
    ds_read_b128 a[64:67], v2 offset:16384
    v_cvt_pk_bf16_f32 v98, v80, v81
    v_mfma_f32_16x16x32_bf16 v[180:183], a[84:87], v[116:119], v[180:183]
    v_add_f32 v36, v36, v82
    v_add_f32 v36, v36, v83
    v_mfma_f32_16x16x32_bf16 v[148:151], a[84:87], v[112:115], v[148:151]
    v_exp_f32 v84, v84
    v_mfma_f32_16x16x32_bf16 v[152:155], a[88:91], v[112:115], v[152:155]
    ds_read_b128 a[68:71], v2 offset:17408
    v_cvt_pk_bf16_f32 v99, v82, v83
    v_mfma_f32_16x16x32_bf16 v[156:159], a[92:95], v[112:115], v[156:159]
    buffer_load_dwordx4 v1, s[8:11], s7 offen offset:3072 sc1 lds
    v_mfma_f32_16x16x32_bf16 v[188:191], a[92:95], v[116:119], v[188:191]
    s_add_u32 m0, s59, 12288
    v_exp_f32 v85, v85
    v_mfma_f32_16x16x32_bf16 v[184:187], a[88:91], v[116:119], v[184:187]
    s_add_u32 s7, s56, 12288
    v_add_f32 v37, v37, v84
    v_add_f32 v37, v37, v85
    v_mfma_f32_16x16x32_bf16 v[216:219], a[88:91], v[120:123], v[216:219]
    v_exp_f32 v86, v86
    v_mfma_f32_16x16x32_bf16 v[220:223], a[92:95], v[120:123], v[220:223]
    ds_read_b128 a[72:75], v2 offset:20480
    v_cvt_pk_bf16_f32 v102, v84, v85
    v_mfma_f32_16x16x32_bf16 v[252:255], a[92:95], v[124:127], v[252:255]
    v_exp_f32 v87, v87
    v_mfma_f32_16x16x32_bf16 v[248:251], a[88:91], v[124:127], v[248:251]
    buffer_load_dwordx4 v1, s[8:11], s7 offen offset:0 sc1 lds
    v_mfma_f32_16x16x32_bf16 v[244:247], a[84:87], v[124:127], v[244:247]
    ds_read_b128 a[76:79], v2 offset:21504
    v_add_f32 v37, v37, v86
    v_mfma_f32_16x16x32_bf16 v[212:215], a[84:87], v[120:123], v[212:215]
    v_exp_f32 v88, v88
    v_mfma_f32_16x16x32_bf16 v[208:211], a[80:83], v[120:123], v[208:211]
    v_add_f32 v37, v37, v87
    v_cvt_pk_bf16_f32 v103, v86, v87
    v_mfma_f32_16x16x32_bf16 v[240:243], a[80:83], v[124:127], v[240:243]
    v_exp_f32 v89, v89
    v_mfma_f32_16x16x32_bf16 v[16:19], a[176:179], v[124:127], v[16:19]
    s_waitcnt lgkmcnt(0)
    v_exp_f32 v90, v90
    v_mfma_f32_16x16x32_bf16 v[80:83], a[64:67], a[0:3], v[64:67]
    buffer_load_dwordx4 v1, s[8:11], s7 offen offset:1024 sc1 lds
    v_mfma_f32_16x16x32_bf16 v[80:83], a[68:71], a[4:7], v[80:83]
    ds_read_b128 a[80:83], v2 offset:32768
    v_cvt_pk_bf16_f32 v106, v88, v89
    v_mfma_f32_16x16x32_bf16 v[80:83], a[72:75], a[8:11], v[80:83]
    v_exp_f32 v91, v91
    v_mfma_f32_16x16x32_bf16 v[80:83], a[76:79], a[12:15], v[80:83]
    v_exp_f32 v92, v92
    v_mfma_f32_16x16x32_bf16 v[84:87], a[76:79], a[28:31], v[68:71]
    v_exp_f32 v93, v93
    v_mfma_f32_16x16x32_bf16 v[84:87], a[72:75], a[24:27], v[84:87]
    ds_read_b128 a[84:87], v2 offset:33792
    v_cvt_pk_bf16_f32 v107, v90, v91
    v_mfma_f32_16x16x32_bf16 v[84:87], a[68:71], a[20:23], v[84:87]
    buffer_load_dwordx4 v1, s[8:11], s7 offen offset:2048 sc1 lds
    v_mfma_f32_16x16x32_bf16 v[84:87], a[64:67], a[16:19], v[84:87]
    v_exp_f32 v94, v94
    v_mfma_f32_16x16x32_bf16 v[88:91], a[64:67], a[32:35], v[72:75]
    ds_read_b128 a[88:91], v2 offset:34816
    v_cvt_pk_bf16_f32 v110, v92, v93
    v_mfma_f32_16x16x32_bf16 v[88:91], a[68:71], a[36:39], v[88:91]
    v_exp_f32 v95, v95
    v_mfma_f32_16x16x32_bf16 v[88:91], a[72:75], a[40:43], v[88:91]
    ds_read_b128 a[92:95], v2 offset:35840
    v_cvt_pk_bf16_f32 v111, v94, v95
    v_mfma_f32_16x16x32_bf16 v[88:91], a[76:79], a[44:47], v[88:91]
    v_exp_f32 v80, v80
    v_mfma_f32_16x16x32_bf16 v[92:95], a[76:79], a[60:63], v[76:79]
    buffer_load_dwordx4 v1, s[8:11], s7 offen offset:3072 sc1 lds
    v_mfma_f32_16x16x32_bf16 v[92:95], a[72:75], a[56:59], v[92:95]
    v_exp_f32 v81, v81
    v_mfma_f32_16x16x32_bf16 v[92:95], a[68:71], a[52:55], v[92:95]
    v_exp_f32 v82, v82
    v_mfma_f32_16x16x32_bf16 v[92:95], a[64:67], a[48:51], v[92:95]
    s_waitcnt lgkmcnt(0)
    v_add_f32 v36, v36, v80
    v_add_f32 v36, v36, v81
    v_mfma_f32_16x16x32_bf16 v[128:131], a[80:83], v[96:99], v[128:131]
    v_exp_f32 v83, v83
    v_mfma_f32_16x16x32_bf16 v[160:163], a[80:83], v[100:103], v[160:163]
    ds_read_b128 a[64:67], v2 offset:18432
    v_cvt_pk_bf16_f32 v112, v80, v81
    v_mfma_f32_16x16x32_bf16 v[164:167], a[84:87], v[100:103], v[164:167]
    v_add_f32 v36, v36, v82
    v_add_f32 v36, v36, v83
    v_mfma_f32_16x16x32_bf16 v[132:135], a[84:87], v[96:99], v[132:135]
    v_exp_f32 v84, v84
    v_mfma_f32_16x16x32_bf16 v[136:139], a[88:91], v[96:99], v[136:139]
    v_exp_f32 v85, v85
    v_mfma_f32_16x16x32_bf16 v[140:143], a[92:95], v[96:99], v[140:143]
    v_cvt_pk_bf16_f32 v113, v82, v83
    v_add_f32 v37, v37, v84
    v_mfma_f32_16x16x32_bf16 v[172:175], a[92:95], v[100:103], v[172:175]
    ds_read_b128 a[68:71], v2 offset:19456
    v_add_f32 v37, v37, v85
    v_mfma_f32_16x16x32_bf16 v[168:171], a[88:91], v[100:103], v[168:171]
    ds_read_b128 a[72:75], v2 offset:22528
    v_cvt_pk_bf16_f32 v116, v84, v85
    v_mfma_f32_16x16x32_bf16 v[200:203], a[88:91], v[104:107], v[200:203]
    v_exp_f32 v86, v86
    v_mfma_f32_16x16x32_bf16 v[204:207], a[92:95], v[104:107], v[204:207]
    s_sub_u32 s7, s56, 65536
    ds_read_b128 a[76:79], v2 offset:23552
    v_add_f32 v37, v37, v86
    v_mfma_f32_16x16x32_bf16 v[236:239], a[92:95], v[108:111], v[236:239]
L_tp17:
    s_cbranch_execz L_walk_end
    s_cmp_eq_u32 s56, s57
    v_exp_f32 v87, v87
    v_mfma_f32_16x16x32_bf16 v[232:235], a[88:91], v[108:111], v[232:235]
    s_cselect_b32 s56, s58, s7
    v_exp_f32 v88, v88
    v_mfma_f32_16x16x32_bf16 v[228:231], a[84:87], v[108:111], v[228:231]
    s_cselect_b32 s58, s62, s58
    v_exp_f32 v89, v89
    v_mfma_f32_16x16x32_bf16 v[196:199], a[84:87], v[104:107], v[196:199]
    s_xor_b32 s59, s59, 65536
    v_add_f32 v37, v37, v87
    v_cvt_pk_bf16_f32 v117, v86, v87
    v_mfma_f32_16x16x32_bf16 v[192:195], a[80:83], v[104:107], v[192:195]
    s_cmp_eq_u32 s56, s62
    v_exp_f32 v90, v90
    v_mfma_f32_16x16x32_bf16 v[224:227], a[80:83], v[108:111], v[224:227]
    s_cselect_b32 s59, s95, s59
    ds_read_b128 a[80:83], v2 offset:36864
    v_cvt_pk_bf16_f32 v120, v88, v89
    v_mfma_f32_16x16x32_bf16 v[12:15], a[176:179], v[104:107], v[12:15]
    s_xor_b32 s90, s90, 65536
    ds_read_b128 a[84:87], v2 offset:37888
    s_sub_u32 s3, s3, 1
    s_waitcnt lgkmcnt(2)
    v_mfma_f32_16x16x32_bf16 v[80:83], a[64:67], a[0:3], v[64:67]
    s_cmp_lg_u32 s3, 0
    v_exp_f32 v91, v91
    v_mfma_f32_16x16x32_bf16 v[80:83], a[68:71], a[4:7], v[80:83]
    ds_read_b128 a[88:91], v2 offset:38912
    v_cvt_pk_bf16_f32 v121, v90, v91
    v_mfma_f32_16x16x32_bf16 v[80:83], a[72:75], a[8:11], v[80:83]
    v_exp_f32 v92, v92
    v_mfma_f32_16x16x32_bf16 v[80:83], a[76:79], a[12:15], v[80:83]
    v_exp_f32 v93, v93
    v_mfma_f32_16x16x32_bf16 v[84:87], a[76:79], a[28:31], v[68:71]
    ds_read_b128 a[92:95], v2 offset:39936
    v_cvt_pk_bf16_f32 v124, v92, v93
    v_mfma_f32_16x16x32_bf16 v[84:87], a[72:75], a[24:27], v[84:87]
    v_exp_f32 v94, v94
    v_mfma_f32_16x16x32_bf16 v[84:87], a[68:71], a[20:23], v[84:87]
    v_exp_f32 v95, v95
    v_mfma_f32_16x16x32_bf16 v[84:87], a[64:67], a[16:19], v[84:87]
    v_exp_f32 v80, v80
    v_mfma_f32_16x16x32_bf16 v[88:91], a[64:67], a[32:35], v[72:75]
    v_exp_f32 v81, v81
    v_mfma_f32_16x16x32_bf16 v[88:91], a[68:71], a[36:39], v[88:91]
    v_cvt_pk_bf16_f32 v125, v94, v95
    v_add_f32 v36, v36, v80
    v_mfma_f32_16x16x32_bf16 v[88:91], a[72:75], a[40:43], v[88:91]
    v_exp_f32 v82, v82
    v_mfma_f32_16x16x32_bf16 v[88:91], a[76:79], a[44:47], v[88:91]
    v_xor_b32 v2, 0x10000, v2
    v_add_f32 v36, v36, v81
    v_mfma_f32_16x16x32_bf16 v[92:95], a[76:79], a[60:63], v[76:79]
    v_exp_f32 v83, v83
    v_mfma_f32_16x16x32_bf16 v[92:95], a[72:75], a[56:59], v[92:95]
    s_waitcnt vmcnt(0) lgkmcnt(0)
    s_barrier
    v_mfma_f32_16x16x32_bf16 v[92:95], a[68:71], a[52:55], v[92:95]
    v_cvt_pk_bf16_f32 v114, v80, v81
    v_add_f32 v36, v36, v82
    v_mfma_f32_16x16x32_bf16 v[92:95], a[64:67], a[48:51], v[92:95]
    v_add_f32 v36, v36, v83
    v_cvt_pk_bf16_f32 v115, v82, v83
    v_mfma_f32_16x16x32_bf16 v[144:147], a[80:83], v[96:99], v[144:147]
    s_cbranch_scc1 L_loop
L_tail:
    s_cmp_lg_u32 s60, 0
    s_cbranch_scc1 L_tail2
    s_and_b32 s7, s68, 0xfffffe00
    ds_read_b128 a[112:115], v2 offset:49152
    v_and_b32 v20, 0x180, v1
    v_mfma_f32_16x16x32_bf16 v[208:211], a[80:83], v[104:107], v[208:211]
    ds_read_b128 a[116:119], v2 offset:50176
    v_add_u32 v20, v20, v23
    v_mfma_f32_16x16x32_bf16 v[240:243], a[80:83], v[108:111], v[240:243]
    ds_read_b128 a[120:123], v2 offset:51200
    buffer_load_dword v24, v20, s[8:11], s7 offen sc1
    v_mfma_f32_16x16x32_bf16 v[244:247], a[84:87], v[108:111], v[244:247]
    ds_read_b128 a[124:127], v2 offset:52224
    v_accvgpr_write_b32 a160, -1
    v_mfma_f32_16x16x32_bf16 v[212:215], a[84:87], v[104:107], v[212:215]
    ds_read_b128 a[128:131], v2 offset:53248
    v_accvgpr_write_b32 a161, -1
    v_mfma_f32_16x16x32_bf16 v[216:219], a[88:91], v[104:107], v[216:219]
    v_accvgpr_write_b32 a162, -1
    v_accvgpr_write_b32 a163, -1
    s_bfe_u32 s74, s69, 0x60007
    s_lshl_b32 s74, s74, 2
    s_add_u32 s74, s74, s6
    s_lshl_b32 s74, s74, 2
    s_add_u32 s74, s74, s67
    s_lshl_b32 s74, s74, 13
    s_add_u32 s7, s74, 62916608
    v_mfma_f32_16x16x32_bf16 v[248:251], a[88:91], v[108:111], v[248:251]
    ds_read_b128 a[132:135], v2 offset:54272
    buffer_store_dwordx4 a[160:163], v1, s[8:11], s7 offen offset:0 sc1
    v_exp_f32 v88, v88
    v_exp_f32 v89, v89
    v_exp_f32 v90, v90
    v_exp_f32 v91, v91
    v_mfma_f32_16x16x32_bf16 v[252:255], a[92:95], v[108:111], v[252:255]
    ds_read_b128 a[136:139], v2 offset:55296
    v_cvt_pk_bf16_f32 v122, v88, v89
    v_cvt_pk_bf16_f32 v123, v90, v91
    v_mfma_f32_16x16x32_bf16 v[220:223], a[92:95], v[104:107], v[220:223]
    ds_read_b128 a[140:143], v2 offset:56320
    v_exp_f32 v92, v92
    v_mfma_f32_16x16x32_bf16 v[16:19], a[176:179], v[108:111], v[16:19]
    buffer_store_dwordx4 a[160:163], v1, s[8:11], s7 offen offset:1024 sc1
    s_waitcnt lgkmcnt(2)
    v_mfma_f32_16x16x32_bf16 v[192:195], a[112:115], v[120:123], v[192:195]
    s_add_u32 s7, s74, 62918656
    buffer_store_dwordx4 a[160:163], v1, s[8:11], s7 offen offset:0 sc1
    v_mfma_f32_16x16x32_bf16 v[196:199], a[116:119], v[120:123], v[196:199]
    v_exp_f32 v93, v93
    v_mfma_f32_16x16x32_bf16 v[200:203], a[120:123], v[120:123], v[200:203]
    v_exp_f32 v94, v94
    v_mfma_f32_16x16x32_bf16 v[204:207], a[124:127], v[120:123], v[204:207]
    v_exp_f32 v95, v95
    v_mfma_f32_16x16x32_bf16 v[208:211], a[128:131], v[120:123], v[208:211]
    v_cvt_pk_bf16_f32 v126, v92, v93
    v_cvt_pk_bf16_f32 v127, v94, v95
    v_mfma_f32_16x16x32_bf16 v[212:215], a[132:135], v[120:123], v[212:215]
    buffer_store_dwordx4 a[160:163], v1, s[8:11], s7 offen offset:1024 sc1
    s_waitcnt lgkmcnt(0)
    v_mfma_f32_16x16x32_bf16 v[216:219], a[136:139], v[120:123], v[216:219]
    s_add_u32 s7, s74, 62920704
    v_cvt_pk_bf16_f32 v192, v192, v193
    v_cvt_pk_bf16_f32 v193, v194, v195
    v_cvt_pk_bf16_f32 v194, v196, v197
    v_cvt_pk_bf16_f32 v195, v198, v199
    v_mfma_f32_16x16x32_bf16 v[220:223], a[140:143], v[120:123], v[220:223]
    ds_write_b128 v5, v[192:195] offset:0
    v_mfma_f32_16x16x32_bf16 v[224:227], a[112:115], v[124:127], v[224:227]
    buffer_store_dwordx4 a[160:163], v1, s[8:11], s7 offen offset:0 sc1
    v_cvt_pk_bf16_f32 v200, v200, v201
    v_cvt_pk_bf16_f32 v201, v202, v203
    v_cvt_pk_bf16_f32 v202, v204, v205
    v_cvt_pk_bf16_f32 v203, v206, v207
    v_mfma_f32_16x16x32_bf16 v[228:231], a[116:119], v[124:127], v[228:231]
    ds_write_b128 v5, v[200:203] offset:1024
    v_mfma_f32_16x16x32_bf16 v[232:235], a[120:123], v[124:127], v[232:235]
    v_cvt_pk_bf16_f32 v208, v208, v209
    v_cvt_pk_bf16_f32 v209, v210, v211
    v_mfma_f32_16x16x32_bf16 v[236:239], a[124:127], v[124:127], v[236:239]
    buffer_store_dwordx4 a[160:163], v1, s[8:11], s7 offen offset:1024 sc1
    v_cvt_pk_bf16_f32 v210, v212, v213
    v_cvt_pk_bf16_f32 v211, v214, v215
    v_mfma_f32_16x16x32_bf16 v[240:243], a[128:131], v[124:127], v[240:243]
    s_sub_u32 s26, 15, s5
    ds_write_b128 v5, v[208:211] offset:2048
    v_mfma_f32_16x16x32_bf16 v[244:247], a[132:135], v[124:127], v[244:247]
    s_bitcmp0_b32 s69, 9
    v_cvt_pk_bf16_f32 v216, v216, v217
    v_cvt_pk_bf16_f32 v217, v218, v219
    v_mfma_f32_16x16x32_bf16 v[248:251], a[136:139], v[124:127], v[248:251]
    s_cselect_b32 s26, s26, s5
    v_cvt_pk_bf16_f32 v218, v220, v221
    v_cvt_pk_bf16_f32 v219, v222, v223
    v_mfma_f32_16x16x32_bf16 v[252:255], a[140:143], v[124:127], v[252:255]
    s_lshl_b32 s26, s26, 1
    ds_write_b128 v5, v[216:219] offset:3072
    v_mfma_f32_16x16x32_bf16 v[12:15], a[176:179], v[120:123], v[12:15]
    s_and_b32 s7, s6, 1
    s_add_u32 s26, s26, s7
    s_lshl_b32 s26, s26, 2
    s_add_u32 s26, s26, s67
    s_lshl_b32 s26, s26, 6
    s_and_b32 s7, s4, 3
    s_add_u32 s26, s26, s7
    s_lshl_b32 s26, s26, 1
    s_lshr_b32 s7, s6, 1
    s_add_u32 s26, s26, s7
    s_lshl_b32 s26, s26, 7
    v_and_b32 v11, 0xf0, v1
    v_lshlrev_b32 v11, 6, v11
    v_lshrrev_b32 v26, 8, v1
    v_lshl_add_u32 v11, v26, 3, v11
    v_mfma_f32_16x16x32_bf16 v[16:19], a[176:179], v[124:127], v[16:19]
    buffer_load_dwordx2 a[164:165], v11, s[40:43], s26 offen offset:0
    v_cvt_pk_bf16_f32 v224, v224, v225
    v_cvt_pk_bf16_f32 v225, v226, v227
    v_cvt_pk_bf16_f32 v226, v228, v229
    v_cvt_pk_bf16_f32 v227, v230, v231
    v_mfma_f32_16x16x32_bf16 v[176:179], a[80:83], v[100:103], v[176:179]
    ds_write_b128 v5, v[224:227] offset:4096
    v_mfma_f32_16x16x32_bf16 v[180:183], a[84:87], v[100:103], v[180:183]
    v_exp_f32 v84, v84
    v_mfma_f32_16x16x32_bf16 v[148:151], a[84:87], v[96:99], v[148:151]
    buffer_load_dwordx2 a[166:167], v11, s[40:43], s26 offen offset:32
    v_exp_f32 v85, v85
    v_exp_f32 v86, v86
    v_exp_f32 v87, v87
    v_cvt_pk_bf16_f32 v232, v232, v233
    v_cvt_pk_bf16_f32 v233, v234, v235
    v_cvt_pk_bf16_f32 v234, v236, v237
    v_cvt_pk_bf16_f32 v235, v238, v239
    v_mfma_f32_16x16x32_bf16 v[152:155], a[88:91], v[96:99], v[152:155]
    ds_write_b128 v5, v[232:235] offset:5120
    v_add_f32 v37, v37, v84
    v_add_f32 v37, v37, v85
    v_cvt_pk_bf16_f32 v118, v84, v85
    v_add_f32 v37, v37, v86
    v_add_f32 v37, v37, v87
    v_cvt_pk_bf16_f32 v119, v86, v87
    v_mfma_f32_16x16x32_bf16 v[184:187], a[88:91], v[100:103], v[184:187]
    v_mul_f32 v38, 0x3e800000, v12
    v_mul_f32 v39, 0x3e800000, v16
    v_mfma_f32_16x16x32_bf16 v[188:191], a[92:95], v[100:103], v[188:191]
    buffer_load_dwordx2 a[168:169], v11, s[40:43], s26 offen offset:64
    v_cvt_pk_bf16_f32 v240, v240, v241
    v_cvt_pk_bf16_f32 v241, v242, v243
    v_cvt_pk_bf16_f32 v242, v244, v245
    v_cvt_pk_bf16_f32 v243, v246, v247
    v_mfma_f32_16x16x32_bf16 v[156:159], a[92:95], v[96:99], v[156:159]
    ds_write_b128 v5, v[240:243] offset:6144
    v_mfma_f32_16x16x32_bf16 v[128:131], a[112:115], v[112:115], v[128:131]
    v_permlane32_swap_b32 v36, v38
    v_permlane32_swap_b32 v37, v39
    v_mfma_f32_16x16x32_bf16 v[132:135], a[116:119], v[112:115], v[132:135]
    buffer_load_dwordx2 a[170:171], v11, s[40:43], s26 offen offset:96
    v_add_f32 v36, v36, v38
    v_add_f32 v37, v37, v39
    v_cvt_pk_bf16_f32 v248, v248, v249
    v_cvt_pk_bf16_f32 v249, v250, v251
    v_cvt_pk_bf16_f32 v250, v252, v253
    v_cvt_pk_bf16_f32 v251, v254, v255
    v_mfma_f32_16x16x32_bf16 v[136:139], a[120:123], v[112:115], v[136:139]
    ds_write_b128 v5, v[248:251] offset:7168
    v_mfma_f32_16x16x32_bf16 v[140:143], a[124:127], v[112:115], v[140:143]
    v_permlane16_swap_b32 v36, v37
    v_add_f32 v36, v36, v37
    v_lshrrev_b32 v10, 1, v0
    v_lshlrev_b32 v10, 10, v10
    v_and_b32 v11, 1, v0
    v_lshl_add_u32 v10, v11, 7, v10
    s_and_b32 s93, s4, 3
    s_lshl_b32 s93, s93, 8
    s_lshl_b32 s7, s67, 20
    s_add_u32 s7, s7, s93
    s_lshl_b32 s94, s5, 17
    s_add_u32 s7, s7, s94
    v_mfma_f32_16x16x32_bf16 v[144:147], a[128:131], v[112:115], v[144:147]
    ds_write_b32 v7, v36
    buffer_load_dword v30, v10, s[32:35], s7 offen
    v_mfma_f32_16x16x32_bf16 v[148:151], a[132:135], v[112:115], v[148:151]
    s_lshl_b32 s7, s31, 16
    s_add_u32 s7, s7, s93
    s_bitcmp0_b32 s4, 2
    v_mfma_f32_16x16x32_bf16 v[152:155], a[136:139], v[112:115], v[152:155]
    s_cselect_b32 s93, 57344, 4
    s_cselect_b32 s93, s93, 32768
    s_mul_i32 s94, s5, s93
    s_add_u32 s7, s7, s94
    s_sub_u32 s93, s93, 896
    v_min_u32 v10, s93, v10
    v_mfma_f32_16x16x32_bf16 v[156:159], a[140:143], v[112:115], v[156:159]
    buffer_load_dword v30, v10, s[36:39], s7 offen
    v_mfma_f32_16x16x32_bf16 v[160:163], a[112:115], v[116:119], v[160:163]
    s_waitcnt lgkmcnt(0)
    s_barrier
    v_mfma_f32_16x16x32_bf16 v[164:167], a[116:119], v[116:119], v[164:167]
    s_lshr_b32 s7, s2, 3
    ds_read_b128 a[80:83], v6 offset:0
    ds_read2_b32 v[80:81], v9 offset0:0 offset1:128
    v_lshlrev_b32 v10, 5, v0
    v_add_u32 v10, s7, v10
    v_lshlrev_b32 v10, 7, v10
    v_min_u32 v10, L_end-L_tail2, v10
    v_add_u32 v10, L_tail2-L_pc, v10
    v_mfma_f32_16x16x32_bf16 v[168:171], a[120:123], v[116:119], v[168:171]
    ds_read2_b32 v[82:83], v9 offset0:16 offset1:144
    global_load_dword v30, v10, s[100:101]
    v_mfma_f32_16x16x32_bf16 v[172:175], a[124:127], v[116:119], v[172:175]
    ds_read2_b32 v[84:85], v8 offset0:0 offset1:128
    ds_read2_b32 v[86:87], v8 offset0:64 offset1:192
    v_mfma_f32_16x16x32_bf16 v[176:179], a[128:131], v[116:119], v[176:179]
    ds_read_b128 a[84:87], v6 offset:1024
    ds_read_b128 a[88:91], v6 offset:2048
    v_mfma_f32_16x16x32_bf16 v[180:183], a[132:135], v[116:119], v[180:183]
    ds_read_b128 a[92:95], v6 offset:3072
    ds_read_b128 a[96:99], v6 offset:4096
    v_mfma_f32_16x16x32_bf16 v[184:187], a[136:139], v[116:119], v[184:187]
    ds_read_b128 a[100:103], v6 offset:5120
    ds_read_b128 a[104:107], v6 offset:6144
    v_mfma_f32_16x16x32_bf16 v[188:191], a[140:143], v[116:119], v[188:191]
    ds_read_b128 a[108:111], v6 offset:7168
    ds_read_b128 a[192:195], v2 offset:0
    s_waitcnt lgkmcnt(6)
    v_mfma_f32_16x16x32_bf16 v[128:131], a[182:185], a[80:83], v[128:131]
    v_add_f32 v80, v80, v81
    v_add_f32 v82, v82, v83
    v_mfma_f32_16x16x32_bf16 v[132:135], a[180:183], a[80:83], v[132:135]
    v_add_f32 v84, v84, v85
    v_add_f32 v86, v86, v87
    v_mfma_f32_16x16x32_bf16 v[136:139], a[182:185], a[84:87], v[136:139]
    v_rcp_f32 v80, v80
    v_mfma_f32_16x16x32_bf16 v[140:143], a[180:183], a[84:87], v[140:143]
    v_rcp_f32 v82, v82
    v_mfma_f32_16x16x32_bf16 v[144:147], a[182:185], a[88:91], v[144:147]
    v_min_f32 v85, v84, v86
    v_add_f32 v87, v84, v86
    v_mfma_f32_16x16x32_bf16 v[148:151], a[180:183], a[88:91], v[148:151]
    v_cmp_nle_f32 vcc, 0x2b800000, v85
    s_mov_b64 s[74:75], vcc
    s_waitcnt lgkmcnt(0)
    v_mfma_f32_16x16x32_bf16 v[152:155], a[182:185], a[92:95], v[152:155]
    v_cmp_nge_f32 vcc, 0x53800000, v87
    s_or_b64 vcc, vcc, s[74:75]
    v_mfma_f32_16x16x32_bf16 v[156:159], a[180:183], a[92:95], v[156:159]
    s_andn2_b64 vcc, vcc, s[96:97]
    s_cbranch_vccnz L_redo
    s_mov_b32 s60, 1
    v_mfma_f32_16x16x32_bf16 v[160:163], a[182:185], a[96:99], v[160:163]
    ds_read_b128 a[196:199], v2 offset:1024
    ds_read_b128 a[200:203], v2 offset:4096
    v_mfma_f32_16x16x32_bf16 v[164:167], a[180:183], a[96:99], v[164:167]
    ds_read_b128 a[204:207], v2 offset:5120
    ds_read_b128 a[208:211], v2 offset:2048
    v_mfma_f32_16x16x32_bf16 v[168:171], a[182:185], a[100:103], v[168:171]
    ds_read_b128 a[212:215], v2 offset:3072
    ds_read_b128 a[216:219], v2 offset:6144
    v_mfma_f32_16x16x32_bf16 v[172:175], a[180:183], a[100:103], v[172:175]
    ds_read_b128 a[220:223], v2 offset:7168
    ds_read_b128 a[224:227], v2 offset:16384
    v_mfma_f32_16x16x32_bf16 v[176:179], a[182:185], a[104:107], v[176:179]
    ds_read_b128 a[228:231], v2 offset:17408
    ds_read_b128 a[232:235], v2 offset:20480
    v_mfma_f32_16x16x32_bf16 v[180:183], a[180:183], a[104:107], v[180:183]
    ds_read_b128 a[236:239], v2 offset:21504
    ds_read_b128 a[0:3], v27 offset:0
    s_add_u32 s70, s5, 1
    v_mfma_f32_16x16x32_bf16 v[184:187], a[182:185], a[108:111], v[184:187]
    ds_read_b128 a[4:7], v27 offset:1024
    s_mov_b32 s92, s61
    v_mfma_f32_16x16x32_bf16 v[188:191], a[180:183], a[108:111], v[188:191]
    ds_read_b128 a[8:11], v27 offset:2048
    s_mov_b32 s63, 99
    ds_read_b128 a[12:15], v27 offset:3072
    s_and_b32 s93, s68, 0xfffffe00
    ds_read_b128 a[16:19], v27 offset:8192
    s_sub_u32 s61, s70, 1
    ds_read_b128 a[20:23], v27 offset:9216
    s_mul_i32 s61, s61, 1441792
    ds_read_b128 a[24:27], v27 offset:10240
    s_lshl_b32 s7, s4, 15
    ds_read_b128 a[28:31], v27 offset:11264
    s_add_u32 s61, s61, s7
    ds_read_b128 a[32:35], v28 offset:0
    s_lshl_b32 s7, s91, 12
    ds_read_b128 a[36:39], v28 offset:1024
    s_add_u32 s61, s61, s7
    ds_read_b128 a[40:43], v28 offset:2048
    s_and_b32 s7, s6, 1
    ds_read_b128 a[44:47], v28 offset:3072
    s_lshl_b32 s7, s7, 10
    ds_read_b128 a[48:51], v28 offset:8192
    s_add_u32 s61, s61, s7
    ds_read_b128 a[52:55], v28 offset:9216
    s_add_u32 s61, s61, 37748736
    ds_read_b128 a[56:59], v28 offset:10240
    s_mov_b32 s3, s70
    ds_read_b128 a[60:63], v28 offset:11264
    s_mov_b32 s71, s56
    s_mov_b32 s72, s90
    s_mov_b32 s73, s58
    v_or_b32 v5, 0x10000, v5
    v_or_b32 v6, 0x10000, v6
    v_or_b32 v7, 0x10000, v7
    v_or_b32 v8, 0x10000, v8
    v_or_b32 v9, 0x10000, v9
    s_waitcnt vmcnt(13)
    v_cmp_gt_u32 vcc, 1, v24
    s_cbranch_vccnz L_poll_h
L_back_h:
    s_waitcnt lgkmcnt(0)
    s_barrier
    s_add_u32 m0, s59, 0
    s_add_u32 s7, s56, 0
    buffer_load_dwordx4 v1, s[8:11], s7 offen offset:0 sc1 lds
    v_pk_mul_f32 v[128:129], v[128:129], v[80:81] op_sel_hi:[1,0]
    v_pk_mul_f32 v[130:131], v[130:131], v[80:81] op_sel_hi:[1,0]
    v_pk_mul_f32 v[132:133], v[132:133], v[80:81] op_sel_hi:[1,0]
    v_pk_mul_f32 v[134:135], v[134:135], v[80:81] op_sel_hi:[1,0]
    v_cvt_pk_bf16_f32 v192, v128, v129
    v_cvt_pk_bf16_f32 v193, v130, v131
    v_cvt_pk_bf16_f32 v194, v132, v133
    v_cvt_pk_bf16_f32 v195, v134, v135
    v_pk_mul_f32 v[136:137], v[136:137], v[80:81] op_sel_hi:[1,0]
    v_pk_mul_f32 v[138:139], v[138:139], v[80:81] op_sel_hi:[1,0]
    v_pk_mul_f32 v[140:141], v[140:141], v[80:81] op_sel_hi:[1,0]
    v_pk_mul_f32 v[142:143], v[142:143], v[80:81] op_sel_hi:[1,0]
    v_cvt_pk_bf16_f32 v200, v136, v137
    v_cvt_pk_bf16_f32 v201, v138, v139
    v_cvt_pk_bf16_f32 v202, v140, v141
    v_cvt_pk_bf16_f32 v203, v142, v143
    buffer_load_dwordx4 v1, s[8:11], s7 offen offset:1024 sc1 lds
    v_pk_mul_f32 v[144:145], v[144:145], v[80:81] op_sel_hi:[1,0]
    v_pk_mul_f32 v[146:147], v[146:147], v[80:81] op_sel_hi:[1,0]
    v_pk_mul_f32 v[148:149], v[148:149], v[80:81] op_sel_hi:[1,0]
    v_pk_mul_f32 v[150:151], v[150:151], v[80:81] op_sel_hi:[1,0]
    v_cvt_pk_bf16_f32 v208, v144, v145
    v_cvt_pk_bf16_f32 v209, v146, v147
    v_cvt_pk_bf16_f32 v210, v148, v149
    v_cvt_pk_bf16_f32 v211, v150, v151
    v_pk_mul_f32 v[152:153], v[152:153], v[80:81] op_sel_hi:[1,0]
    v_pk_mul_f32 v[154:155], v[154:155], v[80:81] op_sel_hi:[1,0]
    v_pk_mul_f32 v[156:157], v[156:157], v[80:81] op_sel_hi:[1,0]
    v_pk_mul_f32 v[158:159], v[158:159], v[80:81] op_sel_hi:[1,0]
    v_cvt_pk_bf16_f32 v216, v152, v153
    v_cvt_pk_bf16_f32 v217, v154, v155
    v_cvt_pk_bf16_f32 v218, v156, v157
    v_cvt_pk_bf16_f32 v219, v158, v159
    v_pk_mul_f32 v[160:161], v[160:161], v[82:83] op_sel_hi:[1,0]
    buffer_load_dwordx4 v1, s[8:11], s7 offen offset:2048 sc1 lds
    v_pk_mul_f32 v[162:163], v[162:163], v[82:83] op_sel_hi:[1,0]
    v_pk_mul_f32 v[164:165], v[164:165], v[82:83] op_sel_hi:[1,0]
    v_pk_mul_f32 v[166:167], v[166:167], v[82:83] op_sel_hi:[1,0]
    v_cvt_pk_bf16_f32 v196, v160, v161
    v_cvt_pk_bf16_f32 v197, v162, v163
    v_cvt_pk_bf16_f32 v198, v164, v165
    v_cvt_pk_bf16_f32 v199, v166, v167
    v_pk_mul_f32 v[168:169], v[168:169], v[82:83] op_sel_hi:[1,0]
    v_pk_mul_f32 v[170:171], v[170:171], v[82:83] op_sel_hi:[1,0]
    v_pk_mul_f32 v[172:173], v[172:173], v[82:83] op_sel_hi:[1,0]
    v_pk_mul_f32 v[174:175], v[174:175], v[82:83] op_sel_hi:[1,0]
    v_cvt_pk_bf16_f32 v204, v168, v169
    v_cvt_pk_bf16_f32 v205, v170, v171
    v_cvt_pk_bf16_f32 v206, v172, v173
    v_cvt_pk_bf16_f32 v207, v174, v175
    v_pk_mul_f32 v[176:177], v[176:177], v[82:83] op_sel_hi:[1,0]
    buffer_load_dwordx4 v1, s[8:11], s7 offen offset:3072 sc1 lds
    v_pk_mul_f32 v[178:179], v[178:179], v[82:83] op_sel_hi:[1,0]
    v_pk_mul_f32 v[180:181], v[180:181], v[82:83] op_sel_hi:[1,0]
    v_pk_mul_f32 v[182:183], v[182:183], v[82:83] op_sel_hi:[1,0]
    v_cvt_pk_bf16_f32 v212, v176, v177
    v_cvt_pk_bf16_f32 v213, v178, v179
    v_cvt_pk_bf16_f32 v214, v180, v181
    v_cvt_pk_bf16_f32 v215, v182, v183
    v_pk_mul_f32 v[184:185], v[184:185], v[82:83] op_sel_hi:[1,0]
    v_pk_mul_f32 v[186:187], v[186:187], v[82:83] op_sel_hi:[1,0]
    v_pk_mul_f32 v[188:189], v[188:189], v[82:83] op_sel_hi:[1,0]
    v_pk_mul_f32 v[190:191], v[190:191], v[82:83] op_sel_hi:[1,0]
    v_cvt_pk_bf16_f32 v220, v184, v185
    v_cvt_pk_bf16_f32 v221, v186, v187
    v_cvt_pk_bf16_f32 v222, v188, v189
    v_cvt_pk_bf16_f32 v223, v190, v191
    v_mov_b64 v[36:37], 0
    v_mov_b64 v[38:39], 0
    s_cmp_lg_u32 s96, 0
    s_cbranch_scc1 L_unredo
L_unredo_back:
    s_mov_b64 exec, 0
    s_bitcmp1_b32 s4, 2
    s_cbranch_scc1 L_walk2_odd
    s_cmp_eq_u32 s6, 0
    s_cbranch_scc1 L_tp21
    s_cmp_eq_u32 s6, 1
    s_cbranch_scc1 L_tp22
    s_cmp_eq_u32 s6, 2
    s_cbranch_scc1 L_tp20
    s_branch L_tp19
L_walk2_odd:
    s_cmp_eq_u32 s6, 0
    s_cbranch_scc1 L_tp23
    s_cmp_eq_u32 s6, 1
    s_cbranch_scc1 L_tp24
    s_cmp_eq_u32 s6, 2
    s_cbranch_scc1 L_tp25
    s_branch L_tp19
L_walk2_end:
    s_mov_b64 exec, -1
L_setblock:
L_block:
L_tp18:
    s_cbranch_execz L_walk_end
    s_cmp_lg_u32 s91, 0
    s_cbranch_scc1 L_diag1
    s_branch L_diag0
    s_nop 0
    s_nop 0
    s_nop 0
L_tail2:
L_tp19:
    s_cbranch_execz L_walk2_end
    s_add_u32 s28, s23, 0
    ds_read_b128 a[112:115], v2 offset:49152
    s_add_u32 m0, s14, 147456
    v_mfma_f32_16x16x32_bf16 v[208:211], a[80:83], v[104:107], v[208:211]
    s_add_u32 s29, s28, 0
    ds_read_b128 a[116:119], v2 offset:50176
    ds_read_b128 a[120:123], v2 offset:51200
    v_mfma_f32_16x16x32_bf16 v[240:243], a[80:83], v[108:111], v[240:243]
    buffer_load_dwordx4 v3, s[36:39], s29 offen lds
    v_mfma_f32_16x16x32_bf16 v[244:247], a[84:87], v[108:111], v[244:247]
    s_add_u32 m0, s14, 148480
    ds_read_b128 a[124:127], v2 offset:52224
    s_add_u32 s29, s28, 4096
    v_mfma_f32_16x16x32_bf16 v[212:215], a[84:87], v[104:107], v[212:215]
    ds_read_b128 a[128:131], v2 offset:53248
    ds_read_b128 a[132:135], v2 offset:54272
    v_mfma_f32_16x16x32_bf16 v[216:219], a[88:91], v[104:107], v[216:219]
    v_exp_f32 v88, v88
    v_mfma_f32_16x16x32_bf16 v[248:251], a[88:91], v[108:111], v[248:251]
    v_exp_f32 v89, v89
    v_exp_f32 v90, v90
    v_exp_f32 v91, v91
    v_mfma_f32_16x16x32_bf16 v[252:255], a[92:95], v[108:111], v[252:255]
    ds_read_b128 a[136:139], v2 offset:55296
    v_cvt_pk_bf16_f32 v122, v88, v89
    v_cvt_pk_bf16_f32 v123, v90, v91
    v_mfma_f32_16x16x32_bf16 v[220:223], a[92:95], v[104:107], v[220:223]
    ds_read_b128 a[140:143], v2 offset:56320
    buffer_load_dwordx4 v4, s[36:39], s29 offen lds
    v_mfma_f32_16x16x32_bf16 v[16:19], a[176:179], v[108:111], v[16:19]
    s_add_u32 m0, s14, 149504
    s_add_u32 s29, s28, 8192
    s_waitcnt lgkmcnt(1)
    v_exp_f32 v92, v92
    v_mfma_f32_16x16x32_bf16 v[192:195], a[112:115], v[120:123], v[192:195]
    v_exp_f32 v93, v93
    v_mfma_f32_16x16x32_bf16 v[196:199], a[116:119], v[120:123], v[196:199]
    v_exp_f32 v94, v94
    v_mfma_f32_16x16x32_bf16 v[200:203], a[120:123], v[120:123], v[200:203]
    buffer_load_dwordx4 v3, s[36:39], s29 offen lds
    v_mfma_f32_16x16x32_bf16 v[204:207], a[124:127], v[120:123], v[204:207]
    s_add_u32 m0, s14, 150528
    v_exp_f32 v95, v95
    v_mfma_f32_16x16x32_bf16 v[208:211], a[128:131], v[120:123], v[208:211]
    s_add_u32 s29, s28, 12288
    v_cvt_pk_bf16_f32 v126, v92, v93
    v_cvt_pk_bf16_f32 v127, v94, v95
    v_mfma_f32_16x16x32_bf16 v[212:215], a[132:135], v[120:123], v[212:215]
    v_cvt_pk_bf16_f32 v192, v192, v193
    v_cvt_pk_bf16_f32 v193, v194, v195
    v_mfma_f32_16x16x32_bf16 v[216:219], a[136:139], v[120:123], v[216:219]
    s_waitcnt lgkmcnt(0)
    v_cvt_pk_bf16_f32 v194, v196, v197
    v_cvt_pk_bf16_f32 v195, v198, v199
    v_mfma_f32_16x16x32_bf16 v[220:223], a[140:143], v[120:123], v[220:223]
    ds_write_b128 v5, v[192:195] offset:0
    v_mfma_f32_16x16x32_bf16 v[224:227], a[112:115], v[124:127], v[224:227]
    buffer_load_dwordx4 v4, s[36:39], s29 offen lds
    v_cvt_pk_bf16_f32 v200, v200, v201
    v_cvt_pk_bf16_f32 v201, v202, v203
    v_cvt_pk_bf16_f32 v202, v204, v205
    v_cvt_pk_bf16_f32 v203, v206, v207
    v_mfma_f32_16x16x32_bf16 v[228:231], a[116:119], v[124:127], v[228:231]
    s_add_u32 s28, s23, 65536
    ds_write_b128 v5, v[200:203] offset:1024
    v_mfma_f32_16x16x32_bf16 v[232:235], a[120:123], v[124:127], v[232:235]
    s_add_u32 m0, s14, 16384
    v_cvt_pk_bf16_f32 v208, v208, v209
    v_cvt_pk_bf16_f32 v209, v210, v211
    v_mfma_f32_16x16x32_bf16 v[236:239], a[124:127], v[124:127], v[236:239]
    s_add_u32 s29, s28, 0
    v_cvt_pk_bf16_f32 v210, v212, v213
    v_cvt_pk_bf16_f32 v211, v214, v215
    v_mfma_f32_16x16x32_bf16 v[240:243], a[128:131], v[124:127], v[240:243]
    ds_write_b128 v5, v[208:211] offset:2048
    v_mfma_f32_16x16x32_bf16 v[244:247], a[132:135], v[124:127], v[244:247]
    buffer_load_dwordx4 v3, s[36:39], s29 offen lds
    v_mfma_f32_16x16x32_bf16 v[248:251], a[136:139], v[124:127], v[248:251]
    s_add_u32 m0, s14, 17408
    v_cvt_pk_bf16_f32 v216, v216, v217
    v_cvt_pk_bf16_f32 v217, v218, v219
    v_cvt_pk_bf16_f32 v218, v220, v221
    v_cvt_pk_bf16_f32 v219, v222, v223
    v_mfma_f32_16x16x32_bf16 v[252:255], a[140:143], v[124:127], v[252:255]
    s_add_u32 s29, s28, 4096
    ds_write_b128 v5, v[216:219] offset:3072
    v_mfma_f32_16x16x32_bf16 v[12:15], a[176:179], v[120:123], v[12:15]
    v_cvt_pk_bf16_f32 v224, v224, v225
    v_cvt_pk_bf16_f32 v225, v226, v227
    v_mfma_f32_16x16x32_bf16 v[16:19], a[176:179], v[124:127], v[16:19]
    v_cvt_pk_bf16_f32 v226, v228, v229
    v_cvt_pk_bf16_f32 v227, v230, v231
    v_mfma_f32_16x16x32_bf16 v[176:179], a[80:83], v[100:103], v[176:179]
    ds_write_b128 v5, v[224:227] offset:4096
    buffer_load_dwordx4 v4, s[36:39], s29 offen lds
    v_mfma_f32_16x16x32_bf16 v[180:183], a[84:87], v[100:103], v[180:183]
    s_add_u32 m0, s14, 18432
    v_exp_f32 v84, v84
    v_mfma_f32_16x16x32_bf16 v[148:151], a[84:87], v[96:99], v[148:151]
    s_add_u32 s29, s28, 8192
    v_exp_f32 v85, v85
    v_exp_f32 v86, v86
    v_exp_f32 v87, v87
    v_cvt_pk_bf16_f32 v232, v232, v233
    v_cvt_pk_bf16_f32 v233, v234, v235
    v_cvt_pk_bf16_f32 v234, v236, v237
    v_cvt_pk_bf16_f32 v235, v238, v239
    v_mfma_f32_16x16x32_bf16 v[152:155], a[88:91], v[96:99], v[152:155]
    ds_write_b128 v5, v[232:235] offset:5120
    v_add_f32 v37, v37, v84
    v_add_f32 v37, v37, v85
    v_cvt_pk_bf16_f32 v118, v84, v85
    v_add_f32 v37, v37, v86
    v_add_f32 v37, v37, v87
    v_cvt_pk_bf16_f32 v119, v86, v87
    v_mfma_f32_16x16x32_bf16 v[184:187], a[88:91], v[100:103], v[184:187]
    v_mul_f32 v38, 0x3e800000, v12
    v_mul_f32 v39, 0x3e800000, v16
    v_mfma_f32_16x16x32_bf16 v[188:191], a[92:95], v[100:103], v[188:191]
    buffer_load_dwordx4 v3, s[36:39], s29 offen lds
    v_cvt_pk_bf16_f32 v240, v240, v241
    v_cvt_pk_bf16_f32 v241, v242, v243
    v_cvt_pk_bf16_f32 v242, v244, v245
    v_cvt_pk_bf16_f32 v243, v246, v247
    v_mfma_f32_16x16x32_bf16 v[156:159], a[92:95], v[96:99], v[156:159]
    s_add_u32 m0, s14, 19456
    ds_write_b128 v5, v[240:243] offset:6144
    v_mfma_f32_16x16x32_bf16 v[128:131], a[112:115], v[112:115], v[128:131]
L_tp20:
    s_cbranch_execz L_walk2_end
    s_add_u32 s29, s28, 12288
    v_permlane32_swap_b32 v36, v38
    v_permlane32_swap_b32 v37, v39
    v_mfma_f32_16x16x32_bf16 v[132:135], a[116:119], v[112:115], v[132:135]
    v_add_f32 v36, v36, v38
    v_add_f32 v37, v37, v39
    v_cvt_pk_bf16_f32 v248, v248, v249
    v_cvt_pk_bf16_f32 v249, v250, v251
    v_cvt_pk_bf16_f32 v250, v252, v253
    v_cvt_pk_bf16_f32 v251, v254, v255
    v_mfma_f32_16x16x32_bf16 v[136:139], a[120:123], v[112:115], v[136:139]
    ds_write_b128 v5, v[248:251] offset:7168
    v_mfma_f32_16x16x32_bf16 v[140:143], a[124:127], v[112:115], v[140:143]
    buffer_load_dwordx4 v4, s[36:39], s29 offen lds
    v_permlane16_swap_b32 v36, v37
    v_add_f32 v36, v36, v37
    v_mfma_f32_16x16x32_bf16 v[144:147], a[128:131], v[112:115], v[144:147]
    s_add_u32 s28, s23, 131072
    ds_write_b32 v7, v36
    v_mfma_f32_16x16x32_bf16 v[148:151], a[132:135], v[112:115], v[148:151]
    s_add_u32 m0, s14, 49152
    s_add_u32 s29, s28, 0
    v_mfma_f32_16x16x32_bf16 v[152:155], a[136:139], v[112:115], v[152:155]
    v_mfma_f32_16x16x32_bf16 v[156:159], a[140:143], v[112:115], v[156:159]
    v_mfma_f32_16x16x32_bf16 v[160:163], a[112:115], v[116:119], v[160:163]
    s_waitcnt lgkmcnt(0)
    s_barrier
    v_mfma_f32_16x16x32_bf16 v[164:167], a[116:119], v[116:119], v[164:167]
    ds_read_b128 a[80:83], v6 offset:0
    ds_read2_b32 v[80:81], v9 offset0:0 offset1:128
    v_mfma_f32_16x16x32_bf16 v[168:171], a[120:123], v[116:119], v[168:171]
    ds_read2_b32 v[82:83], v9 offset0:16 offset1:144
    ds_read2_b32 v[84:85], v8 offset0:0 offset1:128
    v_mfma_f32_16x16x32_bf16 v[172:175], a[124:127], v[116:119], v[172:175]
    buffer_load_dwordx4 v3, s[36:39], s29 offen lds
    v_mfma_f32_16x16x32_bf16 v[176:179], a[128:131], v[116:119], v[176:179]
    s_add_u32 m0, s14, 50176
    ds_read2_b32 v[86:87], v8 offset0:64 offset1:192
    ds_read_b128 a[84:87], v6 offset:1024
    s_add_u32 s29, s28, 4096
    v_mfma_f32_16x16x32_bf16 v[180:183], a[132:135], v[116:119], v[180:183]
    ds_read_b128 a[88:91], v6 offset:2048
    ds_read_b128 a[92:95], v6 offset:3072
    v_mfma_f32_16x16x32_bf16 v[184:187], a[136:139], v[116:119], v[184:187]
    buffer_load_dwordx4 v4, s[36:39], s29 offen lds
    v_mfma_f32_16x16x32_bf16 v[188:191], a[140:143], v[116:119], v[188:191]
    s_add_u32 m0, s14, 51200
    ds_read_b128 a[96:99], v6 offset:4096
    ds_read_b128 a[100:103], v6 offset:5120
    s_add_u32 s29, s28, 8192
    s_waitcnt lgkmcnt(4)
    v_mfma_f32_16x16x32_bf16 v[128:131], a[182:185], a[80:83], v[128:131]
    ds_read_b128 a[104:107], v6 offset:6144
    v_add_f32 v80, v80, v81
    v_mfma_f32_16x16x32_bf16 v[132:135], a[180:183], a[80:83], v[132:135]
    ds_read_b128 a[108:111], v6 offset:7168
    buffer_load_dwordx4 v3, s[36:39], s29 offen lds
    v_mfma_f32_16x16x32_bf16 v[136:139], a[182:185], a[84:87], v[136:139]
    s_add_u32 m0, s14, 52224
    s_add_u32 s29, s28, 12288
    v_add_f32 v82, v82, v83
    v_mfma_f32_16x16x32_bf16 v[140:143], a[180:183], a[84:87], v[140:143]
    buffer_load_dwordx4 v4, s[36:39], s29 offen lds
    s_waitcnt lgkmcnt(1)
    v_mfma_f32_16x16x32_bf16 v[144:147], a[182:185], a[88:91], v[144:147]
    v_add_f32 v84, v84, v85
    v_add_f32 v86, v86, v87
    v_mfma_f32_16x16x32_bf16 v[148:151], a[180:183], a[88:91], v[148:151]
    v_rcp_f32 v80, v80
    v_mfma_f32_16x16x32_bf16 v[152:155], a[182:185], a[92:95], v[152:155]
    v_rcp_f32 v82, v82
    v_mfma_f32_16x16x32_bf16 v[156:159], a[180:183], a[92:95], v[156:159]
    v_min_f32 v85, v84, v86
    v_add_f32 v87, v84, v86
    v_mfma_f32_16x16x32_bf16 v[160:163], a[182:185], a[96:99], v[160:163]
    v_cmp_nle_f32 vcc, 0x2b800000, v85
    s_mov_b64 s[74:75], vcc
    v_cmp_nge_f32 vcc, 0x53800000, v87
    s_or_b64 vcc, vcc, s[74:75]
    s_andn2_b64 vcc, vcc, s[96:97]
    s_cbranch_vccnz L_redo
    v_mfma_f32_16x16x32_bf16 v[164:167], a[180:183], a[96:99], v[164:167]
    v_mfma_f32_16x16x32_bf16 v[168:171], a[182:185], a[100:103], v[168:171]
    v_mfma_f32_16x16x32_bf16 v[172:175], a[180:183], a[100:103], v[172:175]
    v_mfma_f32_16x16x32_bf16 v[176:179], a[182:185], a[104:107], v[176:179]
    v_mfma_f32_16x16x32_bf16 v[180:183], a[180:183], a[104:107], v[180:183]
    s_waitcnt lgkmcnt(0)
    v_mfma_f32_16x16x32_bf16 v[184:187], a[182:185], a[108:111], v[184:187]
    v_mfma_f32_16x16x32_bf16 v[188:191], a[180:183], a[108:111], v[188:191]
    s_add_u32 s7, s61, 0
    v_pk_mul_f32 v[128:129], v[128:129], v[80:81] op_sel_hi:[1,0]
    v_pk_mul_f32 v[130:131], v[130:131], v[80:81] op_sel_hi:[1,0]
    v_pk_mul_f32 v[132:133], v[132:133], v[80:81] op_sel_hi:[1,0]
    v_pk_mul_f32 v[134:135], v[134:135], v[80:81] op_sel_hi:[1,0]
    v_cvt_pk_bf16_f32 v128, v128, v129
    v_cvt_pk_bf16_f32 v129, v130, v131
    v_cvt_pk_bf16_f32 v130, v132, v133
    v_cvt_pk_bf16_f32 v131, v134, v135
    buffer_store_dwordx4 v[128:131], v1, s[8:11], s7 offen offset:0 sc1
    s_add_u32 s7, s61, 8192
    v_pk_mul_f32 v[136:137], v[136:137], v[80:81] op_sel_hi:[1,0]
    v_pk_mul_f32 v[138:139], v[138:139], v[80:81] op_sel_hi:[1,0]
    v_pk_mul_f32 v[140:141], v[140:141], v[80:81] op_sel_hi:[1,0]
    v_pk_mul_f32 v[142:143], v[142:143], v[80:81] op_sel_hi:[1,0]
    v_cvt_pk_bf16_f32 v136, v136, v137
    v_cvt_pk_bf16_f32 v137, v138, v139
    v_cvt_pk_bf16_f32 v138, v140, v141
    v_cvt_pk_bf16_f32 v139, v142, v143
    buffer_store_dwordx4 v[136:139], v1, s[8:11], s7 offen offset:0 sc1
    s_add_u32 s7, s61, 16384
    v_pk_mul_f32 v[144:145], v[144:145], v[80:81] op_sel_hi:[1,0]
    v_pk_mul_f32 v[146:147], v[146:147], v[80:81] op_sel_hi:[1,0]
    v_pk_mul_f32 v[148:149], v[148:149], v[80:81] op_sel_hi:[1,0]
    v_pk_mul_f32 v[150:151], v[150:151], v[80:81] op_sel_hi:[1,0]
    v_cvt_pk_bf16_f32 v144, v144, v145
    v_cvt_pk_bf16_f32 v145, v146, v147
    v_cvt_pk_bf16_f32 v146, v148, v149
    v_cvt_pk_bf16_f32 v147, v150, v151
    buffer_store_dwordx4 v[144:147], v1, s[8:11], s7 offen offset:0 sc1
    s_add_u32 s7, s61, 24576
    v_pk_mul_f32 v[152:153], v[152:153], v[80:81] op_sel_hi:[1,0]
    v_pk_mul_f32 v[154:155], v[154:155], v[80:81] op_sel_hi:[1,0]
    v_pk_mul_f32 v[156:157], v[156:157], v[80:81] op_sel_hi:[1,0]
    v_pk_mul_f32 v[158:159], v[158:159], v[80:81] op_sel_hi:[1,0]
    v_cvt_pk_bf16_f32 v152, v152, v153
    v_cvt_pk_bf16_f32 v153, v154, v155
    v_cvt_pk_bf16_f32 v154, v156, v157
    v_cvt_pk_bf16_f32 v155, v158, v159
    buffer_store_dwordx4 v[152:155], v1, s[8:11], s7 offen offset:0 sc1
    s_add_u32 s7, s61, 0
    v_pk_mul_f32 v[160:161], v[160:161], v[82:83] op_sel_hi:[1,0]
    v_pk_mul_f32 v[162:163], v[162:163], v[82:83] op_sel_hi:[1,0]
    v_pk_mul_f32 v[164:165], v[164:165], v[82:83] op_sel_hi:[1,0]
    v_pk_mul_f32 v[166:167], v[166:167], v[82:83] op_sel_hi:[1,0]
    v_cvt_pk_bf16_f32 v160, v160, v161
    v_cvt_pk_bf16_f32 v161, v162, v163
    v_cvt_pk_bf16_f32 v162, v164, v165
    v_cvt_pk_bf16_f32 v163, v166, v167
    buffer_store_dwordx4 v[160:163], v1, s[8:11], s7 offen offset:2048 sc1
    s_add_u32 s7, s61, 8192
    v_pk_mul_f32 v[168:169], v[168:169], v[82:83] op_sel_hi:[1,0]
    v_pk_mul_f32 v[170:171], v[170:171], v[82:83] op_sel_hi:[1,0]
    v_pk_mul_f32 v[172:173], v[172:173], v[82:83] op_sel_hi:[1,0]
    v_pk_mul_f32 v[174:175], v[174:175], v[82:83] op_sel_hi:[1,0]
    v_cvt_pk_bf16_f32 v168, v168, v169
    v_cvt_pk_bf16_f32 v169, v170, v171
    v_cvt_pk_bf16_f32 v170, v172, v173
    v_cvt_pk_bf16_f32 v171, v174, v175
    buffer_store_dwordx4 v[168:171], v1, s[8:11], s7 offen offset:2048 sc1
    s_add_u32 s7, s61, 16384
    v_pk_mul_f32 v[176:177], v[176:177], v[82:83] op_sel_hi:[1,0]
    v_pk_mul_f32 v[178:179], v[178:179], v[82:83] op_sel_hi:[1,0]
    v_pk_mul_f32 v[180:181], v[180:181], v[82:83] op_sel_hi:[1,0]
    v_pk_mul_f32 v[182:183], v[182:183], v[82:83] op_sel_hi:[1,0]
    v_cvt_pk_bf16_f32 v176, v176, v177
    v_cvt_pk_bf16_f32 v177, v178, v179
    v_cvt_pk_bf16_f32 v178, v180, v181
    v_cvt_pk_bf16_f32 v179, v182, v183
    buffer_store_dwordx4 v[176:179], v1, s[8:11], s7 offen offset:2048 sc1
    s_add_u32 s7, s61, 24576
    v_pk_mul_f32 v[184:185], v[184:185], v[82:83] op_sel_hi:[1,0]
    v_pk_mul_f32 v[186:187], v[186:187], v[82:83] op_sel_hi:[1,0]
    v_pk_mul_f32 v[188:189], v[188:189], v[82:83] op_sel_hi:[1,0]
    v_pk_mul_f32 v[190:191], v[190:191], v[82:83] op_sel_hi:[1,0]
    v_cvt_pk_bf16_f32 v184, v184, v185
    v_cvt_pk_bf16_f32 v185, v186, v187
    v_cvt_pk_bf16_f32 v186, v188, v189
    v_cvt_pk_bf16_f32 v187, v190, v191
    buffer_store_dwordx4 v[184:187], v1, s[8:11], s7 offen offset:2048 sc1
L_attn_done:
    s_bitcmp1_b32 s4, 2
    s_cbranch_scc1 L_p3_odd
    s_and_b32 s1, s6, 1
    s_lshl_b32 s1, s1, 2
    s_xor_b32 s1, s1, s67
    s_lshl_b32 s30, s1, 10
    s_lshl_b32 s1, s1, 9
    s_add_u32 s1, s1, 131072
    v_add_u32 v13, s1, v21
    v_xor_b32 v14, 0x200, v13
    v_xor_b32 v15, 0x400, v13
    v_xor_b32 v16, 0x600, v13
    v_lshrrev_b32 v27, 6, v1
    v_and_b32 v26, 7, v27
    v_lshlrev_b32 v26, 5, v26
    v_lshl_add_u32 v26, v27, 8, v26
    v_and_b32 v27, 24, v21
    v_add_u32 v26, v27, v26
    s_lshr_b32 s1, s6, 1
    s_lshl_b32 s1, s1, 7
    v_xor_b32 v26, s1, v26
    v_add_u32 v17, 0x20000, v26
    v_xor_b32 v18, 32, v17
    v_xor_b32 v19, 64, v17
    v_xor_b32 v20, 0x60, v17
    v_and_b32 v23, 12, v23
    s_lshl_b32 s1, s67, 18
    s_add_u32 s12, s17, s1
    s_lshl_b32 s1, s67, 20
    s_add_u32 s13, s13, s1
    s_mov_b32 s24, 32768
    s_and_b32 s22, s4, 3
    s_lshl_b32 s22, s22, 1
    s_and_b32 s93, s68, 0xffffff80
    s_add_u32 s93, s93, 32
    s_mov_b32 s27, 0
    s_xor_b32 s22, s22, 0
    s_add_u32 s30, s30, 32768
    s_waitcnt vmcnt(12) lgkmcnt(0)
    s_barrier
    s_add_u32 m0, s14, 65536
    s_add_u32 s0, s25, 49152
    buffer_load_dwordx4 v1, s[8:11], s0 offen offset:0 sc1 lds
    ds_read_b64_tr_b16 a[32:33], v17 offset:16384
    ds_read_b64_tr_b16 a[34:35], v17 offset:20480
    ds_read_b64_tr_b16 a[36:37], v17 offset:24576
    ds_read_b64_tr_b16 a[38:39], v17 offset:28672
    buffer_load_dwordx4 v1, s[8:11], s0 offen offset:1024 sc1 lds
    ds_read_b64 a[0:1], v13 offset:0
    ds_read_b64 a[2:3], v13 offset:4096
    ds_read_b64 a[4:5], v13 offset:8192
    ds_read_b64 a[6:7], v13 offset:12288
    buffer_load_dwordx4 v1, s[8:11], s0 offen offset:2048 sc1 lds
    ds_read_b64 a[8:9], v14 offset:0
    ds_read_b64 a[10:11], v14 offset:4096
    ds_read_b64 a[12:13], v14 offset:8192
    ds_read_b64 a[14:15], v14 offset:12288
    buffer_load_dwordx4 v1, s[8:11], s0 offen offset:3072 sc1 lds
    ds_read_b64 a[16:17], v15 offset:0
    ds_read_b64 a[18:19], v15 offset:4096
    ds_read_b64 a[20:21], v15 offset:8192
    ds_read_b64 a[22:23], v15 offset:12288
    ds_read_b64 a[24:25], v16 offset:0
    ds_read_b64 a[26:27], v16 offset:4096
    ds_read_b64 a[28:29], v16 offset:8192
    ds_read_b64 a[30:31], v16 offset:12288
    ds_read_b64_tr_b16 a[40:41], v18 offset:16384
    ds_read_b64_tr_b16 a[42:43], v18 offset:20480
    ds_read_b64_tr_b16 a[44:45], v18 offset:24576
    ds_read_b64_tr_b16 a[46:47], v18 offset:28672
    ds_read_b64_tr_b16 a[48:49], v19 offset:16384
    ds_read_b64_tr_b16 a[50:51], v19 offset:20480
    ds_read_b64_tr_b16 a[52:53], v19 offset:24576
    ds_read_b64_tr_b16 a[54:55], v19 offset:28672
    ds_read_b64_tr_b16 a[56:57], v20 offset:16384
    ds_read_b64_tr_b16 a[58:59], v20 offset:20480
    ds_read_b64_tr_b16 a[60:61], v20 offset:24576
    ds_read_b64_tr_b16 a[62:63], v20 offset:28672
    v_add_u32 v13, 4294836224, v13
    v_add_u32 v14, 4294836224, v14
    v_add_u32 v15, 4294836224, v15
    v_add_u32 v16, 4294836224, v16
    v_add_u32 v17, 4294836224, v17
    v_add_u32 v18, 4294836224, v18
    v_add_u32 v19, 4294836224, v19
    v_add_u32 v20, 4294836224, v20
    s_waitcnt lgkmcnt(0)
    v_mfma_f32_16x16x32_bf16 v[64:67], a[32:35], a[0:3], 0
    ds_read_b64_tr_b16 a[96:97], v17 offset:16384
    ds_read_b64_tr_b16 a[98:99], v17 offset:20480
    v_mfma_f32_16x16x32_bf16 v[64:67], a[36:39], a[4:7], v[64:67]
    s_add_u32 s28, s23, 196608
    ds_read_b64_tr_b16 a[100:101], v17 offset:24576
    ds_read_b64_tr_b16 a[102:103], v17 offset:28672
    s_add_u32 m0, s14, 81920
    v_mfma_f32_16x16x32_bf16 v[80:83], a[36:39], a[12:15], 0
    s_add_u32 s29, s28, 0
    buffer_load_dwordx4 v3, s[36:39], s29 offen lds
    v_mfma_f32_16x16x32_bf16 v[80:83], a[32:35], a[8:11], v[80:83]
    s_add_u32 m0, s14, 82944
    ds_read_b64 a[64:65], v13 offset:0
    ds_read_b64 a[66:67], v13 offset:4096
    s_add_u32 s29, s28, 4096
    v_mfma_f32_16x16x32_bf16 v[96:99], a[32:35], a[16:19], 0
    ds_read_b64 a[68:69], v13 offset:8192
    ds_read_b64 a[70:71], v13 offset:12288
    v_mfma_f32_16x16x32_bf16 v[96:99], a[36:39], a[20:23], v[96:99]
    buffer_load_dwordx4 v4, s[36:39], s29 offen lds
    v_mfma_f32_16x16x32_bf16 v[112:115], a[36:39], a[28:31], 0
    s_add_u32 m0, s14, 83968
    ds_read_b64 a[72:73], v14 offset:0
    ds_read_b64 a[74:75], v14 offset:4096
    s_add_u32 s29, s28, 8192
    v_mfma_f32_16x16x32_bf16 v[112:115], a[32:35], a[24:27], v[112:115]
    ds_read_b64 a[76:77], v14 offset:8192
    ds_read_b64 a[78:79], v14 offset:12288
    v_mfma_f32_16x16x32_bf16 v[116:119], a[40:43], a[24:27], 0
    ds_read_b64 a[80:81], v15 offset:0
    ds_read_b64 a[82:83], v15 offset:4096
    v_mfma_f32_16x16x32_bf16 v[116:119], a[44:47], a[28:31], v[116:119]
    buffer_load_dwordx4 v3, s[36:39], s29 offen lds
    v_mfma_f32_16x16x32_bf16 v[100:103], a[44:47], a[20:23], 0
    s_add_u32 m0, s14, 84992
    ds_read_b64 a[84:85], v15 offset:8192
    ds_read_b64 a[86:87], v15 offset:12288
    s_add_u32 s29, s28, 12288
    v_mfma_f32_16x16x32_bf16 v[100:103], a[40:43], a[16:19], v[100:103]
    ds_read_b64 a[88:89], v16 offset:0
    ds_read_b64 a[90:91], v16 offset:4096
    v_mfma_f32_16x16x32_bf16 v[84:87], a[40:43], a[8:11], 0
    ds_read_b64 a[92:93], v16 offset:8192
    ds_read_b64 a[94:95], v16 offset:12288
    v_mfma_f32_16x16x32_bf16 v[84:87], a[44:47], a[12:15], v[84:87]
    buffer_load_dwordx4 v4, s[36:39], s29 offen lds
    v_mfma_f32_16x16x32_bf16 v[68:71], a[44:47], a[4:7], 0
    s_add_u32 m0, s14, 98304
    ds_read_b64_tr_b16 a[104:105], v18 offset:16384
    ds_read_b64_tr_b16 a[106:107], v18 offset:20480
    s_add_u32 s0, s25, 65536
    v_mfma_f32_16x16x32_bf16 v[68:71], a[40:43], a[0:3], v[68:71]
    ds_read_b64_tr_b16 a[108:109], v18 offset:24576
    ds_read_b64_tr_b16 a[110:111], v18 offset:28672
    v_mfma_f32_16x16x32_bf16 v[72:75], a[48:51], a[0:3], 0
    ds_read_b64_tr_b16 a[112:113], v19 offset:16384
    v_mfma_f32_16x16x32_bf16 v[72:75], a[52:55], a[4:7], v[72:75]
    buffer_load_dwordx4 v1, s[8:11], s0 offen offset:0 sc1 lds
    v_mfma_f32_16x16x32_bf16 v[88:91], a[52:55], a[12:15], 0
    ds_read_b64_tr_b16 a[114:115], v19 offset:20480
    v_mfma_f32_16x16x32_bf16 v[88:91], a[48:51], a[8:11], v[88:91]
    ds_read_b64_tr_b16 a[116:117], v19 offset:24576
    v_mfma_f32_16x16x32_bf16 v[104:107], a[48:51], a[16:19], 0
    buffer_load_dwordx4 v1, s[8:11], s0 offen offset:1024 sc1 lds
    v_mfma_f32_16x16x32_bf16 v[104:107], a[52:55], a[20:23], v[104:107]
    ds_read_b64_tr_b16 a[118:119], v19 offset:28672
    v_mfma_f32_16x16x32_bf16 v[120:123], a[52:55], a[28:31], 0
    ds_read_b64_tr_b16 a[120:121], v20 offset:16384
    v_mfma_f32_16x16x32_bf16 v[120:123], a[48:51], a[24:27], v[120:123]
    ds_read_b64_tr_b16 a[122:123], v20 offset:20480
    v_mfma_f32_16x16x32_bf16 v[124:127], a[56:59], a[24:27], 0
    buffer_load_dwordx4 v1, s[8:11], s0 offen offset:2048 sc1 lds
    v_mfma_f32_16x16x32_bf16 v[124:127], a[60:63], a[28:31], v[124:127]
    ds_read_b64_tr_b16 a[124:125], v20 offset:24576
    v_mfma_f32_16x16x32_bf16 v[108:111], a[60:63], a[20:23], 0
    ds_read_b64_tr_b16 a[126:127], v20 offset:28672
    v_add_u32 v13, 32768, v13
    v_mfma_f32_16x16x32_bf16 v[108:111], a[56:59], a[16:19], v[108:111]
    v_add_u32 v14, 32768, v14
    v_add_u32 v15, 32768, v15
    v_mfma_f32_16x16x32_bf16 v[92:95], a[56:59], a[8:11], 0
    buffer_load_dwordx4 v1, s[8:11], s0 offen offset:3072 sc1 lds
    v_mfma_f32_16x16x32_bf16 v[92:95], a[60:63], a[12:15], v[92:95]
    v_add_u32 v16, 32768, v16
    v_add_u32 v17, 32768, v17
    v_mfma_f32_16x16x32_bf16 v[76:79], a[60:63], a[4:7], 0
    v_add_u32 v18, 32768, v18
    v_add_u32 v19, 32768, v19
    v_mfma_f32_16x16x32_bf16 v[76:79], a[56:59], a[0:3], v[76:79]
    v_add_u32 v20, 32768, v20
    s_waitcnt vmcnt(12) lgkmcnt(0)
    s_barrier
    v_mfma_f32_16x16x32_bf16 v[64:67], a[96:99], a[64:67], v[64:67]
    ds_read_b64_tr_b16 a[32:33], v17 offset:16384
    ds_read_b64_tr_b16 a[34:35], v17 offset:20480
    v_mfma_f32_16x16x32_bf16 v[64:67], a[100:103], a[68:71], v[64:67]
    s_add_u32 s7, s68, 32
    ds_read_b64_tr_b16 a[36:37], v17 offset:24576
    ds_read_b64_tr_b16 a[38:39], v17 offset:28672
    v_mfma_f32_16x16x32_bf16 v[80:83], a[100:103], a[76:79], v[80:83]
    ds_read_b64 a[0:1], v13 offset:0
    ds_read_b64 a[2:3], v13 offset:4096
    v_mfma_f32_16x16x32_bf16 v[80:83], a[96:99], a[72:75], v[80:83]
    ds_read_b64 a[4:5], v13 offset:8192
    ds_read_b64 a[6:7], v13 offset:12288
    buffer_store_dword v25, v22, s[8:11], s7 offen sc1
    v_mfma_f32_16x16x32_bf16 v[96:99], a[96:99], a[80:83], v[96:99]
    ds_read_b64 a[8:9], v14 offset:0
    ds_read_b64 a[10:11], v14 offset:4096
    v_mfma_f32_16x16x32_bf16 v[96:99], a[100:103], a[84:87], v[96:99]
    ds_read_b64 a[12:13], v14 offset:8192
    ds_read_b64 a[14:15], v14 offset:12288
    v_mfma_f32_16x16x32_bf16 v[112:115], a[100:103], a[92:95], v[112:115]
    ds_read_b64 a[16:17], v15 offset:0
    ds_read_b64 a[18:19], v15 offset:4096
    buffer_store_dword v25, v22, s[8:11], s69 offen sc1
    v_mfma_f32_16x16x32_bf16 v[112:115], a[96:99], a[88:91], v[112:115]
    s_add_u32 s28, s23, 262144
    ds_read_b64 a[20:21], v15 offset:8192
    ds_read_b64 a[22:23], v15 offset:12288
    s_add_u32 m0, s14, 114688
    v_mfma_f32_16x16x32_bf16 v[116:119], a[104:107], a[88:91], v[116:119]
    s_add_u32 s29, s28, 0
    ds_read_b64 a[24:25], v16 offset:0
    ds_read_b64 a[26:27], v16 offset:4096
    v_mfma_f32_16x16x32_bf16 v[116:119], a[108:111], a[92:95], v[116:119]
    ds_read_b64 a[28:29], v16 offset:8192
    ds_read_b64 a[30:31], v16 offset:12288
    buffer_load_dwordx4 v3, s[36:39], s29 offen lds
    v_mfma_f32_16x16x32_bf16 v[100:103], a[108:111], a[84:87], v[100:103]
    s_add_u32 m0, s14, 115712
    ds_read_b64_tr_b16 a[40:41], v18 offset:16384
    ds_read_b64_tr_b16 a[42:43], v18 offset:20480
    s_add_u32 s29, s28, 4096
    v_mfma_f32_16x16x32_bf16 v[100:103], a[104:107], a[80:83], v[100:103]
    ds_read_b64_tr_b16 a[44:45], v18 offset:24576
    ds_read_b64_tr_b16 a[46:47], v18 offset:28672
    v_mfma_f32_16x16x32_bf16 v[84:87], a[104:107], a[72:75], v[84:87]
    ds_read_b64_tr_b16 a[48:49], v19 offset:16384
    buffer_load_dwordx4 v4, s[36:39], s29 offen lds
    v_mfma_f32_16x16x32_bf16 v[84:87], a[108:111], a[76:79], v[84:87]
    s_add_u32 m0, s14, 116736
    ds_read_b64_tr_b16 a[50:51], v19 offset:20480
    s_add_u32 s29, s28, 8192
    v_mfma_f32_16x16x32_bf16 v[68:71], a[108:111], a[68:71], v[68:71]
    ds_read_b64_tr_b16 a[52:53], v19 offset:24576
    v_mfma_f32_16x16x32_bf16 v[68:71], a[104:107], a[64:67], v[68:71]
    ds_read_b64_tr_b16 a[54:55], v19 offset:28672
    buffer_load_dwordx4 v3, s[36:39], s29 offen lds
    v_mfma_f32_16x16x32_bf16 v[72:75], a[112:115], a[64:67], v[72:75]
    s_add_u32 m0, s14, 117760
    ds_read_b64_tr_b16 a[56:57], v20 offset:16384
    s_add_u32 s29, s28, 12288
    v_mfma_f32_16x16x32_bf16 v[72:75], a[116:119], a[68:71], v[72:75]
    ds_read_b64_tr_b16 a[58:59], v20 offset:20480
    v_mfma_f32_16x16x32_bf16 v[88:91], a[116:119], a[76:79], v[88:91]
    ds_read_b64_tr_b16 a[60:61], v20 offset:24576
    buffer_load_dwordx4 v4, s[36:39], s29 offen lds
    v_mfma_f32_16x16x32_bf16 v[88:91], a[112:115], a[72:75], v[88:91]
    s_add_u32 m0, s14, 131072
    ds_read_b64_tr_b16 a[62:63], v20 offset:28672
    s_add_u32 s0, s25, 81920
    v_mfma_f32_16x16x32_bf16 v[104:107], a[112:115], a[80:83], v[104:107]
    buffer_load_dwordx4 v1, s[8:11], s0 offen offset:0 sc1 lds
    v_mfma_f32_16x16x32_bf16 v[104:107], a[116:119], a[84:87], v[104:107]
    v_add_u32 v13, 32768, v13
    v_add_u32 v14, 32768, v14
    v_mfma_f32_16x16x32_bf16 v[120:123], a[116:119], a[92:95], v[120:123]
    v_add_u32 v15, 32768, v15
    v_add_u32 v16, 32768, v16
    v_mfma_f32_16x16x32_bf16 v[120:123], a[112:115], a[88:91], v[120:123]
    buffer_load_dwordx4 v1, s[8:11], s0 offen offset:1024 sc1 lds
    v_mfma_f32_16x16x32_bf16 v[124:127], a[120:123], a[88:91], v[124:127]
    v_add_u32 v17, 32768, v17
    v_add_u32 v18, 32768, v18
    v_mfma_f32_16x16x32_bf16 v[124:127], a[124:127], a[92:95], v[124:127]
    v_add_u32 v19, 32768, v19
    v_add_u32 v20, 32768, v20
    v_mfma_f32_16x16x32_bf16 v[108:111], a[124:127], a[84:87], v[108:111]
    buffer_load_dwordx4 v1, s[8:11], s0 offen offset:2048 sc1 lds
    v_mfma_f32_16x16x32_bf16 v[108:111], a[120:123], a[80:83], v[108:111]
    v_mfma_f32_16x16x32_bf16 v[92:95], a[120:123], a[72:75], v[92:95]
    v_mfma_f32_16x16x32_bf16 v[92:95], a[124:127], a[76:79], v[92:95]
    buffer_load_dwordx4 v1, s[8:11], s0 offen offset:3072 sc1 lds
    v_mfma_f32_16x16x32_bf16 v[76:79], a[124:127], a[68:71], v[76:79]
    v_mfma_f32_16x16x32_bf16 v[76:79], a[120:123], a[64:67], v[76:79]
    s_waitcnt vmcnt(14) lgkmcnt(0)
    s_barrier
    v_mfma_f32_16x16x32_bf16 v[64:67], a[32:35], a[0:3], v[64:67]
    ds_read_b64_tr_b16 a[96:97], v17 offset:16384
    ds_read_b64_tr_b16 a[98:99], v17 offset:20480
    v_mfma_f32_16x16x32_bf16 v[64:67], a[36:39], a[4:7], v[64:67]
    s_add_u32 s28, s23, 327680
    ds_read_b64_tr_b16 a[100:101], v17 offset:24576
    ds_read_b64_tr_b16 a[102:103], v17 offset:28672
    s_add_u32 m0, s14, 147456
    v_mfma_f32_16x16x32_bf16 v[80:83], a[36:39], a[12:15], v[80:83]
    s_add_u32 s29, s28, 0
    buffer_load_dwordx4 v3, s[36:39], s29 offen lds
    v_mfma_f32_16x16x32_bf16 v[80:83], a[32:35], a[8:11], v[80:83]
    s_add_u32 m0, s14, 148480
    ds_read_b64 a[64:65], v13 offset:0
    ds_read_b64 a[66:67], v13 offset:4096
    s_add_u32 s29, s28, 4096
    v_mfma_f32_16x16x32_bf16 v[96:99], a[32:35], a[16:19], v[96:99]
    ds_read_b64 a[68:69], v13 offset:8192
    ds_read_b64 a[70:71], v13 offset:12288
    v_mfma_f32_16x16x32_bf16 v[96:99], a[36:39], a[20:23], v[96:99]
    buffer_load_dwordx4 v4, s[36:39], s29 offen lds
    v_mfma_f32_16x16x32_bf16 v[112:115], a[36:39], a[28:31], v[112:115]
    s_add_u32 m0, s14, 149504
    ds_read_b64 a[72:73], v14 offset:0
    ds_read_b64 a[74:75], v14 offset:4096
    s_add_u32 s29, s28, 8192
    v_mfma_f32_16x16x32_bf16 v[112:115], a[32:35], a[24:27], v[112:115]
    ds_read_b64 a[76:77], v14 offset:8192
    ds_read_b64 a[78:79], v14 offset:12288
    v_mfma_f32_16x16x32_bf16 v[116:119], a[40:43], a[24:27], v[116:119]
    ds_read_b64 a[80:81], v15 offset:0
    ds_read_b64 a[82:83], v15 offset:4096
    v_mfma_f32_16x16x32_bf16 v[116:119], a[44:47], a[28:31], v[116:119]
    buffer_load_dwordx4 v3, s[36:39], s29 offen lds
    v_mfma_f32_16x16x32_bf16 v[100:103], a[44:47], a[20:23], v[100:103]
    s_add_u32 m0, s14, 150528
    ds_read_b64 a[84:85], v15 offset:8192
    ds_read_b64 a[86:87], v15 offset:12288
    s_add_u32 s29, s28, 12288
    v_mfma_f32_16x16x32_bf16 v[100:103], a[40:43], a[16:19], v[100:103]
    ds_read_b64 a[88:89], v16 offset:0
    ds_read_b64 a[90:91], v16 offset:4096
    v_mfma_f32_16x16x32_bf16 v[84:87], a[40:43], a[8:11], v[84:87]
    ds_read_b64 a[92:93], v16 offset:8192
    ds_read_b64 a[94:95], v16 offset:12288
    v_mfma_f32_16x16x32_bf16 v[84:87], a[44:47], a[12:15], v[84:87]
    buffer_load_dwordx4 v4, s[36:39], s29 offen lds
    v_mfma_f32_16x16x32_bf16 v[68:71], a[44:47], a[4:7], v[68:71]
    s_add_u32 m0, s14, 0
    ds_read_b64_tr_b16 a[104:105], v18 offset:16384
    ds_read_b64_tr_b16 a[106:107], v18 offset:20480
    s_add_u32 s0, s25, 98304
    v_mfma_f32_16x16x32_bf16 v[68:71], a[40:43], a[0:3], v[68:71]
    ds_read_b64_tr_b16 a[108:109], v18 offset:24576
    ds_read_b64_tr_b16 a[110:111], v18 offset:28672
    v_mfma_f32_16x16x32_bf16 v[72:75], a[48:51], a[0:3], v[72:75]
    ds_read_b64_tr_b16 a[112:113], v19 offset:16384
    v_mfma_f32_16x16x32_bf16 v[72:75], a[52:55], a[4:7], v[72:75]
    buffer_load_dwordx4 v1, s[8:11], s0 offen offset:0 sc1 lds
    v_mfma_f32_16x16x32_bf16 v[88:91], a[52:55], a[12:15], v[88:91]
    ds_read_b64_tr_b16 a[114:115], v19 offset:20480
    v_mfma_f32_16x16x32_bf16 v[88:91], a[48:51], a[8:11], v[88:91]
    ds_read_b64_tr_b16 a[116:117], v19 offset:24576
    v_mfma_f32_16x16x32_bf16 v[104:107], a[48:51], a[16:19], v[104:107]
    buffer_load_dwordx4 v1, s[8:11], s0 offen offset:1024 sc1 lds
    v_mfma_f32_16x16x32_bf16 v[104:107], a[52:55], a[20:23], v[104:107]
    ds_read_b64_tr_b16 a[118:119], v19 offset:28672
    v_mfma_f32_16x16x32_bf16 v[120:123], a[52:55], a[28:31], v[120:123]
    ds_read_b64_tr_b16 a[120:121], v20 offset:16384
    v_mfma_f32_16x16x32_bf16 v[120:123], a[48:51], a[24:27], v[120:123]
    ds_read_b64_tr_b16 a[122:123], v20 offset:20480
    v_mfma_f32_16x16x32_bf16 v[124:127], a[56:59], a[24:27], v[124:127]
    buffer_load_dwordx4 v1, s[8:11], s0 offen offset:2048 sc1 lds
    v_mfma_f32_16x16x32_bf16 v[124:127], a[60:63], a[28:31], v[124:127]
    ds_read_b64_tr_b16 a[124:125], v20 offset:24576
    v_mfma_f32_16x16x32_bf16 v[108:111], a[60:63], a[20:23], v[108:111]
    ds_read_b64_tr_b16 a[126:127], v20 offset:28672
    v_add_u32 v13, 32768, v13
    v_mfma_f32_16x16x32_bf16 v[108:111], a[56:59], a[16:19], v[108:111]
    v_add_u32 v14, 32768, v14
    v_add_u32 v15, 32768, v15
    v_mfma_f32_16x16x32_bf16 v[92:95], a[56:59], a[8:11], v[92:95]
    buffer_load_dwordx4 v1, s[8:11], s0 offen offset:3072 sc1 lds
    v_mfma_f32_16x16x32_bf16 v[92:95], a[60:63], a[12:15], v[92:95]
    v_add_u32 v16, 32768, v16
    v_add_u32 v17, 32768, v17
    v_mfma_f32_16x16x32_bf16 v[76:79], a[60:63], a[4:7], v[76:79]
    v_add_u32 v18, 32768, v18
    v_add_u32 v19, 32768, v19
    v_mfma_f32_16x16x32_bf16 v[76:79], a[56:59], a[0:3], v[76:79]
    v_add_u32 v20, 32768, v20
    s_waitcnt vmcnt(12) lgkmcnt(0)
    s_barrier
    v_mfma_f32_16x16x32_bf16 v[64:67], a[96:99], a[64:67], v[64:67]
    ds_read_b64_tr_b16 a[32:33], v17 offset:16384
    ds_read_b64_tr_b16 a[34:35], v17 offset:20480
    v_mfma_f32_16x16x32_bf16 v[64:67], a[100:103], a[68:71], v[64:67]
    s_add_u32 s28, s23, 393216
    ds_read_b64_tr_b16 a[36:37], v17 offset:24576
    ds_read_b64_tr_b16 a[38:39], v17 offset:28672
    s_add_u32 m0, s14, 16384
    v_mfma_f32_16x16x32_bf16 v[80:83], a[100:103], a[76:79], v[80:83]
L_tp21:
    s_cbranch_execz L_walk2_end
    s_add_u32 s29, s28, 0
    buffer_load_dwordx4 v3, s[36:39], s29 offen lds
    v_mfma_f32_16x16x32_bf16 v[80:83], a[96:99], a[72:75], v[80:83]
    s_add_u32 m0, s14, 17408
    ds_read_b64 a[0:1], v13 offset:0
    ds_read_b64 a[2:3], v13 offset:4096
    s_add_u32 s29, s28, 4096
    v_mfma_f32_16x16x32_bf16 v[96:99], a[96:99], a[80:83], v[96:99]
    ds_read_b64 a[4:5], v13 offset:8192
    ds_read_b64 a[6:7], v13 offset:12288
    v_mfma_f32_16x16x32_bf16 v[96:99], a[100:103], a[84:87], v[96:99]
    buffer_load_dwordx4 v4, s[36:39], s29 offen lds
    v_mfma_f32_16x16x32_bf16 v[112:115], a[100:103], a[92:95], v[112:115]
    s_add_u32 m0, s14, 18432
    ds_read_b64 a[8:9], v14 offset:0
    ds_read_b64 a[10:11], v14 offset:4096
    s_add_u32 s29, s28, 8192
    v_mfma_f32_16x16x32_bf16 v[112:115], a[96:99], a[88:91], v[112:115]
    ds_read_b64 a[12:13], v14 offset:8192
    ds_read_b64 a[14:15], v14 offset:12288
    v_mfma_f32_16x16x32_bf16 v[116:119], a[104:107], a[88:91], v[116:119]
    ds_read_b64 a[16:17], v15 offset:0
    ds_read_b64 a[18:19], v15 offset:4096
    v_mfma_f32_16x16x32_bf16 v[116:119], a[108:111], a[92:95], v[116:119]
    buffer_load_dwordx4 v3, s[36:39], s29 offen lds
    v_mfma_f32_16x16x32_bf16 v[100:103], a[108:111], a[84:87], v[100:103]
    s_add_u32 m0, s14, 19456
    ds_read_b64 a[20:21], v15 offset:8192
    ds_read_b64 a[22:23], v15 offset:12288
    s_add_u32 s29, s28, 12288
    v_mfma_f32_16x16x32_bf16 v[100:103], a[104:107], a[80:83], v[100:103]
    ds_read_b64 a[24:25], v16 offset:0
    ds_read_b64 a[26:27], v16 offset:4096
    v_mfma_f32_16x16x32_bf16 v[84:87], a[104:107], a[72:75], v[84:87]
    ds_read_b64 a[28:29], v16 offset:8192
    ds_read_b64 a[30:31], v16 offset:12288
    v_mfma_f32_16x16x32_bf16 v[84:87], a[108:111], a[76:79], v[84:87]
    buffer_load_dwordx4 v4, s[36:39], s29 offen lds
    v_mfma_f32_16x16x32_bf16 v[68:71], a[108:111], a[68:71], v[68:71]
    s_add_u32 m0, s14, 32768
    ds_read_b64_tr_b16 a[40:41], v18 offset:16384
    ds_read_b64_tr_b16 a[42:43], v18 offset:20480
    s_add_u32 s0, s27, 0
    v_mfma_f32_16x16x32_bf16 v[68:71], a[104:107], a[64:67], v[68:71]
    s_and_b32 s0, s0, 15
    ds_read_b64_tr_b16 a[44:45], v18 offset:24576
    ds_read_b64_tr_b16 a[46:47], v18 offset:28672
    s_xor_b32 s0, s0, s22
    v_mfma_f32_16x16x32_bf16 v[72:75], a[112:115], a[64:67], v[72:75]
    s_lshl_b32 s0, s0, 14
    ds_read_b64_tr_b16 a[48:49], v19 offset:16384
    s_add_u32 s0, s0, s12
    v_mfma_f32_16x16x32_bf16 v[72:75], a[116:119], a[68:71], v[72:75]
    buffer_load_dwordx4 v1, s[8:11], s0 offen offset:0 sc1 lds
    v_mfma_f32_16x16x32_bf16 v[88:91], a[116:119], a[76:79], v[88:91]
    ds_read_b64_tr_b16 a[50:51], v19 offset:20480
    v_mfma_f32_16x16x32_bf16 v[88:91], a[112:115], a[72:75], v[88:91]
    ds_read_b64_tr_b16 a[52:53], v19 offset:24576
    v_mfma_f32_16x16x32_bf16 v[104:107], a[112:115], a[80:83], v[104:107]
    buffer_load_dwordx4 v1, s[8:11], s0 offen offset:1024 sc1 lds
    v_mfma_f32_16x16x32_bf16 v[104:107], a[116:119], a[84:87], v[104:107]
    ds_read_b64_tr_b16 a[54:55], v19 offset:28672
    v_mfma_f32_16x16x32_bf16 v[120:123], a[116:119], a[92:95], v[120:123]
    ds_read_b64_tr_b16 a[56:57], v20 offset:16384
    v_mfma_f32_16x16x32_bf16 v[120:123], a[112:115], a[88:91], v[120:123]
    ds_read_b64_tr_b16 a[58:59], v20 offset:20480
    v_mfma_f32_16x16x32_bf16 v[124:127], a[120:123], a[88:91], v[124:127]
    buffer_load_dwordx4 v1, s[8:11], s0 offen offset:2048 sc1 lds
    v_mfma_f32_16x16x32_bf16 v[124:127], a[124:127], a[92:95], v[124:127]
    ds_read_b64_tr_b16 a[60:61], v20 offset:24576
    v_mfma_f32_16x16x32_bf16 v[108:111], a[124:127], a[84:87], v[108:111]
    ds_read_b64_tr_b16 a[62:63], v20 offset:28672
    v_add_u32 v13, 32768, v13
    v_mfma_f32_16x16x32_bf16 v[108:111], a[120:123], a[80:83], v[108:111]
    v_add_u32 v14, 32768, v14
    v_add_u32 v15, 32768, v15
    v_mfma_f32_16x16x32_bf16 v[92:95], a[120:123], a[72:75], v[92:95]
    buffer_load_dwordx4 v1, s[8:11], s0 offen offset:3072 sc1 lds
    v_mfma_f32_16x16x32_bf16 v[92:95], a[124:127], a[76:79], v[92:95]
    v_add_u32 v16, 32768, v16
    v_add_u32 v17, 32768, v17
    v_mfma_f32_16x16x32_bf16 v[76:79], a[124:127], a[68:71], v[76:79]
    v_add_u32 v18, 32768, v18
    v_add_u32 v19, 32768, v19
    v_mfma_f32_16x16x32_bf16 v[76:79], a[120:123], a[64:67], v[76:79]
    v_add_u32 v20, 32768, v20
    s_waitcnt vmcnt(12) lgkmcnt(0)
    s_barrier
    v_mfma_f32_16x16x32_bf16 v[64:67], a[32:35], a[0:3], v[64:67]
    ds_read_b64_tr_b16 a[96:97], v17 offset:16384
    ds_read_b64_tr_b16 a[98:99], v17 offset:20480
    v_mfma_f32_16x16x32_bf16 v[64:67], a[36:39], a[4:7], v[64:67]
    s_add_u32 s28, s27, 0
    ds_read_b64_tr_b16 a[100:101], v17 offset:24576
    ds_read_b64_tr_b16 a[102:103], v17 offset:28672
    s_and_b32 s28, s28, 15
    v_mfma_f32_16x16x32_bf16 v[80:83], a[36:39], a[12:15], v[80:83]
    s_xor_b32 s28, s28, s22
    s_lshl_b32 s28, s28, 16
    s_add_u32 s28, s28, s13
    s_add_u32 m0, s14, 49152
    s_add_u32 s29, s28, 0
    buffer_load_dwordx4 v3, s[32:35], s29 offen lds
    v_mfma_f32_16x16x32_bf16 v[80:83], a[32:35], a[8:11], v[80:83]
    s_add_u32 m0, s14, 50176
    ds_read_b64 a[64:65], v13 offset:0
    ds_read_b64 a[66:67], v13 offset:4096
    s_add_u32 s29, s28, 4096
    v_mfma_f32_16x16x32_bf16 v[96:99], a[32:35], a[16:19], v[96:99]
    ds_read_b64 a[68:69], v13 offset:8192
    ds_read_b64 a[70:71], v13 offset:12288
    v_mfma_f32_16x16x32_bf16 v[96:99], a[36:39], a[20:23], v[96:99]
    buffer_load_dwordx4 v4, s[32:35], s29 offen lds
    v_mfma_f32_16x16x32_bf16 v[112:115], a[36:39], a[28:31], v[112:115]
    s_add_u32 m0, s14, 51200
    ds_read_b64 a[72:73], v14 offset:0
    ds_read_b64 a[74:75], v14 offset:4096
    s_add_u32 s29, s28, 8192
    v_mfma_f32_16x16x32_bf16 v[112:115], a[32:35], a[24:27], v[112:115]
    ds_read_b64 a[76:77], v14 offset:8192
    ds_read_b64 a[78:79], v14 offset:12288
    v_mfma_f32_16x16x32_bf16 v[116:119], a[40:43], a[24:27], v[116:119]
    ds_read_b64 a[80:81], v15 offset:0
    ds_read_b64 a[82:83], v15 offset:4096
    v_mfma_f32_16x16x32_bf16 v[116:119], a[44:47], a[28:31], v[116:119]
    buffer_load_dwordx4 v3, s[32:35], s29 offen lds
    v_mfma_f32_16x16x32_bf16 v[100:103], a[44:47], a[20:23], v[100:103]
    s_add_u32 m0, s14, 52224
    ds_read_b64 a[84:85], v15 offset:8192
    ds_read_b64 a[86:87], v15 offset:12288
    s_add_u32 s29, s28, 12288
    v_mfma_f32_16x16x32_bf16 v[100:103], a[40:43], a[16:19], v[100:103]
    ds_read_b64 a[88:89], v16 offset:0
    ds_read_b64 a[90:91], v16 offset:4096
    v_mfma_f32_16x16x32_bf16 v[84:87], a[40:43], a[8:11], v[84:87]
    ds_read_b64 a[92:93], v16 offset:8192
    ds_read_b64 a[94:95], v16 offset:12288
    v_mfma_f32_16x16x32_bf16 v[84:87], a[44:47], a[12:15], v[84:87]
    buffer_load_dwordx4 v4, s[32:35], s29 offen lds
    v_mfma_f32_16x16x32_bf16 v[68:71], a[44:47], a[4:7], v[68:71]
    s_add_u32 m0, s14, 65536
    ds_read_b64_tr_b16 a[104:105], v18 offset:16384
    ds_read_b64_tr_b16 a[106:107], v18 offset:20480
    s_add_u32 s0, s27, 1
    v_mfma_f32_16x16x32_bf16 v[68:71], a[40:43], a[0:3], v[68:71]
    s_and_b32 s0, s0, 15
    ds_read_b64_tr_b16 a[108:109], v18 offset:24576
    ds_read_b64_tr_b16 a[110:111], v18 offset:28672
    s_xor_b32 s0, s0, s22
    v_mfma_f32_16x16x32_bf16 v[72:75], a[48:51], a[0:3], v[72:75]
    s_lshl_b32 s0, s0, 14
    ds_read_b64_tr_b16 a[112:113], v19 offset:16384
    s_add_u32 s0, s0, s12
    v_mfma_f32_16x16x32_bf16 v[72:75], a[52:55], a[4:7], v[72:75]
    buffer_load_dwordx4 v1, s[8:11], s0 offen offset:0 sc1 lds
    v_mfma_f32_16x16x32_bf16 v[88:91], a[52:55], a[12:15], v[88:91]
    ds_read_b64_tr_b16 a[114:115], v19 offset:20480
    v_mfma_f32_16x16x32_bf16 v[88:91], a[48:51], a[8:11], v[88:91]
    ds_read_b64_tr_b16 a[116:117], v19 offset:24576
    v_mfma_f32_16x16x32_bf16 v[104:107], a[48:51], a[16:19], v[104:107]
    buffer_load_dwordx4 v1, s[8:11], s0 offen offset:1024 sc1 lds
    v_mfma_f32_16x16x32_bf16 v[104:107], a[52:55], a[20:23], v[104:107]
    ds_read_b64_tr_b16 a[118:119], v19 offset:28672
    v_mfma_f32_16x16x32_bf16 v[120:123], a[52:55], a[28:31], v[120:123]
    ds_read_b64_tr_b16 a[120:121], v20 offset:16384
    v_mfma_f32_16x16x32_bf16 v[120:123], a[48:51], a[24:27], v[120:123]
    ds_read_b64_tr_b16 a[122:123], v20 offset:20480
    v_mfma_f32_16x16x32_bf16 v[124:127], a[56:59], a[24:27], v[124:127]
    buffer_load_dwordx4 v1, s[8:11], s0 offen offset:2048 sc1 lds
    v_mfma_f32_16x16x32_bf16 v[124:127], a[60:63], a[28:31], v[124:127]
    ds_read_b64_tr_b16 a[124:125], v20 offset:24576
    v_mfma_f32_16x16x32_bf16 v[108:111], a[60:63], a[20:23], v[108:111]
    ds_read_b64_tr_b16 a[126:127], v20 offset:28672
    v_add_u32 v13, 4294836224, v13
    v_mfma_f32_16x16x32_bf16 v[108:111], a[56:59], a[16:19], v[108:111]
    v_add_u32 v14, 4294836224, v14
    v_add_u32 v15, 4294836224, v15
    v_mfma_f32_16x16x32_bf16 v[92:95], a[56:59], a[8:11], v[92:95]
    buffer_load_dwordx4 v1, s[8:11], s0 offen offset:3072 sc1 lds
    v_mfma_f32_16x16x32_bf16 v[92:95], a[60:63], a[12:15], v[92:95]
    v_add_u32 v16, 4294836224, v16
    v_add_u32 v17, 4294836224, v17
    v_mfma_f32_16x16x32_bf16 v[76:79], a[60:63], a[4:7], v[76:79]
    v_add_u32 v18, 4294836224, v18
    v_add_u32 v19, 4294836224, v19
    v_mfma_f32_16x16x32_bf16 v[76:79], a[56:59], a[0:3], v[76:79]
    v_add_u32 v20, 4294836224, v20
    s_waitcnt vmcnt(12) lgkmcnt(0)
    s_barrier
    v_mfma_f32_16x16x32_bf16 v[64:67], a[96:99], a[64:67], v[64:67]
    ds_read_b64_tr_b16 a[32:33], v17 offset:16384
    ds_read_b64_tr_b16 a[34:35], v17 offset:20480
    v_mfma_f32_16x16x32_bf16 v[64:67], a[100:103], a[68:71], v[64:67]
    ds_read_b64_tr_b16 a[36:37], v17 offset:24576
    ds_read_b64_tr_b16 a[38:39], v17 offset:28672
    v_mfma_f32_16x16x32_bf16 v[80:83], a[100:103], a[76:79], v[80:83]
    ds_read_b64 a[0:1], v13 offset:0
    ds_read_b64 a[2:3], v13 offset:4096
    v_mfma_f32_16x16x32_bf16 v[80:83], a[96:99], a[72:75], v[80:83]
    ds_read_b64 a[4:5], v13 offset:8192
    ds_read_b64 a[6:7], v13 offset:12288
    buffer_load_dword v24, v23, s[8:11], s93 offen sc1
    v_mfma_f32_16x16x32_bf16 v[96:99], a[96:99], a[80:83], v[96:99]
    s_add_u32 s28, s27, 1
    ds_read_b64 a[8:9], v14 offset:0
    ds_read_b64 a[10:11], v14 offset:4096
    s_and_b32 s28, s28, 15
    v_mfma_f32_16x16x32_bf16 v[96:99], a[100:103], a[84:87], v[96:99]
    s_xor_b32 s28, s28, s22
    ds_read_b64 a[12:13], v14 offset:8192
    ds_read_b64 a[14:15], v14 offset:12288
    s_lshl_b32 s28, s28, 16
    v_mfma_f32_16x16x32_bf16 v[112:115], a[100:103], a[92:95], v[112:115]
    s_add_u32 s28, s28, s13
    ds_read_b64 a[16:17], v15 offset:0
    ds_read_b64 a[18:19], v15 offset:4096
    s_add_u32 m0, s14, 81920
    v_mfma_f32_16x16x32_bf16 v[112:115], a[96:99], a[88:91], v[112:115]
    s_add_u32 s29, s28, 0
    ds_read_b64 a[20:21], v15 offset:8192
    ds_read_b64 a[22:23], v15 offset:12288
    v_mfma_f32_16x16x32_bf16 v[116:119], a[104:107], a[88:91], v[116:119]
    ds_read_b64 a[24:25], v16 offset:0
    ds_read_b64 a[26:27], v16 offset:4096
    v_mfma_f32_16x16x32_bf16 v[116:119], a[108:111], a[92:95], v[116:119]
    ds_read_b64 a[28:29], v16 offset:8192
    ds_read_b64 a[30:31], v16 offset:12288
    buffer_load_dwordx4 v3, s[32:35], s29 offen lds
    v_mfma_f32_16x16x32_bf16 v[100:103], a[108:111], a[84:87], v[100:103]
    s_add_u32 m0, s14, 82944
    ds_read_b64_tr_b16 a[40:41], v18 offset:16384
    ds_read_b64_tr_b16 a[42:43], v18 offset:20480
    s_add_u32 s29, s28, 4096
    v_mfma_f32_16x16x32_bf16 v[100:103], a[104:107], a[80:83], v[100:103]
    ds_read_b64_tr_b16 a[44:45], v18 offset:24576
    ds_read_b64_tr_b16 a[46:47], v18 offset:28672
    v_mfma_f32_16x16x32_bf16 v[84:87], a[104:107], a[72:75], v[84:87]
    ds_read_b64_tr_b16 a[48:49], v19 offset:16384
    v_mfma_f32_16x16x32_bf16 v[84:87], a[108:111], a[76:79], v[84:87]
    ds_read_b64_tr_b16 a[50:51], v19 offset:20480
    v_mfma_f32_16x16x32_bf16 v[68:71], a[108:111], a[68:71], v[68:71]
    ds_read_b64_tr_b16 a[52:53], v19 offset:24576
    v_mfma_f32_16x16x32_bf16 v[68:71], a[104:107], a[64:67], v[68:71]
    ds_read_b64_tr_b16 a[54:55], v19 offset:28672
    buffer_load_dwordx4 v4, s[32:35], s29 offen lds
    v_mfma_f32_16x16x32_bf16 v[72:75], a[112:115], a[64:67], v[72:75]
    s_add_u32 m0, s14, 83968
    ds_read_b64_tr_b16 a[56:57], v20 offset:16384
    s_add_u32 s29, s28, 8192
    v_mfma_f32_16x16x32_bf16 v[72:75], a[116:119], a[68:71], v[72:75]
    ds_read_b64_tr_b16 a[58:59], v20 offset:20480
    v_mfma_f32_16x16x32_bf16 v[88:91], a[116:119], a[76:79], v[88:91]
    ds_read_b64_tr_b16 a[60:61], v20 offset:24576
    v_mfma_f32_16x16x32_bf16 v[88:91], a[112:115], a[72:75], v[88:91]
    ds_read_b64_tr_b16 a[62:63], v20 offset:28672
    v_add_u32 v13, s30, v1
    v_mfma_f32_16x16x32_bf16 v[104:107], a[112:115], a[80:83], v[104:107]
    buffer_load_dwordx4 v3, s[32:35], s29 offen lds
    v_mfma_f32_16x16x32_bf16 v[104:107], a[116:119], a[84:87], v[104:107]
    v_xor_b32 v14, 1024, v13
    v_xor_b32 v15, 2048, v13
    v_mfma_f32_16x16x32_bf16 v[120:123], a[116:119], a[92:95], v[120:123]
    s_add_u32 m0, s14, 84992
    s_add_u32 s29, s28, 12288
    v_xor_b32 v16, 3072, v13
    v_mfma_f32_16x16x32_bf16 v[120:123], a[112:115], a[88:91], v[120:123]
    v_add_u32 v17, 32768, v17
    v_add_u32 v18, 32768, v18
    v_mfma_f32_16x16x32_bf16 v[124:127], a[120:123], a[88:91], v[124:127]
    v_add_u32 v19, 32768, v19
    v_add_u32 v20, 32768, v20
    v_mfma_f32_16x16x32_bf16 v[124:127], a[124:127], a[92:95], v[124:127]
    v_mfma_f32_16x16x32_bf16 v[108:111], a[124:127], a[84:87], v[108:111]
    buffer_load_dwordx4 v4, s[32:35], s29 offen lds
    v_mfma_f32_16x16x32_bf16 v[108:111], a[120:123], a[80:83], v[108:111]
    v_mfma_f32_16x16x32_bf16 v[92:95], a[120:123], a[72:75], v[92:95]
    v_mfma_f32_16x16x32_bf16 v[92:95], a[124:127], a[76:79], v[92:95]
    v_mfma_f32_16x16x32_bf16 v[76:79], a[124:127], a[68:71], v[76:79]
    v_mfma_f32_16x16x32_bf16 v[76:79], a[120:123], a[64:67], v[76:79]
    s_waitcnt vmcnt(4) lgkmcnt(0)
    s_barrier
    v_cmp_gt_u32 vcc, 1, v24
    s_cbranch_vccnz L_poll_c
L_back_c:
    v_mfma_f32_16x16x32_bf16 v[64:67], a[32:35], a[0:3], v[64:67]
    ds_read_b64_tr_b16 a[96:97], v17 offset:16384
    ds_read_b64_tr_b16 a[98:99], v17 offset:20480
    v_mfma_f32_16x16x32_bf16 v[64:67], a[36:39], a[4:7], v[64:67]
    s_add_u32 m0, s14, 98304
    ds_read_b64_tr_b16 a[100:101], v17 offset:24576
    ds_read_b64_tr_b16 a[102:103], v17 offset:28672
    s_add_u32 s0, s27, 2
    v_mfma_f32_16x16x32_bf16 v[80:83], a[36:39], a[12:15], v[80:83]
    s_and_b32 s0, s0, 15
    s_xor_b32 s0, s0, s22
    s_lshl_b32 s0, s0, 14
    s_add_u32 s0, s0, s12
    buffer_load_dwordx4 v1, s[8:11], s0 offen offset:0 sc1 lds
    v_mfma_f32_16x16x32_bf16 v[80:83], a[32:35], a[8:11], v[80:83]
    ds_read_b128 a[64:67], v13 offset:0
    ds_read_b128 a[68:71], v13 offset:8192
    v_mfma_f32_16x16x32_bf16 v[96:99], a[32:35], a[16:19], v[96:99]
    ds_read_b128 a[72:75], v14 offset:0
    v_mfma_f32_16x16x32_bf16 v[96:99], a[36:39], a[20:23], v[96:99]
    buffer_load_dwordx4 v1, s[8:11], s0 offen offset:1024 sc1 lds
    v_mfma_f32_16x16x32_bf16 v[112:115], a[36:39], a[28:31], v[112:115]
    ds_read_b128 a[76:79], v14 offset:8192
    v_mfma_f32_16x16x32_bf16 v[112:115], a[32:35], a[24:27], v[112:115]
    ds_read_b128 a[80:83], v15 offset:0
    v_mfma_f32_16x16x32_bf16 v[116:119], a[40:43], a[24:27], v[116:119]
    ds_read_b128 a[84:87], v15 offset:8192
    v_mfma_f32_16x16x32_bf16 v[116:119], a[44:47], a[28:31], v[116:119]
    buffer_load_dwordx4 v1, s[8:11], s0 offen offset:2048 sc1 lds
    v_mfma_f32_16x16x32_bf16 v[100:103], a[44:47], a[20:23], v[100:103]
    ds_read_b128 a[88:91], v16 offset:0
    v_mfma_f32_16x16x32_bf16 v[100:103], a[40:43], a[16:19], v[100:103]
    ds_read_b128 a[92:95], v16 offset:8192
    v_mfma_f32_16x16x32_bf16 v[84:87], a[40:43], a[8:11], v[84:87]
    ds_read_b64_tr_b16 a[104:105], v18 offset:16384
    v_add_u32 v13, 32768, v13
    v_mfma_f32_16x16x32_bf16 v[84:87], a[44:47], a[12:15], v[84:87]
    buffer_load_dwordx4 v1, s[8:11], s0 offen offset:3072 sc1 lds
    v_mfma_f32_16x16x32_bf16 v[68:71], a[44:47], a[4:7], v[68:71]
    s_add_u32 s28, s27, 2
    ds_read_b64_tr_b16 a[106:107], v18 offset:20480
    v_add_u32 v14, 32768, v14
    v_mfma_f32_16x16x32_bf16 v[68:71], a[40:43], a[0:3], v[68:71]
    s_and_b32 s28, s28, 15
    ds_read_b64_tr_b16 a[108:109], v18 offset:24576
    v_add_u32 v15, 32768, v15
    v_mfma_f32_16x16x32_bf16 v[72:75], a[48:51], a[0:3], v[72:75]
    s_xor_b32 s28, s28, s22
    ds_read_b64_tr_b16 a[110:111], v18 offset:28672
    v_add_u32 v16, 32768, v16
    v_mfma_f32_16x16x32_bf16 v[72:75], a[52:55], a[4:7], v[72:75]
    s_lshl_b32 s28, s28, 16
    s_add_u32 s28, s28, s13
    s_add_u32 m0, s14, 114688
    s_add_u32 s29, s28, 0
    buffer_load_dwordx4 v3, s[32:35], s29 offen lds
    v_mfma_f32_16x16x32_bf16 v[88:91], a[52:55], a[12:15], v[88:91]
    s_add_u32 m0, s14, 115712
    ds_read_b64_tr_b16 a[112:113], v19 offset:16384
    v_add_u32 v17, 32768, v17
    v_mfma_f32_16x16x32_bf16 v[88:91], a[48:51], a[8:11], v[88:91]
    s_add_u32 s29, s28, 4096
    ds_read_b64_tr_b16 a[114:115], v19 offset:20480
    v_mfma_f32_16x16x32_bf16 v[104:107], a[48:51], a[16:19], v[104:107]
    buffer_load_dwordx4 v4, s[32:35], s29 offen lds
    v_mfma_f32_16x16x32_bf16 v[104:107], a[52:55], a[20:23], v[104:107]
    s_add_u32 m0, s14, 116736
    ds_read_b64_tr_b16 a[116:117], v19 offset:24576
    s_add_u32 s29, s28, 8192
    v_mfma_f32_16x16x32_bf16 v[120:123], a[52:55], a[28:31], v[120:123]
    ds_read_b64_tr_b16 a[118:119], v19 offset:28672
    v_mfma_f32_16x16x32_bf16 v[120:123], a[48:51], a[24:27], v[120:123]
    ds_read_b64_tr_b16 a[120:121], v20 offset:16384
    v_mfma_f32_16x16x32_bf16 v[124:127], a[56:59], a[24:27], v[124:127]
    buffer_load_dwordx4 v3, s[32:35], s29 offen lds
    v_mfma_f32_16x16x32_bf16 v[124:127], a[60:63], a[28:31], v[124:127]
    s_add_u32 m0, s14, 117760
    ds_read_b64_tr_b16 a[122:123], v20 offset:20480
    s_add_u32 s29, s28, 12288
    v_mfma_f32_16x16x32_bf16 v[108:111], a[60:63], a[20:23], v[108:111]
    ds_read_b64_tr_b16 a[124:125], v20 offset:24576
    v_mfma_f32_16x16x32_bf16 v[108:111], a[56:59], a[16:19], v[108:111]
    ds_read_b64_tr_b16 a[126:127], v20 offset:28672
    v_add_u32 v18, 32768, v18
    v_mfma_f32_16x16x32_bf16 v[92:95], a[56:59], a[8:11], v[92:95]
    buffer_load_dwordx4 v4, s[32:35], s29 offen lds
    v_mfma_f32_16x16x32_bf16 v[92:95], a[60:63], a[12:15], v[92:95]
    v_add_u32 v19, 32768, v19
    v_add_u32 v20, 32768, v20
    v_mfma_f32_16x16x32_bf16 v[76:79], a[60:63], a[4:7], v[76:79]
    v_mfma_f32_16x16x32_bf16 v[76:79], a[56:59], a[0:3], v[76:79]
    s_waitcnt vmcnt(8) lgkmcnt(0)
    s_barrier
    v_mfma_f32_16x16x32_bf16 v[64:67], a[96:99], a[64:67], v[64:67]
    ds_read_b64_tr_b16 a[32:33], v17 offset:16384
    ds_read_b64_tr_b16 a[34:35], v17 offset:20480
    v_mfma_f32_16x16x32_bf16 v[64:67], a[100:103], a[68:71], v[64:67]
    s_add_u32 m0, s14, 131072
    ds_read_b64_tr_b16 a[36:37], v17 offset:24576
    ds_read_b64_tr_b16 a[38:39], v17 offset:28672
    s_add_u32 s0, s27, 3
    v_mfma_f32_16x16x32_bf16 v[80:83], a[100:103], a[76:79], v[80:83]
    s_and_b32 s0, s0, 15
    s_xor_b32 s0, s0, s22
    s_lshl_b32 s0, s0, 14
    s_add_u32 s0, s0, s12
    buffer_load_dwordx4 v1, s[8:11], s0 offen offset:0 sc1 lds
    v_mfma_f32_16x16x32_bf16 v[80:83], a[96:99], a[72:75], v[80:83]
    ds_read_b128 a[0:3], v13 offset:0
    ds_read_b128 a[4:7], v13 offset:8192
    v_mfma_f32_16x16x32_bf16 v[96:99], a[96:99], a[80:83], v[96:99]
    ds_read_b128 a[8:11], v14 offset:0
    v_mfma_f32_16x16x32_bf16 v[96:99], a[100:103], a[84:87], v[96:99]
    buffer_load_dwordx4 v1, s[8:11], s0 offen offset:1024 sc1 lds
    v_mfma_f32_16x16x32_bf16 v[112:115], a[100:103], a[92:95], v[112:115]
    ds_read_b128 a[12:15], v14 offset:8192
    v_mfma_f32_16x16x32_bf16 v[112:115], a[96:99], a[88:91], v[112:115]
    ds_read_b128 a[16:19], v15 offset:0
    v_mfma_f32_16x16x32_bf16 v[116:119], a[104:107], a[88:91], v[116:119]
    ds_read_b128 a[20:23], v15 offset:8192
    v_mfma_f32_16x16x32_bf16 v[116:119], a[108:111], a[92:95], v[116:119]
    buffer_load_dwordx4 v1, s[8:11], s0 offen offset:2048 sc1 lds
    v_mfma_f32_16x16x32_bf16 v[100:103], a[108:111], a[84:87], v[100:103]
    ds_read_b128 a[24:27], v16 offset:0
    v_mfma_f32_16x16x32_bf16 v[100:103], a[104:107], a[80:83], v[100:103]
    ds_read_b128 a[28:31], v16 offset:8192
    v_mfma_f32_16x16x32_bf16 v[84:87], a[104:107], a[72:75], v[84:87]
    ds_read_b64_tr_b16 a[40:41], v18 offset:16384
    v_add_u32 v13, 32768, v13
    v_mfma_f32_16x16x32_bf16 v[84:87], a[108:111], a[76:79], v[84:87]
    buffer_load_dwordx4 v1, s[8:11], s0 offen offset:3072 sc1 lds
    v_mfma_f32_16x16x32_bf16 v[68:71], a[108:111], a[68:71], v[68:71]
    s_add_u32 s28, s27, 3
    ds_read_b64_tr_b16 a[42:43], v18 offset:20480
    v_add_u32 v14, 32768, v14
    v_mfma_f32_16x16x32_bf16 v[68:71], a[104:107], a[64:67], v[68:71]
    s_and_b32 s28, s28, 15
    ds_read_b64_tr_b16 a[44:45], v18 offset:24576
    v_add_u32 v15, 32768, v15
    v_mfma_f32_16x16x32_bf16 v[72:75], a[112:115], a[64:67], v[72:75]
    s_xor_b32 s28, s28, s22
    ds_read_b64_tr_b16 a[46:47], v18 offset:28672
    v_add_u32 v16, 32768, v16
    v_mfma_f32_16x16x32_bf16 v[72:75], a[116:119], a[68:71], v[72:75]
    s_lshl_b32 s28, s28, 16
    s_add_u32 s28, s28, s13
    s_add_u32 m0, s14, 147456
    s_add_u32 s29, s28, 0
    buffer_load_dwordx4 v3, s[32:35], s29 offen lds
    v_mfma_f32_16x16x32_bf16 v[88:91], a[116:119], a[76:79], v[88:91]
    s_add_u32 m0, s14, 148480
    ds_read_b64_tr_b16 a[48:49], v19 offset:16384
    v_add_u32 v17, 32768, v17
    v_mfma_f32_16x16x32_bf16 v[88:91], a[112:115], a[72:75], v[88:91]
    s_add_u32 s29, s28, 4096
    ds_read_b64_tr_b16 a[50:51], v19 offset:20480
    v_mfma_f32_16x16x32_bf16 v[104:107], a[112:115], a[80:83], v[104:107]
    buffer_load_dwordx4 v4, s[32:35], s29 offen lds
    v_mfma_f32_16x16x32_bf16 v[104:107], a[116:119], a[84:87], v[104:107]
    s_add_u32 m0, s14, 149504
    ds_read_b64_tr_b16 a[52:53], v19 offset:24576
    s_add_u32 s29, s28, 8192
    v_mfma_f32_16x16x32_bf16 v[120:123], a[116:119], a[92:95], v[120:123]
    ds_read_b64_tr_b16 a[54:55], v19 offset:28672
    v_mfma_f32_16x16x32_bf16 v[120:123], a[112:115], a[88:91], v[120:123]
    ds_read_b64_tr_b16 a[56:57], v20 offset:16384
    v_mfma_f32_16x16x32_bf16 v[124:127], a[120:123], a[88:91], v[124:127]
    buffer_load_dwordx4 v3, s[32:35], s29 offen lds
    v_mfma_f32_16x16x32_bf16 v[124:127], a[124:127], a[92:95], v[124:127]
    s_add_u32 m0, s14, 150528
    ds_read_b64_tr_b16 a[58:59], v20 offset:20480
    s_add_u32 s29, s28, 12288
    v_mfma_f32_16x16x32_bf16 v[108:111], a[124:127], a[84:87], v[108:111]
    ds_read_b64_tr_b16 a[60:61], v20 offset:24576
    v_mfma_f32_16x16x32_bf16 v[108:111], a[120:123], a[80:83], v[108:111]
    ds_read_b64_tr_b16 a[62:63], v20 offset:28672
    v_add_u32 v18, 32768, v18
    v_mfma_f32_16x16x32_bf16 v[92:95], a[120:123], a[72:75], v[92:95]
    buffer_load_dwordx4 v4, s[32:35], s29 offen lds
    v_mfma_f32_16x16x32_bf16 v[92:95], a[124:127], a[76:79], v[92:95]
    s_add_u32 s27, s27, 4
    v_add_u32 v19, 32768, v19
    v_add_u32 v20, 32768, v20
    v_mfma_f32_16x16x32_bf16 v[76:79], a[124:127], a[68:71], v[76:79]
    s_add_u32 s14, s14, 0
    s_mov_b32 s15, 3
    s_mov_b32 s16, 1
    v_mfma_f32_16x16x32_bf16 v[76:79], a[120:123], a[64:67], v[76:79]
    s_mov_b32 s3, 0
L_p3_loop:
    s_waitcnt vmcnt(8) lgkmcnt(0)
    s_barrier
    v_mfma_f32_16x16x32_bf16 v[64:67], a[32:35], a[0:3], v[64:67]
    s_add_u32 s15, s15, 1
    ds_read_b64_tr_b16 a[96:97], v17 offset:16384
    ds_read_b64_tr_b16 a[98:99], v17 offset:20480
    s_cmp_eq_u32 s15, 5
    v_mfma_f32_16x16x32_bf16 v[64:67], a[36:39], a[4:7], v[64:67]
    s_cselect_b32 s15, 0, s15
    ds_read_b64_tr_b16 a[100:101], v17 offset:24576
    ds_read_b64_tr_b16 a[102:103], v17 offset:28672
    s_cselect_b32 s19, 4294836224, s24
    v_mfma_f32_16x16x32_bf16 v[80:83], a[36:39], a[12:15], v[80:83]
    s_mov_b32 m0, s14
    s_and_b32 s0, s27, 15
    s_xor_b32 s0, s0, s22
    s_lshl_b32 s0, s0, 14
    s_add_u32 s0, s0, s12
    buffer_load_dwordx4 v1, s[8:11], s0 offen offset:0 sc1 lds
    v_mfma_f32_16x16x32_bf16 v[80:83], a[32:35], a[8:11], v[80:83]
    ds_read_b128 a[64:67], v13 offset:0
    ds_read_b128 a[68:71], v13 offset:8192
    v_mfma_f32_16x16x32_bf16 v[96:99], a[32:35], a[16:19], v[96:99]
    ds_read_b128 a[72:75], v14 offset:0
    v_mfma_f32_16x16x32_bf16 v[96:99], a[36:39], a[20:23], v[96:99]
    buffer_load_dwordx4 v1, s[8:11], s0 offen offset:1024 sc1 lds
    v_mfma_f32_16x16x32_bf16 v[112:115], a[36:39], a[28:31], v[112:115]
    ds_read_b128 a[76:79], v14 offset:8192
    v_mfma_f32_16x16x32_bf16 v[112:115], a[32:35], a[24:27], v[112:115]
    ds_read_b128 a[80:83], v15 offset:0
    v_mfma_f32_16x16x32_bf16 v[116:119], a[40:43], a[24:27], v[116:119]
    ds_read_b128 a[84:87], v15 offset:8192
    v_mfma_f32_16x16x32_bf16 v[116:119], a[44:47], a[28:31], v[116:119]
    buffer_load_dwordx4 v1, s[8:11], s0 offen offset:2048 sc1 lds
    v_mfma_f32_16x16x32_bf16 v[100:103], a[44:47], a[20:23], v[100:103]
    ds_read_b128 a[88:91], v16 offset:0
    v_mfma_f32_16x16x32_bf16 v[100:103], a[40:43], a[16:19], v[100:103]
    ds_read_b128 a[92:95], v16 offset:8192
    v_mfma_f32_16x16x32_bf16 v[84:87], a[40:43], a[8:11], v[84:87]
    ds_read_b64_tr_b16 a[104:105], v18 offset:16384
    v_add_u32 v13, s19, v13
    v_mfma_f32_16x16x32_bf16 v[84:87], a[44:47], a[12:15], v[84:87]
    buffer_load_dwordx4 v1, s[8:11], s0 offen offset:3072 sc1 lds
    v_mfma_f32_16x16x32_bf16 v[68:71], a[44:47], a[4:7], v[68:71]
    s_and_b32 s28, s27, 15
    ds_read_b64_tr_b16 a[106:107], v18 offset:20480
    v_add_u32 v14, s19, v14
    v_mfma_f32_16x16x32_bf16 v[68:71], a[40:43], a[0:3], v[68:71]
    s_xor_b32 s28, s28, s22
    ds_read_b64_tr_b16 a[108:109], v18 offset:24576
    v_add_u32 v15, s19, v15
    v_mfma_f32_16x16x32_bf16 v[72:75], a[48:51], a[0:3], v[72:75]
    s_lshl_b32 s28, s28, 16
    ds_read_b64_tr_b16 a[110:111], v18 offset:28672
    v_add_u32 v16, s19, v16
    v_mfma_f32_16x16x32_bf16 v[72:75], a[52:55], a[4:7], v[72:75]
    s_add_u32 s28, s28, s13
    s_add_u32 m0, s14, 16384
    s_add_u32 s29, s28, 0
    buffer_load_dwordx4 v3, s[32:35], s29 offen lds
    v_mfma_f32_16x16x32_bf16 v[88:91], a[52:55], a[12:15], v[88:91]
    s_add_u32 m0, s14, 17408
    ds_read_b64_tr_b16 a[112:113], v19 offset:16384
    v_add_u32 v17, s19, v17
    v_mfma_f32_16x16x32_bf16 v[88:91], a[48:51], a[8:11], v[88:91]
    s_add_u32 s29, s28, 4096
    ds_read_b64_tr_b16 a[114:115], v19 offset:20480
    v_mfma_f32_16x16x32_bf16 v[104:107], a[48:51], a[16:19], v[104:107]
    buffer_load_dwordx4 v4, s[32:35], s29 offen lds
    v_mfma_f32_16x16x32_bf16 v[104:107], a[52:55], a[20:23], v[104:107]
    s_add_u32 m0, s14, 18432
    ds_read_b64_tr_b16 a[116:117], v19 offset:24576
    s_add_u32 s29, s28, 8192
    v_mfma_f32_16x16x32_bf16 v[120:123], a[52:55], a[28:31], v[120:123]
    ds_read_b64_tr_b16 a[118:119], v19 offset:28672
    v_mfma_f32_16x16x32_bf16 v[120:123], a[48:51], a[24:27], v[120:123]
    ds_read_b64_tr_b16 a[120:121], v20 offset:16384
    v_mfma_f32_16x16x32_bf16 v[124:127], a[56:59], a[24:27], v[124:127]
L_tp22:
    s_cbranch_execz L_tp26
    buffer_load_dwordx4 v3, s[32:35], s29 offen lds
    v_mfma_f32_16x16x32_bf16 v[124:127], a[60:63], a[28:31], v[124:127]
    s_add_u32 m0, s14, 19456
    ds_read_b64_tr_b16 a[122:123], v20 offset:20480
    s_add_u32 s29, s28, 12288
    v_mfma_f32_16x16x32_bf16 v[108:111], a[60:63], a[20:23], v[108:111]
    ds_read_b64_tr_b16 a[124:125], v20 offset:24576
    v_mfma_f32_16x16x32_bf16 v[108:111], a[56:59], a[16:19], v[108:111]
    ds_read_b64_tr_b16 a[126:127], v20 offset:28672
    v_add_u32 v18, s19, v18
    v_mfma_f32_16x16x32_bf16 v[92:95], a[56:59], a[8:11], v[92:95]
    buffer_load_dwordx4 v4, s[32:35], s29 offen lds
    v_mfma_f32_16x16x32_bf16 v[92:95], a[60:63], a[12:15], v[92:95]
    s_add_u32 s27, s27, 1
    v_add_u32 v19, s19, v19
    v_add_u32 v20, s19, v20
    v_mfma_f32_16x16x32_bf16 v[76:79], a[60:63], a[4:7], v[76:79]
    s_add_u32 s14, s14, 32768
    s_sub_u32 s7, s14, 163840
    s_cselect_b32 s14, s14, s7
    v_mfma_f32_16x16x32_bf16 v[76:79], a[56:59], a[0:3], v[76:79]
    s_waitcnt vmcnt(8) lgkmcnt(0)
    s_barrier
    v_mfma_f32_16x16x32_bf16 v[64:67], a[96:99], a[64:67], v[64:67]
    s_add_u32 s15, s15, 1
    ds_read_b64_tr_b16 a[32:33], v17 offset:16384
    ds_read_b64_tr_b16 a[34:35], v17 offset:20480
    s_cmp_eq_u32 s15, 5
    v_mfma_f32_16x16x32_bf16 v[64:67], a[100:103], a[68:71], v[64:67]
    s_cselect_b32 s15, 0, s15
    ds_read_b64_tr_b16 a[36:37], v17 offset:24576
    ds_read_b64_tr_b16 a[38:39], v17 offset:28672
    s_cselect_b32 s19, 4294836224, s24
    v_mfma_f32_16x16x32_bf16 v[80:83], a[100:103], a[76:79], v[80:83]
    s_mov_b32 m0, s14
    s_and_b32 s0, s27, 15
    s_xor_b32 s0, s0, s22
    s_lshl_b32 s0, s0, 14
    s_add_u32 s0, s0, s12
    buffer_load_dwordx4 v1, s[8:11], s0 offen offset:0 sc1 lds
    v_mfma_f32_16x16x32_bf16 v[80:83], a[96:99], a[72:75], v[80:83]
    ds_read_b128 a[0:3], v13 offset:0
    ds_read_b128 a[4:7], v13 offset:8192
    v_mfma_f32_16x16x32_bf16 v[96:99], a[96:99], a[80:83], v[96:99]
    ds_read_b128 a[8:11], v14 offset:0
    v_mfma_f32_16x16x32_bf16 v[96:99], a[100:103], a[84:87], v[96:99]
    buffer_load_dwordx4 v1, s[8:11], s0 offen offset:1024 sc1 lds
    v_mfma_f32_16x16x32_bf16 v[112:115], a[100:103], a[92:95], v[112:115]
    ds_read_b128 a[12:15], v14 offset:8192
    v_mfma_f32_16x16x32_bf16 v[112:115], a[96:99], a[88:91], v[112:115]
    ds_read_b128 a[16:19], v15 offset:0
    v_mfma_f32_16x16x32_bf16 v[116:119], a[104:107], a[88:91], v[116:119]
    ds_read_b128 a[20:23], v15 offset:8192
    v_mfma_f32_16x16x32_bf16 v[116:119], a[108:111], a[92:95], v[116:119]
    buffer_load_dwordx4 v1, s[8:11], s0 offen offset:2048 sc1 lds
    v_mfma_f32_16x16x32_bf16 v[100:103], a[108:111], a[84:87], v[100:103]
    ds_read_b128 a[24:27], v16 offset:0
    v_mfma_f32_16x16x32_bf16 v[100:103], a[104:107], a[80:83], v[100:103]
    ds_read_b128 a[28:31], v16 offset:8192
    v_mfma_f32_16x16x32_bf16 v[84:87], a[104:107], a[72:75], v[84:87]
    ds_read_b64_tr_b16 a[40:41], v18 offset:16384
    v_add_u32 v13, s19, v13
    v_mfma_f32_16x16x32_bf16 v[84:87], a[108:111], a[76:79], v[84:87]
    buffer_load_dwordx4 v1, s[8:11], s0 offen offset:3072 sc1 lds
    v_mfma_f32_16x16x32_bf16 v[68:71], a[108:111], a[68:71], v[68:71]
    s_and_b32 s28, s27, 15
    ds_read_b64_tr_b16 a[42:43], v18 offset:20480
    v_add_u32 v14, s19, v14
    v_mfma_f32_16x16x32_bf16 v[68:71], a[104:107], a[64:67], v[68:71]
    s_xor_b32 s28, s28, s22
    ds_read_b64_tr_b16 a[44:45], v18 offset:24576
    v_add_u32 v15, s19, v15
    v_mfma_f32_16x16x32_bf16 v[72:75], a[112:115], a[64:67], v[72:75]
    s_lshl_b32 s28, s28, 16
    ds_read_b64_tr_b16 a[46:47], v18 offset:28672
    v_add_u32 v16, s19, v16
    v_mfma_f32_16x16x32_bf16 v[72:75], a[116:119], a[68:71], v[72:75]
    s_add_u32 s28, s28, s13
    s_add_u32 m0, s14, 16384
    s_add_u32 s29, s28, 0
    buffer_load_dwordx4 v3, s[32:35], s29 offen lds
    v_mfma_f32_16x16x32_bf16 v[88:91], a[116:119], a[76:79], v[88:91]
    s_add_u32 m0, s14, 17408
    ds_read_b64_tr_b16 a[48:49], v19 offset:16384
    v_add_u32 v17, s19, v17
    v_mfma_f32_16x16x32_bf16 v[88:91], a[112:115], a[72:75], v[88:91]
    s_add_u32 s29, s28, 4096
    ds_read_b64_tr_b16 a[50:51], v19 offset:20480
    v_mfma_f32_16x16x32_bf16 v[104:107], a[112:115], a[80:83], v[104:107]
    buffer_load_dwordx4 v4, s[32:35], s29 offen lds
    v_mfma_f32_16x16x32_bf16 v[104:107], a[116:119], a[84:87], v[104:107]
    s_add_u32 m0, s14, 18432
    ds_read_b64_tr_b16 a[52:53], v19 offset:24576
    s_add_u32 s29, s28, 8192
    v_mfma_f32_16x16x32_bf16 v[120:123], a[116:119], a[92:95], v[120:123]
    ds_read_b64_tr_b16 a[54:55], v19 offset:28672
    v_mfma_f32_16x16x32_bf16 v[120:123], a[112:115], a[88:91], v[120:123]
    ds_read_b64_tr_b16 a[56:57], v20 offset:16384
    v_mfma_f32_16x16x32_bf16 v[124:127], a[120:123], a[88:91], v[124:127]
    buffer_load_dwordx4 v3, s[32:35], s29 offen lds
    v_mfma_f32_16x16x32_bf16 v[124:127], a[124:127], a[92:95], v[124:127]
    s_add_u32 m0, s14, 19456
    ds_read_b64_tr_b16 a[58:59], v20 offset:20480
    s_add_u32 s29, s28, 12288
    v_mfma_f32_16x16x32_bf16 v[108:111], a[124:127], a[84:87], v[108:111]
    ds_read_b64_tr_b16 a[60:61], v20 offset:24576
    v_mfma_f32_16x16x32_bf16 v[108:111], a[120:123], a[80:83], v[108:111]
    ds_read_b64_tr_b16 a[62:63], v20 offset:28672
    v_add_u32 v18, s19, v18
    v_mfma_f32_16x16x32_bf16 v[92:95], a[120:123], a[72:75], v[92:95]
    buffer_load_dwordx4 v4, s[32:35], s29 offen lds
    v_mfma_f32_16x16x32_bf16 v[92:95], a[124:127], a[76:79], v[92:95]
    s_add_u32 s27, s27, 1
    v_add_u32 v19, s19, v19
    v_add_u32 v20, s19, v20
    v_mfma_f32_16x16x32_bf16 v[76:79], a[124:127], a[68:71], v[76:79]
    s_add_u32 s14, s14, 32768
    s_sub_u32 s7, s14, 163840
    s_cselect_b32 s14, s14, s7
    v_mfma_f32_16x16x32_bf16 v[76:79], a[120:123], a[64:67], v[76:79]
    s_sub_u32 s16, s16, 1
    s_cmp_lg_u32 s16, 0
    s_cbranch_scc1 L_p3_loop
    s_add_u32 s3, s3, 1
    s_cmp_eq_u32 s3, 3
    s_cbranch_scc1 L_p3_out
    s_cmp_eq_u32 s3, 2
    s_cbranch_scc1 L_p3_chk
    s_add_u32 s93, s93, 16
    s_mov_b32 s16, 1
    buffer_load_dword v24, v23, s[8:11], s93 offen sc1
    s_branch L_p3_loop
L_p3_chk:
    v_cmp_gt_u32 vcc, 1, v24
    s_cbranch_vccnz L_poll_d
L_back_d:
    s_mov_b32 s16, 4
    s_branch L_p3_loop
L_p3_out:
    s_waitcnt vmcnt(8) lgkmcnt(0)
    s_barrier
    v_mfma_f32_16x16x32_bf16 v[80:83], a[32:35], a[8:11], v[80:83]
    ds_read_b64_tr_b16 a[96:97], v17 offset:16384
    ds_read_b64_tr_b16 a[98:99], v17 offset:20480
    v_mfma_f32_16x16x32_bf16 v[80:83], a[36:39], a[12:15], v[80:83]
    s_and_b32 s93, s69, 0xfffffff0
    ds_read_b64_tr_b16 a[100:101], v17 offset:24576
    ds_read_b64_tr_b16 a[102:103], v17 offset:28672
    v_mfma_f32_16x16x32_bf16 v[96:99], a[36:39], a[20:23], v[96:99]
    ds_read_b128 a[64:67], v13 offset:0
    ds_read_b128 a[68:71], v13 offset:8192
    v_mfma_f32_16x16x32_bf16 v[96:99], a[32:35], a[16:19], v[96:99]
    ds_read_b128 a[72:75], v14 offset:0
    ds_read_b128 a[76:79], v14 offset:8192
    buffer_load_dword v24, v23, s[8:11], s93 offen sc1
    v_mfma_f32_16x16x32_bf16 v[112:115], a[32:35], a[24:27], v[112:115]
    ds_read_b128 a[80:83], v15 offset:0
    ds_read_b128 a[84:87], v15 offset:8192
    v_mfma_f32_16x16x32_bf16 v[112:115], a[36:39], a[28:31], v[112:115]
    ds_read_b128 a[88:91], v16 offset:0
    ds_read_b128 a[92:95], v16 offset:8192
    v_mfma_f32_16x16x32_bf16 v[116:119], a[44:47], a[28:31], v[116:119]
    ds_read_b64_tr_b16 a[104:105], v18 offset:16384
    v_add_u32 v13, 32768, v13
    v_mfma_f32_16x16x32_bf16 v[116:119], a[40:43], a[24:27], v[116:119]
    ds_read_b64_tr_b16 a[106:107], v18 offset:20480
    v_add_u32 v14, 32768, v14
    v_mfma_f32_16x16x32_bf16 v[100:103], a[40:43], a[16:19], v[100:103]
    ds_read_b64_tr_b16 a[108:109], v18 offset:24576
    v_add_u32 v15, 32768, v15
    v_mfma_f32_16x16x32_bf16 v[100:103], a[44:47], a[20:23], v[100:103]
    ds_read_b64_tr_b16 a[110:111], v18 offset:28672
    v_add_u32 v16, 32768, v16
    v_mfma_f32_16x16x32_bf16 v[84:87], a[44:47], a[12:15], v[84:87]
    ds_read_b64_tr_b16 a[112:113], v19 offset:16384
    v_add_u32 v17, 32768, v17
    v_mfma_f32_16x16x32_bf16 v[84:87], a[40:43], a[8:11], v[84:87]
    ds_read_b64_tr_b16 a[114:115], v19 offset:20480
    v_mfma_f32_16x16x32_bf16 v[88:91], a[48:51], a[8:11], v[88:91]
    ds_read_b64_tr_b16 a[116:117], v19 offset:24576
    v_mfma_f32_16x16x32_bf16 v[88:91], a[52:55], a[12:15], v[88:91]
    ds_read_b64_tr_b16 a[118:119], v19 offset:28672
    v_mfma_f32_16x16x32_bf16 v[104:107], a[52:55], a[20:23], v[104:107]
    ds_read_b64_tr_b16 a[120:121], v20 offset:16384
    v_mfma_f32_16x16x32_bf16 v[104:107], a[48:51], a[16:19], v[104:107]
    ds_read_b64_tr_b16 a[122:123], v20 offset:20480
    v_mfma_f32_16x16x32_bf16 v[120:123], a[48:51], a[24:27], v[120:123]
    ds_read_b64_tr_b16 a[124:125], v20 offset:24576
    v_mfma_f32_16x16x32_bf16 v[120:123], a[52:55], a[28:31], v[120:123]
    ds_read_b64_tr_b16 a[126:127], v20 offset:28672
    v_add_u32 v18, 32768, v18
    v_mfma_f32_16x16x32_bf16 v[124:127], a[60:63], a[28:31], v[124:127]
    v_add_u32 v19, 32768, v19
    v_add_u32 v20, 32768, v20
    v_mfma_f32_16x16x32_bf16 v[124:127], a[56:59], a[24:27], v[124:127]
    v_mfma_f32_16x16x32_bf16 v[108:111], a[56:59], a[16:19], v[108:111]
    v_mfma_f32_16x16x32_bf16 v[108:111], a[60:63], a[20:23], v[108:111]
    v_mfma_f32_16x16x32_bf16 v[92:95], a[60:63], a[12:15], v[92:95]
    v_mfma_f32_16x16x32_bf16 v[92:95], a[56:59], a[8:11], v[92:95]
    s_waitcnt vmcnt(0) lgkmcnt(0)
    s_barrier
    v_cmp_gt_u32 vcc, 1, v24
    s_cbranch_vccnz L_poll_r
L_back_r:
    v_mfma_f32_16x16x32_bf16 v[80:83], a[96:99], a[72:75], v[80:83]
    s_bfe_u32 s20, s69, 0x60007
    ds_read_b64_tr_b16 a[224:225], v17 offset:16384
    ds_read_b64_tr_b16 a[226:227], v17 offset:20480
    s_lshl_b32 s20, s20, 2
    v_mfma_f32_16x16x32_bf16 v[80:83], a[100:103], a[76:79], v[80:83]
    s_add_u32 s20, s20, s6
    ds_read_b64_tr_b16 a[228:229], v17 offset:24576
    ds_read_b64_tr_b16 a[230:231], v17 offset:28672
    s_lshl_b32 s20, s20, 15
    v_mfma_f32_16x16x32_bf16 v[96:99], a[100:103], a[84:87], v[96:99]
    s_add_u32 s20, s20, 62914560
    ds_read_b128 a[192:195], v13 offset:0
    ds_read_b128 a[196:199], v13 offset:8192
    s_lshl_b32 s7, s67, 13
    v_mfma_f32_16x16x32_bf16 v[96:99], a[96:99], a[80:83], v[96:99]
    s_add_u32 s17, s20, s7
    ds_read_b128 a[200:203], v14 offset:0
    ds_read_b128 a[204:207], v14 offset:8192
    s_lshl_b32 s7, s6, 12
    v_mfma_f32_16x16x32_bf16 v[112:115], a[96:99], a[88:91], v[112:115]
    ds_read_b128 a[208:211], v15 offset:0
    ds_read_b128 a[212:215], v15 offset:8192
    v_bfe_u32 v26, v1, 4, 4
    v_mfma_f32_16x16x32_bf16 v[112:115], a[100:103], a[92:95], v[112:115]
    ds_read_b128 a[216:219], v16 offset:0
    ds_read_b128 a[220:223], v16 offset:8192
    v_mul_u32_u24 v28, 144, v26
    v_mfma_f32_16x16x32_bf16 v[116:119], a[108:111], a[92:95], v[116:119]
    ds_read_b64_tr_b16 a[232:233], v18 offset:16384
    v_add_u32 v13, 32768, v13
    v_mfma_f32_16x16x32_bf16 v[116:119], a[104:107], a[88:91], v[116:119]
    ds_read_b64_tr_b16 a[234:235], v18 offset:20480
    v_add_u32 v14, 32768, v14
    v_mfma_f32_16x16x32_bf16 v[100:103], a[104:107], a[80:83], v[100:103]
    ds_read_b64_tr_b16 a[236:237], v18 offset:24576
    v_add_u32 v15, 32768, v15
    v_mfma_f32_16x16x32_bf16 v[100:103], a[108:111], a[84:87], v[100:103]
    ds_read_b64_tr_b16 a[238:239], v18 offset:28672
    v_add_u32 v16, 32768, v16
    v_mfma_f32_16x16x32_bf16 v[84:87], a[108:111], a[76:79], v[84:87]
    ds_read_b64_tr_b16 a[240:241], v19 offset:16384
    v_add_u32 v17, 32768, v17
    v_mfma_f32_16x16x32_bf16 v[84:87], a[104:107], a[72:75], v[84:87]
    ds_read_b64_tr_b16 a[242:243], v19 offset:20480
    v_lshrrev_b32 v26, 8, v1
    v_mfma_f32_16x16x32_bf16 v[88:91], a[112:115], a[72:75], v[88:91]
    ds_read_b64_tr_b16 a[244:245], v19 offset:24576
    v_lshl_add_u32 v28, v26, 3, v28
    v_mfma_f32_16x16x32_bf16 v[88:91], a[116:119], a[76:79], v[88:91]
    ds_read_b64_tr_b16 a[246:247], v19 offset:28672
    v_add_u32 v28, s7, v28
    v_mfma_f32_16x16x32_bf16 v[104:107], a[116:119], a[84:87], v[104:107]
    ds_read_b64_tr_b16 a[248:249], v20 offset:16384
    v_lshrrev_b32 v26, 7, v1
    v_mfma_f32_16x16x32_bf16 v[104:107], a[112:115], a[80:83], v[104:107]
    ds_read_b64_tr_b16 a[250:251], v20 offset:20480
    v_and_b32 v27, 0x70, v1
    v_mfma_f32_16x16x32_bf16 v[120:123], a[112:115], a[88:91], v[120:123]
    ds_read_b64_tr_b16 a[252:253], v20 offset:24576
    v_mul_u32_u24 v29, 144, v26
    v_mfma_f32_16x16x32_bf16 v[120:123], a[116:119], a[92:95], v[120:123]
    ds_read_b64_tr_b16 a[254:255], v20 offset:28672
    v_add3_u32 v29, v29, v27, s7
    v_mfma_f32_16x16x32_bf16 v[124:127], a[124:127], a[92:95], v[124:127]
    v_lshl_add_u32 v27, v26, 10, v27
    v_add_u32 v18, 32768, v18
    v_mfma_f32_16x16x32_bf16 v[124:127], a[120:123], a[88:91], v[124:127]
    v_add_u32 v19, 32768, v19
    v_add_u32 v20, 32768, v20
    v_mfma_f32_16x16x32_bf16 v[108:111], a[120:123], a[80:83], v[108:111]
    v_mfma_f32_16x16x32_bf16 v[108:111], a[124:127], a[84:87], v[108:111]
    v_mfma_f32_16x16x32_bf16 v[92:95], a[124:127], a[76:79], v[92:95]
    v_mfma_f32_16x16x32_bf16 v[92:95], a[120:123], a[72:75], v[92:95]
    s_waitcnt lgkmcnt(0)
    v_mfma_f32_16x16x32_bf16 v[80:83], a[224:227], a[200:203], v[80:83]
    v_mfma_f32_16x16x32_bf16 v[80:83], a[228:231], a[204:207], v[80:83]
    v_mfma_f32_16x16x32_bf16 v[84:87], a[236:239], a[204:207], v[84:87]
    v_mfma_f32_16x16x32_bf16 v[84:87], a[232:235], a[200:203], v[84:87]
    v_mfma_f32_16x16x32_bf16 v[88:91], a[240:243], a[200:203], v[88:91]
    v_mfma_f32_16x16x32_bf16 v[88:91], a[244:247], a[204:207], v[88:91]
    v_mfma_f32_16x16x32_bf16 v[92:95], a[252:255], a[204:207], v[92:95]
    v_mfma_f32_16x16x32_bf16 v[92:95], a[248:251], a[200:203], v[92:95]
    s_xor_b32 s7, s67, 1
    s_lshl_b32 s7, s7, 13
    s_add_u32 s7, s7, s20
    v_mfma_f32_16x16x32_bf16 v[108:111], a[248:251], a[208:211], v[108:111]
    s_add_u32 s7, s7, 2048
    v_mfma_f32_16x16x32_bf16 v[108:111], a[252:255], a[212:215], v[108:111]
    v_mfma_f32_16x16x32_bf16 v[104:107], a[244:247], a[212:215], v[104:107]
    v_mfma_f32_16x16x32_bf16 v[104:107], a[240:243], a[208:211], v[104:107]
    v_cvt_pk_bf16_f32 v80, v80, v81
    v_cvt_pk_bf16_f32 v81, v82, v83
    v_mfma_f32_16x16x32_bf16 v[100:103], a[232:235], a[208:211], v[100:103]
    v_cvt_pk_bf16_f32 v82, v84, v85
    v_cvt_pk_bf16_f32 v83, v86, v87
    v_mfma_f32_16x16x32_bf16 v[100:103], a[236:239], a[212:215], v[100:103]
    buffer_store_dwordx4 v[80:83], v1, s[8:11], s7 offen offset:0 sc1
    v_mfma_f32_16x16x32_bf16 v[96:99], a[228:231], a[212:215], v[96:99]
    v_cvt_pk_bf16_f32 v84, v88, v89
    v_cvt_pk_bf16_f32 v85, v90, v91
    v_mfma_f32_16x16x32_bf16 v[96:99], a[224:227], a[208:211], v[96:99]
    v_cvt_pk_bf16_f32 v86, v92, v93
    v_cvt_pk_bf16_f32 v87, v94, v95
    v_mfma_f32_16x16x32_bf16 v[112:115], a[224:227], a[216:219], v[112:115]
    buffer_store_dwordx4 v[84:87], v1, s[8:11], s7 offen offset:1024 sc1
    v_mfma_f32_16x16x32_bf16 v[112:115], a[228:231], a[220:223], v[112:115]
    s_xor_b32 s7, s67, 2
    s_lshl_b32 s7, s7, 13
    s_add_u32 s7, s7, s20
    v_mfma_f32_16x16x32_bf16 v[116:119], a[236:239], a[220:223], v[116:119]
    s_add_u32 s7, s7, 4096
    v_cvt_pk_bf16_f32 v96, v96, v97
    v_cvt_pk_bf16_f32 v97, v98, v99
    v_mfma_f32_16x16x32_bf16 v[116:119], a[232:235], a[216:219], v[116:119]
    v_cvt_pk_bf16_f32 v98, v100, v101
    v_cvt_pk_bf16_f32 v99, v102, v103
    v_mfma_f32_16x16x32_bf16 v[120:123], a[240:243], a[216:219], v[120:123]
    buffer_store_dwordx4 v[96:99], v1, s[8:11], s7 offen offset:0 sc1
    v_mfma_f32_16x16x32_bf16 v[120:123], a[244:247], a[220:223], v[120:123]
    v_cvt_pk_bf16_f32 v100, v104, v105
    v_cvt_pk_bf16_f32 v101, v106, v107
    v_mfma_f32_16x16x32_bf16 v[124:127], a[252:255], a[220:223], v[124:127]
    v_cvt_pk_bf16_f32 v102, v108, v109
    v_cvt_pk_bf16_f32 v103, v110, v111
    v_mfma_f32_16x16x32_bf16 v[124:127], a[248:251], a[216:219], v[124:127]
    buffer_store_dwordx4 v[100:103], v1, s[8:11], s7 offen offset:1024 sc1
    v_mfma_f32_16x16x32_bf16 v[76:79], a[248:251], a[192:195], v[76:79]
    s_xor_b32 s7, s67, 3
    s_lshl_b32 s7, s7, 13
    s_add_u32 s7, s7, s20
    v_mfma_f32_16x16x32_bf16 v[76:79], a[252:255], a[196:199], v[76:79]
    s_add_u32 s7, s7, 6144
    v_mfma_f32_16x16x32_bf16 v[72:75], a[244:247], a[196:199], v[72:75]
    v_cvt_pk_bf16_f32 v112, v112, v113
    v_cvt_pk_bf16_f32 v113, v114, v115
    v_mfma_f32_16x16x32_bf16 v[72:75], a[240:243], a[192:195], v[72:75]
    v_cvt_pk_bf16_f32 v114, v116, v117
    v_cvt_pk_bf16_f32 v115, v118, v119
    v_mfma_f32_16x16x32_bf16 v[68:71], a[232:235], a[192:195], v[68:71]
    buffer_store_dwordx4 v[112:115], v1, s[8:11], s7 offen offset:0 sc1
    v_mfma_f32_16x16x32_bf16 v[68:71], a[236:239], a[196:199], v[68:71]
    v_cvt_pk_bf16_f32 v116, v120, v121
    v_cvt_pk_bf16_f32 v117, v122, v123
    v_mfma_f32_16x16x32_bf16 v[64:67], a[228:231], a[196:199], v[64:67]
    v_cvt_pk_bf16_f32 v118, v124, v125
    v_cvt_pk_bf16_f32 v119, v126, v127
    v_mfma_f32_16x16x32_bf16 v[64:67], a[224:227], a[192:195], v[64:67]
    buffer_store_dwordx4 v[116:119], v1, s[8:11], s7 offen offset:1024 sc1
    v_mfma_f32_16x16x32_bf16 v[64:67], a[32:35], a[0:3], v[64:67]
    v_mfma_f32_16x16x32_bf16 v[64:67], a[36:39], a[4:7], v[64:67]
    v_mfma_f32_16x16x32_bf16 v[68:71], a[40:43], a[0:3], v[68:71]
    v_mfma_f32_16x16x32_bf16 v[68:71], a[44:47], a[4:7], v[68:71]
    v_mfma_f32_16x16x32_bf16 v[72:75], a[48:51], a[0:3], v[72:75]
    v_mfma_f32_16x16x32_bf16 v[72:75], a[52:55], a[4:7], v[72:75]
    v_mfma_f32_16x16x32_bf16 v[76:79], a[56:59], a[0:3], v[76:79]
    v_mfma_f32_16x16x32_bf16 v[76:79], a[60:63], a[4:7], v[76:79]
    v_mfma_f32_16x16x32_bf16 v[64:67], a[96:99], a[64:67], v[64:67]
    v_mfma_f32_16x16x32_bf16 v[64:67], a[100:103], a[68:71], v[64:67]
    v_mfma_f32_16x16x32_bf16 v[68:71], a[104:107], a[64:67], v[68:71]
    v_mfma_f32_16x16x32_bf16 v[68:71], a[108:111], a[68:71], v[68:71]
    v_mfma_f32_16x16x32_bf16 v[72:75], a[112:115], a[64:67], v[72:75]
    v_mfma_f32_16x16x32_bf16 v[72:75], a[116:119], a[68:71], v[72:75]
    v_mfma_f32_16x16x32_bf16 v[76:79], a[120:123], a[64:67], v[76:79]
    v_mfma_f32_16x16x32_bf16 v[76:79], a[124:127], a[68:71], v[76:79]
    v_mfma_f32_16x16x32_bf16 v[68:71], a[180:183], a[164:167], v[68:71]
    v_mfma_f32_16x16x32_bf16 v[72:75], a[182:185], a[168:171], v[72:75]
    v_mfma_f32_16x16x32_bf16 v[76:79], a[180:183], a[168:171], v[76:79]
    v_mfma_f32_16x16x32_bf16 v[64:67], a[182:185], a[164:167], v[64:67]
    s_branch L_p3_done
L_p3_odd:
L_tp23:
    s_cbranch_execz L_walk2_end
    s_and_b32 s1, s6, 1
    s_lshl_b32 s1, s1, 2
    s_xor_b32 s1, s1, s67
    s_lshl_b32 s30, s1, 10
    s_lshl_b32 s1, s1, 9
    s_add_u32 s1, s1, 131072
    v_add_u32 v13, s1, v21
    v_xor_b32 v14, 0x200, v13
    v_xor_b32 v15, 0x400, v13
    v_xor_b32 v16, 0x600, v13
    v_lshrrev_b32 v27, 6, v1
    v_and_b32 v26, 7, v27
    v_lshlrev_b32 v26, 5, v26
    v_lshl_add_u32 v26, v27, 8, v26
    v_and_b32 v27, 24, v21
    v_add_u32 v26, v27, v26
    s_lshr_b32 s1, s6, 1
    s_lshl_b32 s1, s1, 7
    v_xor_b32 v26, s1, v26
    v_add_u32 v17, 0x20000, v26
    v_xor_b32 v18, 32, v17
    v_xor_b32 v19, 64, v17
    v_xor_b32 v20, 0x60, v17
    v_and_b32 v23, 12, v23
    s_lshl_b32 s1, s67, 18
    s_add_u32 s12, s17, s1
    s_lshl_b32 s1, s67, 20
    s_add_u32 s13, s13, s1
    s_mov_b32 s24, 32768
    s_and_b32 s22, s4, 3
    s_lshl_b32 s22, s22, 1
    s_and_b32 s93, s68, 0xffffff80
    s_add_u32 s93, s93, 32
    s_mov_b32 s27, 14
    s_xor_b32 s22, s22, 6
    s_add_u32 s30, s30, 98304
    s_waitcnt vmcnt(12) lgkmcnt(0)
    s_barrier
    s_add_u32 m0, s14, 65536
    s_add_u32 s0, s25, 49152
    buffer_load_dwordx4 v1, s[8:11], s0 offen offset:0 sc1 lds
    ds_read_b64_tr_b16 a[32:33], v17 offset:16384
    ds_read_b64_tr_b16 a[34:35], v17 offset:20480
    ds_read_b64_tr_b16 a[36:37], v17 offset:24576
    ds_read_b64_tr_b16 a[38:39], v17 offset:28672
    buffer_load_dwordx4 v1, s[8:11], s0 offen offset:1024 sc1 lds
    ds_read_b64 a[0:1], v13 offset:0
    ds_read_b64 a[2:3], v13 offset:4096
    ds_read_b64 a[4:5], v13 offset:8192
    ds_read_b64 a[6:7], v13 offset:12288
    buffer_load_dwordx4 v1, s[8:11], s0 offen offset:2048 sc1 lds
    ds_read_b64 a[8:9], v14 offset:0
    ds_read_b64 a[10:11], v14 offset:4096
    ds_read_b64 a[12:13], v14 offset:8192
    ds_read_b64 a[14:15], v14 offset:12288
    buffer_load_dwordx4 v1, s[8:11], s0 offen offset:3072 sc1 lds
    ds_read_b64 a[16:17], v15 offset:0
    ds_read_b64 a[18:19], v15 offset:4096
    ds_read_b64 a[20:21], v15 offset:8192
    ds_read_b64 a[22:23], v15 offset:12288
    s_add_u32 s28, s23, 196608
    s_add_u32 m0, s14, 81920
    s_add_u32 s29, s28, 0
    buffer_load_dwordx4 v3, s[36:39], s29 offen lds
    ds_read_b64 a[24:25], v16 offset:0
    ds_read_b64 a[26:27], v16 offset:4096
    ds_read_b64 a[28:29], v16 offset:8192
    ds_read_b64 a[30:31], v16 offset:12288
    s_add_u32 m0, s14, 82944
    s_add_u32 s29, s28, 4096
    buffer_load_dwordx4 v4, s[36:39], s29 offen lds
    ds_read_b64_tr_b16 a[40:41], v18 offset:16384
    ds_read_b64_tr_b16 a[42:43], v18 offset:20480
    ds_read_b64_tr_b16 a[44:45], v18 offset:24576
    ds_read_b64_tr_b16 a[46:47], v18 offset:28672
    s_add_u32 m0, s14, 83968
    s_add_u32 s29, s28, 8192
    buffer_load_dwordx4 v3, s[36:39], s29 offen lds
    ds_read_b64_tr_b16 a[48:49], v19 offset:16384
    ds_read_b64_tr_b16 a[50:51], v19 offset:20480
    ds_read_b64_tr_b16 a[52:53], v19 offset:24576
    ds_read_b64_tr_b16 a[54:55], v19 offset:28672
    s_add_u32 m0, s14, 84992
    s_add_u32 s29, s28, 12288
    buffer_load_dwordx4 v4, s[36:39], s29 offen lds
    ds_read_b64_tr_b16 a[56:57], v20 offset:16384
    ds_read_b64_tr_b16 a[58:59], v20 offset:20480
    ds_read_b64_tr_b16 a[60:61], v20 offset:24576
    ds_read_b64_tr_b16 a[62:63], v20 offset:28672
    v_add_u32 v13, 4294836224, v13
    v_add_u32 v14, 4294836224, v14
    v_add_u32 v15, 4294836224, v15
    v_add_u32 v16, 4294836224, v16
    v_add_u32 v17, 4294836224, v17
    v_add_u32 v18, 4294836224, v18
    v_add_u32 v19, 4294836224, v19
    v_add_u32 v20, 4294836224, v20
    s_waitcnt lgkmcnt(0)
    v_mfma_f32_16x16x32_bf16 v[64:67], a[32:35], a[0:3], 0
    ds_read_b64_tr_b16 a[96:97], v17 offset:16384
    ds_read_b64_tr_b16 a[98:99], v17 offset:20480
    v_mfma_f32_16x16x32_bf16 v[64:67], a[36:39], a[4:7], v[64:67]
    s_add_u32 s28, s27, 0
    ds_read_b64_tr_b16 a[100:101], v17 offset:24576
    ds_read_b64_tr_b16 a[102:103], v17 offset:28672
    s_and_b32 s28, s28, 15
    v_mfma_f32_16x16x32_bf16 v[80:83], a[36:39], a[12:15], 0
    s_xor_b32 s28, s28, s22
    ds_read_b64 a[64:65], v13 offset:0
    ds_read_b64 a[66:67], v13 offset:4096
    s_lshl_b32 s28, s28, 16
    v_mfma_f32_16x16x32_bf16 v[80:83], a[32:35], a[8:11], v[80:83]
    s_add_u32 s28, s28, s13
    ds_read_b64 a[68:69], v13 offset:8192
    ds_read_b64 a[70:71], v13 offset:12288
    s_add_u32 m0, s14, 114688
    s_add_u32 s29, s28, 0
    buffer_load_dwordx4 v3, s[32:35], s29 offen lds
    v_mfma_f32_16x16x32_bf16 v[96:99], a[32:35], a[16:19], 0
    ds_read_b64 a[72:73], v14 offset:0
    ds_read_b64 a[74:75], v14 offset:4096
    v_mfma_f32_16x16x32_bf16 v[96:99], a[36:39], a[20:23], v[96:99]
    s_add_u32 m0, s14, 115712
    ds_read_b64 a[76:77], v14 offset:8192
    ds_read_b64 a[78:79], v14 offset:12288
    s_add_u32 s29, s28, 4096
    v_mfma_f32_16x16x32_bf16 v[112:115], a[36:39], a[28:31], 0
    ds_read_b64 a[80:81], v15 offset:0
    ds_read_b64 a[82:83], v15 offset:4096
    v_mfma_f32_16x16x32_bf16 v[112:115], a[32:35], a[24:27], v[112:115]
    ds_read_b64 a[84:85], v15 offset:8192
    ds_read_b64 a[86:87], v15 offset:12288
    v_mfma_f32_16x16x32_bf16 v[116:119], a[40:43], a[24:27], 0
    ds_read_b64 a[88:89], v16 offset:0
    ds_read_b64 a[90:91], v16 offset:4096
    v_mfma_f32_16x16x32_bf16 v[116:119], a[44:47], a[28:31], v[116:119]
    ds_read_b64 a[92:93], v16 offset:8192
    ds_read_b64 a[94:95], v16 offset:12288
    v_mfma_f32_16x16x32_bf16 v[100:103], a[44:47], a[20:23], 0
    ds_read_b64_tr_b16 a[104:105], v18 offset:16384
    ds_read_b64_tr_b16 a[106:107], v18 offset:20480
    buffer_load_dwordx4 v4, s[32:35], s29 offen lds
    v_mfma_f32_16x16x32_bf16 v[100:103], a[40:43], a[16:19], v[100:103]
    ds_read_b64_tr_b16 a[108:109], v18 offset:24576
    ds_read_b64_tr_b16 a[110:111], v18 offset:28672
    v_mfma_f32_16x16x32_bf16 v[84:87], a[40:43], a[8:11], 0
    ds_read_b64_tr_b16 a[112:113], v19 offset:16384
    v_mfma_f32_16x16x32_bf16 v[84:87], a[44:47], a[12:15], v[84:87]
    s_add_u32 m0, s14, 116736
    ds_read_b64_tr_b16 a[114:115], v19 offset:20480
    s_add_u32 s29, s28, 8192
    v_mfma_f32_16x16x32_bf16 v[68:71], a[44:47], a[4:7], 0
    ds_read_b64_tr_b16 a[116:117], v19 offset:24576
    v_mfma_f32_16x16x32_bf16 v[68:71], a[40:43], a[0:3], v[68:71]
    ds_read_b64_tr_b16 a[118:119], v19 offset:28672
    v_mfma_f32_16x16x32_bf16 v[72:75], a[48:51], a[0:3], 0
    ds_read_b64_tr_b16 a[120:121], v20 offset:16384
    v_mfma_f32_16x16x32_bf16 v[72:75], a[52:55], a[4:7], v[72:75]
    ds_read_b64_tr_b16 a[122:123], v20 offset:20480
    v_mfma_f32_16x16x32_bf16 v[88:91], a[52:55], a[12:15], 0
    ds_read_b64_tr_b16 a[124:125], v20 offset:24576
    buffer_load_dwordx4 v3, s[32:35], s29 offen lds
    v_mfma_f32_16x16x32_bf16 v[88:91], a[48:51], a[8:11], v[88:91]
    ds_read_b64_tr_b16 a[126:127], v20 offset:28672
    v_add_u32 v13, 32768, v13
    v_mfma_f32_16x16x32_bf16 v[104:107], a[48:51], a[16:19], 0
    s_add_u32 m0, s14, 117760
    s_add_u32 s29, s28, 12288
    v_add_u32 v14, 32768, v14
    v_mfma_f32_16x16x32_bf16 v[104:107], a[52:55], a[20:23], v[104:107]
    v_add_u32 v15, 32768, v15
    v_add_u32 v16, 32768, v16
    v_mfma_f32_16x16x32_bf16 v[120:123], a[52:55], a[28:31], 0
    v_add_u32 v17, 32768, v17
    v_add_u32 v18, 32768, v18
    v_mfma_f32_16x16x32_bf16 v[120:123], a[48:51], a[24:27], v[120:123]
    v_add_u32 v19, 32768, v19
    v_add_u32 v20, 32768, v20
    v_mfma_f32_16x16x32_bf16 v[124:127], a[56:59], a[24:27], 0
    buffer_load_dwordx4 v4, s[32:35], s29 offen lds
    v_mfma_f32_16x16x32_bf16 v[124:127], a[60:63], a[28:31], v[124:127]
    v_mfma_f32_16x16x32_bf16 v[108:111], a[60:63], a[20:23], 0
    v_mfma_f32_16x16x32_bf16 v[108:111], a[56:59], a[16:19], v[108:111]
    v_mfma_f32_16x16x32_bf16 v[92:95], a[56:59], a[8:11], 0
    v_mfma_f32_16x16x32_bf16 v[92:95], a[60:63], a[12:15], v[92:95]
    v_mfma_f32_16x16x32_bf16 v[76:79], a[60:63], a[4:7], 0
    v_mfma_f32_16x16x32_bf16 v[76:79], a[56:59], a[0:3], v[76:79]
    s_waitcnt vmcnt(12) lgkmcnt(0)
    s_barrier
    v_mfma_f32_16x16x32_bf16 v[64:67], a[96:99], a[64:67], v[64:67]
    ds_read_b64_tr_b16 a[32:33], v17 offset:16384
    ds_read_b64_tr_b16 a[34:35], v17 offset:20480
    v_mfma_f32_16x16x32_bf16 v[64:67], a[100:103], a[68:71], v[64:67]
    s_add_u32 s7, s68, 32
    ds_read_b64_tr_b16 a[36:37], v17 offset:24576
    ds_read_b64_tr_b16 a[38:39], v17 offset:28672
    v_mfma_f32_16x16x32_bf16 v[80:83], a[100:103], a[76:79], v[80:83]
L_tp24:
    s_cbranch_execz L_tp26
    ds_read_b64 a[0:1], v13 offset:0
    ds_read_b64 a[2:3], v13 offset:4096
    v_mfma_f32_16x16x32_bf16 v[80:83], a[96:99], a[72:75], v[80:83]
    ds_read_b64 a[4:5], v13 offset:8192
    ds_read_b64 a[6:7], v13 offset:12288
    buffer_store_dword v25, v22, s[8:11], s7 offen sc1
    v_mfma_f32_16x16x32_bf16 v[96:99], a[96:99], a[80:83], v[96:99]
    ds_read_b64 a[8:9], v14 offset:0
    ds_read_b64 a[10:11], v14 offset:4096
    v_mfma_f32_16x16x32_bf16 v[96:99], a[100:103], a[84:87], v[96:99]
    ds_read_b64 a[12:13], v14 offset:8192
    ds_read_b64 a[14:15], v14 offset:12288
    v_mfma_f32_16x16x32_bf16 v[112:115], a[100:103], a[92:95], v[112:115]
    ds_read_b64 a[16:17], v15 offset:0
    ds_read_b64 a[18:19], v15 offset:4096
    buffer_store_dword v25, v22, s[8:11], s69 offen sc1
    v_mfma_f32_16x16x32_bf16 v[112:115], a[96:99], a[88:91], v[112:115]
    s_add_u32 m0, s14, 98304
    ds_read_b64 a[20:21], v15 offset:8192
    ds_read_b64 a[22:23], v15 offset:12288
    s_add_u32 s0, s27, 0
    v_mfma_f32_16x16x32_bf16 v[116:119], a[104:107], a[88:91], v[116:119]
    s_and_b32 s0, s0, 15
    ds_read_b64 a[24:25], v16 offset:0
    ds_read_b64 a[26:27], v16 offset:4096
    s_xor_b32 s0, s0, s22
    v_mfma_f32_16x16x32_bf16 v[116:119], a[108:111], a[92:95], v[116:119]
    s_lshl_b32 s0, s0, 14
    ds_read_b64 a[28:29], v16 offset:8192
    ds_read_b64 a[30:31], v16 offset:12288
    s_add_u32 s0, s0, s12
    buffer_load_dwordx4 v1, s[8:11], s0 offen offset:0 sc1 lds
    v_mfma_f32_16x16x32_bf16 v[100:103], a[108:111], a[84:87], v[100:103]
    ds_read_b64_tr_b16 a[40:41], v18 offset:16384
    ds_read_b64_tr_b16 a[42:43], v18 offset:20480
    v_mfma_f32_16x16x32_bf16 v[100:103], a[104:107], a[80:83], v[100:103]
    ds_read_b64_tr_b16 a[44:45], v18 offset:24576
    ds_read_b64_tr_b16 a[46:47], v18 offset:28672
    v_mfma_f32_16x16x32_bf16 v[84:87], a[104:107], a[72:75], v[84:87]
    ds_read_b64_tr_b16 a[48:49], v19 offset:16384
    buffer_load_dwordx4 v1, s[8:11], s0 offen offset:1024 sc1 lds
    v_mfma_f32_16x16x32_bf16 v[84:87], a[108:111], a[76:79], v[84:87]
    ds_read_b64_tr_b16 a[50:51], v19 offset:20480
    v_mfma_f32_16x16x32_bf16 v[68:71], a[108:111], a[68:71], v[68:71]
    ds_read_b64_tr_b16 a[52:53], v19 offset:24576
    v_mfma_f32_16x16x32_bf16 v[68:71], a[104:107], a[64:67], v[68:71]
    ds_read_b64_tr_b16 a[54:55], v19 offset:28672
    buffer_load_dwordx4 v1, s[8:11], s0 offen offset:2048 sc1 lds
    v_mfma_f32_16x16x32_bf16 v[72:75], a[112:115], a[64:67], v[72:75]
    ds_read_b64_tr_b16 a[56:57], v20 offset:16384
    v_mfma_f32_16x16x32_bf16 v[72:75], a[116:119], a[68:71], v[72:75]
    ds_read_b64_tr_b16 a[58:59], v20 offset:20480
    v_mfma_f32_16x16x32_bf16 v[88:91], a[116:119], a[76:79], v[88:91]
    ds_read_b64_tr_b16 a[60:61], v20 offset:24576
    buffer_load_dwordx4 v1, s[8:11], s0 offen offset:3072 sc1 lds
    v_mfma_f32_16x16x32_bf16 v[88:91], a[112:115], a[72:75], v[88:91]
    s_add_u32 s28, s27, 1
    ds_read_b64_tr_b16 a[62:63], v20 offset:28672
    s_and_b32 s28, s28, 15
    v_mfma_f32_16x16x32_bf16 v[104:107], a[112:115], a[80:83], v[104:107]
    s_xor_b32 s28, s28, s22
    s_lshl_b32 s28, s28, 16
    s_add_u32 s28, s28, s13
    v_mfma_f32_16x16x32_bf16 v[104:107], a[116:119], a[84:87], v[104:107]
    s_add_u32 m0, s14, 147456
    s_add_u32 s29, s28, 0
    buffer_load_dwordx4 v3, s[32:35], s29 offen lds
    v_mfma_f32_16x16x32_bf16 v[120:123], a[116:119], a[92:95], v[120:123]
    s_add_u32 m0, s14, 148480
    s_add_u32 s29, s28, 4096
    v_add_u32 v13, 32768, v13
    v_mfma_f32_16x16x32_bf16 v[120:123], a[112:115], a[88:91], v[120:123]
    buffer_load_dwordx4 v4, s[32:35], s29 offen lds
    v_mfma_f32_16x16x32_bf16 v[124:127], a[120:123], a[88:91], v[124:127]
    s_add_u32 m0, s14, 149504
    s_add_u32 s29, s28, 8192
    v_add_u32 v14, 32768, v14
    v_mfma_f32_16x16x32_bf16 v[124:127], a[124:127], a[92:95], v[124:127]
    v_add_u32 v15, 32768, v15
    v_add_u32 v16, 32768, v16
    v_mfma_f32_16x16x32_bf16 v[108:111], a[124:127], a[84:87], v[108:111]
    buffer_load_dwordx4 v3, s[32:35], s29 offen lds
    v_mfma_f32_16x16x32_bf16 v[108:111], a[120:123], a[80:83], v[108:111]
    s_add_u32 m0, s14, 150528
    s_add_u32 s29, s28, 12288
    v_add_u32 v17, 32768, v17
    v_mfma_f32_16x16x32_bf16 v[92:95], a[120:123], a[72:75], v[92:95]
    v_add_u32 v18, 32768, v18
    v_add_u32 v19, 32768, v19
    v_mfma_f32_16x16x32_bf16 v[92:95], a[124:127], a[76:79], v[92:95]
    buffer_load_dwordx4 v4, s[32:35], s29 offen lds
    v_mfma_f32_16x16x32_bf16 v[76:79], a[124:127], a[68:71], v[76:79]
    v_add_u32 v20, 32768, v20
    v_mfma_f32_16x16x32_bf16 v[76:79], a[120:123], a[64:67], v[76:79]
    s_waitcnt vmcnt(14) lgkmcnt(0)
    s_barrier
    v_mfma_f32_16x16x32_bf16 v[64:67], a[32:35], a[0:3], v[64:67]
    ds_read_b64_tr_b16 a[96:97], v17 offset:16384
    ds_read_b64_tr_b16 a[98:99], v17 offset:20480
    v_mfma_f32_16x16x32_bf16 v[64:67], a[36:39], a[4:7], v[64:67]
    ds_read_b64_tr_b16 a[100:101], v17 offset:24576
    ds_read_b64_tr_b16 a[102:103], v17 offset:28672
    v_mfma_f32_16x16x32_bf16 v[80:83], a[36:39], a[12:15], v[80:83]
    ds_read_b64 a[64:65], v13 offset:0
    ds_read_b64 a[66:67], v13 offset:4096
    v_mfma_f32_16x16x32_bf16 v[80:83], a[32:35], a[8:11], v[80:83]
    ds_read_b64 a[68:69], v13 offset:8192
    ds_read_b64 a[70:71], v13 offset:12288
    buffer_load_dword v24, v23, s[8:11], s93 offen sc1
    v_mfma_f32_16x16x32_bf16 v[96:99], a[32:35], a[16:19], v[96:99]
    s_add_u32 m0, s14, 131072
    ds_read_b64 a[72:73], v14 offset:0
    ds_read_b64 a[74:75], v14 offset:4096
    s_add_u32 s0, s27, 1
    v_mfma_f32_16x16x32_bf16 v[96:99], a[36:39], a[20:23], v[96:99]
    s_and_b32 s0, s0, 15
    ds_read_b64 a[76:77], v14 offset:8192
    ds_read_b64 a[78:79], v14 offset:12288
    s_xor_b32 s0, s0, s22
    v_mfma_f32_16x16x32_bf16 v[112:115], a[36:39], a[28:31], v[112:115]
    s_lshl_b32 s0, s0, 14
    ds_read_b64 a[80:81], v15 offset:0
    ds_read_b64 a[82:83], v15 offset:4096
    s_add_u32 s0, s0, s12
    buffer_load_dwordx4 v1, s[8:11], s0 offen offset:0 sc1 lds
    v_mfma_f32_16x16x32_bf16 v[112:115], a[32:35], a[24:27], v[112:115]
    ds_read_b64 a[84:85], v15 offset:8192
    ds_read_b64 a[86:87], v15 offset:12288
    v_mfma_f32_16x16x32_bf16 v[116:119], a[40:43], a[24:27], v[116:119]
    ds_read_b64 a[88:89], v16 offset:0
    ds_read_b64 a[90:91], v16 offset:4096
    v_mfma_f32_16x16x32_bf16 v[116:119], a[44:47], a[28:31], v[116:119]
    ds_read_b64 a[92:93], v16 offset:8192
    ds_read_b64 a[94:95], v16 offset:12288
    buffer_load_dwordx4 v1, s[8:11], s0 offen offset:1024 sc1 lds
    v_mfma_f32_16x16x32_bf16 v[100:103], a[44:47], a[20:23], v[100:103]
    ds_read_b64_tr_b16 a[104:105], v18 offset:16384
    ds_read_b64_tr_b16 a[106:107], v18 offset:20480
    v_mfma_f32_16x16x32_bf16 v[100:103], a[40:43], a[16:19], v[100:103]
    ds_read_b64_tr_b16 a[108:109], v18 offset:24576
    ds_read_b64_tr_b16 a[110:111], v18 offset:28672
    v_mfma_f32_16x16x32_bf16 v[84:87], a[40:43], a[8:11], v[84:87]
    ds_read_b64_tr_b16 a[112:113], v19 offset:16384
    v_mfma_f32_16x16x32_bf16 v[84:87], a[44:47], a[12:15], v[84:87]
    ds_read_b64_tr_b16 a[114:115], v19 offset:20480
    buffer_load_dwordx4 v1, s[8:11], s0 offen offset:2048 sc1 lds
    v_mfma_f32_16x16x32_bf16 v[68:71], a[44:47], a[4:7], v[68:71]
    ds_read_b64_tr_b16 a[116:117], v19 offset:24576
    v_mfma_f32_16x16x32_bf16 v[68:71], a[40:43], a[0:3], v[68:71]
    ds_read_b64_tr_b16 a[118:119], v19 offset:28672
    v_mfma_f32_16x16x32_bf16 v[72:75], a[48:51], a[0:3], v[72:75]
    ds_read_b64_tr_b16 a[120:121], v20 offset:16384
    buffer_load_dwordx4 v1, s[8:11], s0 offen offset:3072 sc1 lds
    v_mfma_f32_16x16x32_bf16 v[72:75], a[52:55], a[4:7], v[72:75]
    s_add_u32 s28, s27, 2
    ds_read_b64_tr_b16 a[122:123], v20 offset:20480
    s_and_b32 s28, s28, 15
    v_mfma_f32_16x16x32_bf16 v[88:91], a[52:55], a[12:15], v[88:91]
    s_xor_b32 s28, s28, s22
    ds_read_b64_tr_b16 a[124:125], v20 offset:24576
    s_lshl_b32 s28, s28, 16
    v_mfma_f32_16x16x32_bf16 v[88:91], a[48:51], a[8:11], v[88:91]
    s_add_u32 s28, s28, s13
    ds_read_b64_tr_b16 a[126:127], v20 offset:28672
    s_add_u32 m0, s14, 16384
    s_add_u32 s29, s28, 0
    buffer_load_dwordx4 v3, s[32:35], s29 offen lds
    v_mfma_f32_16x16x32_bf16 v[104:107], a[48:51], a[16:19], v[104:107]
    s_add_u32 m0, s14, 17408
    s_add_u32 s29, s28, 4096
    v_add_u32 v13, s30, v1
    v_mfma_f32_16x16x32_bf16 v[104:107], a[52:55], a[20:23], v[104:107]
    v_xor_b32 v14, 1024, v13
    v_xor_b32 v15, 2048, v13
    v_mfma_f32_16x16x32_bf16 v[120:123], a[52:55], a[28:31], v[120:123]
    buffer_load_dwordx4 v4, s[32:35], s29 offen lds
    v_mfma_f32_16x16x32_bf16 v[120:123], a[48:51], a[24:27], v[120:123]
    s_add_u32 m0, s14, 18432
    s_add_u32 s29, s28, 8192
    v_xor_b32 v16, 3072, v13
    v_mfma_f32_16x16x32_bf16 v[124:127], a[56:59], a[24:27], v[124:127]
    v_add_u32 v17, 32768, v17
    v_add_u32 v18, 32768, v18
    v_mfma_f32_16x16x32_bf16 v[124:127], a[60:63], a[28:31], v[124:127]
    buffer_load_dwordx4 v3, s[32:35], s29 offen lds
    v_mfma_f32_16x16x32_bf16 v[108:111], a[60:63], a[20:23], v[108:111]
    s_add_u32 m0, s14, 19456
    s_add_u32 s29, s28, 12288
    v_add_u32 v19, 32768, v19
    v_mfma_f32_16x16x32_bf16 v[108:111], a[56:59], a[16:19], v[108:111]
    v_add_u32 v20, 32768, v20
    v_mfma_f32_16x16x32_bf16 v[92:95], a[56:59], a[8:11], v[92:95]
    buffer_load_dwordx4 v4, s[32:35], s29 offen lds
    v_mfma_f32_16x16x32_bf16 v[92:95], a[60:63], a[12:15], v[92:95]
    v_mfma_f32_16x16x32_bf16 v[76:79], a[60:63], a[4:7], v[76:79]
    v_mfma_f32_16x16x32_bf16 v[76:79], a[56:59], a[0:3], v[76:79]
    s_waitcnt vmcnt(8) lgkmcnt(0)
    s_barrier
    v_cmp_gt_u32 vcc, 1, v24
    s_cbranch_vccnz L_poll_c_o
L_back_c_o:
    v_mfma_f32_16x16x32_bf16 v[64:67], a[96:99], a[64:67], v[64:67]
    ds_read_b64_tr_b16 a[32:33], v17 offset:16384
    ds_read_b64_tr_b16 a[34:35], v17 offset:20480
    v_mfma_f32_16x16x32_bf16 v[64:67], a[100:103], a[68:71], v[64:67]
    s_add_u32 m0, s14, 0
    ds_read_b64_tr_b16 a[36:37], v17 offset:24576
    ds_read_b64_tr_b16 a[38:39], v17 offset:28672
    s_add_u32 s0, s27, 2
    v_mfma_f32_16x16x32_bf16 v[80:83], a[100:103], a[76:79], v[80:83]
    s_and_b32 s0, s0, 15
    ds_read_b128 a[0:3], v13 offset:0
    ds_read_b128 a[4:7], v13 offset:8192
    s_xor_b32 s0, s0, s22
    v_mfma_f32_16x16x32_bf16 v[80:83], a[96:99], a[72:75], v[80:83]
    s_lshl_b32 s0, s0, 14
    ds_read_b128 a[8:11], v14 offset:0
    s_add_u32 s0, s0, s12
    buffer_load_dwordx4 v1, s[8:11], s0 offen offset:0 sc1 lds
    v_mfma_f32_16x16x32_bf16 v[96:99], a[96:99], a[80:83], v[96:99]
    ds_read_b128 a[12:15], v14 offset:8192
    v_mfma_f32_16x16x32_bf16 v[96:99], a[100:103], a[84:87], v[96:99]
    ds_read_b128 a[16:19], v15 offset:0
    v_mfma_f32_16x16x32_bf16 v[112:115], a[100:103], a[92:95], v[112:115]
    ds_read_b128 a[20:23], v15 offset:8192
    v_mfma_f32_16x16x32_bf16 v[112:115], a[96:99], a[88:91], v[112:115]
    ds_read_b128 a[24:27], v16 offset:0
    v_mfma_f32_16x16x32_bf16 v[116:119], a[104:107], a[88:91], v[116:119]
    ds_read_b128 a[28:31], v16 offset:8192
    v_mfma_f32_16x16x32_bf16 v[116:119], a[108:111], a[92:95], v[116:119]
    ds_read_b64_tr_b16 a[40:41], v18 offset:16384
    v_add_u32 v13, 32768, v13
    v_mfma_f32_16x16x32_bf16 v[100:103], a[108:111], a[84:87], v[100:103]
    ds_read_b64_tr_b16 a[42:43], v18 offset:20480
    buffer_load_dwordx4 v1, s[8:11], s0 offen offset:1024 sc1 lds
    v_add_u32 v14, 32768, v14
    v_mfma_f32_16x16x32_bf16 v[100:103], a[104:107], a[80:83], v[100:103]
    ds_read_b64_tr_b16 a[44:45], v18 offset:24576
    v_add_u32 v15, 32768, v15
    v_mfma_f32_16x16x32_bf16 v[84:87], a[104:107], a[72:75], v[84:87]
    ds_read_b64_tr_b16 a[46:47], v18 offset:28672
    v_add_u32 v16, 32768, v16
    v_mfma_f32_16x16x32_bf16 v[84:87], a[108:111], a[76:79], v[84:87]
    ds_read_b64_tr_b16 a[48:49], v19 offset:16384
    v_add_u32 v17, 32768, v17
    v_mfma_f32_16x16x32_bf16 v[68:71], a[108:111], a[68:71], v[68:71]
    ds_read_b64_tr_b16 a[50:51], v19 offset:20480
    v_mfma_f32_16x16x32_bf16 v[68:71], a[104:107], a[64:67], v[68:71]
    ds_read_b64_tr_b16 a[52:53], v19 offset:24576
    v_mfma_f32_16x16x32_bf16 v[72:75], a[112:115], a[64:67], v[72:75]
    ds_read_b64_tr_b16 a[54:55], v19 offset:28672
    v_mfma_f32_16x16x32_bf16 v[72:75], a[116:119], a[68:71], v[72:75]
    ds_read_b64_tr_b16 a[56:57], v20 offset:16384
    v_mfma_f32_16x16x32_bf16 v[88:91], a[116:119], a[76:79], v[88:91]
    ds_read_b64_tr_b16 a[58:59], v20 offset:20480
    buffer_load_dwordx4 v1, s[8:11], s0 offen offset:2048 sc1 lds
    v_mfma_f32_16x16x32_bf16 v[88:91], a[112:115], a[72:75], v[88:91]
    ds_read_b64_tr_b16 a[60:61], v20 offset:24576
    v_mfma_f32_16x16x32_bf16 v[104:107], a[112:115], a[80:83], v[104:107]
    ds_read_b64_tr_b16 a[62:63], v20 offset:28672
    v_add_u32 v18, 32768, v18
    v_mfma_f32_16x16x32_bf16 v[104:107], a[116:119], a[84:87], v[104:107]
    v_add_u32 v19, 32768, v19
    v_add_u32 v20, 32768, v20
    v_mfma_f32_16x16x32_bf16 v[120:123], a[116:119], a[92:95], v[120:123]
    v_mfma_f32_16x16x32_bf16 v[120:123], a[112:115], a[88:91], v[120:123]
    v_mfma_f32_16x16x32_bf16 v[124:127], a[120:123], a[88:91], v[124:127]
    buffer_load_dwordx4 v1, s[8:11], s0 offen offset:3072 sc1 lds
    v_mfma_f32_16x16x32_bf16 v[124:127], a[124:127], a[92:95], v[124:127]
    v_mfma_f32_16x16x32_bf16 v[108:111], a[124:127], a[84:87], v[108:111]
    v_mfma_f32_16x16x32_bf16 v[108:111], a[120:123], a[80:83], v[108:111]
    v_mfma_f32_16x16x32_bf16 v[92:95], a[120:123], a[72:75], v[92:95]
    v_mfma_f32_16x16x32_bf16 v[92:95], a[124:127], a[76:79], v[92:95]
    v_mfma_f32_16x16x32_bf16 v[76:79], a[124:127], a[68:71], v[76:79]
    v_mfma_f32_16x16x32_bf16 v[76:79], a[120:123], a[64:67], v[76:79]
    s_waitcnt vmcnt(8) lgkmcnt(0)
    s_barrier
    v_mfma_f32_16x16x32_bf16 v[64:67], a[32:35], a[0:3], v[64:67]
    ds_read_b64_tr_b16 a[96:97], v17 offset:16384
    ds_read_b64_tr_b16 a[98:99], v17 offset:20480
    v_mfma_f32_16x16x32_bf16 v[64:67], a[36:39], a[4:7], v[64:67]
    s_add_u32 m0, s14, 32768
    ds_read_b64_tr_b16 a[100:101], v17 offset:24576
    ds_read_b64_tr_b16 a[102:103], v17 offset:28672
    s_add_u32 s0, s27, 3
    v_mfma_f32_16x16x32_bf16 v[80:83], a[36:39], a[12:15], v[80:83]
    s_and_b32 s0, s0, 15
    s_xor_b32 s0, s0, s22
    s_lshl_b32 s0, s0, 14
    s_add_u32 s0, s0, s12
    buffer_load_dwordx4 v1, s[8:11], s0 offen offset:0 sc1 lds
    v_mfma_f32_16x16x32_bf16 v[80:83], a[32:35], a[8:11], v[80:83]
    ds_read_b128 a[64:67], v13 offset:0
    ds_read_b128 a[68:71], v13 offset:8192
    v_mfma_f32_16x16x32_bf16 v[96:99], a[32:35], a[16:19], v[96:99]
    ds_read_b128 a[72:75], v14 offset:0
    v_mfma_f32_16x16x32_bf16 v[96:99], a[36:39], a[20:23], v[96:99]
    buffer_load_dwordx4 v1, s[8:11], s0 offen offset:1024 sc1 lds
    v_mfma_f32_16x16x32_bf16 v[112:115], a[36:39], a[28:31], v[112:115]
    ds_read_b128 a[76:79], v14 offset:8192
    v_mfma_f32_16x16x32_bf16 v[112:115], a[32:35], a[24:27], v[112:115]
    ds_read_b128 a[80:83], v15 offset:0
    v_mfma_f32_16x16x32_bf16 v[116:119], a[40:43], a[24:27], v[116:119]
    ds_read_b128 a[84:87], v15 offset:8192
    v_mfma_f32_16x16x32_bf16 v[116:119], a[44:47], a[28:31], v[116:119]
    buffer_load_dwordx4 v1, s[8:11], s0 offen offset:2048 sc1 lds
    v_mfma_f32_16x16x32_bf16 v[100:103], a[44:47], a[20:23], v[100:103]
    ds_read_b128 a[88:91], v16 offset:0
    v_mfma_f32_16x16x32_bf16 v[100:103], a[40:43], a[16:19], v[100:103]
    ds_read_b128 a[92:95], v16 offset:8192
    v_mfma_f32_16x16x32_bf16 v[84:87], a[40:43], a[8:11], v[84:87]
    ds_read_b64_tr_b16 a[104:105], v18 offset:16384
    v_add_u32 v13, 4294836224, v13
    v_mfma_f32_16x16x32_bf16 v[84:87], a[44:47], a[12:15], v[84:87]
    buffer_load_dwordx4 v1, s[8:11], s0 offen offset:3072 sc1 lds
    v_mfma_f32_16x16x32_bf16 v[68:71], a[44:47], a[4:7], v[68:71]
    s_add_u32 s28, s27, 3
    ds_read_b64_tr_b16 a[106:107], v18 offset:20480
    v_add_u32 v14, 4294836224, v14
    v_mfma_f32_16x16x32_bf16 v[68:71], a[40:43], a[0:3], v[68:71]
    s_and_b32 s28, s28, 15
    ds_read_b64_tr_b16 a[108:109], v18 offset:24576
    v_add_u32 v15, 4294836224, v15
    v_mfma_f32_16x16x32_bf16 v[72:75], a[48:51], a[0:3], v[72:75]
    s_xor_b32 s28, s28, s22
    ds_read_b64_tr_b16 a[110:111], v18 offset:28672
    v_add_u32 v16, 4294836224, v16
    v_mfma_f32_16x16x32_bf16 v[72:75], a[52:55], a[4:7], v[72:75]
    s_lshl_b32 s28, s28, 16
    s_add_u32 s28, s28, s13
    s_add_u32 m0, s14, 49152
    s_add_u32 s29, s28, 0
    buffer_load_dwordx4 v3, s[32:35], s29 offen lds
    v_mfma_f32_16x16x32_bf16 v[88:91], a[52:55], a[12:15], v[88:91]
    s_add_u32 m0, s14, 50176
    ds_read_b64_tr_b16 a[112:113], v19 offset:16384
    v_add_u32 v17, 4294836224, v17
    v_mfma_f32_16x16x32_bf16 v[88:91], a[48:51], a[8:11], v[88:91]
    s_add_u32 s29, s28, 4096
    ds_read_b64_tr_b16 a[114:115], v19 offset:20480
    v_mfma_f32_16x16x32_bf16 v[104:107], a[48:51], a[16:19], v[104:107]
    buffer_load_dwordx4 v4, s[32:35], s29 offen lds
    v_mfma_f32_16x16x32_bf16 v[104:107], a[52:55], a[20:23], v[104:107]
    s_add_u32 m0, s14, 51200
    ds_read_b64_tr_b16 a[116:117], v19 offset:24576
    s_add_u32 s29, s28, 8192
    v_mfma_f32_16x16x32_bf16 v[120:123], a[52:55], a[28:31], v[120:123]
    ds_read_b64_tr_b16 a[118:119], v19 offset:28672
    v_mfma_f32_16x16x32_bf16 v[120:123], a[48:51], a[24:27], v[120:123]
    ds_read_b64_tr_b16 a[120:121], v20 offset:16384
    v_mfma_f32_16x16x32_bf16 v[124:127], a[56:59], a[24:27], v[124:127]
    buffer_load_dwordx4 v3, s[32:35], s29 offen lds
    v_mfma_f32_16x16x32_bf16 v[124:127], a[60:63], a[28:31], v[124:127]
    s_add_u32 m0, s14, 52224
    ds_read_b64_tr_b16 a[122:123], v20 offset:20480
    s_add_u32 s29, s28, 12288
    v_mfma_f32_16x16x32_bf16 v[108:111], a[60:63], a[20:23], v[108:111]
    ds_read_b64_tr_b16 a[124:125], v20 offset:24576
    v_mfma_f32_16x16x32_bf16 v[108:111], a[56:59], a[16:19], v[108:111]
    ds_read_b64_tr_b16 a[126:127], v20 offset:28672
    v_add_u32 v18, 4294836224, v18
    v_mfma_f32_16x16x32_bf16 v[92:95], a[56:59], a[8:11], v[92:95]
    buffer_load_dwordx4 v4, s[32:35], s29 offen lds
    v_mfma_f32_16x16x32_bf16 v[92:95], a[60:63], a[12:15], v[92:95]
    v_add_u32 v19, 4294836224, v19
    v_add_u32 v20, 4294836224, v20
    v_mfma_f32_16x16x32_bf16 v[76:79], a[60:63], a[4:7], v[76:79]
    v_mfma_f32_16x16x32_bf16 v[76:79], a[56:59], a[0:3], v[76:79]
    s_waitcnt vmcnt(8) lgkmcnt(0)
    s_barrier
    v_mfma_f32_16x16x32_bf16 v[64:67], a[96:99], a[64:67], v[64:67]
    ds_read_b64_tr_b16 a[32:33], v17 offset:16384
    ds_read_b64_tr_b16 a[34:35], v17 offset:20480
    v_mfma_f32_16x16x32_bf16 v[64:67], a[100:103], a[68:71], v[64:67]
    s_add_u32 m0, s14, 65536
    ds_read_b64_tr_b16 a[36:37], v17 offset:24576
    ds_read_b64_tr_b16 a[38:39], v17 offset:28672
    s_add_u32 s0, s27, 4
    v_mfma_f32_16x16x32_bf16 v[80:83], a[100:103], a[76:79], v[80:83]
    s_and_b32 s0, s0, 15
    s_xor_b32 s0, s0, s22
    s_lshl_b32 s0, s0, 14
    s_add_u32 s0, s0, s12
    buffer_load_dwordx4 v1, s[8:11], s0 offen offset:0 sc1 lds
    v_mfma_f32_16x16x32_bf16 v[80:83], a[96:99], a[72:75], v[80:83]
    ds_read_b128 a[0:3], v13 offset:0
    ds_read_b128 a[4:7], v13 offset:8192
    v_mfma_f32_16x16x32_bf16 v[96:99], a[96:99], a[80:83], v[96:99]
    ds_read_b128 a[8:11], v14 offset:0
    v_mfma_f32_16x16x32_bf16 v[96:99], a[100:103], a[84:87], v[96:99]
    buffer_load_dwordx4 v1, s[8:11], s0 offen offset:1024 sc1 lds
    v_mfma_f32_16x16x32_bf16 v[112:115], a[100:103], a[92:95], v[112:115]
    ds_read_b128 a[12:15], v14 offset:8192
    v_mfma_f32_16x16x32_bf16 v[112:115], a[96:99], a[88:91], v[112:115]
    ds_read_b128 a[16:19], v15 offset:0
    v_mfma_f32_16x16x32_bf16 v[116:119], a[104:107], a[88:91], v[116:119]
    ds_read_b128 a[20:23], v15 offset:8192
    v_mfma_f32_16x16x32_bf16 v[116:119], a[108:111], a[92:95], v[116:119]
    buffer_load_dwordx4 v1, s[8:11], s0 offen offset:2048 sc1 lds
    v_mfma_f32_16x16x32_bf16 v[100:103], a[108:111], a[84:87], v[100:103]
    ds_read_b128 a[24:27], v16 offset:0
    v_mfma_f32_16x16x32_bf16 v[100:103], a[104:107], a[80:83], v[100:103]
    ds_read_b128 a[28:31], v16 offset:8192
    v_mfma_f32_16x16x32_bf16 v[84:87], a[104:107], a[72:75], v[84:87]
    ds_read_b64_tr_b16 a[40:41], v18 offset:16384
    v_add_u32 v13, 32768, v13
    v_mfma_f32_16x16x32_bf16 v[84:87], a[108:111], a[76:79], v[84:87]
    buffer_load_dwordx4 v1, s[8:11], s0 offen offset:3072 sc1 lds
    v_mfma_f32_16x16x32_bf16 v[68:71], a[108:111], a[68:71], v[68:71]
    s_add_u32 s28, s27, 4
    ds_read_b64_tr_b16 a[42:43], v18 offset:20480
    v_add_u32 v14, 32768, v14
    v_mfma_f32_16x16x32_bf16 v[68:71], a[104:107], a[64:67], v[68:71]
    s_and_b32 s28, s28, 15
    ds_read_b64_tr_b16 a[44:45], v18 offset:24576
    v_add_u32 v15, 32768, v15
    v_mfma_f32_16x16x32_bf16 v[72:75], a[112:115], a[64:67], v[72:75]
    s_xor_b32 s28, s28, s22
    ds_read_b64_tr_b16 a[46:47], v18 offset:28672
    v_add_u32 v16, 32768, v16
    v_mfma_f32_16x16x32_bf16 v[72:75], a[116:119], a[68:71], v[72:75]
    s_lshl_b32 s28, s28, 16
    s_add_u32 s28, s28, s13
    s_add_u32 m0, s14, 81920
    s_add_u32 s29, s28, 0
    buffer_load_dwordx4 v3, s[32:35], s29 offen lds
    v_mfma_f32_16x16x32_bf16 v[88:91], a[116:119], a[76:79], v[88:91]
    s_add_u32 m0, s14, 82944
    ds_read_b64_tr_b16 a[48:49], v19 offset:16384
    v_add_u32 v17, 32768, v17
    v_mfma_f32_16x16x32_bf16 v[88:91], a[112:115], a[72:75], v[88:91]
    s_add_u32 s29, s28, 4096
    ds_read_b64_tr_b16 a[50:51], v19 offset:20480
    v_mfma_f32_16x16x32_bf16 v[104:107], a[112:115], a[80:83], v[104:107]
    buffer_load_dwordx4 v4, s[32:35], s29 offen lds
    v_mfma_f32_16x16x32_bf16 v[104:107], a[116:119], a[84:87], v[104:107]
    s_add_u32 m0, s14, 83968
    ds_read_b64_tr_b16 a[52:53], v19 offset:24576
    s_add_u32 s29, s28, 8192
    v_mfma_f32_16x16x32_bf16 v[120:123], a[116:119], a[92:95], v[120:123]
    ds_read_b64_tr_b16 a[54:55], v19 offset:28672
    v_mfma_f32_16x16x32_bf16 v[120:123], a[112:115], a[88:91], v[120:123]
    ds_read_b64_tr_b16 a[56:57], v20 offset:16384
    v_mfma_f32_16x16x32_bf16 v[124:127], a[120:123], a[88:91], v[124:127]
    buffer_load_dwordx4 v3, s[32:35], s29 offen lds
    v_mfma_f32_16x16x32_bf16 v[124:127], a[124:127], a[92:95], v[124:127]
    s_add_u32 m0, s14, 84992
    ds_read_b64_tr_b16 a[58:59], v20 offset:20480
    s_add_u32 s29, s28, 12288
    v_mfma_f32_16x16x32_bf16 v[108:111], a[124:127], a[84:87], v[108:111]
    ds_read_b64_tr_b16 a[60:61], v20 offset:24576
    v_mfma_f32_16x16x32_bf16 v[108:111], a[120:123], a[80:83], v[108:111]
    ds_read_b64_tr_b16 a[62:63], v20 offset:28672
    v_add_u32 v18, 32768, v18
    v_mfma_f32_16x16x32_bf16 v[92:95], a[120:123], a[72:75], v[92:95]
    buffer_load_dwordx4 v4, s[32:35], s29 offen lds
    v_mfma_f32_16x16x32_bf16 v[92:95], a[124:127], a[76:79], v[92:95]
    s_add_u32 s27, s27, 5
    v_add_u32 v19, 32768, v19
    v_add_u32 v20, 32768, v20
    v_mfma_f32_16x16x32_bf16 v[76:79], a[124:127], a[68:71], v[76:79]
    s_add_u32 s14, s14, 98304
    s_mov_b32 s15, 1
    s_mov_b32 s16, 1
    v_mfma_f32_16x16x32_bf16 v[76:79], a[120:123], a[64:67], v[76:79]
    s_mov_b32 s3, 0
L_p3_loop_o:
    s_waitcnt vmcnt(8) lgkmcnt(0)
    s_barrier
    v_mfma_f32_16x16x32_bf16 v[64:67], a[32:35], a[0:3], v[64:67]
    s_add_u32 s15, s15, 1
    ds_read_b64_tr_b16 a[96:97], v17 offset:16384
    ds_read_b64_tr_b16 a[98:99], v17 offset:20480
    s_cmp_eq_u32 s15, 5
    v_mfma_f32_16x16x32_bf16 v[64:67], a[36:39], a[4:7], v[64:67]
    s_cselect_b32 s15, 0, s15
    ds_read_b64_tr_b16 a[100:101], v17 offset:24576
    ds_read_b64_tr_b16 a[102:103], v17 offset:28672
    s_cselect_b32 s19, 4294836224, s24
    v_mfma_f32_16x16x32_bf16 v[80:83], a[36:39], a[12:15], v[80:83]
    s_mov_b32 m0, s14
    s_and_b32 s0, s27, 15
    s_xor_b32 s0, s0, s22
    s_lshl_b32 s0, s0, 14
    s_add_u32 s0, s0, s12
    buffer_load_dwordx4 v1, s[8:11], s0 offen offset:0 sc1 lds
    v_mfma_f32_16x16x32_bf16 v[80:83], a[32:35], a[8:11], v[80:83]
    ds_read_b128 a[64:67], v13 offset:0
    ds_read_b128 a[68:71], v13 offset:8192
    v_mfma_f32_16x16x32_bf16 v[96:99], a[32:35], a[16:19], v[96:99]
    ds_read_b128 a[72:75], v14 offset:0
    v_mfma_f32_16x16x32_bf16 v[96:99], a[36:39], a[20:23], v[96:99]
    buffer_load_dwordx4 v1, s[8:11], s0 offen offset:1024 sc1 lds
    v_mfma_f32_16x16x32_bf16 v[112:115], a[36:39], a[28:31], v[112:115]
    ds_read_b128 a[76:79], v14 offset:8192
    v_mfma_f32_16x16x32_bf16 v[112:115], a[32:35], a[24:27], v[112:115]
    ds_read_b128 a[80:83], v15 offset:0
    v_mfma_f32_16x16x32_bf16 v[116:119], a[40:43], a[24:27], v[116:119]
    ds_read_b128 a[84:87], v15 offset:8192
    v_mfma_f32_16x16x32_bf16 v[116:119], a[44:47], a[28:31], v[116:119]
    buffer_load_dwordx4 v1, s[8:11], s0 offen offset:2048 sc1 lds
    v_mfma_f32_16x16x32_bf16 v[100:103], a[44:47], a[20:23], v[100:103]
    ds_read_b128 a[88:91], v16 offset:0
    v_mfma_f32_16x16x32_bf16 v[100:103], a[40:43], a[16:19], v[100:103]
    ds_read_b128 a[92:95], v16 offset:8192
    v_mfma_f32_16x16x32_bf16 v[84:87], a[40:43], a[8:11], v[84:87]
    ds_read_b64_tr_b16 a[104:105], v18 offset:16384
    v_add_u32 v13, s19, v13
    v_mfma_f32_16x16x32_bf16 v[84:87], a[44:47], a[12:15], v[84:87]
    buffer_load_dwordx4 v1, s[8:11], s0 offen offset:3072 sc1 lds
    v_mfma_f32_16x16x32_bf16 v[68:71], a[44:47], a[4:7], v[68:71]
    s_and_b32 s28, s27, 15
    ds_read_b64_tr_b16 a[106:107], v18 offset:20480
    v_add_u32 v14, s19, v14
    v_mfma_f32_16x16x32_bf16 v[68:71], a[40:43], a[0:3], v[68:71]
    s_xor_b32 s28, s28, s22
    ds_read_b64_tr_b16 a[108:109], v18 offset:24576
    v_add_u32 v15, s19, v15
    v_mfma_f32_16x16x32_bf16 v[72:75], a[48:51], a[0:3], v[72:75]
    s_lshl_b32 s28, s28, 16
    ds_read_b64_tr_b16 a[110:111], v18 offset:28672
    v_add_u32 v16, s19, v16
    v_mfma_f32_16x16x32_bf16 v[72:75], a[52:55], a[4:7], v[72:75]
    s_add_u32 s28, s28, s13
    s_add_u32 m0, s14, 16384
    s_add_u32 s29, s28, 0
    buffer_load_dwordx4 v3, s[32:35], s29 offen lds
    v_mfma_f32_16x16x32_bf16 v[88:91], a[52:55], a[12:15], v[88:91]
    s_add_u32 m0, s14, 17408
    ds_read_b64_tr_b16 a[112:113], v19 offset:16384
    v_add_u32 v17, s19, v17
    v_mfma_f32_16x16x32_bf16 v[88:91], a[48:51], a[8:11], v[88:91]
    s_add_u32 s29, s28, 4096
    ds_read_b64_tr_b16 a[114:115], v19 offset:20480
    v_mfma_f32_16x16x32_bf16 v[104:107], a[48:51], a[16:19], v[104:107]
    buffer_load_dwordx4 v4, s[32:35], s29 offen lds
    v_mfma_f32_16x16x32_bf16 v[104:107], a[52:55], a[20:23], v[104:107]
    s_add_u32 m0, s14, 18432
    ds_read_b64_tr_b16 a[116:117], v19 offset:24576
    s_add_u32 s29, s28, 8192
    v_mfma_f32_16x16x32_bf16 v[120:123], a[52:55], a[28:31], v[120:123]
    ds_read_b64_tr_b16 a[118:119], v19 offset:28672
    v_mfma_f32_16x16x32_bf16 v[120:123], a[48:51], a[24:27], v[120:123]
    ds_read_b64_tr_b16 a[120:121], v20 offset:16384
    v_mfma_f32_16x16x32_bf16 v[124:127], a[56:59], a[24:27], v[124:127]
    buffer_load_dwordx4 v3, s[32:35], s29 offen lds
    v_mfma_f32_16x16x32_bf16 v[124:127], a[60:63], a[28:31], v[124:127]
    s_add_u32 m0, s14, 19456
    ds_read_b64_tr_b16 a[122:123], v20 offset:20480
    s_add_u32 s29, s28, 12288
    v_mfma_f32_16x16x32_bf16 v[108:111], a[60:63], a[20:23], v[108:111]
    ds_read_b64_tr_b16 a[124:125], v20 offset:24576
    v_mfma_f32_16x16x32_bf16 v[108:111], a[56:59], a[16:19], v[108:111]
    ds_read_b64_tr_b16 a[126:127], v20 offset:28672
    v_add_u32 v18, s19, v18
    v_mfma_f32_16x16x32_bf16 v[92:95], a[56:59], a[8:11], v[92:95]
L_tp25:
    s_cbranch_execz L_tp20
    buffer_load_dwordx4 v4, s[32:35], s29 offen lds
    v_mfma_f32_16x16x32_bf16 v[92:95], a[60:63], a[12:15], v[92:95]
    s_add_u32 s27, s27, 1
    v_add_u32 v19, s19, v19
    v_add_u32 v20, s19, v20
    v_mfma_f32_16x16x32_bf16 v[76:79], a[60:63], a[4:7], v[76:79]
    s_add_u32 s14, s14, 32768
    s_sub_u32 s7, s14, 163840
    s_cselect_b32 s14, s14, s7
    v_mfma_f32_16x16x32_bf16 v[76:79], a[56:59], a[0:3], v[76:79]
    s_waitcnt vmcnt(8) lgkmcnt(0)
    s_barrier
    v_mfma_f32_16x16x32_bf16 v[64:67], a[96:99], a[64:67], v[64:67]
    s_add_u32 s15, s15, 1
    ds_read_b64_tr_b16 a[32:33], v17 offset:16384
    ds_read_b64_tr_b16 a[34:35], v17 offset:20480
    s_cmp_eq_u32 s15, 5
    v_mfma_f32_16x16x32_bf16 v[64:67], a[100:103], a[68:71], v[64:67]
    s_cselect_b32 s15, 0, s15
    ds_read_b64_tr_b16 a[36:37], v17 offset:24576
    ds_read_b64_tr_b16 a[38:39], v17 offset:28672
    s_cselect_b32 s19, 4294836224, s24
    v_mfma_f32_16x16x32_bf16 v[80:83], a[100:103], a[76:79], v[80:83]
    s_mov_b32 m0, s14
    s_and_b32 s0, s27, 15
    s_xor_b32 s0, s0, s22
    s_lshl_b32 s0, s0, 14
    s_add_u32 s0, s0, s12
    buffer_load_dwordx4 v1, s[8:11], s0 offen offset:0 sc1 lds
    v_mfma_f32_16x16x32_bf16 v[80:83], a[96:99], a[72:75], v[80:83]
    ds_read_b128 a[0:3], v13 offset:0
    ds_read_b128 a[4:7], v13 offset:8192
    v_mfma_f32_16x16x32_bf16 v[96:99], a[96:99], a[80:83], v[96:99]
    ds_read_b128 a[8:11], v14 offset:0
    v_mfma_f32_16x16x32_bf16 v[96:99], a[100:103], a[84:87], v[96:99]
    buffer_load_dwordx4 v1, s[8:11], s0 offen offset:1024 sc1 lds
    v_mfma_f32_16x16x32_bf16 v[112:115], a[100:103], a[92:95], v[112:115]
    ds_read_b128 a[12:15], v14 offset:8192
    v_mfma_f32_16x16x32_bf16 v[112:115], a[96:99], a[88:91], v[112:115]
    ds_read_b128 a[16:19], v15 offset:0
    v_mfma_f32_16x16x32_bf16 v[116:119], a[104:107], a[88:91], v[116:119]
    ds_read_b128 a[20:23], v15 offset:8192
    v_mfma_f32_16x16x32_bf16 v[116:119], a[108:111], a[92:95], v[116:119]
    buffer_load_dwordx4 v1, s[8:11], s0 offen offset:2048 sc1 lds
    v_mfma_f32_16x16x32_bf16 v[100:103], a[108:111], a[84:87], v[100:103]
    ds_read_b128 a[24:27], v16 offset:0
    v_mfma_f32_16x16x32_bf16 v[100:103], a[104:107], a[80:83], v[100:103]
    ds_read_b128 a[28:31], v16 offset:8192
    v_mfma_f32_16x16x32_bf16 v[84:87], a[104:107], a[72:75], v[84:87]
    ds_read_b64_tr_b16 a[40:41], v18 offset:16384
    v_add_u32 v13, s19, v13
    v_mfma_f32_16x16x32_bf16 v[84:87], a[108:111], a[76:79], v[84:87]
    buffer_load_dwordx4 v1, s[8:11], s0 offen offset:3072 sc1 lds
    v_mfma_f32_16x16x32_bf16 v[68:71], a[108:111], a[68:71], v[68:71]
    s_and_b32 s28, s27, 15
    ds_read_b64_tr_b16 a[42:43], v18 offset:20480
    v_add_u32 v14, s19, v14
    v_mfma_f32_16x16x32_bf16 v[68:71], a[104:107], a[64:67], v[68:71]
    s_xor_b32 s28, s28, s22
    ds_read_b64_tr_b16 a[44:45], v18 offset:24576
    v_add_u32 v15, s19, v15
    v_mfma_f32_16x16x32_bf16 v[72:75], a[112:115], a[64:67], v[72:75]
    s_lshl_b32 s28, s28, 16
    ds_read_b64_tr_b16 a[46:47], v18 offset:28672
    v_add_u32 v16, s19, v16
    v_mfma_f32_16x16x32_bf16 v[72:75], a[116:119], a[68:71], v[72:75]
    s_add_u32 s28, s28, s13
    s_add_u32 m0, s14, 16384
    s_add_u32 s29, s28, 0
    buffer_load_dwordx4 v3, s[32:35], s29 offen lds
    v_mfma_f32_16x16x32_bf16 v[88:91], a[116:119], a[76:79], v[88:91]
    s_add_u32 m0, s14, 17408
    ds_read_b64_tr_b16 a[48:49], v19 offset:16384
    v_add_u32 v17, s19, v17
    v_mfma_f32_16x16x32_bf16 v[88:91], a[112:115], a[72:75], v[88:91]
    s_add_u32 s29, s28, 4096
    ds_read_b64_tr_b16 a[50:51], v19 offset:20480
    v_mfma_f32_16x16x32_bf16 v[104:107], a[112:115], a[80:83], v[104:107]
    buffer_load_dwordx4 v4, s[32:35], s29 offen lds
    v_mfma_f32_16x16x32_bf16 v[104:107], a[116:119], a[84:87], v[104:107]
    s_add_u32 m0, s14, 18432
    ds_read_b64_tr_b16 a[52:53], v19 offset:24576
    s_add_u32 s29, s28, 8192
    v_mfma_f32_16x16x32_bf16 v[120:123], a[116:119], a[92:95], v[120:123]
    ds_read_b64_tr_b16 a[54:55], v19 offset:28672
    v_mfma_f32_16x16x32_bf16 v[120:123], a[112:115], a[88:91], v[120:123]
    ds_read_b64_tr_b16 a[56:57], v20 offset:16384
    v_mfma_f32_16x16x32_bf16 v[124:127], a[120:123], a[88:91], v[124:127]
    buffer_load_dwordx4 v3, s[32:35], s29 offen lds
    v_mfma_f32_16x16x32_bf16 v[124:127], a[124:127], a[92:95], v[124:127]
    s_add_u32 m0, s14, 19456
    ds_read_b64_tr_b16 a[58:59], v20 offset:20480
    s_add_u32 s29, s28, 12288
    v_mfma_f32_16x16x32_bf16 v[108:111], a[124:127], a[84:87], v[108:111]
    ds_read_b64_tr_b16 a[60:61], v20 offset:24576
    v_mfma_f32_16x16x32_bf16 v[108:111], a[120:123], a[80:83], v[108:111]
    ds_read_b64_tr_b16 a[62:63], v20 offset:28672
    v_add_u32 v18, s19, v18
    v_mfma_f32_16x16x32_bf16 v[92:95], a[120:123], a[72:75], v[92:95]
    buffer_load_dwordx4 v4, s[32:35], s29 offen lds
    v_mfma_f32_16x16x32_bf16 v[92:95], a[124:127], a[76:79], v[92:95]
    s_add_u32 s27, s27, 1
    v_add_u32 v19, s19, v19
    v_add_u32 v20, s19, v20
    v_mfma_f32_16x16x32_bf16 v[76:79], a[124:127], a[68:71], v[76:79]
    s_add_u32 s14, s14, 32768
    s_sub_u32 s7, s14, 163840
    s_cselect_b32 s14, s14, s7
    v_mfma_f32_16x16x32_bf16 v[76:79], a[120:123], a[64:67], v[76:79]
    s_sub_u32 s16, s16, 1
    s_cmp_lg_u32 s16, 0
    s_cbranch_scc1 L_p3_loop_o
    s_add_u32 s3, s3, 1
    s_cmp_eq_u32 s3, 3
    s_cbranch_scc1 L_p3_out_o
    s_cmp_eq_u32 s3, 2
    s_cbranch_scc1 L_p3_chk_o
    s_add_u32 s93, s93, 16
    s_mov_b32 s16, 1
    buffer_load_dword v24, v23, s[8:11], s93 offen sc1
    s_branch L_p3_loop_o
L_p3_chk_o:
    v_cmp_gt_u32 vcc, 1, v24
    s_cbranch_vccnz L_poll_d_o
L_back_d_o:
    s_mov_b32 s16, 3
    s_branch L_p3_loop_o
L_p3_out_o:
    s_waitcnt vmcnt(8) lgkmcnt(0)
    s_barrier
    v_mfma_f32_16x16x32_bf16 v[64:67], a[32:35], a[0:3], v[64:67]
    ds_read_b64_tr_b16 a[96:97], v17 offset:16384
    ds_read_b64_tr_b16 a[98:99], v17 offset:20480
    v_mfma_f32_16x16x32_bf16 v[64:67], a[36:39], a[4:7], v[64:67]
    s_and_b32 s93, s69, 0xfffffff0
    ds_read_b64_tr_b16 a[100:101], v17 offset:24576
    ds_read_b64_tr_b16 a[102:103], v17 offset:28672
    v_mfma_f32_16x16x32_bf16 v[80:83], a[36:39], a[12:15], v[80:83]
    ds_read_b128 a[64:67], v13 offset:0
    ds_read_b128 a[68:71], v13 offset:8192
    v_mfma_f32_16x16x32_bf16 v[80:83], a[32:35], a[8:11], v[80:83]
    ds_read_b128 a[72:75], v14 offset:0
    buffer_load_dword v24, v23, s[8:11], s93 offen sc1
    v_mfma_f32_16x16x32_bf16 v[96:99], a[32:35], a[16:19], v[96:99]
    s_mov_b32 m0, s14
    ds_read_b128 a[76:79], v14 offset:8192
    s_and_b32 s0, s27, 15
    v_mfma_f32_16x16x32_bf16 v[96:99], a[36:39], a[20:23], v[96:99]
    s_xor_b32 s0, s0, s22
    ds_read_b128 a[80:83], v15 offset:0
    s_lshl_b32 s0, s0, 14
    v_mfma_f32_16x16x32_bf16 v[112:115], a[36:39], a[28:31], v[112:115]
    s_add_u32 s0, s0, s12
    ds_read_b128 a[84:87], v15 offset:8192
    buffer_load_dwordx4 v1, s[8:11], s0 offen offset:0 sc1 lds
    v_mfma_f32_16x16x32_bf16 v[112:115], a[32:35], a[24:27], v[112:115]
    ds_read_b128 a[88:91], v16 offset:0
    v_mfma_f32_16x16x32_bf16 v[116:119], a[40:43], a[24:27], v[116:119]
    ds_read_b128 a[92:95], v16 offset:8192
    v_mfma_f32_16x16x32_bf16 v[116:119], a[44:47], a[28:31], v[116:119]
    ds_read_b64_tr_b16 a[104:105], v18 offset:16384
    buffer_load_dwordx4 v1, s[8:11], s0 offen offset:1024 sc1 lds
    v_add_u32 v13, 32768, v13
    v_mfma_f32_16x16x32_bf16 v[100:103], a[44:47], a[20:23], v[100:103]
    ds_read_b64_tr_b16 a[106:107], v18 offset:20480
    v_add_u32 v14, 32768, v14
    v_mfma_f32_16x16x32_bf16 v[100:103], a[40:43], a[16:19], v[100:103]
    ds_read_b64_tr_b16 a[108:109], v18 offset:24576
    v_add_u32 v15, 32768, v15
    v_mfma_f32_16x16x32_bf16 v[84:87], a[40:43], a[8:11], v[84:87]
    ds_read_b64_tr_b16 a[110:111], v18 offset:28672
    v_add_u32 v16, 32768, v16
    v_mfma_f32_16x16x32_bf16 v[84:87], a[44:47], a[12:15], v[84:87]
    ds_read_b64_tr_b16 a[112:113], v19 offset:16384
    buffer_load_dwordx4 v1, s[8:11], s0 offen offset:2048 sc1 lds
    v_add_u32 v17, 32768, v17
    v_mfma_f32_16x16x32_bf16 v[68:71], a[44:47], a[4:7], v[68:71]
    ds_read_b64_tr_b16 a[114:115], v19 offset:20480
    v_mfma_f32_16x16x32_bf16 v[68:71], a[40:43], a[0:3], v[68:71]
    ds_read_b64_tr_b16 a[116:117], v19 offset:24576
    v_mfma_f32_16x16x32_bf16 v[72:75], a[48:51], a[0:3], v[72:75]
    ds_read_b64_tr_b16 a[118:119], v19 offset:28672
    buffer_load_dwordx4 v1, s[8:11], s0 offen offset:3072 sc1 lds
    v_mfma_f32_16x16x32_bf16 v[72:75], a[52:55], a[4:7], v[72:75]
    s_and_b32 s28, s27, 15
    ds_read_b64_tr_b16 a[120:121], v20 offset:16384
    s_xor_b32 s28, s28, s22
    v_mfma_f32_16x16x32_bf16 v[88:91], a[52:55], a[12:15], v[88:91]
    s_lshl_b32 s28, s28, 16
    ds_read_b64_tr_b16 a[122:123], v20 offset:20480
    s_add_u32 s28, s28, s13
    v_mfma_f32_16x16x32_bf16 v[88:91], a[48:51], a[8:11], v[88:91]
    s_add_u32 m0, s14, 16384
    ds_read_b64_tr_b16 a[124:125], v20 offset:24576
    s_add_u32 s29, s28, 0
    buffer_load_dwordx4 v3, s[32:35], s29 offen lds
    v_mfma_f32_16x16x32_bf16 v[104:107], a[48:51], a[16:19], v[104:107]
    s_add_u32 m0, s14, 17408
    ds_read_b64_tr_b16 a[126:127], v20 offset:28672
    s_add_u32 s29, s28, 4096
    v_mfma_f32_16x16x32_bf16 v[104:107], a[52:55], a[20:23], v[104:107]
    v_add_u32 v18, 32768, v18
    v_add_u32 v19, 32768, v19
    v_mfma_f32_16x16x32_bf16 v[120:123], a[52:55], a[28:31], v[120:123]
    buffer_load_dwordx4 v4, s[32:35], s29 offen lds
    v_mfma_f32_16x16x32_bf16 v[120:123], a[48:51], a[24:27], v[120:123]
    s_add_u32 m0, s14, 18432
    s_add_u32 s29, s28, 8192
    v_add_u32 v20, 32768, v20
    v_mfma_f32_16x16x32_bf16 v[124:127], a[56:59], a[24:27], v[124:127]
    v_mfma_f32_16x16x32_bf16 v[124:127], a[60:63], a[28:31], v[124:127]
    buffer_load_dwordx4 v3, s[32:35], s29 offen lds
    v_mfma_f32_16x16x32_bf16 v[108:111], a[60:63], a[20:23], v[108:111]
    s_add_u32 m0, s14, 19456
    s_add_u32 s29, s28, 12288
    v_mfma_f32_16x16x32_bf16 v[108:111], a[56:59], a[16:19], v[108:111]
    v_mfma_f32_16x16x32_bf16 v[92:95], a[56:59], a[8:11], v[92:95]
    buffer_load_dwordx4 v4, s[32:35], s29 offen lds
    v_mfma_f32_16x16x32_bf16 v[92:95], a[60:63], a[12:15], v[92:95]
    v_mfma_f32_16x16x32_bf16 v[76:79], a[60:63], a[4:7], v[76:79]
    v_mfma_f32_16x16x32_bf16 v[76:79], a[56:59], a[0:3], v[76:79]
    s_waitcnt vmcnt(8) lgkmcnt(0)
    s_barrier
    v_mfma_f32_16x16x32_bf16 v[80:83], a[96:99], a[72:75], v[80:83]
    ds_read_b64_tr_b16 a[32:33], v17 offset:16384
    ds_read_b64_tr_b16 a[34:35], v17 offset:20480
    v_mfma_f32_16x16x32_bf16 v[80:83], a[100:103], a[76:79], v[80:83]
    ds_read_b64_tr_b16 a[36:37], v17 offset:24576
    ds_read_b64_tr_b16 a[38:39], v17 offset:28672
    v_mfma_f32_16x16x32_bf16 v[96:99], a[100:103], a[84:87], v[96:99]
    ds_read_b128 a[0:3], v13 offset:0
    ds_read_b128 a[4:7], v13 offset:8192
    v_mfma_f32_16x16x32_bf16 v[96:99], a[96:99], a[80:83], v[96:99]
    ds_read_b128 a[8:11], v14 offset:0
    ds_read_b128 a[12:15], v14 offset:8192
    v_mfma_f32_16x16x32_bf16 v[112:115], a[96:99], a[88:91], v[112:115]
    ds_read_b128 a[16:19], v15 offset:0
    ds_read_b128 a[20:23], v15 offset:8192
    v_mfma_f32_16x16x32_bf16 v[112:115], a[100:103], a[92:95], v[112:115]
    ds_read_b128 a[24:27], v16 offset:0
    ds_read_b128 a[28:31], v16 offset:8192
    v_mfma_f32_16x16x32_bf16 v[116:119], a[108:111], a[92:95], v[116:119]
    ds_read_b64_tr_b16 a[40:41], v18 offset:16384
    v_add_u32 v13, 32768, v13
    v_mfma_f32_16x16x32_bf16 v[116:119], a[104:107], a[88:91], v[116:119]
    ds_read_b64_tr_b16 a[42:43], v18 offset:20480
    v_add_u32 v14, 32768, v14
    v_mfma_f32_16x16x32_bf16 v[100:103], a[104:107], a[80:83], v[100:103]
    ds_read_b64_tr_b16 a[44:45], v18 offset:24576
    v_add_u32 v15, 32768, v15
    v_mfma_f32_16x16x32_bf16 v[100:103], a[108:111], a[84:87], v[100:103]
    ds_read_b64_tr_b16 a[46:47], v18 offset:28672
    v_add_u32 v16, 32768, v16
    v_mfma_f32_16x16x32_bf16 v[84:87], a[108:111], a[76:79], v[84:87]
    ds_read_b64_tr_b16 a[48:49], v19 offset:16384
    v_add_u32 v17, 32768, v17
    v_mfma_f32_16x16x32_bf16 v[84:87], a[104:107], a[72:75], v[84:87]
    ds_read_b64_tr_b16 a[50:51], v19 offset:20480
    v_mfma_f32_16x16x32_bf16 v[88:91], a[112:115], a[72:75], v[88:91]
    ds_read_b64_tr_b16 a[52:53], v19 offset:24576
    v_mfma_f32_16x16x32_bf16 v[88:91], a[116:119], a[76:79], v[88:91]
    ds_read_b64_tr_b16 a[54:55], v19 offset:28672
    v_mfma_f32_16x16x32_bf16 v[104:107], a[116:119], a[84:87], v[104:107]
    ds_read_b64_tr_b16 a[56:57], v20 offset:16384
    v_mfma_f32_16x16x32_bf16 v[104:107], a[112:115], a[80:83], v[104:107]
    ds_read_b64_tr_b16 a[58:59], v20 offset:20480
    v_mfma_f32_16x16x32_bf16 v[120:123], a[112:115], a[88:91], v[120:123]
    ds_read_b64_tr_b16 a[60:61], v20 offset:24576
    v_mfma_f32_16x16x32_bf16 v[120:123], a[116:119], a[92:95], v[120:123]
    ds_read_b64_tr_b16 a[62:63], v20 offset:28672
    v_add_u32 v18, 32768, v18
    v_mfma_f32_16x16x32_bf16 v[124:127], a[124:127], a[92:95], v[124:127]
    v_add_u32 v19, 32768, v19
    v_add_u32 v20, 32768, v20
    v_mfma_f32_16x16x32_bf16 v[124:127], a[120:123], a[88:91], v[124:127]
    v_mfma_f32_16x16x32_bf16 v[108:111], a[120:123], a[80:83], v[108:111]
    v_mfma_f32_16x16x32_bf16 v[108:111], a[124:127], a[84:87], v[108:111]
    v_mfma_f32_16x16x32_bf16 v[92:95], a[124:127], a[76:79], v[92:95]
    v_mfma_f32_16x16x32_bf16 v[92:95], a[120:123], a[72:75], v[92:95]
    s_waitcnt vmcnt(0) lgkmcnt(0)
    s_barrier
    v_cmp_gt_u32 vcc, 1, v24
    s_cbranch_vccnz L_poll_r_o
L_back_r_o:
    v_mfma_f32_16x16x32_bf16 v[80:83], a[32:35], a[8:11], v[80:83]
    s_bfe_u32 s20, s69, 0x60007
    ds_read_b64_tr_b16 a[224:225], v17 offset:16384
    ds_read_b64_tr_b16 a[226:227], v17 offset:20480
    s_lshl_b32 s20, s20, 2
    v_mfma_f32_16x16x32_bf16 v[80:83], a[36:39], a[12:15], v[80:83]
    s_add_u32 s20, s20, s6
    ds_read_b64_tr_b16 a[228:229], v17 offset:24576
    ds_read_b64_tr_b16 a[230:231], v17 offset:28672
    s_lshl_b32 s20, s20, 15
    v_mfma_f32_16x16x32_bf16 v[96:99], a[36:39], a[20:23], v[96:99]
    s_add_u32 s20, s20, 62914560
    ds_read_b128 a[192:195], v13 offset:0
    ds_read_b128 a[196:199], v13 offset:8192
    s_lshl_b32 s7, s67, 13
    v_mfma_f32_16x16x32_bf16 v[96:99], a[32:35], a[16:19], v[96:99]
    s_add_u32 s17, s20, s7
    ds_read_b128 a[200:203], v14 offset:0
    ds_read_b128 a[204:207], v14 offset:8192
    s_lshl_b32 s7, s6, 12
    v_mfma_f32_16x16x32_bf16 v[112:115], a[32:35], a[24:27], v[112:115]
    ds_read_b128 a[208:211], v15 offset:0
    ds_read_b128 a[212:215], v15 offset:8192
    v_bfe_u32 v26, v1, 4, 4
    v_mfma_f32_16x16x32_bf16 v[112:115], a[36:39], a[28:31], v[112:115]
    ds_read_b128 a[216:219], v16 offset:0
    ds_read_b128 a[220:223], v16 offset:8192
    v_mul_u32_u24 v28, 144, v26
    v_mfma_f32_16x16x32_bf16 v[116:119], a[44:47], a[28:31], v[116:119]
    ds_read_b64_tr_b16 a[232:233], v18 offset:16384
    v_add_u32 v13, 32768, v13
    v_mfma_f32_16x16x32_bf16 v[116:119], a[40:43], a[24:27], v[116:119]
    ds_read_b64_tr_b16 a[234:235], v18 offset:20480
    v_add_u32 v14, 32768, v14
    v_mfma_f32_16x16x32_bf16 v[100:103], a[40:43], a[16:19], v[100:103]
    ds_read_b64_tr_b16 a[236:237], v18 offset:24576
    v_add_u32 v15, 32768, v15
    v_mfma_f32_16x16x32_bf16 v[100:103], a[44:47], a[20:23], v[100:103]
    ds_read_b64_tr_b16 a[238:239], v18 offset:28672
    v_add_u32 v16, 32768, v16
    v_mfma_f32_16x16x32_bf16 v[84:87], a[44:47], a[12:15], v[84:87]
    ds_read_b64_tr_b16 a[240:241], v19 offset:16384
    v_add_u32 v17, 32768, v17
    v_mfma_f32_16x16x32_bf16 v[84:87], a[40:43], a[8:11], v[84:87]
    ds_read_b64_tr_b16 a[242:243], v19 offset:20480
    v_lshrrev_b32 v26, 8, v1
    v_mfma_f32_16x16x32_bf16 v[88:91], a[48:51], a[8:11], v[88:91]
    ds_read_b64_tr_b16 a[244:245], v19 offset:24576
    v_lshl_add_u32 v28, v26, 3, v28
    v_mfma_f32_16x16x32_bf16 v[88:91], a[52:55], a[12:15], v[88:91]
    ds_read_b64_tr_b16 a[246:247], v19 offset:28672
    v_add_u32 v28, s7, v28
    v_mfma_f32_16x16x32_bf16 v[104:107], a[52:55], a[20:23], v[104:107]
    ds_read_b64_tr_b16 a[248:249], v20 offset:16384
    v_lshrrev_b32 v26, 7, v1
    v_mfma_f32_16x16x32_bf16 v[104:107], a[48:51], a[16:19], v[104:107]
    ds_read_b64_tr_b16 a[250:251], v20 offset:20480
    v_and_b32 v27, 0x70, v1
    v_mfma_f32_16x16x32_bf16 v[120:123], a[48:51], a[24:27], v[120:123]
    ds_read_b64_tr_b16 a[252:253], v20 offset:24576
    v_mul_u32_u24 v29, 144, v26
    v_mfma_f32_16x16x32_bf16 v[120:123], a[52:55], a[28:31], v[120:123]
    ds_read_b64_tr_b16 a[254:255], v20 offset:28672
    v_add3_u32 v29, v29, v27, s7
    v_mfma_f32_16x16x32_bf16 v[124:127], a[60:63], a[28:31], v[124:127]
    v_lshl_add_u32 v27, v26, 10, v27
    v_add_u32 v18, 32768, v18
    v_mfma_f32_16x16x32_bf16 v[124:127], a[56:59], a[24:27], v[124:127]
    v_add_u32 v19, 32768, v19
    v_add_u32 v20, 32768, v20
    v_mfma_f32_16x16x32_bf16 v[108:111], a[56:59], a[16:19], v[108:111]
    v_mfma_f32_16x16x32_bf16 v[108:111], a[60:63], a[20:23], v[108:111]
    v_mfma_f32_16x16x32_bf16 v[92:95], a[60:63], a[12:15], v[92:95]
    v_mfma_f32_16x16x32_bf16 v[92:95], a[56:59], a[8:11], v[92:95]
    s_waitcnt lgkmcnt(0)
    v_mfma_f32_16x16x32_bf16 v[80:83], a[224:227], a[200:203], v[80:83]
    v_mfma_f32_16x16x32_bf16 v[80:83], a[228:231], a[204:207], v[80:83]
    v_mfma_f32_16x16x32_bf16 v[84:87], a[236:239], a[204:207], v[84:87]
    v_mfma_f32_16x16x32_bf16 v[84:87], a[232:235], a[200:203], v[84:87]
    v_mfma_f32_16x16x32_bf16 v[88:91], a[240:243], a[200:203], v[88:91]
    v_mfma_f32_16x16x32_bf16 v[88:91], a[244:247], a[204:207], v[88:91]
    v_mfma_f32_16x16x32_bf16 v[92:95], a[252:255], a[204:207], v[92:95]
    v_mfma_f32_16x16x32_bf16 v[92:95], a[248:251], a[200:203], v[92:95]
    s_xor_b32 s7, s67, 1
    s_lshl_b32 s7, s7, 13
    s_add_u32 s7, s7, s20
    v_mfma_f32_16x16x32_bf16 v[108:111], a[248:251], a[208:211], v[108:111]
    s_add_u32 s7, s7, 2048
    v_mfma_f32_16x16x32_bf16 v[108:111], a[252:255], a[212:215], v[108:111]
    v_mfma_f32_16x16x32_bf16 v[104:107], a[244:247], a[212:215], v[104:107]
    v_mfma_f32_16x16x32_bf16 v[104:107], a[240:243], a[208:211], v[104:107]
    v_cvt_pk_bf16_f32 v80, v80, v81
    v_cvt_pk_bf16_f32 v81, v82, v83
    v_mfma_f32_16x16x32_bf16 v[100:103], a[232:235], a[208:211], v[100:103]
    v_cvt_pk_bf16_f32 v82, v84, v85
    v_cvt_pk_bf16_f32 v83, v86, v87
    v_mfma_f32_16x16x32_bf16 v[100:103], a[236:239], a[212:215], v[100:103]
    buffer_store_dwordx4 v[80:83], v1, s[8:11], s7 offen offset:0 sc1
    v_mfma_f32_16x16x32_bf16 v[96:99], a[228:231], a[212:215], v[96:99]
    v_cvt_pk_bf16_f32 v84, v88, v89
    v_cvt_pk_bf16_f32 v85, v90, v91
    v_mfma_f32_16x16x32_bf16 v[96:99], a[224:227], a[208:211], v[96:99]
    v_cvt_pk_bf16_f32 v86, v92, v93
    v_cvt_pk_bf16_f32 v87, v94, v95
    v_mfma_f32_16x16x32_bf16 v[112:115], a[224:227], a[216:219], v[112:115]
    buffer_store_dwordx4 v[84:87], v1, s[8:11], s7 offen offset:1024 sc1
    v_mfma_f32_16x16x32_bf16 v[112:115], a[228:231], a[220:223], v[112:115]
    s_xor_b32 s7, s67, 2
    s_lshl_b32 s7, s7, 13
    s_add_u32 s7, s7, s20
    v_mfma_f32_16x16x32_bf16 v[116:119], a[236:239], a[220:223], v[116:119]
    s_add_u32 s7, s7, 4096
    v_cvt_pk_bf16_f32 v96, v96, v97
    v_cvt_pk_bf16_f32 v97, v98, v99
    v_mfma_f32_16x16x32_bf16 v[116:119], a[232:235], a[216:219], v[116:119]
    v_cvt_pk_bf16_f32 v98, v100, v101
    v_cvt_pk_bf16_f32 v99, v102, v103
    v_mfma_f32_16x16x32_bf16 v[120:123], a[240:243], a[216:219], v[120:123]
    buffer_store_dwordx4 v[96:99], v1, s[8:11], s7 offen offset:0 sc1
    v_mfma_f32_16x16x32_bf16 v[120:123], a[244:247], a[220:223], v[120:123]
    v_cvt_pk_bf16_f32 v100, v104, v105
    v_cvt_pk_bf16_f32 v101, v106, v107
    v_mfma_f32_16x16x32_bf16 v[124:127], a[252:255], a[220:223], v[124:127]
    v_cvt_pk_bf16_f32 v102, v108, v109
    v_cvt_pk_bf16_f32 v103, v110, v111
    v_mfma_f32_16x16x32_bf16 v[124:127], a[248:251], a[216:219], v[124:127]
    buffer_store_dwordx4 v[100:103], v1, s[8:11], s7 offen offset:1024 sc1
    v_mfma_f32_16x16x32_bf16 v[76:79], a[248:251], a[192:195], v[76:79]
    s_xor_b32 s7, s67, 3
    s_lshl_b32 s7, s7, 13
    s_add_u32 s7, s7, s20
    v_mfma_f32_16x16x32_bf16 v[76:79], a[252:255], a[196:199], v[76:79]
    s_add_u32 s7, s7, 6144
    v_mfma_f32_16x16x32_bf16 v[72:75], a[244:247], a[196:199], v[72:75]
    v_cvt_pk_bf16_f32 v112, v112, v113
    v_cvt_pk_bf16_f32 v113, v114, v115
    v_mfma_f32_16x16x32_bf16 v[72:75], a[240:243], a[192:195], v[72:75]
    v_cvt_pk_bf16_f32 v114, v116, v117
    v_cvt_pk_bf16_f32 v115, v118, v119
    v_mfma_f32_16x16x32_bf16 v[68:71], a[232:235], a[192:195], v[68:71]
    buffer_store_dwordx4 v[112:115], v1, s[8:11], s7 offen offset:0 sc1
    v_mfma_f32_16x16x32_bf16 v[68:71], a[236:239], a[196:199], v[68:71]
    v_cvt_pk_bf16_f32 v116, v120, v121
    v_cvt_pk_bf16_f32 v117, v122, v123
    v_mfma_f32_16x16x32_bf16 v[64:67], a[228:231], a[196:199], v[64:67]
    v_cvt_pk_bf16_f32 v118, v124, v125
    v_cvt_pk_bf16_f32 v119, v126, v127
    v_mfma_f32_16x16x32_bf16 v[64:67], a[224:227], a[192:195], v[64:67]
    buffer_store_dwordx4 v[116:119], v1, s[8:11], s7 offen offset:1024 sc1
    v_mfma_f32_16x16x32_bf16 v[64:67], a[96:99], a[64:67], v[64:67]
    v_mfma_f32_16x16x32_bf16 v[64:67], a[100:103], a[68:71], v[64:67]
    v_mfma_f32_16x16x32_bf16 v[68:71], a[104:107], a[64:67], v[68:71]
    v_mfma_f32_16x16x32_bf16 v[68:71], a[108:111], a[68:71], v[68:71]
    v_mfma_f32_16x16x32_bf16 v[72:75], a[112:115], a[64:67], v[72:75]
    v_mfma_f32_16x16x32_bf16 v[72:75], a[116:119], a[68:71], v[72:75]
    v_mfma_f32_16x16x32_bf16 v[76:79], a[120:123], a[64:67], v[76:79]
    v_mfma_f32_16x16x32_bf16 v[76:79], a[124:127], a[68:71], v[76:79]
    v_mfma_f32_16x16x32_bf16 v[64:67], a[32:35], a[0:3], v[64:67]
    v_mfma_f32_16x16x32_bf16 v[64:67], a[36:39], a[4:7], v[64:67]
    v_mfma_f32_16x16x32_bf16 v[68:71], a[40:43], a[0:3], v[68:71]
    v_mfma_f32_16x16x32_bf16 v[68:71], a[44:47], a[4:7], v[68:71]
    v_mfma_f32_16x16x32_bf16 v[72:75], a[48:51], a[0:3], v[72:75]
    v_mfma_f32_16x16x32_bf16 v[72:75], a[52:55], a[4:7], v[72:75]
    v_mfma_f32_16x16x32_bf16 v[76:79], a[56:59], a[0:3], v[76:79]
    v_mfma_f32_16x16x32_bf16 v[76:79], a[60:63], a[4:7], v[76:79]
    v_mfma_f32_16x16x32_bf16 v[68:71], a[180:183], a[164:167], v[68:71]
    v_mfma_f32_16x16x32_bf16 v[72:75], a[182:185], a[168:171], v[72:75]
    v_mfma_f32_16x16x32_bf16 v[76:79], a[180:183], a[168:171], v[76:79]
    v_mfma_f32_16x16x32_bf16 v[64:67], a[182:185], a[164:167], v[64:67]
L_p3_done:
L_tp26:
    s_cbranch_execz L_walk2_end
L_p3_pub:
    s_mov_b32 s94, 0
    s_add_u32 s7, s17, 2048
    buffer_load_dwordx4 v[136:139], v1, s[8:11], s7 offen offset:0 sc1
    buffer_load_dwordx4 v[140:143], v1, s[8:11], s7 offen offset:1024 sc1
    s_add_u32 s7, s17, 4096
    buffer_load_dwordx4 v[144:147], v1, s[8:11], s7 offen offset:0 sc1
    buffer_load_dwordx4 v[148:151], v1, s[8:11], s7 offen offset:1024 sc1
    s_add_u32 s7, s17, 6144
    buffer_load_dwordx4 v[152:155], v1, s[8:11], s7 offen offset:0 sc1
    buffer_load_dwordx4 v[156:159], v1, s[8:11], s7 offen offset:1024 sc1
L_p3_wait:
    s_waitcnt vmcnt(0)
L_p3_test:
    v_max3_u32 v42, v136, v137, v138
    v_max3_u32 v43, v144, v145, v146
    v_max3_u32 v44, v152, v153, v154
    v_max3_u32 v42, v42, v139, v140
    v_max3_u32 v43, v43, v147, v148
    v_max3_u32 v44, v44, v155, v156
    v_max3_u32 v42, v42, v141, v142
    v_max3_u32 v43, v43, v149, v150
    v_max3_u32 v44, v44, v157, v158
    v_max_u32 v42, v42, v143
    v_max_u32 v43, v43, v151
    v_max_u32 v44, v44, v159
    v_cmp_eq_u32 s[70:71], -1, v42
    v_cmp_eq_u32 s[72:73], -1, v43
    v_cmp_eq_u32 s[74:75], -1, v44
    s_or_b64 vcc, s[70:71], s[72:73]
    s_or_b64 vcc, vcc, s[74:75]
    s_cbranch_vccz L_p3_have
    s_add_u32 s94, s94, 1
    s_cmp_ge_u32 s94, 0x8000
    s_cbranch_scc1 L_p3_have
    s_cmp_eq_u64 s[70:71], 0
    s_cbranch_scc1 L_p3_got0
    s_add_u32 s7, s17, 2048
    buffer_load_dwordx4 v[136:139], v1, s[8:11], s7 offen offset:0 sc1
    buffer_load_dwordx4 v[140:143], v1, s[8:11], s7 offen offset:1024 sc1
L_p3_got0:
    s_cmp_eq_u64 s[72:73], 0
    s_cbranch_scc1 L_p3_got1
    s_add_u32 s7, s17, 4096
    buffer_load_dwordx4 v[144:147], v1, s[8:11], s7 offen offset:0 sc1
    buffer_load_dwordx4 v[148:151], v1, s[8:11], s7 offen offset:1024 sc1
L_p3_got1:
    s_cmp_eq_u64 s[74:75], 0
    s_cbranch_scc1 L_p3_got2
    s_add_u32 s7, s17, 6144
    buffer_load_dwordx4 v[152:155], v1, s[8:11], s7 offen offset:0 sc1
    buffer_load_dwordx4 v[156:159], v1, s[8:11], s7 offen offset:1024 sc1
L_p3_got2:
    s_branch L_p3_wait
L_p3_have:
    v_mfma_f32_16x16x32_bf16 v[64:67], a[182:185], v[136:139], v[64:67]
    v_mfma_f32_16x16x32_bf16 v[64:67], a[182:185], v[144:147], v[64:67]
    v_mfma_f32_16x16x32_bf16 v[64:67], a[182:185], v[152:155], v[64:67]
    v_mfma_f32_16x16x32_bf16 v[68:71], a[180:183], v[136:139], v[68:71]
    v_mfma_f32_16x16x32_bf16 v[68:71], a[180:183], v[144:147], v[68:71]
    v_mfma_f32_16x16x32_bf16 v[68:71], a[180:183], v[152:155], v[68:71]
    v_mfma_f32_16x16x32_bf16 v[72:75], a[182:185], v[140:143], v[72:75]
    v_mfma_f32_16x16x32_bf16 v[72:75], a[182:185], v[148:151], v[72:75]
    v_mfma_f32_16x16x32_bf16 v[72:75], a[182:185], v[156:159], v[72:75]
    v_mfma_f32_16x16x32_bf16 v[76:79], a[180:183], v[140:143], v[76:79]
    v_mfma_f32_16x16x32_bf16 v[76:79], a[180:183], v[148:151], v[76:79]
    v_mfma_f32_16x16x32_bf16 v[76:79], a[180:183], v[156:159], v[76:79]
    s_nop 1
    v_cvt_pk_bf16_f32 v32, v64, v65
    v_cvt_pk_bf16_f32 v33, v66, v67
    ds_write_b64 v28, v[32:33] offset:0
    v_cvt_pk_bf16_f32 v34, v68, v69
    v_cvt_pk_bf16_f32 v35, v70, v71
    ds_write_b64 v28, v[34:35] offset:32
    v_cvt_pk_bf16_f32 v36, v72, v73
    v_cvt_pk_bf16_f32 v37, v74, v75
    ds_write_b64 v28, v[36:37] offset:64
    v_cvt_pk_bf16_f32 v38, v76, v77
    v_cvt_pk_bf16_f32 v39, v78, v79
    ds_write_b64 v28, v[38:39] offset:96
    ds_read_b128 v[40:43], v29
    ds_read_b128 v[44:47], v29 offset:1152
    s_add_u32 s7, s26, 8192
    s_waitcnt lgkmcnt(1)
    buffer_store_dwordx4 v[40:43], v27, s[44:47], s26 offen sc1
    s_waitcnt lgkmcnt(0)
    buffer_store_dwordx4 v[44:47], v27, s[44:47], s7 offen sc1
L_end:
    s_endpgm
L_redo:
    s_mov_b64 s[96:97], -1
    s_nop 7
    s_waitcnt vmcnt(0) lgkmcnt(0)
    s_barrier
    s_lshl_b32 s74, s4, 20
    s_add_u32 s74, s74, 4194304
    s_mov_b32 s75, 0
    s_lshl_b32 s76, s70, 7
    v_lshrrev_b32 v10, 4, v1
    v_and_b32 v11, 15, v10
    v_lshrrev_b32 v10, 4, v10
    v_lshlrev_b32 v10, 2, v10
    v_sub_u32 v10, v11, v10
    s_and_b32 s7, s6, 1
    s_lshl_b32 s7, s7, 4
    s_add_u32 s7, s7, s76
    s_sub_u32 s7, s7, 128
    v_add_u32 v10, s7, v10
    v_mov_b32 v20, 0xff800000
    v_mov_b32 v36, 0xff800000
    v_mov_b32 v37, 0xff800000
    v_mov_b32 v38, 0xff800000
    v_mov_b32 v39, 0xff800000
L_redo_loop:
    s_lshr_b32 s7, s75, 5
    s_and_b32 s7, s7, 3
    s_lshl_b32 s7, s7, 2
    s_lshr_b32 s7, 0x0132, s7
    s_and_b32 s7, s7, 3
    s_lshl_b32 s7, s7, 13
    s_lshr_b32 s93, s75, 7
    s_lshl_b32 s93, s93, 16
    s_add_u32 s7, s7, s93
    s_and_b32 s93, s75, 16
    s_lshl_b32 s93, s93, 7
    s_add_u32 s7, s7, s93
    s_add_u32 s7, s7, s74
    s_add_u32 s93, s7, 4096
    buffer_load_dwordx4 a[64:67], v1, s[8:11], s7 offen offset:0 sc1
    buffer_load_dwordx4 a[68:71], v1, s[8:11], s7 offen offset:1024 sc1
    buffer_load_dwordx4 a[72:75], v1, s[8:11], s93 offen offset:0 sc1
    buffer_load_dwordx4 a[76:79], v1, s[8:11], s93 offen offset:1024 sc1
    s_waitcnt vmcnt(0)
    v_mfma_f32_16x16x32_bf16 v[80:83], a[64:67], a[0:3], 0
    v_mfma_f32_16x16x32_bf16 v[80:83], a[68:71], a[4:7], v[80:83]
    v_mfma_f32_16x16x32_bf16 v[80:83], a[72:75], a[8:11], v[80:83]
    v_mfma_f32_16x16x32_bf16 v[80:83], a[76:79], a[12:15], v[80:83]
    v_mfma_f32_16x16x32_bf16 v[84:87], a[64:67], a[16:19], 0
    v_mfma_f32_16x16x32_bf16 v[84:87], a[68:71], a[20:23], v[84:87]
    v_mfma_f32_16x16x32_bf16 v[84:87], a[72:75], a[24:27], v[84:87]
    v_mfma_f32_16x16x32_bf16 v[84:87], a[76:79], a[28:31], v[84:87]
    v_mfma_f32_16x16x32_bf16 v[88:91], a[64:67], a[32:35], 0
    v_mfma_f32_16x16x32_bf16 v[88:91], a[68:71], a[36:39], v[88:91]
    v_mfma_f32_16x16x32_bf16 v[88:91], a[72:75], a[40:43], v[88:91]
    v_mfma_f32_16x16x32_bf16 v[88:91], a[76:79], a[44:47], v[88:91]
    v_mfma_f32_16x16x32_bf16 v[92:95], a[64:67], a[48:51], 0
    v_mfma_f32_16x16x32_bf16 v[92:95], a[68:71], a[52:55], v[92:95]
    v_mfma_f32_16x16x32_bf16 v[92:95], a[72:75], a[56:59], v[92:95]
    v_mfma_f32_16x16x32_bf16 v[92:95], a[76:79], a[60:63], v[92:95]
    s_nop 7
    s_lshl_b32 s7, s91, 1
    s_xor_b32 s7, s7, 0
    s_lshl_b32 s7, s7, 5
    s_sub_u32 s7, s75, s7
    v_cmp_le_i32 vcc, s7, v10
    s_add_u32 s7, s7, 1
    s_nop 0
    v_cndmask_b32 v11, v20, v80, vcc
    v_max_f32 v36, v36, v11
    v_cmp_le_i32 vcc, s7, v10
    s_add_u32 s7, s7, 1
    s_nop 0
    v_cndmask_b32 v11, v20, v81, vcc
    v_max_f32 v36, v36, v11
    v_cmp_le_i32 vcc, s7, v10
    s_add_u32 s7, s7, 1
    s_nop 0
    v_cndmask_b32 v11, v20, v82, vcc
    v_max_f32 v36, v36, v11
    v_cmp_le_i32 vcc, s7, v10
    s_add_u32 s7, s7, 1
    s_nop 0
    v_cndmask_b32 v11, v20, v83, vcc
    v_max_f32 v36, v36, v11
    s_lshl_b32 s7, s91, 1
    s_xor_b32 s7, s7, 1
    s_lshl_b32 s7, s7, 5
    s_sub_u32 s7, s75, s7
    v_cmp_le_i32 vcc, s7, v10
    s_add_u32 s7, s7, 1
    s_nop 0
    v_cndmask_b32 v11, v20, v84, vcc
    v_max_f32 v37, v37, v11
    v_cmp_le_i32 vcc, s7, v10
    s_add_u32 s7, s7, 1
    s_nop 0
    v_cndmask_b32 v11, v20, v85, vcc
    v_max_f32 v37, v37, v11
    v_cmp_le_i32 vcc, s7, v10
    s_add_u32 s7, s7, 1
    s_nop 0
    v_cndmask_b32 v11, v20, v86, vcc
    v_max_f32 v37, v37, v11
    v_cmp_le_i32 vcc, s7, v10
    s_add_u32 s7, s7, 1
    s_nop 0
    v_cndmask_b32 v11, v20, v87, vcc
    v_max_f32 v37, v37, v11
    s_lshl_b32 s7, s91, 1
    s_xor_b32 s7, s7, 2
    s_lshl_b32 s7, s7, 5
    s_sub_u32 s7, s75, s7
    v_cmp_le_i32 vcc, s7, v10
    s_add_u32 s7, s7, 1
    s_nop 0
    v_cndmask_b32 v11, v20, v88, vcc
    v_max_f32 v38, v38, v11
    v_cmp_le_i32 vcc, s7, v10
    s_add_u32 s7, s7, 1
    s_nop 0
    v_cndmask_b32 v11, v20, v89, vcc
    v_max_f32 v38, v38, v11
    v_cmp_le_i32 vcc, s7, v10
    s_add_u32 s7, s7, 1
    s_nop 0
    v_cndmask_b32 v11, v20, v90, vcc
    v_max_f32 v38, v38, v11
    v_cmp_le_i32 vcc, s7, v10
    s_add_u32 s7, s7, 1
    s_nop 0
    v_cndmask_b32 v11, v20, v91, vcc
    v_max_f32 v38, v38, v11
    s_lshl_b32 s7, s91, 1
    s_xor_b32 s7, s7, 3
    s_lshl_b32 s7, s7, 5
    s_sub_u32 s7, s75, s7
    v_cmp_le_i32 vcc, s7, v10
    s_add_u32 s7, s7, 1
    s_nop 0
    v_cndmask_b32 v11, v20, v92, vcc
    v_max_f32 v39, v39, v11
    v_cmp_le_i32 vcc, s7, v10
    s_add_u32 s7, s7, 1
    s_nop 0
    v_cndmask_b32 v11, v20, v93, vcc
    v_max_f32 v39, v39, v11
    v_cmp_le_i32 vcc, s7, v10
    s_add_u32 s7, s7, 1
    s_nop 0
    v_cndmask_b32 v11, v20, v94, vcc
    v_max_f32 v39, v39, v11
    v_cmp_le_i32 vcc, s7, v10
    s_add_u32 s7, s7, 1
    s_nop 0
    v_cndmask_b32 v11, v20, v95, vcc
    v_max_f32 v39, v39, v11
    s_add_u32 s75, s75, 16
    s_cmp_lt_u32 s75, s76
    s_cbranch_scc1 L_redo_loop
    v_mov_b32 v11, v36
    s_nop 1
    v_permlane16_swap_b32 v36, v11
    v_max_f32 v36, v36, v11
    v_mov_b32 v11, v36
    s_nop 1
    v_permlane32_swap_b32 v36, v11
    v_max_f32 v36, v36, v11
    v_sub_f32 v64, 0, v36
    v_sub_f32 v65, 0, v36
    v_sub_f32 v66, 0, v36
    v_sub_f32 v67, 0, v36
    v_mov_b32 v11, v37
    s_nop 1
    v_permlane16_swap_b32 v37, v11
    v_max_f32 v37, v37, v11
    v_mov_b32 v11, v37
    s_nop 1
    v_permlane32_swap_b32 v37, v11
    v_max_f32 v37, v37, v11
    v_sub_f32 v68, 0, v37
    v_sub_f32 v69, 0, v37
    v_sub_f32 v70, 0, v37
    v_sub_f32 v71, 0, v37
    v_mov_b32 v11, v38
    s_nop 1
    v_permlane16_swap_b32 v38, v11
    v_max_f32 v38, v38, v11
    v_mov_b32 v11, v38
    s_nop 1
    v_permlane32_swap_b32 v38, v11
    v_max_f32 v38, v38, v11
    v_sub_f32 v72, 0, v38
    v_sub_f32 v73, 0, v38
    v_sub_f32 v74, 0, v38
    v_sub_f32 v75, 0, v38
    v_mov_b32 v11, v39
    s_nop 1
    v_permlane16_swap_b32 v39, v11
    v_max_f32 v39, v39, v11
    v_mov_b32 v11, v39
    s_nop 1
    v_permlane32_swap_b32 v39, v11
    v_max_f32 v39, v39, v11
    v_sub_f32 v76, 0, v39
    v_sub_f32 v77, 0, v39
    v_sub_f32 v78, 0, v39
    v_sub_f32 v79, 0, v39
    s_mov_b32 s90, s72
    s_mov_b32 s58, s73
    s_mov_b32 s3, s70
    s_lshl_b32 s59, s6, 14
    s_add_u32 s59, s59, s90
    s_lshl_b32 s7, s91, 13
    s_add_u32 s7, s7, s90
    v_add_u32 v2, s7, v1
    s_sub_u32 s56, s70, 1
    s_lshl_b32 s56, s56, 16
    s_add_u32 s56, s56, s57
    s_add_u32 m0, s59, 0
    s_add_u32 s7, s56, 0
    buffer_load_dwordx4 v1, s[8:11], s7 offen offset:0 sc1 lds
    buffer_load_dwordx4 v1, s[8:11], s7 offen offset:1024 sc1 lds
    buffer_load_dwordx4 v1, s[8:11], s7 offen offset:2048 sc1 lds
    buffer_load_dwordx4 v1, s[8:11], s7 offen offset:3072 sc1 lds
    s_add_u32 m0, s59, 4096
    s_add_u32 s7, s56, 4096
    buffer_load_dwordx4 v1, s[8:11], s7 offen offset:0 sc1 lds
    buffer_load_dwordx4 v1, s[8:11], s7 offen offset:1024 sc1 lds
    buffer_load_dwordx4 v1, s[8:11], s7 offen offset:2048 sc1 lds
    buffer_load_dwordx4 v1, s[8:11], s7 offen offset:3072 sc1 lds
    s_add_u32 m0, s59, 8192
    s_add_u32 s7, s56, 8192
    buffer_load_dwordx4 v1, s[8:11], s7 offen offset:0 sc1 lds
    buffer_load_dwordx4 v1, s[8:11], s7 offen offset:1024 sc1 lds
    buffer_load_dwordx4 v1, s[8:11], s7 offen offset:2048 sc1 lds
    buffer_load_dwordx4 v1, s[8:11], s7 offen offset:3072 sc1 lds
    s_add_u32 m0, s59, 12288
    s_add_u32 s7, s56, 12288
    buffer_load_dwordx4 v1, s[8:11], s7 offen offset:0 sc1 lds
    buffer_load_dwordx4 v1, s[8:11], s7 offen offset:1024 sc1 lds
    buffer_load_dwordx4 v1, s[8:11], s7 offen offset:2048 sc1 lds
    buffer_load_dwordx4 v1, s[8:11], s7 offen offset:3072 sc1 lds
    s_xor_b32 s59, s59, 65536
    s_mov_b32 s56, s71
    s_cmp_eq_u32 s56, s62
    s_cselect_b32 s59, s95, s59
    s_waitcnt vmcnt(0)
    s_barrier
    s_and_b32 s93, s66, 0xffffff80
    s_add_u32 s93, s93, 32
    s_add_u32 m0, s59, 0
    s_add_u32 s7, s56, 0
    buffer_load_dwordx4 v1, s[8:11], s7 offen offset:0 sc1 lds
    buffer_load_dwordx4 v1, s[8:11], s7 offen offset:1024 sc1 lds
    buffer_load_dwordx4 v1, s[8:11], s7 offen offset:2048 sc1 lds
    buffer_load_dwordx4 v1, s[8:11], s7 offen offset:3072 sc1 lds
    ds_read_b128 a[192:195], v2 offset:0
    ds_read_b128 a[196:199], v2 offset:1024
    ds_read_b128 a[200:203], v2 offset:4096
    ds_read_b128 a[204:207], v2 offset:5120
    ds_read_b128 a[208:211], v2 offset:2048
    ds_read_b128 a[212:215], v2 offset:3072
    ds_read_b128 a[216:219], v2 offset:6144
    ds_read_b128 a[220:223], v2 offset:7168
    ds_read_b128 a[224:227], v2 offset:16384
    ds_read_b128 a[228:231], v2 offset:17408
    ds_read_b128 a[232:235], v2 offset:20480
    ds_read_b128 a[236:239], v2 offset:21504
    v_add_f32 v48, v40, v64
    v_add_f32 v49, v41, v65
    v_add_f32 v50, v42, v66
    v_add_f32 v51, v43, v67
    v_add_f32 v52, v44, v64
    v_add_f32 v53, v45, v65
    v_add_f32 v54, v46, v66
    v_add_f32 v55, v47, v67
    v_add_f32 v56, v40, v76
    v_add_f32 v57, v41, v77
    v_add_f32 v58, v42, v78
    v_add_f32 v59, v43, v79
    v_add_f32 v60, v44, v76
    v_add_f32 v61, v45, v77
    v_add_f32 v62, v46, v78
    v_add_f32 v63, v47, v79
    v_mov_b64 v[36:37], 0
    v_mov_b64 v[38:39], 0
    s_waitcnt lgkmcnt(0)
    s_branch L_block
L_unredo:
    v_mov_b32 v64, 0
    v_mov_b32 v65, 0
    v_mov_b32 v66, 0
    v_mov_b32 v67, 0
    v_mov_b32 v68, 0
    v_mov_b32 v69, 0
    v_mov_b32 v70, 0
    v_mov_b32 v71, 0
    v_mov_b32 v72, 0
    v_mov_b32 v73, 0
    v_mov_b32 v74, 0
    v_mov_b32 v75, 0
    v_mov_b32 v76, 0
    v_mov_b32 v77, 0
    v_mov_b32 v78, 0
    v_mov_b32 v79, 0
    v_add_f32 v48, v40, v64
    v_add_f32 v49, v41, v65
    v_add_f32 v50, v42, v66
    v_add_f32 v51, v43, v67
    v_add_f32 v52, v44, v64
    v_add_f32 v53, v45, v65
    v_add_f32 v54, v46, v66
    v_add_f32 v55, v47, v67
    v_add_f32 v56, v40, v76
    v_add_f32 v57, v41, v77
    v_add_f32 v58, v42, v78
    v_add_f32 v59, v43, v79
    v_add_f32 v60, v44, v76
    v_add_f32 v61, v45, v77
    v_add_f32 v62, v46, v78
    v_add_f32 v63, v47, v79
    s_mov_b64 s[96:97], 0
    s_branch L_unredo_back
L_poll_xnK:
    s_mov_b32 s94, 0
L_poll_xnK_loop:
    s_sleep 2
    buffer_load_dword v24, v23, s[48:51], 0 offen sc1
    s_waitcnt vmcnt(0)
    v_cmp_gt_u32 vcc, 32, v24
    s_cbranch_vccz L_back_xnK
    s_add_u32 s94, s94, 1
    s_cmp_lt_u32 s94, 0x8000
    s_cbranch_scc1 L_poll_xnK_loop
    s_branch L_back_xnK
L_poll_xnV:
    s_mov_b32 s94, 0
L_poll_xnV_loop:
    s_sleep 2
    buffer_load_dword v24, v23, s[48:51], 0 offen sc1
    s_waitcnt vmcnt(0)
    v_cmp_gt_u32 vcc, 32, v24
    s_cbranch_vccz L_back_xnV
    s_add_u32 s94, s94, 1
    s_cmp_lt_u32 s94, 0x8000
    s_cbranch_scc1 L_poll_xnV_loop
    s_branch L_back_xnV
L_poll_kve:
    s_mov_b32 s94, 0
L_poll_kve_loop:
    s_sleep 2
    buffer_load_dword v24, v23, s[8:11], s93 offen sc1
    s_waitcnt vmcnt(0)
    v_cmp_gt_u32 vcc, 1, v24
    s_cbranch_vccz L_back_kve
    s_add_u32 s94, s94, 1
    s_cmp_lt_u32 s94, 0x8000
    s_cbranch_scc1 L_poll_kve_loop
    s_branch L_back_kve
L_poll_h:
    s_mov_b32 s94, 0
L_poll_h_loop:
    s_sleep 2
    buffer_load_dword v24, v20, s[8:11], s93 offen sc1
    s_waitcnt vmcnt(0)
    v_cmp_gt_u32 vcc, 1, v24
    s_cbranch_vccz L_back_h
    s_add_u32 s94, s94, 1
    s_cmp_lt_u32 s94, 0x8000
    s_cbranch_scc1 L_poll_h_loop
    s_branch L_back_h
L_poll_kvl:
    s_mov_b32 s94, 0
L_poll_kvl_loop:
    s_sleep 2
    buffer_load_dword v24, v23, s[8:11], s93 offen sc1
    s_waitcnt vmcnt(0)
    v_cmp_gt_u32 vcc, 1, v24
    s_cbranch_vccz L_back_kvl
    s_add_u32 s94, s94, 1
    s_cmp_lt_u32 s94, 0x8000
    s_cbranch_scc1 L_poll_kvl_loop
    s_branch L_back_kvl
L_poll_c:
    s_mov_b32 s94, 0
L_poll_c_loop:
    s_sleep 2
    buffer_load_dword v24, v23, s[8:11], s93 offen sc1
    s_waitcnt vmcnt(0)
    v_cmp_gt_u32 vcc, 1, v24
    s_cbranch_vccz L_back_c
    s_add_u32 s94, s94, 1
    s_cmp_lt_u32 s94, 0x8000
    s_cbranch_scc1 L_poll_c_loop
    s_branch L_back_c
L_poll_d:
    s_mov_b32 s94, 0
L_poll_d_loop:
    s_sleep 2
    buffer_load_dword v24, v23, s[8:11], s93 offen sc1
    s_waitcnt vmcnt(0)
    v_cmp_gt_u32 vcc, 1, v24
    s_cbranch_vccz L_back_d
    s_add_u32 s94, s94, 1
    s_cmp_lt_u32 s94, 0x8000
    s_cbranch_scc1 L_poll_d_loop
    s_branch L_back_d
L_poll_r:
    s_mov_b32 s94, 0
L_poll_r_loop:
    s_sleep 2
    buffer_load_dword v24, v23, s[8:11], s93 offen sc1
    s_waitcnt vmcnt(0)
    v_cmp_gt_u32 vcc, 1, v24
    s_cbranch_vccz L_back_r
    s_add_u32 s94, s94, 1
    s_cmp_lt_u32 s94, 0x8000
    s_cbranch_scc1 L_poll_r_loop
    s_branch L_back_r
L_poll_c_o:
    s_mov_b32 s94, 0
L_poll_c_o_loop:
    s_sleep 2
    buffer_load_dword v24, v23, s[8:11], s93 offen sc1
    s_waitcnt vmcnt(0)
    v_cmp_gt_u32 vcc, 1, v24
    s_cbranch_vccz L_back_c_o
    s_add_u32 s94, s94, 1
    s_cmp_lt_u32 s94, 0x8000
    s_cbranch_scc1 L_poll_c_o_loop
    s_branch L_back_c_o
L_poll_d_o:
    s_mov_b32 s94, 0
L_poll_d_o_loop:
    s_sleep 2
    buffer_load_dword v24, v23, s[8:11], s93 offen sc1
    s_waitcnt vmcnt(0)
    v_cmp_gt_u32 vcc, 1, v24
    s_cbranch_vccz L_back_d_o
    s_add_u32 s94, s94, 1
    s_cmp_lt_u32 s94, 0x8000
    s_cbranch_scc1 L_poll_d_o_loop
    s_branch L_back_d_o
L_poll_r_o:
    s_mov_b32 s94, 0
L_poll_r_o_loop:
    s_sleep 2
    buffer_load_dword v24, v23, s[8:11], s93 offen sc1
    s_waitcnt vmcnt(0)
    v_cmp_gt_u32 vcc, 1, v24
    s_cbranch_vccz L_back_r_o
    s_add_u32 s94, s94, 1
    s_cmp_lt_u32 s94, 0x8000
    s_cbranch_scc1 L_poll_r_o_loop
    s_branch L_back_r_o
L_last:
    s_endpgm
.section .rodata,"a"
.p2align 6
.amdhsa_kernel parallel_sum__compressed_kv_cla__glu_gated_glu__prompt_kernel
  .amdhsa_next_free_vgpr 512
  .amdhsa_next_free_sgpr 102
  .amdhsa_accum_offset 256
  .amdhsa_group_segment_fixed_size 0
  .amdhsa_kernarg_size 104
  .amdhsa_user_sgpr_count 2
  .amdhsa_user_sgpr_kernarg_segment_ptr 1
  .amdhsa_system_sgpr_workgroup_id_x 1
.end_amdhsa_kernel
```
